```python
import torch

def _softmax(x, axis=-1):
    return torch.softmax(x, dim=axis)
def _gelu(x):
    return torch.nn.functional.gelu(x, approximate="tanh")
def _silu(x):
    return torch.nn.functional.silu(x)
def _sigmoid(x):
    return torch.sigmoid(x)
def _layernorm(x, axis=-1, eps=1e-5):
    m = x.mean(dim=axis, keepdim=True)
    v = x.var(dim=axis, keepdim=True, unbiased=False)
    return (x - m) / torch.sqrt(v + eps)
def _scatter_add(tgt, idx, src, axis=0):
    return tgt.clone().index_add_(axis, idx, src)
def _segment_sum(src, seg, n):
    out = torch.zeros((n,) + src.shape[1:], dtype=src.dtype)
    return out.index_add_(0, seg, src)
def _pad(x, pw):
    flat = tuple(v for pair in reversed(pw) for v in pair)
    return torch.nn.functional.pad(x, flat)

kernel_name = 'gated_mix__compressed_kv_cla__geglu_ffn__prompt'

def setup_inputs():

    _w = (lambda a: (lambda t: t.to(torch.bfloat16) if t.is_floating_point() else t)(torch.as_tensor(a)))
    def _A_setup():
        B, H, Sq, Sk, D, M = 1, 16, 2048, 2048, 256, 448
        Dc = 4 * D
        return {
            "x": _w((lambda *s: torch.randn(*s, dtype=torch.bfloat16) * 0.05)(B, Sq, M)),
            "c_kv": _w((lambda *s: torch.randn(*s, dtype=torch.bfloat16) * 0.8)(B, Sk, Dc)),
            "w_q": _w((lambda *s: torch.randn(*s, dtype=torch.bfloat16) * 6.4)(M, H, D) * (M ** -0.5)),
            "w_uk": _w((lambda *s: torch.randn(*s, dtype=torch.bfloat16) * 6.4)(Dc, H, D) * (Dc ** -0.5)),
            "w_uv": _w((lambda *s: torch.randn(*s, dtype=torch.bfloat16) * 0.8)(Dc, H, D) * (Dc ** -0.5)),
            "w_o": _w((lambda *s: torch.randn(*s, dtype=torch.bfloat16) * 0.8)(H, D, M) * ((H * D) ** -0.5)),
        }
    _A_in = _A_setup()

    def _B_setup():
        B, S, D, F = 1, 2048, 448, 1792
        return {
            "x": _w((lambda *s: torch.randn(*s, dtype=torch.bfloat16) * 0.05)(B, S, D)),
            "w_gate": _w((lambda *s: torch.randn(*s, dtype=torch.bfloat16) * 0.2)(D, F)),
            "w_up": _w((lambda *s: torch.randn(*s, dtype=torch.bfloat16) * 0.2)(D, F)),
            "w_down": _w((lambda *s: torch.randn(*s, dtype=torch.bfloat16) * 0.2)(F, D)),
        }
    _B_in = _B_setup()

    return {
        "A_x": _A_in["x"],
        "A_c_kv": _A_in["c_kv"],
        "A_w_q": _A_in["w_q"],
        "A_w_uk": _A_in["w_uk"],
        "A_w_uv": _A_in["w_uv"],
        "A_w_o": _A_in["w_o"],
        "B_x": _B_in["x"],
        "B_w_gate": _B_in["w_gate"],
        "B_w_up": _B_in["w_up"],
        "B_w_down": _B_in["w_down"],
        "gate_w": _w((lambda *s: torch.randn(*s, dtype=torch.bfloat16) * 0.05)(448) * 16.0),
    }

def reference(A_x, A_c_kv, A_w_q, A_w_uk, A_w_uv, A_w_o, B_x, B_w_gate, B_w_up, B_w_down, gate_w):
    def _A_ref(x, c_kv, w_q, w_uk, w_uv, w_o):
        B, Sq, M = x.shape[0], x.shape[1], x.shape[2]
        Sk = c_kv.shape[1]
        H, D = w_q.shape[1], w_q.shape[2]
        q = torch.einsum("bqm,mhd->bhqd", x, w_q)
        k = torch.einsum("bkc,chd->bhkd", c_kv, w_uk)
        v = torch.einsum("bkc,chd->bhkd", c_kv, w_uv)
        scores = torch.einsum("bhqd,bhkd->bhqk", q, k) * (D ** -0.5)
        off = Sk - Sq
        qi = torch.arange(Sq)[:, None]
        kj = torch.arange(Sk)[None, :]
        cmask = kj <= (qi + off)
        scores = torch.where(cmask[None, None], scores, -1e9)
        p = _softmax(scores, axis=-1)
        ctx = torch.einsum("bhqk,bhkd->bhqd", p, v)
        return torch.einsum("bhqd,hdm->bqm", ctx, w_o)

    def _B_ref(x, w_gate, w_up, w_down):
        return (_gelu(x @ w_gate) * (x @ w_up)) @ w_down

    x = A_x
    g = _sigmoid((x * gate_w).sum(-1, keepdims=True))
    a = _A_ref(x, A_c_kv, A_w_q, A_w_uk, A_w_uv, A_w_o)
    b = _B_ref(x, B_w_gate, B_w_up, B_w_down)
    return g * a + (1 - g) * b
```

```asm
; @launch kernel=k1_proj_kernel grid=(256,1,1) block=(256,1,1) lds=163840
; @launch kernel=k2_attn_kernel grid=(256,1,1) block=(256,1,1) lds=163840
; @launch kernel=k3_reduce_kernel grid=(448,1,1) block=(256,1,1) lds=0
.amdgcn_target "amdgcn-amd-amdhsa--gfx950"
.text
.globl k1_proj_kernel
.p2align 8
.type k1_proj_kernel,@function
k1_proj_kernel:
  s_cmp_ge_u32 s2, 256
  s_cbranch_scc1 L_k1_end
  s_load_dwordx16 s[64:79], s[0:1], 0
  s_load_dwordx8 s[80:87], s[0:1], 64
  s_load_dwordx4 s[88:91], s[0:1], 96
  s_getpc_b64 s[92:93]
  s_mov_b32 s94, 0xc000
  s_mov_b32 s95, 0x20000
  s_lshr_b32 s3, s2, 3
  s_lshl_b32 s3, s3, 11
  v_lshlrev_b32 v3, 7, v0
  v_mov_b32 v4, 0x7ff00000
  v_cmp_gt_u32 vcc, 16, v0
  s_nop 1
  v_cndmask_b32 v3, v4, v3, vcc
  buffer_load_dword v47, v3, s[92:95], s3 offen
  v_lshrrev_b32 v3, 6, v0
  v_and_b32 v0, 63, v0
  v_readfirstlane_b32 s4, v3
  s_and_b32 s3, s2, 7
  s_lshr_b32 s49, s2, 3
  s_and_b32 s50, s49, 1
  s_lshl_b32 s3, s3, 1
  s_add_u32 s5, s3, s50
  s_lshr_b32 s6, s49, 1
  s_mov_b32 s101, s6
  s_lshl_b32 s7, s6, 2
  s_add_u32 s7, s7, s4
  v_lshlrev_b32 v1, 4, v0
  v_add_u32 v2, 0x2000, v1
  s_mul_i32 s44, s4, 14336
  s_mul_i32 s45, s4, 16384
  s_mul_i32 s47, s4, 28672
  s_add_u32 s47, s47, 49152
  s_lshl_b32 s48, s4, 13
  s_add_u32 s48, s48, 131072
  s_lshl_b32 s57, s5, 9
  s_lshl_b32 s58, s5, 8
  s_cmp_lt_u32 s5, 14
  s_cselect_b32 s58, s58, 0x10000000
  s_mov_b32 s52, 0x3db8aa3b
  s_mov_b32 s62, 0xc0135761
  v_mov_b32 v46, 0xbdd2d3e8
  s_lshl_b32 s49, s5, 6
  s_add_u32 s49, s49, s7
  s_lshl_b32 s53, s49, 14
  s_add_u32 s53, s53, 0x2000000
  s_lshl_b32 s55, s49, 15
  s_lshl_b32 s49, s7, 4
  s_add_u32 s49, s49, s5
  s_lshl_b32 s54, s49, 13
  s_add_u32 s54, s54, 0x3000000
  s_waitcnt lgkmcnt(0)
  s_mov_b32 s8, s64
  s_and_b32 s9, s65, 0xffff
  s_mov_b32 s10, 0x1c0000
  s_mov_b32 s11, 0x20000
  s_mov_b32 s12, s66
  s_and_b32 s13, s67, 0xffff
  s_mov_b32 s14, 0x400000
  s_mov_b32 s15, 0x20000
  s_mov_b32 s16, s68
  s_and_b32 s17, s69, 0xffff
  s_mov_b32 s18, 0x380000
  s_mov_b32 s19, 0x20000
  s_mov_b32 s20, s78
  s_and_b32 s21, s79, 0xffff
  s_mov_b32 s22, 0x188000
  s_mov_b32 s23, 0x20000
  s_mov_b32 s24, s80
  s_and_b32 s25, s81, 0xffff
  s_mov_b32 s26, 0x188000
  s_mov_b32 s27, 0x20000
  s_mov_b32 s28, s70
  s_and_b32 s29, s71, 0xffff
  s_mov_b32 s30, 0x800000
  s_mov_b32 s31, 0x20000
  s_mov_b32 s32, s72
  s_and_b32 s33, s73, 0xffff
  s_mov_b32 s34, 0x800000
  s_mov_b32 s35, 0x20000
  s_mov_b32 s36, s90
  s_and_b32 s37, s91, 0xffff
  s_mov_b32 s38, 0x10000000
  s_mov_b32 s39, 0x20000
  s_mov_b32 s40, s84
  s_and_b32 s41, s85, 0xffff
  s_mov_b32 s42, 0x380
  s_mov_b32 s43, 0x20000
  s_mov_b32 s96, s70
  s_and_b32 s97, s71, 0xffff
  s_mov_b32 s98, 0x800000
  s_mov_b32 s99, 0x20000
  s_lshl_b32 s49, s101, 2
  s_add_u32 s49, s49, s4
  v_and_b32 v3, 7, v0
  s_mul_i32 s50, s49, 8
  v_add_u32 v3, s50, v3
  v_cmp_gt_u32 vcc, 8, v0
  v_mov_b32 v6, 0x7ff00000
  v_lshlrev_b32 v7, 13, v3
  v_cndmask_b32 v34, v6, v7, vcc
  v_mul_u32_u24 v7, 3584, v3
  v_cndmask_b32 v35, v6, v7, vcc
  v_and_b32 v3, 15, v0
  s_lshl_b32 s50, s50, 1
  v_add_u32 v3, s50, v3
  v_cmp_gt_u32 vcc, 16, v0
  v_lshlrev_b32 v7, 13, v3
  s_nop 0
  v_cndmask_b32 v11, v6, v7, vcc
  v_lshrrev_b32 v3, 3, v0
  s_lshl_b32 s49, s7, 5
  v_add_u32 v4, s49, v3
  s_mov_b32 s50, 896
  v_mul_lo_u32 v4, s50, v4
  v_lshrrev_b32 v5, 4, v0
  v_and_b32 v6, 7, v0
  v_xor_b32 v5, v5, v6
  v_lshl_add_u32 v7, v5, 4, v4
  v_add_u32 v36, 0x0, v7
  v_xor_b32 v7, 4, v5
  v_lshl_add_u32 v7, v7, 4, v4
  v_add_u32 v37, 0x1800, v7
  v_lshl_add_u32 v7, v5, 4, v4
  v_add_u32 v38, 0x3000, v7
  v_xor_b32 v7, 4, v5
  v_lshl_add_u32 v7, v7, 4, v4
  v_add_u32 v39, 0x4800, v7
  s_add_u32 m0, s47, 0
  s_movk_i32 s60, 0
  buffer_load_dwordx4 v36, s[8:11], s60 offen offset:0 lds
  buffer_load_dwordx4 v37, s[8:11], s60 offen offset:1024 lds
  buffer_load_dwordx4 v38, s[8:11], s60 offen offset:2048 lds
  buffer_load_dwordx4 v39, s[8:11], s60 offen offset:3072 lds
  s_add_u32 m0, s47, 4096
  s_movk_i32 s60, 128
  buffer_load_dwordx4 v36, s[8:11], s60 offen offset:0 lds
  buffer_load_dwordx4 v37, s[8:11], s60 offen offset:1024 lds
  buffer_load_dwordx4 v38, s[8:11], s60 offen offset:2048 lds
  buffer_load_dwordx4 v39, s[8:11], s60 offen offset:3072 lds
  s_add_u32 m0, s47, 8192
  s_movk_i32 s60, 256
  buffer_load_dwordx4 v36, s[8:11], s60 offen offset:0 lds
  buffer_load_dwordx4 v37, s[8:11], s60 offen offset:1024 lds
  buffer_load_dwordx4 v38, s[8:11], s60 offen offset:2048 lds
  buffer_load_dwordx4 v39, s[8:11], s60 offen offset:3072 lds
  s_add_u32 m0, s47, 12288
  s_movk_i32 s60, 384
  buffer_load_dwordx4 v36, s[8:11], s60 offen offset:0 lds
  buffer_load_dwordx4 v37, s[8:11], s60 offen offset:1024 lds
  buffer_load_dwordx4 v38, s[8:11], s60 offen offset:2048 lds
  buffer_load_dwordx4 v39, s[8:11], s60 offen offset:3072 lds
  s_add_u32 m0, s47, 16384
  s_movk_i32 s60, 512
  buffer_load_dwordx4 v36, s[8:11], s60 offen offset:0 lds
  buffer_load_dwordx4 v37, s[8:11], s60 offen offset:1024 lds
  buffer_load_dwordx4 v38, s[8:11], s60 offen offset:2048 lds
  buffer_load_dwordx4 v39, s[8:11], s60 offen offset:3072 lds
  s_add_u32 m0, s47, 20480
  s_movk_i32 s60, 640
  buffer_load_dwordx4 v36, s[8:11], s60 offen offset:0 lds
  buffer_load_dwordx4 v37, s[8:11], s60 offen offset:1024 lds
  buffer_load_dwordx4 v38, s[8:11], s60 offen offset:2048 lds
  buffer_load_dwordx4 v39, s[8:11], s60 offen offset:3072 lds
  s_add_u32 m0, s47, 24576
  s_movk_i32 s60, 768
  buffer_load_dwordx4 v36, s[8:11], s60 offen offset:0 lds
  buffer_load_dwordx4 v37, s[8:11], s60 offen offset:1024 lds
  buffer_load_dwordx4 v38, s[8:11], s60 offen offset:2048 lds
  buffer_load_dwordx4 v39, s[8:11], s60 offen offset:3072 lds
  v_lshrrev_b32 v3, 3, v0
  s_mul_i32 s49, s4, 401408
  v_mul_u32_u24 v4, 3584, v3
  v_add_u32 v4, s49, v4
  v_bfe_u32 v5, v0, 4, 2
  v_bfe_u32 v6, v0, 1, 2
  v_xor_b32 v5, v5, v6
  v_and_b32 v6, 1, v0
  v_lshlrev_b32 v6, 4, v6
  v_add_u32 v4, v4, v6
  v_lshl_add_u32 v44, v5, 5, v4
  v_xor_b32 v5, 2, v5
  v_lshl_add_u32 v45, v5, 5, v4
  v_add_u32 v20, 0x0, v44
  v_add_u32 v21, 0x6c00, v45
  v_add_u32 v22, 0xd800, v44
  v_add_u32 v23, 0x14400, v45
  v_add_u32 v24, 0x1c000, v44
  v_add_u32 v25, 0x22c00, v45
  v_add_u32 v26, 0x29800, v44
  v_add_u32 v27, 0x30400, v45
  v_add_u32 v28, 0x38000, v44
  v_add_u32 v29, 0x3ec00, v45
  v_add_u32 v30, 0x45800, v44
  v_add_u32 v31, 0x4c400, v45
  v_add_u32 v32, 0x54000, v44
  v_add_u32 v33, 0x5ac00, v45
  s_add_u32 s46, s58, 0
  s_cmp_eq_u32 s4, 3
  s_cbranch_scc1 L_k1_w3a
  s_add_u32 m0, s44, 0
  s_nop 0
  buffer_load_dwordx4 v20, s[20:23], s46 offen offset:0 lds
  buffer_load_dwordx4 v21, s[20:23], s46 offen offset:1024 lds
  buffer_load_dwordx4 v22, s[20:23], s46 offen offset:2048 lds
  buffer_load_dwordx4 v23, s[20:23], s46 offen offset:3072 lds
  s_add_u32 m0, s44, 4096
  s_nop 0
  buffer_load_dwordx4 v24, s[20:23], s46 offen offset:0 lds
  buffer_load_dwordx4 v25, s[20:23], s46 offen offset:1024 lds
  buffer_load_dwordx4 v26, s[20:23], s46 offen offset:2048 lds
  buffer_load_dwordx4 v27, s[20:23], s46 offen offset:3072 lds
  s_add_u32 m0, s44, 8192
  s_nop 0
  buffer_load_dwordx4 v28, s[20:23], s46 offen offset:0 lds
  buffer_load_dwordx4 v29, s[20:23], s46 offen offset:1024 lds
  buffer_load_dwordx4 v30, s[20:23], s46 offen offset:2048 lds
  buffer_load_dwordx4 v31, s[20:23], s46 offen offset:3072 lds
  s_add_u32 m0, s44, 12288
  s_nop 0
  buffer_load_dwordx4 v32, s[20:23], s46 offen offset:0 lds
  buffer_load_dwordx4 v33, s[20:23], s46 offen offset:1024 lds
  s_branch L_k1_w3b
L_k1_w3a:
  s_add_u32 m0, s44, 0
  s_nop 0
  buffer_load_dwordx4 v20, s[20:23], s46 offen offset:0 lds
  buffer_load_dwordx4 v21, s[20:23], s46 offen offset:1024 lds
  buffer_load_dwordx4 v22, s[20:23], s46 offen offset:2048 lds
  buffer_load_dwordx4 v23, s[20:23], s46 offen offset:3072 lds
  s_add_u32 m0, s44, 4096
  s_nop 0
  buffer_load_dwordx4 v24, s[20:23], s46 offen offset:0 lds
  buffer_load_dwordx4 v25, s[20:23], s46 offen offset:1024 lds
L_k1_w3b:
  v_lshrrev_b32 v3, 4, v0
  v_lshlrev_b32 v3, 4, v3
  s_mov_b32 exec_lo, 0x00010001
  s_mov_b32 exec_hi, 0x00010001
  buffer_load_dwordx4 a[0:3], v3, s[40:43], 0 offen offset:0
  buffer_load_dwordx4 a[4:7], v3, s[40:43], 0 offen offset:64
  buffer_load_dwordx4 a[8:11], v3, s[40:43], 0 offen offset:128
  buffer_load_dwordx4 a[12:15], v3, s[40:43], 0 offen offset:192
  buffer_load_dwordx4 a[16:19], v3, s[40:43], 0 offen offset:256
  buffer_load_dwordx4 a[20:23], v3, s[40:43], 0 offen offset:320
  buffer_load_dwordx4 a[24:27], v3, s[40:43], 0 offen offset:384
  buffer_load_dwordx4 a[28:31], v3, s[40:43], 0 offen offset:448
  buffer_load_dwordx4 a[32:35], v3, s[40:43], 0 offen offset:512
  buffer_load_dwordx4 a[36:39], v3, s[40:43], 0 offen offset:576
  buffer_load_dwordx4 a[40:43], v3, s[40:43], 0 offen offset:640
  buffer_load_dwordx4 a[44:47], v3, s[40:43], 0 offen offset:704
  buffer_load_dwordx4 a[48:51], v3, s[40:43], 0 offen offset:768
  buffer_load_dwordx4 a[52:55], v3, s[40:43], 0 offen offset:832
  s_mov_b64 exec, -1
  s_lshl_b32 s49, s101, 2
  s_add_u32 s49, s49, s4
  s_mul_i32 s49, s49, 7
  v_mov_b32 v6, 0x7ff00000
  v_lshrrev_b32 v3, 1, v0
  v_cmp_gt_u32 vcc, 7, v3
  v_add_u32 v3, s49, v3
  v_mul_u32_u24 v3, 3584, v3
  v_and_b32 v4, 1, v0
  v_lshl_add_u32 v3, v4, 7, v3
  v_cndmask_b32 v3, v6, v3, vcc
  buffer_load_dword v47, v3, s[20:23], s58 offen
  buffer_load_dword v47, v3, s[24:27], s58 offen
  v_lshrrev_b32 v3, 2, v0
  v_cmp_gt_u32 vcc, 7, v3
  v_add_u32 v3, s49, v3
  v_mul_u32_u24 v3, 8192, v3
  v_and_b32 v4, 3, v0
  v_lshl_add_u32 v3, v4, 7, v3
  v_cndmask_b32 v3, v6, v3, vcc
  buffer_load_dword v47, v3, s[16:19], s57 offen
  s_lshl_b32 s50, s2, 14
  s_lshl_b32 s51, s4, 12
  s_add_u32 s100, s50, s51
  v_lshlrev_b32 v3, 7, v0
  v_cmp_gt_u32 vcc, 32, v0
  s_nop 1
  v_cndmask_b32 v3, v6, v3, vcc
  buffer_load_dword v47, v3, s[12:15], s100 offen
  s_add_u32 s100, s57, 0
  buffer_load_dword v47, v11, s[28:31], s100 offen
  v_lshrrev_b32 v3, 4, v0
  v_bfe_u32 v4, v0, 2, 2
  v_and_b32 v5, 3, v0
  v_lshl_add_u32 v6, v3, 3, v4
  v_lshlrev_b32 v6, 7, v6
  v_lshl_add_u32 v6, v5, 3, v6
  v_lshrrev_b32 v7, 1, v4
  v_and_b32 v8, 1, v3
  v_lshlrev_b32 v8, 1, v8
  v_xor_b32 v7, v7, v8
  v_xor_b32 v8, 0, v7
  v_lshl_add_u32 v12, v8, 5, v6
  v_add_u32 v16, 0x10000, v12
  v_xor_b32 v8, 1, v7
  v_lshl_add_u32 v13, v8, 5, v6
  v_add_u32 v17, 0x10000, v13
  v_xor_b32 v8, 2, v7
  v_lshl_add_u32 v14, v8, 5, v6
  v_add_u32 v18, 0x10000, v14
  v_xor_b32 v8, 3, v7
  v_lshl_add_u32 v15, v8, 5, v6
  v_add_u32 v19, 0x10000, v15
  v_and_b32 v4, 15, v0
  v_bfe_u32 v5, v0, 1, 3
  v_xor_b32 v5, v5, v3
  v_lshlrev_b32 v4, 7, v4
  v_lshl_add_u32 v40, v5, 4, v4
  v_xor_b32 v41, 64, v40
  v_add_u32 v9, s47, v40
  v_add_u32 v10, s47, v41
  v_add_u32 v40, s48, v40
  v_add_u32 v41, s48, v41
  s_waitcnt vmcnt(5)
  ds_read_b128 v[48:51], v9 offset:0
  ds_read_b128 v[52:55], v9 offset:2048
  ds_read_b128 v[56:59], v10 offset:0
  ds_read_b128 v[60:63], v10 offset:2048
  ds_read_b128 v[64:67], v9 offset:4096
  ds_read_b128 v[68:71], v9 offset:6144
  ds_read_b128 v[72:75], v10 offset:4096
  ds_read_b128 v[76:79], v10 offset:6144
  ds_read_b128 v[80:83], v9 offset:8192
  ds_read_b128 v[84:87], v9 offset:10240
  ds_read_b128 v[88:91], v10 offset:8192
  ds_read_b128 v[92:95], v10 offset:10240
  ds_read_b128 v[96:99], v9 offset:12288
  ds_read_b128 v[100:103], v9 offset:14336
  ds_read_b128 v[104:107], v10 offset:12288
  ds_read_b128 v[108:111], v10 offset:14336
  ds_read_b128 v[112:115], v9 offset:16384
  ds_read_b128 v[116:119], v9 offset:18432
  ds_read_b128 v[120:123], v10 offset:16384
  ds_read_b128 v[124:127], v10 offset:18432
  ds_read_b128 a[192:195], v9 offset:20480
  ds_read_b128 a[196:199], v9 offset:22528
  ds_read_b128 a[200:203], v10 offset:20480
  ds_read_b128 a[204:207], v10 offset:22528
  ds_read_b128 a[208:211], v9 offset:24576
  ds_read_b128 a[212:215], v9 offset:26624
  ds_read_b128 a[216:219], v10 offset:24576
  ds_read_b128 a[220:223], v10 offset:26624
  v_lshrrev_b32 v3, 3, v0
  s_lshl_b32 s49, s7, 5
  v_add_u32 v4, s49, v3
  s_mov_b32 s50, 2048
  v_mul_lo_u32 v4, s50, v4
  v_lshrrev_b32 v5, 4, v0
  v_and_b32 v6, 7, v0
  v_xor_b32 v5, v5, v6
  v_lshl_add_u32 v7, v5, 4, v4
  v_add_u32 v36, 0x0, v7
  v_xor_b32 v7, 4, v5
  v_lshl_add_u32 v7, v7, 4, v4
  v_add_u32 v37, 0x3c00, v7
  v_lshl_add_u32 v7, v5, 4, v4
  v_add_u32 v38, 0x7800, v7
  v_xor_b32 v7, 4, v5
  v_lshl_add_u32 v7, v7, 4, v4
  v_add_u32 v39, 0xb400, v7
  s_waitcnt lgkmcnt(0)
  s_barrier
  s_cmp_eq_u32 s4, 3
  s_cbranch_scc0 L_k1_w3c
  s_add_u32 m0, s44, 4096
  s_nop 0
  buffer_load_dwordx4 v26, s[20:23], s46 offen offset:2048 lds
  buffer_load_dwordx4 v27, s[20:23], s46 offen offset:3072 lds
  s_add_u32 m0, s44, 8192
  s_nop 0
  buffer_load_dwordx4 v28, s[20:23], s46 offen offset:0 lds
  buffer_load_dwordx4 v29, s[20:23], s46 offen offset:1024 lds
  buffer_load_dwordx4 v30, s[20:23], s46 offen offset:2048 lds
  buffer_load_dwordx4 v31, s[20:23], s46 offen offset:3072 lds
  s_add_u32 m0, s44, 12288
  s_nop 0
  buffer_load_dwordx4 v32, s[20:23], s46 offen offset:0 lds
  buffer_load_dwordx4 v33, s[20:23], s46 offen offset:1024 lds
L_k1_w3c:
  ds_read_b64_tr_b16 a[224:225], v12 offset:0
  ds_read_b64_tr_b16 a[226:227], v14 offset:512
  ds_read_b64_tr_b16 a[228:229], v12 offset:4096
  ds_read_b64_tr_b16 a[230:231], v14 offset:4608
  ds_read_b64_tr_b16 a[232:233], v13 offset:0
  ds_read_b64_tr_b16 a[234:235], v15 offset:512
  ds_read_b64_tr_b16 a[236:237], v13 offset:4096
  ds_read_b64_tr_b16 a[238:239], v15 offset:4608
  ds_read_b64_tr_b16 a[240:241], v14 offset:0
  ds_read_b64_tr_b16 a[242:243], v12 offset:512
  ds_read_b64_tr_b16 a[244:245], v14 offset:4096
  ds_read_b64_tr_b16 a[246:247], v12 offset:4608
  v_mfma_f32_16x16x32_bf16 v[224:227], a[0:3], v[48:51], 0
  v_mfma_f32_16x16x32_bf16 v[224:227], a[4:7], v[56:59], v[224:227]
  v_mfma_f32_16x16x32_bf16 v[224:227], a[8:11], v[64:67], v[224:227]
  v_mfma_f32_16x16x32_bf16 v[224:227], a[12:15], v[72:75], v[224:227]
  v_mfma_f32_16x16x32_bf16 v[224:227], a[16:19], v[80:83], v[224:227]
  v_mfma_f32_16x16x32_bf16 v[224:227], a[20:23], v[88:91], v[224:227]
  v_mfma_f32_16x16x32_bf16 v[224:227], a[24:27], v[96:99], v[224:227]
  v_mfma_f32_16x16x32_bf16 v[224:227], a[28:31], v[104:107], v[224:227]
  v_mfma_f32_16x16x32_bf16 v[224:227], a[32:35], v[112:115], v[224:227]
  v_mfma_f32_16x16x32_bf16 v[224:227], a[36:39], v[120:123], v[224:227]
  v_mfma_f32_16x16x32_bf16 v[224:227], a[40:43], a[192:195], v[224:227]
  v_mfma_f32_16x16x32_bf16 v[224:227], a[44:47], a[200:203], v[224:227]
  v_mfma_f32_16x16x32_bf16 v[224:227], a[48:51], a[208:211], v[224:227]
  v_mfma_f32_16x16x32_bf16 v[224:227], a[52:55], a[216:219], v[224:227]
  v_mfma_f32_16x16x32_bf16 v[228:231], a[0:3], v[52:55], 0
  v_mfma_f32_16x16x32_bf16 v[228:231], a[4:7], v[60:63], v[228:231]
  v_mfma_f32_16x16x32_bf16 v[228:231], a[8:11], v[68:71], v[228:231]
  v_mfma_f32_16x16x32_bf16 v[228:231], a[12:15], v[76:79], v[228:231]
  v_mfma_f32_16x16x32_bf16 v[228:231], a[16:19], v[84:87], v[228:231]
  v_mfma_f32_16x16x32_bf16 v[228:231], a[20:23], v[92:95], v[228:231]
  v_mfma_f32_16x16x32_bf16 v[228:231], a[24:27], v[100:103], v[228:231]
  v_mfma_f32_16x16x32_bf16 v[228:231], a[28:31], v[108:111], v[228:231]
  v_mfma_f32_16x16x32_bf16 v[228:231], a[32:35], v[116:119], v[228:231]
  v_mfma_f32_16x16x32_bf16 v[228:231], a[36:39], v[124:127], v[228:231]
  v_mfma_f32_16x16x32_bf16 v[228:231], a[40:43], a[196:199], v[228:231]
  v_mfma_f32_16x16x32_bf16 v[228:231], a[44:47], a[204:207], v[228:231]
  v_mfma_f32_16x16x32_bf16 v[228:231], a[48:51], a[212:215], v[228:231]
  v_mfma_f32_16x16x32_bf16 v[228:231], a[52:55], a[220:223], v[228:231]
  v_and_b32 v7, 15, v0
  v_lshlrev_b32 v7, 2, v7
  s_nop 7
  ds_bpermute_b32 v3, v7, v224
  ds_bpermute_b32 v4, v7, v228
  s_waitcnt lgkmcnt(0)
  v_mul_f32 v3, 0xbfb8aa3b, v3
  v_mul_f32 v4, 0xbfb8aa3b, v4
  v_exp_f32 v3, v3
  v_exp_f32 v4, v4
  s_nop 0
  v_add_f32 v3, 1.0, v3
  v_add_f32 v4, 1.0, v4
  v_rcp_f32 v3, v3
  v_rcp_f32 v4, v4
  s_nop 0
  v_sub_f32 v5, 1.0, v3
  v_max_f32 v5, 0x0da24260, v5
  v_sub_f32 v6, 1.0, v4
  v_max_f32 v6, 0x0da24260, v6
  v_rcp_f32 v42, v5
  v_rcp_f32 v43, v6
  s_cmp_eq_u32 s5, 0
  s_cbranch_scc0 L_k1_nog
  v_and_b32 v7, 15, v0
  v_lshlrev_b32 v7, 2, v7
  s_lshl_b32 s49, s7, 7
  s_add_u32 s49, s49, 0x5c80000
  buffer_store_dword v3, v7, s[36:39], s49 offen
  buffer_store_dword v4, v7, s[36:39], s49 offen offset:64
  v_mov_b32 v8, 0
  v_lshlrev_b32 v9, 2, v0
  s_lshl_b32 s49, s7, 8
  s_add_u32 s49, s49, 0x5c82000
  buffer_store_dword v8, v9, s[36:39], s49 offen
L_k1_nog:
  s_waitcnt lgkmcnt(0)
  v_mfma_f32_16x16x32_bf16 v[160:163], a[224:227], v[48:51], 0
  s_add_u32 s46, s58, 0
  ds_read_b64_tr_b16 a[248:249], v15 offset:0
  v_mfma_f32_16x16x32_bf16 v[160:163], a[228:231], v[56:59], v[160:163]
  s_add_u32 m0, s44, 65536
  ds_read_b64_tr_b16 a[250:251], v13 offset:512
  buffer_load_dwordx4 v20, s[24:27], s46 offen offset:0 lds
  v_mfma_f32_16x16x32_bf16 v[164:167], a[224:227], v[52:55], 0
  ds_read_b64_tr_b16 a[252:253], v15 offset:4096
  v_mfma_f32_16x16x32_bf16 v[164:167], a[228:231], v[60:63], v[164:167]
  ds_read_b64_tr_b16 a[254:255], v13 offset:4608
  v_mfma_f32_16x16x32_bf16 v[168:171], a[232:235], v[48:51], 0
  ds_read_b64_tr_b16 a[224:225], v12 offset:8192
  buffer_load_dwordx4 v21, s[24:27], s46 offen offset:1024 lds
  v_mfma_f32_16x16x32_bf16 v[168:171], a[236:239], v[56:59], v[168:171]
  ds_read_b64_tr_b16 a[226:227], v14 offset:8704
  v_mfma_f32_16x16x32_bf16 v[172:175], a[232:235], v[52:55], 0
  ds_read_b64_tr_b16 a[228:229], v12 offset:12288
  v_mfma_f32_16x16x32_bf16 v[172:175], a[236:239], v[60:63], v[172:175]
  s_waitcnt lgkmcnt(3)
  ds_read_b64_tr_b16 a[230:231], v14 offset:12800
  v_mfma_f32_16x16x32_bf16 v[176:179], a[240:243], v[48:51], 0
  ds_read_b64_tr_b16 a[232:233], v13 offset:8192
  buffer_load_dwordx4 v22, s[24:27], s46 offen offset:2048 lds
  v_mfma_f32_16x16x32_bf16 v[176:179], a[244:247], v[56:59], v[176:179]
  ds_read_b64_tr_b16 a[234:235], v15 offset:8704
  v_mfma_f32_16x16x32_bf16 v[180:183], a[240:243], v[52:55], 0
  ds_read_b64_tr_b16 a[236:237], v13 offset:12288
  v_mfma_f32_16x16x32_bf16 v[180:183], a[244:247], v[60:63], v[180:183]
  ds_read_b64_tr_b16 a[238:239], v15 offset:12800
  v_mfma_f32_16x16x32_bf16 v[184:187], a[248:251], v[48:51], 0
  ds_read_b64_tr_b16 a[240:241], v14 offset:8192
  buffer_load_dwordx4 v23, s[24:27], s46 offen offset:3072 lds
  v_mfma_f32_16x16x32_bf16 v[184:187], a[252:255], v[56:59], v[184:187]
  s_add_u32 m0, s44, 69632
  ds_read_b64_tr_b16 a[242:243], v12 offset:8704
  v_mfma_f32_16x16x32_bf16 v[188:191], a[248:251], v[52:55], 0
  ds_read_b64_tr_b16 a[244:245], v14 offset:12288
  v_mfma_f32_16x16x32_bf16 v[188:191], a[252:255], v[60:63], v[188:191]
  s_waitcnt lgkmcnt(3)
  ds_read_b64_tr_b16 a[246:247], v12 offset:12800
  v_mfma_f32_16x16x32_bf16 v[160:163], a[224:227], v[64:67], v[160:163]
  ds_read_b64_tr_b16 a[248:249], v15 offset:8192
  buffer_load_dwordx4 v24, s[24:27], s46 offen offset:0 lds
  v_mfma_f32_16x16x32_bf16 v[160:163], a[228:231], v[72:75], v[160:163]
  ds_read_b64_tr_b16 a[250:251], v13 offset:8704
  v_mfma_f32_16x16x32_bf16 v[164:167], a[224:227], v[68:71], v[164:167]
  ds_read_b64_tr_b16 a[252:253], v15 offset:12288
  v_mfma_f32_16x16x32_bf16 v[164:167], a[228:231], v[76:79], v[164:167]
  ds_read_b64_tr_b16 a[254:255], v13 offset:12800
  buffer_load_dwordx4 v25, s[24:27], s46 offen offset:1024 lds
  v_mfma_f32_16x16x32_bf16 v[168:171], a[232:235], v[64:67], v[168:171]
  ds_read_b64_tr_b16 a[224:225], v12 offset:16384
  v_mfma_f32_16x16x32_bf16 v[168:171], a[236:239], v[72:75], v[168:171]
  ds_read_b64_tr_b16 a[226:227], v14 offset:16896
  v_mfma_f32_16x16x32_bf16 v[172:175], a[232:235], v[68:71], v[172:175]
  ds_read_b64_tr_b16 a[228:229], v12 offset:20480
  v_mfma_f32_16x16x32_bf16 v[172:175], a[236:239], v[76:79], v[172:175]
  s_waitcnt lgkmcnt(3)
  ds_read_b64_tr_b16 a[230:231], v14 offset:20992
  buffer_load_dwordx4 v26, s[24:27], s46 offen offset:2048 lds
  v_mfma_f32_16x16x32_bf16 v[176:179], a[240:243], v[64:67], v[176:179]
  ds_read_b64_tr_b16 a[232:233], v13 offset:16384
  v_mfma_f32_16x16x32_bf16 v[176:179], a[244:247], v[72:75], v[176:179]
  ds_read_b64_tr_b16 a[234:235], v15 offset:16896
  v_mfma_f32_16x16x32_bf16 v[180:183], a[240:243], v[68:71], v[180:183]
  ds_read_b64_tr_b16 a[236:237], v13 offset:20480
  v_mfma_f32_16x16x32_bf16 v[180:183], a[244:247], v[76:79], v[180:183]
  ds_read_b64_tr_b16 a[238:239], v15 offset:20992
  buffer_load_dwordx4 v27, s[24:27], s46 offen offset:3072 lds
  v_mfma_f32_16x16x32_bf16 v[184:187], a[248:251], v[64:67], v[184:187]
  s_add_u32 m0, s44, 73728
  ds_read_b64_tr_b16 a[240:241], v14 offset:16384
  v_mfma_f32_16x16x32_bf16 v[184:187], a[252:255], v[72:75], v[184:187]
  ds_read_b64_tr_b16 a[242:243], v12 offset:16896
  v_mfma_f32_16x16x32_bf16 v[188:191], a[248:251], v[68:71], v[188:191]
  ds_read_b64_tr_b16 a[244:245], v14 offset:20480
  v_mfma_f32_16x16x32_bf16 v[188:191], a[252:255], v[76:79], v[188:191]
  s_waitcnt lgkmcnt(3)
  ds_read_b64_tr_b16 a[246:247], v12 offset:20992
  buffer_load_dwordx4 v28, s[24:27], s46 offen offset:0 lds
  v_mfma_f32_16x16x32_bf16 v[160:163], a[224:227], v[80:83], v[160:163]
  ds_read_b64_tr_b16 a[248:249], v15 offset:16384
  v_mfma_f32_16x16x32_bf16 v[160:163], a[228:231], v[88:91], v[160:163]
  ds_read_b64_tr_b16 a[250:251], v13 offset:16896
  v_mfma_f32_16x16x32_bf16 v[164:167], a[224:227], v[84:87], v[164:167]
  ds_read_b64_tr_b16 a[252:253], v15 offset:20480
  v_mfma_f32_16x16x32_bf16 v[164:167], a[228:231], v[92:95], v[164:167]
  ds_read_b64_tr_b16 a[254:255], v13 offset:20992
  buffer_load_dwordx4 v29, s[24:27], s46 offen offset:1024 lds
  v_mfma_f32_16x16x32_bf16 v[168:171], a[232:235], v[80:83], v[168:171]
  ds_read_b64_tr_b16 a[224:225], v12 offset:24576
  v_mfma_f32_16x16x32_bf16 v[168:171], a[236:239], v[88:91], v[168:171]
  ds_read_b64_tr_b16 a[226:227], v14 offset:25088
  v_mfma_f32_16x16x32_bf16 v[172:175], a[232:235], v[84:87], v[172:175]
  ds_read_b64_tr_b16 a[228:229], v12 offset:28672
  buffer_load_dwordx4 v30, s[24:27], s46 offen offset:2048 lds
  v_mfma_f32_16x16x32_bf16 v[172:175], a[236:239], v[92:95], v[172:175]
  s_waitcnt lgkmcnt(3)
  ds_read_b64_tr_b16 a[230:231], v14 offset:29184
  v_mfma_f32_16x16x32_bf16 v[176:179], a[240:243], v[80:83], v[176:179]
  ds_read_b64_tr_b16 a[232:233], v13 offset:24576
  v_mfma_f32_16x16x32_bf16 v[176:179], a[244:247], v[88:91], v[176:179]
  ds_read_b64_tr_b16 a[234:235], v15 offset:25088
  v_mfma_f32_16x16x32_bf16 v[180:183], a[240:243], v[84:87], v[180:183]
  ds_read_b64_tr_b16 a[236:237], v13 offset:28672
  buffer_load_dwordx4 v31, s[24:27], s46 offen offset:3072 lds
  v_mfma_f32_16x16x32_bf16 v[180:183], a[244:247], v[92:95], v[180:183]
  ds_read_b64_tr_b16 a[238:239], v15 offset:29184
  v_mfma_f32_16x16x32_bf16 v[184:187], a[248:251], v[80:83], v[184:187]
  s_add_u32 m0, s44, 77824
  ds_read_b64_tr_b16 a[240:241], v14 offset:24576
  v_mfma_f32_16x16x32_bf16 v[184:187], a[252:255], v[88:91], v[184:187]
  ds_read_b64_tr_b16 a[242:243], v12 offset:25088
  v_mfma_f32_16x16x32_bf16 v[188:191], a[248:251], v[84:87], v[188:191]
  ds_read_b64_tr_b16 a[244:245], v14 offset:28672
  buffer_load_dwordx4 v32, s[24:27], s46 offen offset:0 lds
  v_mfma_f32_16x16x32_bf16 v[188:191], a[252:255], v[92:95], v[188:191]
  s_waitcnt lgkmcnt(3)
  ds_read_b64_tr_b16 a[246:247], v12 offset:29184
  v_mfma_f32_16x16x32_bf16 v[160:163], a[224:227], v[96:99], v[160:163]
  ds_read_b64_tr_b16 a[248:249], v15 offset:24576
  v_mfma_f32_16x16x32_bf16 v[160:163], a[228:231], v[104:107], v[160:163]
  ds_read_b64_tr_b16 a[250:251], v13 offset:25088
  v_mfma_f32_16x16x32_bf16 v[164:167], a[224:227], v[100:103], v[164:167]
  ds_read_b64_tr_b16 a[252:253], v15 offset:28672
  buffer_load_dwordx4 v33, s[24:27], s46 offen offset:1024 lds
  v_mfma_f32_16x16x32_bf16 v[164:167], a[228:231], v[108:111], v[164:167]
  ds_read_b64_tr_b16 a[254:255], v13 offset:29184
  v_mfma_f32_16x16x32_bf16 v[168:171], a[232:235], v[96:99], v[168:171]
  ds_read_b64_tr_b16 a[224:225], v12 offset:32768
  v_mfma_f32_16x16x32_bf16 v[168:171], a[236:239], v[104:107], v[168:171]
  ds_read_b64_tr_b16 a[226:227], v14 offset:33280
  v_mfma_f32_16x16x32_bf16 v[172:175], a[232:235], v[100:103], v[172:175]
  ds_read_b64_tr_b16 a[228:229], v12 offset:36864
  v_mfma_f32_16x16x32_bf16 v[172:175], a[236:239], v[108:111], v[172:175]
  s_waitcnt lgkmcnt(3)
  ds_read_b64_tr_b16 a[230:231], v14 offset:37376
  v_mfma_f32_16x16x32_bf16 v[176:179], a[240:243], v[96:99], v[176:179]
  s_add_u32 m0, s48, 0
  ds_read_b64_tr_b16 a[232:233], v13 offset:32768
  v_mfma_f32_16x16x32_bf16 v[176:179], a[244:247], v[104:107], v[176:179]
  s_movk_i32 s60, 0
  ds_read_b64_tr_b16 a[234:235], v15 offset:33280
  buffer_load_dwordx4 v36, s[12:15], s60 offen offset:0 lds
  v_mfma_f32_16x16x32_bf16 v[180:183], a[240:243], v[100:103], v[180:183]
  ds_read_b64_tr_b16 a[236:237], v13 offset:36864
  v_mfma_f32_16x16x32_bf16 v[180:183], a[244:247], v[108:111], v[180:183]
  ds_read_b64_tr_b16 a[238:239], v15 offset:37376
  v_mfma_f32_16x16x32_bf16 v[184:187], a[248:251], v[96:99], v[184:187]
  ds_read_b64_tr_b16 a[240:241], v14 offset:32768
  buffer_load_dwordx4 v37, s[12:15], s60 offen offset:1024 lds
  v_mfma_f32_16x16x32_bf16 v[184:187], a[252:255], v[104:107], v[184:187]
  ds_read_b64_tr_b16 a[242:243], v12 offset:33280
  v_mfma_f32_16x16x32_bf16 v[188:191], a[248:251], v[100:103], v[188:191]
  ds_read_b64_tr_b16 a[244:245], v14 offset:36864
  v_mfma_f32_16x16x32_bf16 v[188:191], a[252:255], v[108:111], v[188:191]
  s_waitcnt lgkmcnt(3)
  ds_read_b64_tr_b16 a[246:247], v12 offset:37376
  v_mfma_f32_16x16x32_bf16 v[160:163], a[224:227], v[112:115], v[160:163]
  ds_read_b64_tr_b16 a[248:249], v15 offset:32768
  buffer_load_dwordx4 v38, s[12:15], s60 offen offset:2048 lds
  v_mfma_f32_16x16x32_bf16 v[160:163], a[228:231], v[120:123], v[160:163]
  ds_read_b64_tr_b16 a[250:251], v13 offset:33280
  v_mfma_f32_16x16x32_bf16 v[164:167], a[224:227], v[116:119], v[164:167]
  ds_read_b64_tr_b16 a[252:253], v15 offset:36864
  v_mfma_f32_16x16x32_bf16 v[164:167], a[228:231], v[124:127], v[164:167]
  ds_read_b64_tr_b16 a[254:255], v13 offset:37376
  v_mfma_f32_16x16x32_bf16 v[168:171], a[232:235], v[112:115], v[168:171]
  ds_read_b64_tr_b16 a[224:225], v12 offset:40960
  buffer_load_dwordx4 v39, s[12:15], s60 offen offset:3072 lds
  v_mfma_f32_16x16x32_bf16 v[168:171], a[236:239], v[120:123], v[168:171]
  s_add_u32 m0, s48, 4096
  ds_read_b64_tr_b16 a[226:227], v14 offset:41472
  v_mfma_f32_16x16x32_bf16 v[172:175], a[232:235], v[116:119], v[172:175]
  s_movk_i32 s60, 128
  ds_read_b64_tr_b16 a[228:229], v12 offset:45056
  v_mfma_f32_16x16x32_bf16 v[172:175], a[236:239], v[124:127], v[172:175]
  s_waitcnt lgkmcnt(3)
  ds_read_b64_tr_b16 a[230:231], v14 offset:45568
  v_mfma_f32_16x16x32_bf16 v[176:179], a[240:243], v[112:115], v[176:179]
  ds_read_b64_tr_b16 a[232:233], v13 offset:40960
  buffer_load_dwordx4 v36, s[12:15], s60 offen offset:0 lds
  v_mfma_f32_16x16x32_bf16 v[176:179], a[244:247], v[120:123], v[176:179]
  ds_read_b64_tr_b16 a[234:235], v15 offset:41472
  v_mfma_f32_16x16x32_bf16 v[180:183], a[240:243], v[116:119], v[180:183]
  ds_read_b64_tr_b16 a[236:237], v13 offset:45056
  v_mfma_f32_16x16x32_bf16 v[180:183], a[244:247], v[124:127], v[180:183]
  ds_read_b64_tr_b16 a[238:239], v15 offset:45568
  buffer_load_dwordx4 v37, s[12:15], s60 offen offset:1024 lds
  v_mfma_f32_16x16x32_bf16 v[184:187], a[248:251], v[112:115], v[184:187]
  s_waitcnt vmcnt(20)
  s_barrier
  ds_read_b64_tr_b16 a[240:241], v14 offset:40960
  v_mfma_f32_16x16x32_bf16 v[184:187], a[252:255], v[120:123], v[184:187]
  ds_read_b64_tr_b16 a[242:243], v12 offset:41472
  v_mfma_f32_16x16x32_bf16 v[188:191], a[248:251], v[116:119], v[188:191]
  ds_read_b64_tr_b16 a[244:245], v14 offset:45056
  v_mfma_f32_16x16x32_bf16 v[188:191], a[252:255], v[124:127], v[188:191]
  s_waitcnt lgkmcnt(3)
  ds_read_b64_tr_b16 a[246:247], v12 offset:45568
  buffer_load_dwordx4 v38, s[12:15], s60 offen offset:2048 lds
  v_mfma_f32_16x16x32_bf16 v[160:163], a[224:227], a[192:195], v[160:163]
  ds_read_b64_tr_b16 a[248:249], v15 offset:40960
  v_mfma_f32_16x16x32_bf16 v[160:163], a[228:231], a[200:203], v[160:163]
  ds_read_b64_tr_b16 a[250:251], v13 offset:41472
  v_mfma_f32_16x16x32_bf16 v[164:167], a[224:227], a[196:199], v[164:167]
  ds_read_b64_tr_b16 a[252:253], v15 offset:45056
  v_mfma_f32_16x16x32_bf16 v[164:167], a[228:231], a[204:207], v[164:167]
  ds_read_b64_tr_b16 a[254:255], v13 offset:45568
  buffer_load_dwordx4 v39, s[12:15], s60 offen offset:3072 lds
  v_mfma_f32_16x16x32_bf16 v[168:171], a[232:235], a[192:195], v[168:171]
  s_add_u32 s100, s58, 128
  ds_read_b64_tr_b16 a[224:225], v12 offset:49152
  v_mfma_f32_16x16x32_bf16 v[168:171], a[236:239], a[200:203], v[168:171]
  ds_read_b64_tr_b16 a[226:227], v14 offset:49664
  v_mfma_f32_16x16x32_bf16 v[172:175], a[232:235], a[196:199], v[172:175]
  ds_read_b64_tr_b16 a[228:229], v12 offset:53248
  v_mfma_f32_16x16x32_bf16 v[172:175], a[236:239], a[204:207], v[172:175]
  s_waitcnt lgkmcnt(3)
  ds_read_b64_tr_b16 a[230:231], v14 offset:53760
  buffer_load_dword v47, v35, s[24:27], s100 offen
  v_mfma_f32_16x16x32_bf16 v[176:179], a[240:243], a[192:195], v[176:179]
  ds_read_b64_tr_b16 a[232:233], v13 offset:49152
  v_mfma_f32_16x16x32_bf16 v[176:179], a[244:247], a[200:203], v[176:179]
  ds_read_b64_tr_b16 a[234:235], v15 offset:49664
  v_mfma_f32_16x16x32_bf16 v[180:183], a[240:243], a[196:199], v[180:183]
  ds_read_b64_tr_b16 a[236:237], v13 offset:53248
  v_mfma_f32_16x16x32_bf16 v[180:183], a[244:247], a[204:207], v[180:183]
  ds_read_b64_tr_b16 a[238:239], v15 offset:53760
  v_mfma_f32_16x16x32_bf16 v[184:187], a[248:251], a[192:195], v[184:187]
  ds_read_b64_tr_b16 a[240:241], v14 offset:49152
  v_mfma_f32_16x16x32_bf16 v[184:187], a[252:255], a[200:203], v[184:187]
  ds_read_b64_tr_b16 a[242:243], v12 offset:49664
  v_mfma_f32_16x16x32_bf16 v[188:191], a[248:251], a[196:199], v[188:191]
  ds_read_b64_tr_b16 a[244:245], v14 offset:53248
  v_mfma_f32_16x16x32_bf16 v[188:191], a[252:255], a[204:207], v[188:191]
  s_waitcnt lgkmcnt(3)
  ds_read_b64_tr_b16 a[246:247], v12 offset:53760
  v_mfma_f32_16x16x32_bf16 v[160:163], a[224:227], a[208:211], v[160:163]
  ds_read_b64_tr_b16 a[248:249], v15 offset:49152
  v_mfma_f32_16x16x32_bf16 v[160:163], a[228:231], a[216:219], v[160:163]
  ds_read_b64_tr_b16 a[250:251], v13 offset:49664
  v_mfma_f32_16x16x32_bf16 v[164:167], a[224:227], a[212:215], v[164:167]
  ds_read_b64_tr_b16 a[252:253], v15 offset:53248
  v_mfma_f32_16x16x32_bf16 v[164:167], a[228:231], a[220:223], v[164:167]
  ds_read_b64_tr_b16 a[254:255], v13 offset:53760
  v_mfma_f32_16x16x32_bf16 v[168:171], a[232:235], a[208:211], v[168:171]
  v_mfma_f32_16x16x32_bf16 v[168:171], a[236:239], a[216:219], v[168:171]
  v_mfma_f32_16x16x32_bf16 v[172:175], a[232:235], a[212:215], v[172:175]
  v_mfma_f32_16x16x32_bf16 v[172:175], a[236:239], a[220:223], v[172:175]
  s_waitcnt vmcnt(9) lgkmcnt(0)
  s_barrier
  v_mfma_f32_16x16x32_bf16 v[176:179], a[240:243], a[208:211], v[176:179]
  ds_read_b64_tr_b16 a[224:225], v16 offset:0
  ds_read_b64_tr_b16 a[226:227], v18 offset:512
  v_mfma_f32_16x16x32_bf16 v[176:179], a[244:247], a[216:219], v[176:179]
  ds_read_b64_tr_b16 a[228:229], v16 offset:4096
  ds_read_b64_tr_b16 a[230:231], v18 offset:4608
  v_mfma_f32_16x16x32_bf16 v[180:183], a[240:243], a[212:215], v[180:183]
  ds_read_b64_tr_b16 a[232:233], v17 offset:0
  ds_read_b64_tr_b16 a[234:235], v19 offset:512
  v_mfma_f32_16x16x32_bf16 v[180:183], a[244:247], a[220:223], v[180:183]
  ds_read_b64_tr_b16 a[236:237], v17 offset:4096
  ds_read_b64_tr_b16 a[238:239], v19 offset:4608
  ds_read_b64_tr_b16 a[240:241], v18 offset:0
  v_mfma_f32_16x16x32_bf16 v[184:187], a[248:251], a[208:211], v[184:187]
  ds_read_b64_tr_b16 a[242:243], v16 offset:512
  v_mfma_f32_16x16x32_bf16 v[184:187], a[252:255], a[216:219], v[184:187]
  ds_read_b64_tr_b16 a[244:245], v18 offset:4096
  v_mfma_f32_16x16x32_bf16 v[188:191], a[248:251], a[212:215], v[188:191]
  ds_read_b64_tr_b16 a[246:247], v16 offset:4608
  v_mfma_f32_16x16x32_bf16 v[188:191], a[252:255], a[220:223], v[188:191]
  s_waitcnt lgkmcnt(8)
  v_mfma_f32_16x16x32_bf16 v[192:195], a[224:227], v[48:51], 0
  s_add_u32 s46, s58, 128
  ds_read_b64_tr_b16 a[248:249], v19 offset:0
  v_mfma_f32_16x16x32_bf16 v[192:195], a[228:231], v[56:59], v[192:195]
  s_add_u32 m0, s44, 0
  ds_read_b64_tr_b16 a[250:251], v17 offset:512
  buffer_load_dwordx4 v20, s[20:23], s46 offen offset:0 lds
  v_mfma_f32_16x16x32_bf16 v[196:199], a[224:227], v[52:55], 0
  ds_read_b64_tr_b16 a[252:253], v19 offset:4096
  v_mfma_f32_16x16x32_bf16 v[196:199], a[228:231], v[60:63], v[196:199]
  s_waitcnt lgkmcnt(7)
  ds_read_b64_tr_b16 a[254:255], v17 offset:4608
  v_mfma_f32_16x16x32_bf16 v[200:203], a[232:235], v[48:51], 0
  ds_read_b64_tr_b16 a[224:225], v16 offset:8192
  buffer_load_dwordx4 v21, s[20:23], s46 offen offset:1024 lds
  v_mfma_f32_16x16x32_bf16 v[200:203], a[236:239], v[56:59], v[200:203]
  ds_read_b64_tr_b16 a[226:227], v18 offset:8704
  v_mfma_f32_16x16x32_bf16 v[204:207], a[232:235], v[52:55], 0
  ds_read_b64_tr_b16 a[228:229], v16 offset:12288
  v_mul_f32 v7, v160, v160
  v_mfma_f32_16x16x32_bf16 v[204:207], a[236:239], v[60:63], v[204:207]
  s_waitcnt lgkmcnt(3)
  ds_read_b64_tr_b16 a[230:231], v18 offset:12800
  v_mul_f32 v8, v161, v161
  v_mfma_f32_16x16x32_bf16 v[208:211], a[240:243], v[48:51], 0
  ds_read_b64_tr_b16 a[232:233], v17 offset:8192
  buffer_load_dwordx4 v22, s[20:23], s46 offen offset:2048 lds
  v_mfma_f32_16x16x32_bf16 v[208:211], a[244:247], v[56:59], v[208:211]
  ds_read_b64_tr_b16 a[234:235], v19 offset:8704
  v_mul_f32 v9, v162, v162
  v_mfma_f32_16x16x32_bf16 v[212:215], a[240:243], v[52:55], 0
  ds_read_b64_tr_b16 a[236:237], v17 offset:12288
  v_mul_f32 v10, v163, v163
  v_mfma_f32_16x16x32_bf16 v[212:215], a[244:247], v[60:63], v[212:215]
  ds_read_b64_tr_b16 a[238:239], v19 offset:12800
  v_fma_f32 v7, v7, v46, s62
  v_mfma_f32_16x16x32_bf16 v[216:219], a[248:251], v[48:51], 0
  ds_read_b64_tr_b16 a[240:241], v18 offset:8192
  buffer_load_dwordx4 v23, s[20:23], s46 offen offset:3072 lds
  v_mfma_f32_16x16x32_bf16 v[216:219], a[252:255], v[56:59], v[216:219]
  s_add_u32 m0, s44, 4096
  ds_read_b64_tr_b16 a[242:243], v16 offset:8704
  v_fma_f32 v8, v8, v46, s62
  v_mfma_f32_16x16x32_bf16 v[220:223], a[248:251], v[52:55], 0
  ds_read_b64_tr_b16 a[244:245], v18 offset:12288
  v_fma_f32 v9, v9, v46, s62
  v_mfma_f32_16x16x32_bf16 v[220:223], a[252:255], v[60:63], v[220:223]
  s_waitcnt lgkmcnt(3)
  ds_read_b64_tr_b16 a[246:247], v16 offset:12800
  v_fma_f32 v10, v10, v46, s62
  v_mfma_f32_16x16x32_bf16 v[192:195], a[224:227], v[64:67], v[192:195]
  ds_read_b64_tr_b16 a[248:249], v19 offset:8192
  buffer_load_dwordx4 v24, s[20:23], s46 offen offset:0 lds
  v_mfma_f32_16x16x32_bf16 v[192:195], a[228:231], v[72:75], v[192:195]
  ds_read_b64_tr_b16 a[250:251], v17 offset:8704
  v_mul_f32 v7, v160, v7
  v_mfma_f32_16x16x32_bf16 v[196:199], a[224:227], v[68:71], v[196:199]
  ds_read_b64_tr_b16 a[252:253], v19 offset:12288
  v_mul_f32 v8, v161, v8
  v_mfma_f32_16x16x32_bf16 v[196:199], a[228:231], v[76:79], v[196:199]
  ds_read_b64_tr_b16 a[254:255], v17 offset:12800
  buffer_load_dwordx4 v25, s[20:23], s46 offen offset:1024 lds
  v_mfma_f32_16x16x32_bf16 v[200:203], a[232:235], v[64:67], v[200:203]
  ds_read_b64_tr_b16 a[224:225], v16 offset:16384
  v_mul_f32 v9, v162, v9
  v_mfma_f32_16x16x32_bf16 v[200:203], a[236:239], v[72:75], v[200:203]
  ds_read_b64_tr_b16 a[226:227], v18 offset:16896
  v_mul_f32 v10, v163, v10
  v_mfma_f32_16x16x32_bf16 v[204:207], a[232:235], v[68:71], v[204:207]
  ds_read_b64_tr_b16 a[228:229], v16 offset:20480
  ds_read_b64_tr_b16 a[230:231], v18 offset:20992
  v_mfma_f32_16x16x32_bf16 v[204:207], a[236:239], v[76:79], v[204:207]
  s_waitcnt lgkmcnt(4)
  v_exp_f32 v7, v7
  v_mfma_f32_16x16x32_bf16 v[208:211], a[240:243], v[64:67], v[208:211]
  ds_read_b64_tr_b16 a[232:233], v17 offset:16384
  buffer_load_dwordx4 v26, s[20:23], s46 offen offset:2048 lds
  v_mfma_f32_16x16x32_bf16 v[208:211], a[244:247], v[72:75], v[208:211]
  ds_read_b64_tr_b16 a[234:235], v19 offset:16896
  ds_read_b64_tr_b16 a[236:237], v17 offset:20480
  v_mfma_f32_16x16x32_bf16 v[212:215], a[240:243], v[68:71], v[212:215]
  v_exp_f32 v8, v8
  v_mfma_f32_16x16x32_bf16 v[212:215], a[244:247], v[76:79], v[212:215]
  ds_read_b64_tr_b16 a[238:239], v19 offset:20992
  buffer_load_dwordx4 v27, s[20:23], s46 offen offset:3072 lds
  v_mfma_f32_16x16x32_bf16 v[216:219], a[248:251], v[64:67], v[216:219]
  s_add_u32 m0, s44, 8192
  ds_read_b64_tr_b16 a[240:241], v18 offset:16384
  ds_read_b64_tr_b16 a[242:243], v16 offset:16896
  v_mfma_f32_16x16x32_bf16 v[216:219], a[252:255], v[72:75], v[216:219]
  v_exp_f32 v9, v9
  v_mfma_f32_16x16x32_bf16 v[220:223], a[248:251], v[68:71], v[220:223]
  ds_read_b64_tr_b16 a[244:245], v18 offset:20480
  ds_read_b64_tr_b16 a[246:247], v16 offset:20992
  v_mfma_f32_16x16x32_bf16 v[220:223], a[252:255], v[76:79], v[220:223]
  s_waitcnt lgkmcnt(4)
  v_exp_f32 v10, v10
  v_mfma_f32_16x16x32_bf16 v[192:195], a[224:227], v[80:83], v[192:195]
  ds_read_b64_tr_b16 a[248:249], v19 offset:16384
  buffer_load_dwordx4 v28, s[20:23], s46 offen offset:0 lds
  v_mfma_f32_16x16x32_bf16 v[192:195], a[228:231], v[88:91], v[192:195]
  ds_read_b64_tr_b16 a[250:251], v17 offset:16896
  s_waitcnt vmcnt(10)
  ds_read_b128 a[0:3], v40 offset:0
  v_mfma_f32_16x16x32_bf16 v[196:199], a[224:227], v[84:87], v[196:199]
  ds_read_b64_tr_b16 a[252:253], v19 offset:20480
  ds_read_b128 a[4:7], v40 offset:2048
  v_mfma_f32_16x16x32_bf16 v[196:199], a[228:231], v[92:95], v[196:199]
  ds_read_b64_tr_b16 a[254:255], v17 offset:20992
  ds_read_b128 a[8:11], v41 offset:0
  v_mfma_f32_16x16x32_bf16 v[200:203], a[232:235], v[80:83], v[200:203]
  ds_read_b64_tr_b16 a[224:225], v16 offset:24576
  ds_read_b128 a[12:15], v41 offset:2048
  v_mfma_f32_16x16x32_bf16 v[200:203], a[236:239], v[88:91], v[200:203]
  ds_read_b64_tr_b16 a[226:227], v18 offset:25088
  ds_read_b128 a[16:19], v40 offset:4096
  v_mfma_f32_16x16x32_bf16 v[204:207], a[232:235], v[84:87], v[204:207]
  ds_read_b64_tr_b16 a[228:229], v16 offset:28672
  ds_read_b128 a[20:23], v40 offset:6144
  v_mfma_f32_16x16x32_bf16 v[204:207], a[236:239], v[92:95], v[204:207]
  s_waitcnt lgkmcnt(7)
  ds_read_b64_tr_b16 a[230:231], v18 offset:29184
  ds_read_b128 a[24:27], v41 offset:4096
  v_mfma_f32_16x16x32_bf16 v[208:211], a[240:243], v[80:83], v[208:211]
  ds_read_b64_tr_b16 a[232:233], v17 offset:24576
  ds_read_b128 a[28:31], v41 offset:6144
  v_mfma_f32_16x16x32_bf16 v[208:211], a[244:247], v[88:91], v[208:211]
  ds_read_b64_tr_b16 a[234:235], v19 offset:25088
  buffer_load_dwordx4 v29, s[20:23], s46 offen offset:1024 lds
  v_mfma_f32_16x16x32_bf16 v[212:215], a[240:243], v[84:87], v[212:215]
  ds_read_b64_tr_b16 a[236:237], v17 offset:28672
  v_fma_f32 v7, v7, v42, v42
  v_mfma_f32_16x16x32_bf16 v[212:215], a[244:247], v[92:95], v[212:215]
  ds_read_b64_tr_b16 a[238:239], v19 offset:29184
  v_fma_f32 v8, v8, v42, v42
  v_mfma_f32_16x16x32_bf16 v[216:219], a[248:251], v[80:83], v[216:219]
  ds_read_b64_tr_b16 a[240:241], v18 offset:24576
  buffer_load_dwordx4 v30, s[20:23], s46 offen offset:2048 lds
  v_mfma_f32_16x16x32_bf16 v[216:219], a[252:255], v[88:91], v[216:219]
  ds_read_b64_tr_b16 a[242:243], v16 offset:25088
  v_fma_f32 v9, v9, v42, v42
  v_mfma_f32_16x16x32_bf16 v[220:223], a[248:251], v[84:87], v[220:223]
  ds_read_b64_tr_b16 a[244:245], v18 offset:28672
  v_fma_f32 v10, v10, v42, v42
  v_mfma_f32_16x16x32_bf16 v[220:223], a[252:255], v[92:95], v[220:223]
  s_waitcnt lgkmcnt(3)
  ds_read_b64_tr_b16 a[246:247], v16 offset:29184
  ds_read_b64_tr_b16 a[248:249], v19 offset:24576
  v_mfma_f32_16x16x32_bf16 v[192:195], a[224:227], v[96:99], v[192:195]
  v_rcp_f32 v7, v7
  v_mfma_f32_16x16x32_bf16 v[192:195], a[228:231], v[104:107], v[192:195]
  ds_read_b64_tr_b16 a[250:251], v17 offset:25088
  buffer_load_dwordx4 v31, s[20:23], s46 offen offset:3072 lds
  v_mfma_f32_16x16x32_bf16 v[196:199], a[224:227], v[100:103], v[196:199]
  s_add_u32 m0, s44, 12288
  ds_read_b64_tr_b16 a[252:253], v19 offset:28672
  ds_read_b64_tr_b16 a[254:255], v17 offset:29184
  v_mfma_f32_16x16x32_bf16 v[196:199], a[228:231], v[108:111], v[196:199]
  v_rcp_f32 v8, v8
  v_mfma_f32_16x16x32_bf16 v[200:203], a[232:235], v[96:99], v[200:203]
  ds_read_b64_tr_b16 a[224:225], v16 offset:32768
  buffer_load_dwordx4 v32, s[20:23], s46 offen offset:0 lds
  v_mfma_f32_16x16x32_bf16 v[200:203], a[236:239], v[104:107], v[200:203]
  ds_read_b64_tr_b16 a[226:227], v18 offset:33280
  ds_read_b64_tr_b16 a[228:229], v16 offset:36864
  v_mfma_f32_16x16x32_bf16 v[204:207], a[232:235], v[100:103], v[204:207]
  v_rcp_f32 v9, v9
  v_mfma_f32_16x16x32_bf16 v[204:207], a[236:239], v[108:111], v[204:207]
  s_waitcnt lgkmcnt(3)
  ds_read_b64_tr_b16 a[230:231], v18 offset:37376
  ds_read_b64_tr_b16 a[232:233], v17 offset:32768
  v_mfma_f32_16x16x32_bf16 v[208:211], a[240:243], v[96:99], v[208:211]
  v_rcp_f32 v10, v10
  v_mfma_f32_16x16x32_bf16 v[208:211], a[244:247], v[104:107], v[208:211]
  ds_read_b64_tr_b16 a[234:235], v19 offset:33280
  buffer_load_dwordx4 v33, s[20:23], s46 offen offset:1024 lds
  v_mfma_f32_16x16x32_bf16 v[212:215], a[240:243], v[100:103], v[212:215]
  s_add_u32 m0, s48, 0
  ds_read_b64_tr_b16 a[236:237], v17 offset:36864
  v_mul_f32 v160, v160, v7
  v_mfma_f32_16x16x32_bf16 v[212:215], a[244:247], v[108:111], v[212:215]
  ds_read_b64_tr_b16 a[238:239], v19 offset:37376
  v_mul_f32 v161, v161, v8
  v_mfma_f32_16x16x32_bf16 v[216:219], a[248:251], v[96:99], v[216:219]
  s_movk_i32 s60, 256
  ds_read_b64_tr_b16 a[240:241], v18 offset:32768
  buffer_load_dwordx4 v36, s[12:15], s60 offen offset:0 lds
  v_mfma_f32_16x16x32_bf16 v[216:219], a[252:255], v[104:107], v[216:219]
  ds_read_b64_tr_b16 a[242:243], v16 offset:33280
  v_mul_f32 v162, v162, v9
  v_mfma_f32_16x16x32_bf16 v[220:223], a[248:251], v[100:103], v[220:223]
  ds_read_b64_tr_b16 a[244:245], v18 offset:36864
  v_mul_f32 v163, v163, v10
  v_mfma_f32_16x16x32_bf16 v[220:223], a[252:255], v[108:111], v[220:223]
  s_waitcnt lgkmcnt(3)
  ds_read_b64_tr_b16 a[246:247], v16 offset:37376
  v_mul_f32 v7, v164, v164
  v_mfma_f32_16x16x32_bf16 v[192:195], a[224:227], v[112:115], v[192:195]
  ds_read_b64_tr_b16 a[248:249], v19 offset:32768
  buffer_load_dwordx4 v37, s[12:15], s60 offen offset:1024 lds
  v_mfma_f32_16x16x32_bf16 v[192:195], a[228:231], v[120:123], v[192:195]
  ds_read_b64_tr_b16 a[250:251], v17 offset:33280
  v_mul_f32 v8, v165, v165
  v_mfma_f32_16x16x32_bf16 v[196:199], a[224:227], v[116:119], v[196:199]
  ds_read_b64_tr_b16 a[252:253], v19 offset:36864
  v_mul_f32 v9, v166, v166
  v_mfma_f32_16x16x32_bf16 v[196:199], a[228:231], v[124:127], v[196:199]
  ds_read_b64_tr_b16 a[254:255], v17 offset:37376
  v_mul_f32 v10, v167, v167
  v_mfma_f32_16x16x32_bf16 v[200:203], a[232:235], v[112:115], v[200:203]
  ds_read_b64_tr_b16 a[224:225], v16 offset:40960
  buffer_load_dwordx4 v38, s[12:15], s60 offen offset:2048 lds
  v_mfma_f32_16x16x32_bf16 v[200:203], a[236:239], v[120:123], v[200:203]
  ds_read_b64_tr_b16 a[226:227], v18 offset:41472
  v_fma_f32 v7, v7, v46, s62
  v_mfma_f32_16x16x32_bf16 v[204:207], a[232:235], v[116:119], v[204:207]
  ds_read_b64_tr_b16 a[228:229], v16 offset:45056
  v_fma_f32 v8, v8, v46, s62
  v_mfma_f32_16x16x32_bf16 v[204:207], a[236:239], v[124:127], v[204:207]
  s_waitcnt lgkmcnt(3)
  ds_read_b64_tr_b16 a[230:231], v18 offset:45568
  v_fma_f32 v9, v9, v46, s62
  v_mfma_f32_16x16x32_bf16 v[208:211], a[240:243], v[112:115], v[208:211]
  ds_read_b64_tr_b16 a[232:233], v17 offset:40960
  buffer_load_dwordx4 v39, s[12:15], s60 offen offset:3072 lds
  v_mfma_f32_16x16x32_bf16 v[208:211], a[244:247], v[120:123], v[208:211]
  s_add_u32 m0, s48, 4096
  ds_read_b64_tr_b16 a[234:235], v19 offset:41472
  v_fma_f32 v10, v10, v46, s62
  v_mfma_f32_16x16x32_bf16 v[212:215], a[240:243], v[116:119], v[212:215]
  s_movk_i32 s60, 384
  ds_read_b64_tr_b16 a[236:237], v17 offset:45056
  v_mul_f32 v7, v164, v7
  v_mfma_f32_16x16x32_bf16 v[212:215], a[244:247], v[124:127], v[212:215]
  ds_read_b64_tr_b16 a[238:239], v19 offset:45568
  buffer_load_dwordx4 v36, s[12:15], s60 offen offset:0 lds
  v_mfma_f32_16x16x32_bf16 v[216:219], a[248:251], v[112:115], v[216:219]
  ds_read_b64_tr_b16 a[240:241], v18 offset:40960
  v_mul_f32 v8, v165, v8
  v_mfma_f32_16x16x32_bf16 v[216:219], a[252:255], v[120:123], v[216:219]
  ds_read_b64_tr_b16 a[242:243], v16 offset:41472
  v_mul_f32 v9, v166, v9
  v_mfma_f32_16x16x32_bf16 v[220:223], a[248:251], v[116:119], v[220:223]
  ds_read_b64_tr_b16 a[244:245], v18 offset:45056
  v_mul_f32 v10, v167, v10
  v_mfma_f32_16x16x32_bf16 v[220:223], a[252:255], v[124:127], v[220:223]
  s_waitcnt lgkmcnt(3)
  ds_read_b64_tr_b16 a[246:247], v16 offset:45568
  buffer_load_dwordx4 v37, s[12:15], s60 offen offset:1024 lds
  v_mfma_f32_16x16x32_bf16 v[192:195], a[224:227], a[192:195], v[192:195]
  ds_read_b64_tr_b16 a[248:249], v19 offset:40960
  ds_read_b64_tr_b16 a[250:251], v17 offset:41472
  v_mfma_f32_16x16x32_bf16 v[192:195], a[228:231], a[200:203], v[192:195]
  v_exp_f32 v7, v7
  v_mfma_f32_16x16x32_bf16 v[196:199], a[224:227], a[196:199], v[196:199]
  ds_read_b64_tr_b16 a[252:253], v19 offset:45056
  ds_read_b64_tr_b16 a[254:255], v17 offset:45568
  v_mfma_f32_16x16x32_bf16 v[196:199], a[228:231], a[204:207], v[196:199]
  v_exp_f32 v8, v8
  v_mfma_f32_16x16x32_bf16 v[200:203], a[232:235], a[192:195], v[200:203]
  ds_read_b64_tr_b16 a[224:225], v16 offset:49152
  buffer_load_dwordx4 v38, s[12:15], s60 offen offset:2048 lds
  v_mfma_f32_16x16x32_bf16 v[200:203], a[236:239], a[200:203], v[200:203]
  ds_read_b64_tr_b16 a[226:227], v18 offset:49664
  ds_read_b64_tr_b16 a[228:229], v16 offset:53248
  v_mfma_f32_16x16x32_bf16 v[204:207], a[232:235], a[196:199], v[204:207]
  v_exp_f32 v9, v9
  v_mfma_f32_16x16x32_bf16 v[204:207], a[236:239], a[204:207], v[204:207]
  s_waitcnt lgkmcnt(3)
  ds_read_b64_tr_b16 a[230:231], v18 offset:53760
  buffer_load_dwordx4 v39, s[12:15], s60 offen offset:3072 lds
  v_mfma_f32_16x16x32_bf16 v[208:211], a[240:243], a[192:195], v[208:211]
  s_add_u32 s100, s57, 0
  ds_read_b64_tr_b16 a[232:233], v17 offset:49152
  ds_read_b64_tr_b16 a[234:235], v19 offset:49664
  v_mfma_f32_16x16x32_bf16 v[208:211], a[244:247], a[200:203], v[208:211]
  v_exp_f32 v10, v10
  v_mfma_f32_16x16x32_bf16 v[212:215], a[240:243], a[196:199], v[212:215]
  ds_read_b64_tr_b16 a[236:237], v17 offset:53248
  v_fma_f32 v7, v7, v43, v43
  v_mfma_f32_16x16x32_bf16 v[212:215], a[244:247], a[204:207], v[212:215]
  ds_read_b64_tr_b16 a[238:239], v19 offset:53760
  buffer_load_dword v47, v34, s[16:19], s100 offen
  v_mfma_f32_16x16x32_bf16 v[216:219], a[248:251], a[192:195], v[216:219]
  ds_read_b64_tr_b16 a[240:241], v18 offset:49152
  v_fma_f32 v8, v8, v43, v43
  v_mfma_f32_16x16x32_bf16 v[216:219], a[252:255], a[200:203], v[216:219]
  ds_read_b64_tr_b16 a[242:243], v16 offset:49664
  v_fma_f32 v9, v9, v43, v43
  v_mfma_f32_16x16x32_bf16 v[220:223], a[248:251], a[196:199], v[220:223]
  ds_read_b64_tr_b16 a[244:245], v18 offset:53248
  v_fma_f32 v10, v10, v43, v43
  v_mfma_f32_16x16x32_bf16 v[220:223], a[252:255], a[204:207], v[220:223]
  s_waitcnt lgkmcnt(3)
  ds_read_b64_tr_b16 a[246:247], v16 offset:53760
  ds_read_b64_tr_b16 a[248:249], v19 offset:49152
  v_mfma_f32_16x16x32_bf16 v[192:195], a[224:227], a[208:211], v[192:195]
  v_rcp_f32 v7, v7
  v_mfma_f32_16x16x32_bf16 v[192:195], a[228:231], a[216:219], v[192:195]
  ds_read_b64_tr_b16 a[250:251], v17 offset:49664
  ds_read_b64_tr_b16 a[252:253], v19 offset:53248
  v_mfma_f32_16x16x32_bf16 v[196:199], a[224:227], a[212:215], v[196:199]
  v_rcp_f32 v8, v8
  v_mfma_f32_16x16x32_bf16 v[196:199], a[228:231], a[220:223], v[196:199]
  ds_read_b64_tr_b16 a[254:255], v17 offset:53760
  v_mfma_f32_16x16x32_bf16 v[200:203], a[232:235], a[208:211], v[200:203]
  v_rcp_f32 v9, v9
  v_mfma_f32_16x16x32_bf16 v[200:203], a[236:239], a[216:219], v[200:203]
  v_rcp_f32 v10, v10
  v_mfma_f32_16x16x32_bf16 v[204:207], a[232:235], a[212:215], v[204:207]
  v_mul_f32 v164, v164, v7
  v_mul_f32 v165, v165, v8
  v_mfma_f32_16x16x32_bf16 v[204:207], a[236:239], a[220:223], v[204:207]
  s_waitcnt vmcnt(9) lgkmcnt(0)
  s_barrier
  v_mfma_f32_16x16x32_bf16 v[208:211], a[240:243], a[208:211], v[208:211]
  ds_read_b64_tr_b16 a[224:225], v12 offset:0
  ds_read_b64_tr_b16 a[226:227], v14 offset:512
  v_mfma_f32_16x16x32_bf16 v[208:211], a[244:247], a[216:219], v[208:211]
  ds_read_b64_tr_b16 a[228:229], v12 offset:4096
  ds_read_b64_tr_b16 a[230:231], v14 offset:4608
  v_mfma_f32_16x16x32_bf16 v[212:215], a[240:243], a[212:215], v[212:215]
  ds_read_b64_tr_b16 a[232:233], v13 offset:0
  ds_read_b64_tr_b16 a[234:235], v15 offset:512
  v_mfma_f32_16x16x32_bf16 v[212:215], a[244:247], a[220:223], v[212:215]
  ds_read_b64_tr_b16 a[236:237], v13 offset:4096
  ds_read_b64_tr_b16 a[238:239], v15 offset:4608
  ds_read_b64_tr_b16 a[240:241], v14 offset:0
  v_mfma_f32_16x16x32_bf16 v[216:219], a[248:251], a[208:211], v[216:219]
  ds_read_b64_tr_b16 a[242:243], v12 offset:512
  v_mul_f32 v166, v166, v9
  v_mfma_f32_16x16x32_bf16 v[216:219], a[252:255], a[216:219], v[216:219]
  ds_read_b64_tr_b16 a[244:245], v14 offset:4096
  v_mul_f32 v167, v167, v10
  v_mfma_f32_16x16x32_bf16 v[220:223], a[248:251], a[212:215], v[220:223]
  ds_read_b64_tr_b16 a[246:247], v12 offset:4608
  v_mul_f32 v7, v168, v168
  v_mfma_f32_16x16x32_bf16 v[220:223], a[252:255], a[220:223], v[220:223]
  v_mul_f32 v8, v169, v169
  v_mul_f32 v9, v170, v170
  s_waitcnt lgkmcnt(8)
  v_mfma_f32_16x16x32_bf16 v[224:227], a[224:227], v[48:51], 0
  s_add_u32 s46, s58, 128
  ds_read_b64_tr_b16 a[248:249], v15 offset:0
  v_mul_f32 v10, v171, v171
  v_mfma_f32_16x16x32_bf16 v[224:227], a[228:231], v[56:59], v[224:227]
  s_add_u32 m0, s44, 65536
  ds_read_b64_tr_b16 a[250:251], v13 offset:512
  buffer_load_dwordx4 v20, s[24:27], s46 offen offset:0 lds
  v_mfma_f32_16x16x32_bf16 v[228:231], a[224:227], v[52:55], 0
  ds_read_b64_tr_b16 a[252:253], v15 offset:4096
  v_fma_f32 v7, v7, v46, s62
  v_mfma_f32_16x16x32_bf16 v[228:231], a[228:231], v[60:63], v[228:231]
  s_waitcnt lgkmcnt(7)
  ds_read_b64_tr_b16 a[254:255], v13 offset:4608
  v_fma_f32 v8, v8, v46, s62
  v_mfma_f32_16x16x32_bf16 v[232:235], a[232:235], v[48:51], 0
  ds_read_b64_tr_b16 a[224:225], v12 offset:8192
  buffer_load_dwordx4 v21, s[24:27], s46 offen offset:1024 lds
  v_mfma_f32_16x16x32_bf16 v[232:235], a[236:239], v[56:59], v[232:235]
  ds_read_b64_tr_b16 a[226:227], v14 offset:8704
  v_fma_f32 v9, v9, v46, s62
  v_mfma_f32_16x16x32_bf16 v[236:239], a[232:235], v[52:55], 0
  ds_read_b64_tr_b16 a[228:229], v12 offset:12288
  v_fma_f32 v10, v10, v46, s62
  v_mfma_f32_16x16x32_bf16 v[236:239], a[236:239], v[60:63], v[236:239]
  s_waitcnt lgkmcnt(3)
  ds_read_b64_tr_b16 a[230:231], v14 offset:12800
  v_mul_f32 v7, v168, v7
  v_mfma_f32_16x16x32_bf16 v[240:243], a[240:243], v[48:51], 0
  ds_read_b64_tr_b16 a[232:233], v13 offset:8192
  buffer_load_dwordx4 v22, s[24:27], s46 offen offset:2048 lds
  v_mfma_f32_16x16x32_bf16 v[240:243], a[244:247], v[56:59], v[240:243]
  ds_read_b64_tr_b16 a[234:235], v15 offset:8704
  v_mul_f32 v8, v169, v8
  v_mfma_f32_16x16x32_bf16 v[244:247], a[240:243], v[52:55], 0
  ds_read_b64_tr_b16 a[236:237], v13 offset:12288
  v_mul_f32 v9, v170, v9
  v_mfma_f32_16x16x32_bf16 v[244:247], a[244:247], v[60:63], v[244:247]
  ds_read_b64_tr_b16 a[238:239], v15 offset:12800
  v_mul_f32 v10, v171, v10
  v_mfma_f32_16x16x32_bf16 v[248:251], a[248:251], v[48:51], 0
  ds_read_b64_tr_b16 a[240:241], v14 offset:8192
  buffer_load_dwordx4 v23, s[24:27], s46 offen offset:3072 lds
  v_mfma_f32_16x16x32_bf16 v[248:251], a[252:255], v[56:59], v[248:251]
  s_add_u32 m0, s44, 69632
  ds_read_b64_tr_b16 a[242:243], v12 offset:8704
  ds_read_b64_tr_b16 a[244:245], v14 offset:12288
  v_mfma_f32_16x16x32_bf16 v[252:255], a[248:251], v[52:55], 0
  v_exp_f32 v7, v7
  v_mfma_f32_16x16x32_bf16 v[252:255], a[252:255], v[60:63], v[252:255]
  s_waitcnt lgkmcnt(3)
  ds_read_b64_tr_b16 a[246:247], v12 offset:12800
  ds_read_b64_tr_b16 a[248:249], v15 offset:8192
  v_mfma_f32_16x16x32_bf16 v[224:227], a[224:227], v[64:67], v[224:227]
  v_exp_f32 v8, v8
  v_mfma_f32_16x16x32_bf16 v[224:227], a[228:231], v[72:75], v[224:227]
  ds_read_b64_tr_b16 a[250:251], v13 offset:8704
  buffer_load_dwordx4 v24, s[24:27], s46 offen offset:0 lds
  v_mfma_f32_16x16x32_bf16 v[228:231], a[224:227], v[68:71], v[228:231]
  ds_read_b64_tr_b16 a[252:253], v15 offset:12288
  ds_read_b64_tr_b16 a[254:255], v13 offset:12800
  v_mfma_f32_16x16x32_bf16 v[228:231], a[228:231], v[76:79], v[228:231]
  v_exp_f32 v9, v9
  v_mfma_f32_16x16x32_bf16 v[232:235], a[232:235], v[64:67], v[232:235]
  ds_read_b64_tr_b16 a[224:225], v12 offset:16384
  buffer_load_dwordx4 v25, s[24:27], s46 offen offset:1024 lds
  v_mfma_f32_16x16x32_bf16 v[232:235], a[236:239], v[72:75], v[232:235]
  ds_read_b64_tr_b16 a[226:227], v14 offset:16896
  ds_read_b64_tr_b16 a[228:229], v12 offset:20480
  v_mfma_f32_16x16x32_bf16 v[236:239], a[232:235], v[68:71], v[236:239]
  v_exp_f32 v10, v10
  v_mfma_f32_16x16x32_bf16 v[236:239], a[236:239], v[76:79], v[236:239]
  s_waitcnt lgkmcnt(3)
  ds_read_b64_tr_b16 a[230:231], v14 offset:20992
  v_fma_f32 v7, v7, v42, v42
  v_mfma_f32_16x16x32_bf16 v[240:243], a[240:243], v[64:67], v[240:243]
  ds_read_b64_tr_b16 a[232:233], v13 offset:16384
  buffer_load_dwordx4 v26, s[24:27], s46 offen offset:2048 lds
  v_mfma_f32_16x16x32_bf16 v[240:243], a[244:247], v[72:75], v[240:243]
  ds_read_b64_tr_b16 a[234:235], v15 offset:16896
  v_fma_f32 v8, v8, v42, v42
  v_mfma_f32_16x16x32_bf16 v[244:247], a[240:243], v[68:71], v[244:247]
  ds_read_b64_tr_b16 a[236:237], v13 offset:20480
  v_fma_f32 v9, v9, v42, v42
  v_mfma_f32_16x16x32_bf16 v[244:247], a[244:247], v[76:79], v[244:247]
  ds_read_b64_tr_b16 a[238:239], v15 offset:20992
  v_fma_f32 v10, v10, v42, v42
  v_mfma_f32_16x16x32_bf16 v[248:251], a[248:251], v[64:67], v[248:251]
  ds_read_b64_tr_b16 a[240:241], v14 offset:16384
  buffer_load_dwordx4 v27, s[24:27], s46 offen offset:3072 lds
  v_mfma_f32_16x16x32_bf16 v[248:251], a[252:255], v[72:75], v[248:251]
  s_add_u32 m0, s44, 73728
  ds_read_b64_tr_b16 a[242:243], v12 offset:16896
  ds_read_b64_tr_b16 a[244:245], v14 offset:20480
  v_mfma_f32_16x16x32_bf16 v[252:255], a[248:251], v[68:71], v[252:255]
  v_rcp_f32 v7, v7
  v_mfma_f32_16x16x32_bf16 v[252:255], a[252:255], v[76:79], v[252:255]
  s_waitcnt lgkmcnt(3)
  ds_read_b64_tr_b16 a[246:247], v12 offset:20992
  ds_read_b64_tr_b16 a[248:249], v15 offset:16384
  v_mfma_f32_16x16x32_bf16 v[224:227], a[224:227], v[80:83], v[224:227]
  v_rcp_f32 v8, v8
  v_mfma_f32_16x16x32_bf16 v[224:227], a[228:231], v[88:91], v[224:227]
  ds_read_b64_tr_b16 a[250:251], v13 offset:16896
  s_waitcnt vmcnt(9)
  ds_read_b128 a[32:35], v40 offset:0
  v_mfma_f32_16x16x32_bf16 v[228:231], a[224:227], v[84:87], v[228:231]
  ds_read_b64_tr_b16 a[252:253], v15 offset:20480
  ds_read_b128 a[36:39], v40 offset:2048
  v_mfma_f32_16x16x32_bf16 v[228:231], a[228:231], v[92:95], v[228:231]
  ds_read_b64_tr_b16 a[254:255], v13 offset:20992
  ds_read_b128 a[40:43], v41 offset:0
  v_mfma_f32_16x16x32_bf16 v[232:235], a[232:235], v[80:83], v[232:235]
  ds_read_b64_tr_b16 a[224:225], v12 offset:24576
  ds_read_b128 a[44:47], v41 offset:2048
  v_mfma_f32_16x16x32_bf16 v[232:235], a[236:239], v[88:91], v[232:235]
  ds_read_b64_tr_b16 a[226:227], v14 offset:25088
  ds_read_b128 a[48:51], v40 offset:4096
  v_mfma_f32_16x16x32_bf16 v[236:239], a[232:235], v[84:87], v[236:239]
  ds_read_b64_tr_b16 a[228:229], v12 offset:28672
  ds_read_b128 a[52:55], v40 offset:6144
  v_mfma_f32_16x16x32_bf16 v[236:239], a[236:239], v[92:95], v[236:239]
  s_waitcnt lgkmcnt(7)
  ds_read_b64_tr_b16 a[230:231], v14 offset:29184
  ds_read_b128 a[56:59], v41 offset:4096
  v_mfma_f32_16x16x32_bf16 v[240:243], a[240:243], v[80:83], v[240:243]
  ds_read_b64_tr_b16 a[232:233], v13 offset:24576
  ds_read_b128 a[60:63], v41 offset:6144
  v_mfma_f32_16x16x32_bf16 v[240:243], a[244:247], v[88:91], v[240:243]
  ds_read_b64_tr_b16 a[234:235], v15 offset:25088
  buffer_load_dwordx4 v28, s[24:27], s46 offen offset:0 lds
  v_mfma_f32_16x16x32_bf16 v[244:247], a[240:243], v[84:87], v[244:247]
  ds_read_b64_tr_b16 a[236:237], v13 offset:28672
  ds_read_b64_tr_b16 a[238:239], v15 offset:29184
  v_mfma_f32_16x16x32_bf16 v[244:247], a[244:247], v[92:95], v[244:247]
  v_rcp_f32 v9, v9
  v_mfma_f32_16x16x32_bf16 v[248:251], a[248:251], v[80:83], v[248:251]
  ds_read_b64_tr_b16 a[240:241], v14 offset:24576
  buffer_load_dwordx4 v29, s[24:27], s46 offen offset:1024 lds
  v_mfma_f32_16x16x32_bf16 v[248:251], a[252:255], v[88:91], v[248:251]
  ds_read_b64_tr_b16 a[242:243], v12 offset:25088
  ds_read_b64_tr_b16 a[244:245], v14 offset:28672
  v_mfma_f32_16x16x32_bf16 v[252:255], a[248:251], v[84:87], v[252:255]
  v_rcp_f32 v10, v10
  v_mfma_f32_16x16x32_bf16 v[252:255], a[252:255], v[92:95], v[252:255]
  s_waitcnt lgkmcnt(3)
  ds_read_b64_tr_b16 a[246:247], v12 offset:29184
  v_mul_f32 v168, v168, v7
  v_mfma_f32_16x16x32_bf16 v[224:227], a[224:227], v[96:99], v[224:227]
  ds_read_b64_tr_b16 a[248:249], v15 offset:24576
  buffer_load_dwordx4 v30, s[24:27], s46 offen offset:2048 lds
  v_mfma_f32_16x16x32_bf16 v[224:227], a[228:231], v[104:107], v[224:227]
  ds_read_b64_tr_b16 a[250:251], v13 offset:25088
  v_mul_f32 v169, v169, v8
  v_mfma_f32_16x16x32_bf16 v[228:231], a[224:227], v[100:103], v[228:231]
  ds_read_b64_tr_b16 a[252:253], v15 offset:28672
  v_mul_f32 v170, v170, v9
  v_mfma_f32_16x16x32_bf16 v[228:231], a[228:231], v[108:111], v[228:231]
  ds_read_b64_tr_b16 a[254:255], v13 offset:29184
  v_mul_f32 v171, v171, v10
  v_mfma_f32_16x16x32_bf16 v[232:235], a[232:235], v[96:99], v[232:235]
  ds_read_b64_tr_b16 a[224:225], v12 offset:32768
  buffer_load_dwordx4 v31, s[24:27], s46 offen offset:3072 lds
  v_mfma_f32_16x16x32_bf16 v[232:235], a[236:239], v[104:107], v[232:235]
  s_add_u32 m0, s44, 77824
  ds_read_b64_tr_b16 a[226:227], v14 offset:33280
  v_mul_f32 v7, v172, v172
  v_mfma_f32_16x16x32_bf16 v[236:239], a[232:235], v[100:103], v[236:239]
  ds_read_b64_tr_b16 a[228:229], v12 offset:36864
  v_mul_f32 v8, v173, v173
  v_mfma_f32_16x16x32_bf16 v[236:239], a[236:239], v[108:111], v[236:239]
  s_waitcnt lgkmcnt(3)
  ds_read_b64_tr_b16 a[230:231], v14 offset:37376
  v_mul_f32 v9, v174, v174
  v_mfma_f32_16x16x32_bf16 v[240:243], a[240:243], v[96:99], v[240:243]
  ds_read_b64_tr_b16 a[232:233], v13 offset:32768
  buffer_load_dwordx4 v32, s[24:27], s46 offen offset:0 lds
  v_mfma_f32_16x16x32_bf16 v[240:243], a[244:247], v[104:107], v[240:243]
  ds_read_b64_tr_b16 a[234:235], v15 offset:33280
  v_mul_f32 v10, v175, v175
  v_mfma_f32_16x16x32_bf16 v[244:247], a[240:243], v[100:103], v[244:247]
  ds_read_b64_tr_b16 a[236:237], v13 offset:36864
  v_fma_f32 v7, v7, v46, s62
  v_mfma_f32_16x16x32_bf16 v[244:247], a[244:247], v[108:111], v[244:247]
  ds_read_b64_tr_b16 a[238:239], v15 offset:37376
  buffer_load_dwordx4 v33, s[24:27], s46 offen offset:1024 lds
  v_mfma_f32_16x16x32_bf16 v[248:251], a[248:251], v[96:99], v[248:251]
  s_add_u32 m0, s48, 0
  ds_read_b64_tr_b16 a[240:241], v14 offset:32768
  v_fma_f32 v8, v8, v46, s62
  v_mfma_f32_16x16x32_bf16 v[248:251], a[252:255], v[104:107], v[248:251]
  s_movk_i32 s60, 512
  ds_read_b64_tr_b16 a[242:243], v12 offset:33280
  v_lshrrev_b32 v3, 3, v0
  v_mfma_f32_16x16x32_bf16 v[252:255], a[248:251], v[100:103], v[252:255]
  s_mul_i32 s49, s4, 917504
  ds_read_b64_tr_b16 a[244:245], v14 offset:36864
  v_mul_u32_u24 v4, 8192, v3
  v_mfma_f32_16x16x32_bf16 v[252:255], a[252:255], v[108:111], v[252:255]
  s_waitcnt lgkmcnt(3)
  ds_read_b64_tr_b16 a[246:247], v12 offset:37376
  buffer_load_dwordx4 v36, s[12:15], s60 offen offset:0 lds
  v_mfma_f32_16x16x32_bf16 v[224:227], a[224:227], v[112:115], v[224:227]
  ds_read_b64_tr_b16 a[248:249], v15 offset:32768
  v_add_u32 v4, s49, v4
  v_mfma_f32_16x16x32_bf16 v[224:227], a[228:231], v[120:123], v[224:227]
  ds_read_b64_tr_b16 a[250:251], v13 offset:33280
  v_bfe_u32 v5, v0, 4, 2
  v_mfma_f32_16x16x32_bf16 v[228:231], a[224:227], v[116:119], v[228:231]
  ds_read_b64_tr_b16 a[252:253], v15 offset:36864
  v_bfe_u32 v6, v0, 1, 2
  v_mfma_f32_16x16x32_bf16 v[228:231], a[228:231], v[124:127], v[228:231]
  ds_read_b64_tr_b16 a[254:255], v13 offset:37376
  buffer_load_dwordx4 v37, s[12:15], s60 offen offset:1024 lds
  v_mfma_f32_16x16x32_bf16 v[232:235], a[232:235], v[112:115], v[232:235]
  ds_read_b64_tr_b16 a[224:225], v12 offset:40960
  v_xor_b32 v5, v5, v6
  v_mfma_f32_16x16x32_bf16 v[232:235], a[236:239], v[120:123], v[232:235]
  ds_read_b64_tr_b16 a[226:227], v14 offset:41472
  v_and_b32 v6, 1, v0
  v_mfma_f32_16x16x32_bf16 v[236:239], a[232:235], v[116:119], v[236:239]
  ds_read_b64_tr_b16 a[228:229], v12 offset:45056
  v_lshlrev_b32 v6, 4, v6
  v_mfma_f32_16x16x32_bf16 v[236:239], a[236:239], v[124:127], v[236:239]
  s_waitcnt lgkmcnt(3)
  ds_read_b64_tr_b16 a[230:231], v14 offset:45568
  buffer_load_dwordx4 v38, s[12:15], s60 offen offset:2048 lds
  v_mfma_f32_16x16x32_bf16 v[240:243], a[240:243], v[112:115], v[240:243]
  ds_read_b64_tr_b16 a[232:233], v13 offset:40960
  v_add_u32 v4, v4, v6
  v_mfma_f32_16x16x32_bf16 v[240:243], a[244:247], v[120:123], v[240:243]
  ds_read_b64_tr_b16 a[234:235], v15 offset:41472
  v_lshl_add_u32 v44, v5, 5, v4
  v_mfma_f32_16x16x32_bf16 v[244:247], a[240:243], v[116:119], v[244:247]
  ds_read_b64_tr_b16 a[236:237], v13 offset:45056
  v_xor_b32 v5, 2, v5
  v_mfma_f32_16x16x32_bf16 v[244:247], a[244:247], v[124:127], v[244:247]
  ds_read_b64_tr_b16 a[238:239], v15 offset:45568
  buffer_load_dwordx4 v39, s[12:15], s60 offen offset:3072 lds
  v_mfma_f32_16x16x32_bf16 v[248:251], a[248:251], v[112:115], v[248:251]
  s_add_u32 m0, s48, 4096
  ds_read_b64_tr_b16 a[240:241], v14 offset:40960
  v_lshl_add_u32 v45, v5, 5, v4
  v_mfma_f32_16x16x32_bf16 v[248:251], a[252:255], v[120:123], v[248:251]
  s_movk_i32 s60, 640
  ds_read_b64_tr_b16 a[242:243], v12 offset:41472
  v_add_u32 v20, 0x0, v44
  v_mfma_f32_16x16x32_bf16 v[252:255], a[248:251], v[116:119], v[252:255]
  ds_read_b64_tr_b16 a[244:245], v14 offset:45056
  buffer_load_dwordx4 v36, s[12:15], s60 offen offset:0 lds
  v_mfma_f32_16x16x32_bf16 v[252:255], a[252:255], v[124:127], v[252:255]
  s_waitcnt lgkmcnt(3)
  ds_read_b64_tr_b16 a[246:247], v12 offset:45568
  v_add_u32 v21, 0xfc00, v45
  v_mfma_f32_16x16x32_bf16 v[224:227], a[224:227], a[192:195], v[224:227]
  ds_read_b64_tr_b16 a[248:249], v15 offset:40960
  v_add_u32 v22, 0x1f800, v44
  v_mfma_f32_16x16x32_bf16 v[224:227], a[228:231], a[200:203], v[224:227]
  ds_read_b64_tr_b16 a[250:251], v13 offset:41472
  v_add_u32 v23, 0x2f400, v45
  v_mfma_f32_16x16x32_bf16 v[228:231], a[224:227], a[196:199], v[228:231]
  ds_read_b64_tr_b16 a[252:253], v15 offset:45056
  buffer_load_dwordx4 v37, s[12:15], s60 offen offset:1024 lds
  v_mfma_f32_16x16x32_bf16 v[228:231], a[228:231], a[204:207], v[228:231]
  ds_read_b64_tr_b16 a[254:255], v13 offset:45568
  v_add_u32 v24, 0x40000, v44
  v_mfma_f32_16x16x32_bf16 v[232:235], a[232:235], a[192:195], v[232:235]
  ds_read_b64_tr_b16 a[224:225], v12 offset:49152
  v_add_u32 v25, 0x4fc00, v45
  v_mfma_f32_16x16x32_bf16 v[232:235], a[236:239], a[200:203], v[232:235]
  ds_read_b64_tr_b16 a[226:227], v14 offset:49664
  v_add_u32 v26, 0x5f800, v44
  v_mfma_f32_16x16x32_bf16 v[236:239], a[232:235], a[196:199], v[236:239]
  ds_read_b64_tr_b16 a[228:229], v12 offset:53248
  buffer_load_dwordx4 v38, s[12:15], s60 offen offset:2048 lds
  v_mfma_f32_16x16x32_bf16 v[236:239], a[236:239], a[204:207], v[236:239]
  s_waitcnt lgkmcnt(3)
  ds_read_b64_tr_b16 a[230:231], v14 offset:53760
  v_add_u32 v27, 0x6f400, v45
  v_mfma_f32_16x16x32_bf16 v[240:243], a[240:243], a[192:195], v[240:243]
  ds_read_b64_tr_b16 a[232:233], v13 offset:49152
  v_add_u32 v28, 0x80000, v44
  v_mfma_f32_16x16x32_bf16 v[240:243], a[244:247], a[200:203], v[240:243]
  ds_read_b64_tr_b16 a[234:235], v15 offset:49664
  v_add_u32 v29, 0x8fc00, v45
  v_mfma_f32_16x16x32_bf16 v[244:247], a[240:243], a[196:199], v[244:247]
  ds_read_b64_tr_b16 a[236:237], v13 offset:53248
  buffer_load_dwordx4 v39, s[12:15], s60 offen offset:3072 lds
  v_mfma_f32_16x16x32_bf16 v[244:247], a[244:247], a[204:207], v[244:247]
  ds_read_b64_tr_b16 a[238:239], v15 offset:53760
  v_add_u32 v30, 0x9f800, v44
  v_mfma_f32_16x16x32_bf16 v[248:251], a[248:251], a[192:195], v[248:251]
  s_add_u32 s100, s57, 128
  ds_read_b64_tr_b16 a[240:241], v14 offset:49152
  v_add_u32 v31, 0xaf400, v45
  v_mfma_f32_16x16x32_bf16 v[248:251], a[252:255], a[200:203], v[248:251]
  ds_read_b64_tr_b16 a[242:243], v12 offset:49664
  v_add_u32 v32, 0xc0000, v44
  v_mfma_f32_16x16x32_bf16 v[252:255], a[248:251], a[196:199], v[252:255]
  ds_read_b64_tr_b16 a[244:245], v14 offset:53248
  buffer_load_dword v47, v34, s[16:19], s100 offen
  v_mfma_f32_16x16x32_bf16 v[252:255], a[252:255], a[204:207], v[252:255]
  s_waitcnt lgkmcnt(3)
  ds_read_b64_tr_b16 a[246:247], v12 offset:53760
  v_add_u32 v33, 0xcfc00, v45
  v_mfma_f32_16x16x32_bf16 v[224:227], a[224:227], a[208:211], v[224:227]
  ds_read_b64_tr_b16 a[248:249], v15 offset:49152
  v_fma_f32 v9, v9, v46, s62
  v_mfma_f32_16x16x32_bf16 v[224:227], a[228:231], a[216:219], v[224:227]
  ds_read_b64_tr_b16 a[250:251], v13 offset:49664
  v_fma_f32 v10, v10, v46, s62
  v_mfma_f32_16x16x32_bf16 v[228:231], a[224:227], a[212:215], v[228:231]
  ds_read_b64_tr_b16 a[252:253], v15 offset:53248
  v_mul_f32 v7, v172, v7
  v_mfma_f32_16x16x32_bf16 v[228:231], a[228:231], a[220:223], v[228:231]
  ds_read_b64_tr_b16 a[254:255], v13 offset:53760
  v_mul_f32 v8, v173, v8
  v_mfma_f32_16x16x32_bf16 v[232:235], a[232:235], a[208:211], v[232:235]
  v_mul_f32 v9, v174, v9
  v_mul_f32 v10, v175, v10
  v_mfma_f32_16x16x32_bf16 v[232:235], a[236:239], a[216:219], v[232:235]
  v_exp_f32 v7, v7
  v_mfma_f32_16x16x32_bf16 v[236:239], a[232:235], a[212:215], v[236:239]
  v_exp_f32 v8, v8
  v_mfma_f32_16x16x32_bf16 v[236:239], a[236:239], a[220:223], v[236:239]
  s_waitcnt vmcnt(9) lgkmcnt(0)
  s_barrier
  v_mfma_f32_16x16x32_bf16 v[240:243], a[240:243], a[208:211], v[240:243]
  ds_read_b64_tr_b16 a[224:225], v16 offset:0
  ds_read_b64_tr_b16 a[226:227], v18 offset:512
  v_mfma_f32_16x16x32_bf16 v[240:243], a[244:247], a[216:219], v[240:243]
  ds_read_b64_tr_b16 a[228:229], v16 offset:4096
  ds_read_b64_tr_b16 a[230:231], v18 offset:4608
  v_mfma_f32_16x16x32_bf16 v[244:247], a[240:243], a[212:215], v[244:247]
  ds_read_b64_tr_b16 a[232:233], v17 offset:0
  ds_read_b64_tr_b16 a[234:235], v19 offset:512
  v_mfma_f32_16x16x32_bf16 v[244:247], a[244:247], a[220:223], v[244:247]
  ds_read_b64_tr_b16 a[236:237], v17 offset:4096
  ds_read_b64_tr_b16 a[238:239], v19 offset:4608
  ds_read_b64_tr_b16 a[240:241], v18 offset:0
  v_mfma_f32_16x16x32_bf16 v[248:251], a[248:251], a[208:211], v[248:251]
  ds_read_b64_tr_b16 a[242:243], v16 offset:512
  v_mfma_f32_16x16x32_bf16 v[248:251], a[252:255], a[216:219], v[248:251]
  ds_read_b64_tr_b16 a[244:245], v18 offset:4096
  v_mfma_f32_16x16x32_bf16 v[252:255], a[248:251], a[212:215], v[252:255]
  ds_read_b64_tr_b16 a[246:247], v16 offset:4608
  v_mfma_f32_16x16x32_bf16 v[252:255], a[252:255], a[220:223], v[252:255]
  v_exp_f32 v9, v9
  s_waitcnt lgkmcnt(8)
  v_mfma_f32_16x16x32_bf16 v[128:131], a[224:227], v[48:51], 0
  s_add_u32 s46, s57, 0
  ds_read_b64_tr_b16 a[248:249], v19 offset:0
  ds_read_b64_tr_b16 a[250:251], v17 offset:512
  v_mfma_f32_16x16x32_bf16 v[128:131], a[228:231], v[56:59], v[128:131]
  s_add_u32 m0, s44, 0
  v_exp_f32 v10, v10
  v_mfma_f32_16x16x32_bf16 v[132:135], a[224:227], v[52:55], 0
  ds_read_b64_tr_b16 a[252:253], v19 offset:4096
  buffer_load_dwordx4 v20, s[16:19], s46 offen offset:0 lds
  v_mfma_f32_16x16x32_bf16 v[132:135], a[228:231], v[60:63], v[132:135]
  s_waitcnt lgkmcnt(7)
  ds_read_b64_tr_b16 a[254:255], v17 offset:4608
  v_fma_f32 v7, v7, v43, v43
  v_mfma_f32_16x16x32_bf16 v[136:139], a[232:235], v[48:51], 0
  ds_read_b64_tr_b16 a[224:225], v16 offset:8192
  v_fma_f32 v8, v8, v43, v43
  v_mfma_f32_16x16x32_bf16 v[136:139], a[236:239], v[56:59], v[136:139]
  ds_read_b64_tr_b16 a[226:227], v18 offset:8704
  buffer_load_dwordx4 v21, s[16:19], s46 offen offset:1024 lds
  v_mfma_f32_16x16x32_bf16 v[140:143], a[232:235], v[52:55], 0
  ds_read_b64_tr_b16 a[228:229], v16 offset:12288
  v_fma_f32 v9, v9, v43, v43
  v_mfma_f32_16x16x32_bf16 v[140:143], a[236:239], v[60:63], v[140:143]
  s_waitcnt lgkmcnt(3)
  ds_read_b64_tr_b16 a[230:231], v18 offset:12800
  v_fma_f32 v10, v10, v43, v43
  v_mfma_f32_16x16x32_bf16 v[144:147], a[240:243], v[48:51], 0
  ds_read_b64_tr_b16 a[232:233], v17 offset:8192
  ds_read_b64_tr_b16 a[234:235], v19 offset:8704
  v_mfma_f32_16x16x32_bf16 v[144:147], a[244:247], v[56:59], v[144:147]
  v_rcp_f32 v7, v7
  v_mfma_f32_16x16x32_bf16 v[148:151], a[240:243], v[52:55], 0
  ds_read_b64_tr_b16 a[236:237], v17 offset:12288
  buffer_load_dwordx4 v22, s[16:19], s46 offen offset:2048 lds
  v_mfma_f32_16x16x32_bf16 v[148:151], a[244:247], v[60:63], v[148:151]
  ds_read_b64_tr_b16 a[238:239], v19 offset:12800
  ds_read_b64_tr_b16 a[240:241], v18 offset:8192
  v_mfma_f32_16x16x32_bf16 v[152:155], a[248:251], v[48:51], 0
  v_rcp_f32 v8, v8
  v_mfma_f32_16x16x32_bf16 v[152:155], a[252:255], v[56:59], v[152:155]
  ds_read_b64_tr_b16 a[242:243], v16 offset:8704
  buffer_load_dwordx4 v23, s[16:19], s46 offen offset:3072 lds
  v_mfma_f32_16x16x32_bf16 v[156:159], a[248:251], v[52:55], 0
  s_add_u32 m0, s44, 4096
  ds_read_b64_tr_b16 a[244:245], v18 offset:12288
  ds_read_b64_tr_b16 a[246:247], v16 offset:12800
  v_mfma_f32_16x16x32_bf16 v[156:159], a[252:255], v[60:63], v[156:159]
  s_waitcnt lgkmcnt(4)
  v_rcp_f32 v9, v9
  v_mfma_f32_16x16x32_bf16 v[128:131], a[224:227], v[64:67], v[128:131]
  ds_read_b64_tr_b16 a[248:249], v19 offset:8192
  ds_read_b64_tr_b16 a[250:251], v17 offset:8704
  v_mfma_f32_16x16x32_bf16 v[128:131], a[228:231], v[72:75], v[128:131]
  v_rcp_f32 v10, v10
  v_mfma_f32_16x16x32_bf16 v[132:135], a[224:227], v[68:71], v[132:135]
  ds_read_b64_tr_b16 a[252:253], v19 offset:12288
  buffer_load_dwordx4 v24, s[16:19], s46 offen offset:0 lds
  v_mfma_f32_16x16x32_bf16 v[132:135], a[228:231], v[76:79], v[132:135]
  ds_read_b64_tr_b16 a[254:255], v17 offset:12800
  v_mul_f32 v172, v172, v7
  v_mfma_f32_16x16x32_bf16 v[136:139], a[232:235], v[64:67], v[136:139]
  ds_read_b64_tr_b16 a[224:225], v16 offset:16384
  v_mul_f32 v173, v173, v8
  v_mfma_f32_16x16x32_bf16 v[136:139], a[236:239], v[72:75], v[136:139]
  ds_read_b64_tr_b16 a[226:227], v18 offset:16896
  buffer_load_dwordx4 v25, s[16:19], s46 offen offset:1024 lds
  v_mfma_f32_16x16x32_bf16 v[140:143], a[232:235], v[68:71], v[140:143]
  ds_read_b64_tr_b16 a[228:229], v16 offset:20480
  v_mul_f32 v174, v174, v9
  v_mfma_f32_16x16x32_bf16 v[140:143], a[236:239], v[76:79], v[140:143]
  s_waitcnt lgkmcnt(3)
  ds_read_b64_tr_b16 a[230:231], v18 offset:20992
  v_mul_f32 v175, v175, v10
  v_mfma_f32_16x16x32_bf16 v[144:147], a[240:243], v[64:67], v[144:147]
  ds_read_b64_tr_b16 a[232:233], v17 offset:16384
  v_mul_f32 v7, v176, v176
  v_mfma_f32_16x16x32_bf16 v[144:147], a[244:247], v[72:75], v[144:147]
  ds_read_b64_tr_b16 a[234:235], v19 offset:16896
  buffer_load_dwordx4 v26, s[16:19], s46 offen offset:2048 lds
  v_mfma_f32_16x16x32_bf16 v[148:151], a[240:243], v[68:71], v[148:151]
  ds_read_b64_tr_b16 a[236:237], v17 offset:20480
  v_mul_f32 v8, v177, v177
  v_mfma_f32_16x16x32_bf16 v[148:151], a[244:247], v[76:79], v[148:151]
  ds_read_b64_tr_b16 a[238:239], v19 offset:20992
  v_mul_f32 v9, v178, v178
  v_mfma_f32_16x16x32_bf16 v[152:155], a[248:251], v[64:67], v[152:155]
  ds_read_b64_tr_b16 a[240:241], v18 offset:16384
  v_mul_f32 v10, v179, v179
  v_mfma_f32_16x16x32_bf16 v[152:155], a[252:255], v[72:75], v[152:155]
  ds_read_b64_tr_b16 a[242:243], v16 offset:16896
  buffer_load_dwordx4 v27, s[16:19], s46 offen offset:3072 lds
  v_mfma_f32_16x16x32_bf16 v[156:159], a[248:251], v[68:71], v[156:159]
  s_add_u32 m0, s44, 8192
  ds_read_b64_tr_b16 a[244:245], v18 offset:20480
  v_fma_f32 v7, v7, v46, s62
  v_mfma_f32_16x16x32_bf16 v[156:159], a[252:255], v[76:79], v[156:159]
  s_waitcnt lgkmcnt(3)
  ds_read_b64_tr_b16 a[246:247], v16 offset:20992
  v_fma_f32 v8, v8, v46, s62
  v_mfma_f32_16x16x32_bf16 v[128:131], a[224:227], v[80:83], v[128:131]
  ds_read_b64_tr_b16 a[248:249], v19 offset:16384
  v_fma_f32 v9, v9, v46, s62
  v_mfma_f32_16x16x32_bf16 v[128:131], a[228:231], v[88:91], v[128:131]
  ds_read_b64_tr_b16 a[250:251], v17 offset:16896
  s_waitcnt vmcnt(9)
  ds_read_b128 a[64:67], v40 offset:0
  v_mfma_f32_16x16x32_bf16 v[132:135], a[224:227], v[84:87], v[132:135]
  ds_read_b64_tr_b16 a[252:253], v19 offset:20480
  ds_read_b128 a[68:71], v40 offset:2048
  v_mfma_f32_16x16x32_bf16 v[132:135], a[228:231], v[92:95], v[132:135]
  ds_read_b64_tr_b16 a[254:255], v17 offset:20992
  ds_read_b128 a[72:75], v41 offset:0
  v_mfma_f32_16x16x32_bf16 v[136:139], a[232:235], v[80:83], v[136:139]
  ds_read_b64_tr_b16 a[224:225], v16 offset:24576
  ds_read_b128 a[76:79], v41 offset:2048
  v_mfma_f32_16x16x32_bf16 v[136:139], a[236:239], v[88:91], v[136:139]
  ds_read_b64_tr_b16 a[226:227], v18 offset:25088
  ds_read_b128 a[80:83], v40 offset:4096
  v_mfma_f32_16x16x32_bf16 v[140:143], a[232:235], v[84:87], v[140:143]
  ds_read_b64_tr_b16 a[228:229], v16 offset:28672
  ds_read_b128 a[84:87], v40 offset:6144
  v_mfma_f32_16x16x32_bf16 v[140:143], a[236:239], v[92:95], v[140:143]
  s_waitcnt lgkmcnt(7)
  ds_read_b64_tr_b16 a[230:231], v18 offset:29184
  ds_read_b128 a[88:91], v41 offset:4096
  v_mfma_f32_16x16x32_bf16 v[144:147], a[240:243], v[80:83], v[144:147]
  ds_read_b64_tr_b16 a[232:233], v17 offset:24576
  ds_read_b128 a[92:95], v41 offset:6144
  v_mfma_f32_16x16x32_bf16 v[144:147], a[244:247], v[88:91], v[144:147]
  ds_read_b64_tr_b16 a[234:235], v19 offset:25088
  buffer_load_dwordx4 v28, s[16:19], s46 offen offset:0 lds
  v_mfma_f32_16x16x32_bf16 v[148:151], a[240:243], v[84:87], v[148:151]
  ds_read_b64_tr_b16 a[236:237], v17 offset:28672
  v_fma_f32 v10, v10, v46, s62
  v_mfma_f32_16x16x32_bf16 v[148:151], a[244:247], v[92:95], v[148:151]
  ds_read_b64_tr_b16 a[238:239], v19 offset:29184
  v_mul_f32 v7, v176, v7
  v_mfma_f32_16x16x32_bf16 v[152:155], a[248:251], v[80:83], v[152:155]
  ds_read_b64_tr_b16 a[240:241], v18 offset:24576
  buffer_load_dwordx4 v29, s[16:19], s46 offen offset:1024 lds
  v_mfma_f32_16x16x32_bf16 v[152:155], a[252:255], v[88:91], v[152:155]
  ds_read_b64_tr_b16 a[242:243], v16 offset:25088
  v_mul_f32 v8, v177, v8
  v_mfma_f32_16x16x32_bf16 v[156:159], a[248:251], v[84:87], v[156:159]
  ds_read_b64_tr_b16 a[244:245], v18 offset:28672
  v_mul_f32 v9, v178, v9
  v_mfma_f32_16x16x32_bf16 v[156:159], a[252:255], v[92:95], v[156:159]
  s_waitcnt lgkmcnt(3)
  ds_read_b64_tr_b16 a[246:247], v16 offset:29184
  v_mul_f32 v10, v179, v10
  v_mfma_f32_16x16x32_bf16 v[128:131], a[224:227], v[96:99], v[128:131]
  ds_read_b64_tr_b16 a[248:249], v19 offset:24576
  buffer_load_dwordx4 v30, s[16:19], s46 offen offset:2048 lds
  v_mfma_f32_16x16x32_bf16 v[128:131], a[228:231], v[104:107], v[128:131]
  ds_read_b64_tr_b16 a[250:251], v17 offset:25088
  ds_read_b64_tr_b16 a[252:253], v19 offset:28672
  v_mfma_f32_16x16x32_bf16 v[132:135], a[224:227], v[100:103], v[132:135]
  v_exp_f32 v7, v7
  v_mfma_f32_16x16x32_bf16 v[132:135], a[228:231], v[108:111], v[132:135]
  ds_read_b64_tr_b16 a[254:255], v17 offset:29184
  ds_read_b64_tr_b16 a[224:225], v16 offset:32768
  v_mfma_f32_16x16x32_bf16 v[136:139], a[232:235], v[96:99], v[136:139]
  v_exp_f32 v8, v8
  v_mfma_f32_16x16x32_bf16 v[136:139], a[236:239], v[104:107], v[136:139]
  ds_read_b64_tr_b16 a[226:227], v18 offset:33280
  buffer_load_dwordx4 v31, s[16:19], s46 offen offset:3072 lds
  v_mfma_f32_16x16x32_bf16 v[140:143], a[232:235], v[100:103], v[140:143]
  s_add_u32 m0, s44, 12288
  ds_read_b64_tr_b16 a[228:229], v16 offset:36864
  ds_read_b64_tr_b16 a[230:231], v18 offset:37376
  v_mfma_f32_16x16x32_bf16 v[140:143], a[236:239], v[108:111], v[140:143]
  s_waitcnt lgkmcnt(4)
  v_exp_f32 v9, v9
  v_mfma_f32_16x16x32_bf16 v[144:147], a[240:243], v[96:99], v[144:147]
  ds_read_b64_tr_b16 a[232:233], v17 offset:32768
  buffer_load_dwordx4 v32, s[16:19], s46 offen offset:0 lds
  v_mfma_f32_16x16x32_bf16 v[144:147], a[244:247], v[104:107], v[144:147]
  ds_read_b64_tr_b16 a[234:235], v19 offset:33280
  ds_read_b64_tr_b16 a[236:237], v17 offset:36864
  v_mfma_f32_16x16x32_bf16 v[148:151], a[240:243], v[100:103], v[148:151]
  v_exp_f32 v10, v10
  v_mfma_f32_16x16x32_bf16 v[148:151], a[244:247], v[108:111], v[148:151]
  ds_read_b64_tr_b16 a[238:239], v19 offset:37376
  v_fma_f32 v7, v7, v42, v42
  v_mfma_f32_16x16x32_bf16 v[152:155], a[248:251], v[96:99], v[152:155]
  ds_read_b64_tr_b16 a[240:241], v18 offset:32768
  buffer_load_dwordx4 v33, s[16:19], s46 offen offset:1024 lds
  v_mfma_f32_16x16x32_bf16 v[152:155], a[252:255], v[104:107], v[152:155]
  s_add_u32 m0, s48, 0
  ds_read_b64_tr_b16 a[242:243], v16 offset:33280
  v_fma_f32 v8, v8, v42, v42
  v_mfma_f32_16x16x32_bf16 v[156:159], a[248:251], v[100:103], v[156:159]
  s_movk_i32 s60, 768
  ds_read_b64_tr_b16 a[244:245], v18 offset:36864
  v_fma_f32 v9, v9, v42, v42
  v_mfma_f32_16x16x32_bf16 v[156:159], a[252:255], v[108:111], v[156:159]
  s_waitcnt lgkmcnt(3)
  ds_read_b64_tr_b16 a[246:247], v16 offset:37376
  v_fma_f32 v10, v10, v42, v42
  v_mfma_f32_16x16x32_bf16 v[128:131], a[224:227], v[112:115], v[128:131]
  ds_read_b64_tr_b16 a[248:249], v19 offset:32768
  buffer_load_dwordx4 v36, s[12:15], s60 offen offset:0 lds
  v_mfma_f32_16x16x32_bf16 v[128:131], a[228:231], v[120:123], v[128:131]
  ds_read_b64_tr_b16 a[250:251], v17 offset:33280
  ds_read_b64_tr_b16 a[252:253], v19 offset:36864
  v_mfma_f32_16x16x32_bf16 v[132:135], a[224:227], v[116:119], v[132:135]
  v_rcp_f32 v7, v7
  v_mfma_f32_16x16x32_bf16 v[132:135], a[228:231], v[124:127], v[132:135]
  ds_read_b64_tr_b16 a[254:255], v17 offset:37376
  ds_read_b64_tr_b16 a[224:225], v16 offset:40960
  v_mfma_f32_16x16x32_bf16 v[136:139], a[232:235], v[112:115], v[136:139]
  v_rcp_f32 v8, v8
  v_mfma_f32_16x16x32_bf16 v[136:139], a[236:239], v[120:123], v[136:139]
  ds_read_b64_tr_b16 a[226:227], v18 offset:41472
  buffer_load_dwordx4 v37, s[12:15], s60 offen offset:1024 lds
  v_mfma_f32_16x16x32_bf16 v[140:143], a[232:235], v[116:119], v[140:143]
  ds_read_b64_tr_b16 a[228:229], v16 offset:45056
  ds_read_b64_tr_b16 a[230:231], v18 offset:45568
  v_mfma_f32_16x16x32_bf16 v[140:143], a[236:239], v[124:127], v[140:143]
  s_waitcnt lgkmcnt(4)
  v_rcp_f32 v9, v9
  v_mfma_f32_16x16x32_bf16 v[144:147], a[240:243], v[112:115], v[144:147]
  ds_read_b64_tr_b16 a[232:233], v17 offset:40960
  buffer_load_dwordx4 v38, s[12:15], s60 offen offset:2048 lds
  v_mfma_f32_16x16x32_bf16 v[144:147], a[244:247], v[120:123], v[144:147]
  ds_read_b64_tr_b16 a[234:235], v19 offset:41472
  ds_read_b64_tr_b16 a[236:237], v17 offset:45056
  v_mfma_f32_16x16x32_bf16 v[148:151], a[240:243], v[116:119], v[148:151]
  v_rcp_f32 v10, v10
  v_mfma_f32_16x16x32_bf16 v[148:151], a[244:247], v[124:127], v[148:151]
  ds_read_b64_tr_b16 a[238:239], v19 offset:45568
  v_mul_f32 v176, v176, v7
  v_mfma_f32_16x16x32_bf16 v[152:155], a[248:251], v[112:115], v[152:155]
  ds_read_b64_tr_b16 a[240:241], v18 offset:40960
  buffer_load_dwordx4 v39, s[12:15], s60 offen offset:3072 lds
  v_mfma_f32_16x16x32_bf16 v[152:155], a[252:255], v[120:123], v[152:155]
  s_add_u32 m0, s48, 4096
  ds_read_b64_tr_b16 a[242:243], v16 offset:41472
  v_mul_f32 v177, v177, v8
  v_mfma_f32_16x16x32_bf16 v[156:159], a[248:251], v[116:119], v[156:159]
  s_movk_i32 s60, 896
  ds_read_b64_tr_b16 a[244:245], v18 offset:45056
  v_mul_f32 v178, v178, v9
  v_mfma_f32_16x16x32_bf16 v[156:159], a[252:255], v[124:127], v[156:159]
  s_waitcnt lgkmcnt(3)
  ds_read_b64_tr_b16 a[246:247], v16 offset:45568
  v_mul_f32 v179, v179, v10
  v_mfma_f32_16x16x32_bf16 v[128:131], a[224:227], a[192:195], v[128:131]
  ds_read_b64_tr_b16 a[248:249], v19 offset:40960
  buffer_load_dwordx4 v36, s[12:15], s60 offen offset:0 lds
  v_mfma_f32_16x16x32_bf16 v[128:131], a[228:231], a[200:203], v[128:131]
  ds_read_b64_tr_b16 a[250:251], v17 offset:41472
  v_mul_f32 v7, v180, v180
  v_mfma_f32_16x16x32_bf16 v[132:135], a[224:227], a[196:199], v[132:135]
  ds_read_b64_tr_b16 a[252:253], v19 offset:45056
  v_mul_f32 v8, v181, v181
  v_mfma_f32_16x16x32_bf16 v[132:135], a[228:231], a[204:207], v[132:135]
  ds_read_b64_tr_b16 a[254:255], v17 offset:45568
  v_mul_f32 v9, v182, v182
  v_mfma_f32_16x16x32_bf16 v[136:139], a[232:235], a[192:195], v[136:139]
  ds_read_b64_tr_b16 a[224:225], v16 offset:49152
  buffer_load_dwordx4 v37, s[12:15], s60 offen offset:1024 lds
  v_mfma_f32_16x16x32_bf16 v[136:139], a[236:239], a[200:203], v[136:139]
  ds_read_b64_tr_b16 a[226:227], v18 offset:49664
  v_mul_f32 v10, v183, v183
  v_mfma_f32_16x16x32_bf16 v[140:143], a[232:235], a[196:199], v[140:143]
  ds_read_b64_tr_b16 a[228:229], v16 offset:53248
  v_fma_f32 v7, v7, v46, s62
  v_mfma_f32_16x16x32_bf16 v[140:143], a[236:239], a[204:207], v[140:143]
  s_waitcnt lgkmcnt(3)
  ds_read_b64_tr_b16 a[230:231], v18 offset:53760
  buffer_load_dwordx4 v38, s[12:15], s60 offen offset:2048 lds
  v_mfma_f32_16x16x32_bf16 v[144:147], a[240:243], a[192:195], v[144:147]
  ds_read_b64_tr_b16 a[232:233], v17 offset:49152
  v_fma_f32 v8, v8, v46, s62
  v_mfma_f32_16x16x32_bf16 v[144:147], a[244:247], a[200:203], v[144:147]
  ds_read_b64_tr_b16 a[234:235], v19 offset:49664
  v_fma_f32 v9, v9, v46, s62
  v_mfma_f32_16x16x32_bf16 v[148:151], a[240:243], a[196:199], v[148:151]
  ds_read_b64_tr_b16 a[236:237], v17 offset:53248
  v_fma_f32 v10, v10, v46, s62
  v_mfma_f32_16x16x32_bf16 v[148:151], a[244:247], a[204:207], v[148:151]
  ds_read_b64_tr_b16 a[238:239], v19 offset:53760
  buffer_load_dwordx4 v39, s[12:15], s60 offen offset:3072 lds
  v_mfma_f32_16x16x32_bf16 v[152:155], a[248:251], a[192:195], v[152:155]
  s_add_u32 s100, s57, 256
  ds_read_b64_tr_b16 a[240:241], v18 offset:49152
  v_mul_f32 v7, v180, v7
  v_mfma_f32_16x16x32_bf16 v[152:155], a[252:255], a[200:203], v[152:155]
  ds_read_b64_tr_b16 a[242:243], v16 offset:49664
  v_mul_f32 v8, v181, v8
  v_mfma_f32_16x16x32_bf16 v[156:159], a[248:251], a[196:199], v[156:159]
  ds_read_b64_tr_b16 a[244:245], v18 offset:53248
  v_mul_f32 v9, v182, v9
  v_mfma_f32_16x16x32_bf16 v[156:159], a[252:255], a[204:207], v[156:159]
  s_waitcnt lgkmcnt(3)
  ds_read_b64_tr_b16 a[246:247], v16 offset:53760
  buffer_load_dword v47, v34, s[16:19], s100 offen
  v_mfma_f32_16x16x32_bf16 v[128:131], a[224:227], a[208:211], v[128:131]
  ds_read_b64_tr_b16 a[248:249], v19 offset:49152
  v_mul_f32 v10, v183, v10
  v_mfma_f32_16x16x32_bf16 v[128:131], a[228:231], a[216:219], v[128:131]
  ds_read_b64_tr_b16 a[250:251], v17 offset:49664
  ds_read_b64_tr_b16 a[252:253], v19 offset:53248
  v_mfma_f32_16x16x32_bf16 v[132:135], a[224:227], a[212:215], v[132:135]
  v_exp_f32 v7, v7
  v_mfma_f32_16x16x32_bf16 v[132:135], a[228:231], a[220:223], v[132:135]
  ds_read_b64_tr_b16 a[254:255], v17 offset:53760
  v_mfma_f32_16x16x32_bf16 v[136:139], a[232:235], a[208:211], v[136:139]
  v_exp_f32 v8, v8
  v_mfma_f32_16x16x32_bf16 v[136:139], a[236:239], a[216:219], v[136:139]
  v_exp_f32 v9, v9
  v_mfma_f32_16x16x32_bf16 v[140:143], a[232:235], a[212:215], v[140:143]
  v_exp_f32 v10, v10
  v_mfma_f32_16x16x32_bf16 v[140:143], a[236:239], a[220:223], v[140:143]
  s_waitcnt vmcnt(9) lgkmcnt(0)
  s_barrier
  v_mfma_f32_16x16x32_bf16 v[144:147], a[240:243], a[208:211], v[144:147]
  ds_read_b64_tr_b16 a[224:225], v12 offset:0
  ds_read_b64_tr_b16 a[226:227], v14 offset:512
  v_mfma_f32_16x16x32_bf16 v[144:147], a[244:247], a[216:219], v[144:147]
  ds_read_b64_tr_b16 a[228:229], v12 offset:4096
  ds_read_b64_tr_b16 a[230:231], v14 offset:4608
  v_mfma_f32_16x16x32_bf16 v[148:151], a[240:243], a[212:215], v[148:151]
  ds_read_b64_tr_b16 a[232:233], v13 offset:0
  ds_read_b64_tr_b16 a[234:235], v15 offset:512
  v_mfma_f32_16x16x32_bf16 v[148:151], a[244:247], a[220:223], v[148:151]
  ds_read_b64_tr_b16 a[236:237], v13 offset:4096
  ds_read_b64_tr_b16 a[238:239], v15 offset:4608
  ds_read_b64_tr_b16 a[240:241], v14 offset:0
  v_mfma_f32_16x16x32_bf16 v[152:155], a[248:251], a[208:211], v[152:155]
  ds_read_b64_tr_b16 a[242:243], v12 offset:512
  v_fma_f32 v7, v7, v43, v43
  v_mfma_f32_16x16x32_bf16 v[152:155], a[252:255], a[216:219], v[152:155]
  ds_read_b64_tr_b16 a[244:245], v14 offset:4096
  v_fma_f32 v8, v8, v43, v43
  v_mfma_f32_16x16x32_bf16 v[156:159], a[248:251], a[212:215], v[156:159]
  ds_read_b64_tr_b16 a[246:247], v12 offset:4608
  v_fma_f32 v9, v9, v43, v43
  v_mfma_f32_16x16x32_bf16 v[156:159], a[252:255], a[220:223], v[156:159]
  v_fma_f32 v10, v10, v43, v43
  v_rcp_f32 v7, v7
  v_rcp_f32 v8, v8
  v_rcp_f32 v9, v9
  v_rcp_f32 v10, v10
  v_mul_f32 v180, v180, v7
  v_mul_f32 v181, v181, v8
  v_mul_f32 v182, v182, v9
  v_mul_f32 v183, v183, v10
  v_mul_f32 v7, v184, v184
  v_mul_f32 v8, v185, v185
  v_mul_f32 v9, v186, v186
  v_mul_f32 v10, v187, v187
  v_fma_f32 v7, v7, v46, s62
  v_fma_f32 v8, v8, v46, s62
  v_fma_f32 v9, v9, v46, s62
  v_fma_f32 v10, v10, v46, s62
  v_mul_f32 v7, v184, v7
  v_mul_f32 v8, v185, v8
  v_mul_f32 v9, v186, v9
  v_mul_f32 v10, v187, v10
  v_exp_f32 v7, v7
  v_exp_f32 v8, v8
  v_exp_f32 v9, v9
  v_exp_f32 v10, v10
  v_fma_f32 v7, v7, v42, v42
  v_fma_f32 v8, v8, v42, v42
  v_fma_f32 v9, v9, v42, v42
  v_fma_f32 v10, v10, v42, v42
  v_rcp_f32 v7, v7
  v_rcp_f32 v8, v8
  v_rcp_f32 v9, v9
  v_rcp_f32 v10, v10
  v_mul_f32 v184, v184, v7
  v_mul_f32 v185, v185, v8
  v_mul_f32 v186, v186, v9
  v_mul_f32 v187, v187, v10
  v_mul_f32 v7, v188, v188
  v_mul_f32 v8, v189, v189
  v_mul_f32 v9, v190, v190
  v_mul_f32 v10, v191, v191
  v_fma_f32 v7, v7, v46, s62
  v_fma_f32 v8, v8, v46, s62
  v_fma_f32 v9, v9, v46, s62
  v_fma_f32 v10, v10, v46, s62
  v_mul_f32 v7, v188, v7
  v_mul_f32 v8, v189, v8
  v_mul_f32 v9, v190, v9
  v_mul_f32 v10, v191, v10
  v_exp_f32 v7, v7
  v_exp_f32 v8, v8
  v_exp_f32 v9, v9
  v_exp_f32 v10, v10
  v_fma_f32 v7, v7, v43, v43
  v_fma_f32 v8, v8, v43, v43
  v_fma_f32 v9, v9, v43, v43
  v_fma_f32 v10, v10, v43, v43
  v_rcp_f32 v7, v7
  v_rcp_f32 v8, v8
  v_rcp_f32 v9, v9
  v_rcp_f32 v10, v10
  v_mul_f32 v188, v188, v7
  v_mul_f32 v189, v189, v8
  v_mul_f32 v190, v190, v9
  v_mul_f32 v191, v191, v10
  s_add_u32 s63, s54, 0
  v_mul_f32 v160, v160, v192
  v_mul_f32 v161, v161, v193
  v_mul_f32 v162, v162, v194
  v_mul_f32 v163, v163, v195
  v_cvt_pk_bf16_f32 v192, v160, v161
  v_cvt_pk_bf16_f32 v193, v162, v163
  v_mul_f32 v168, v168, v200
  v_mul_f32 v169, v169, v201
  v_mul_f32 v170, v170, v202
  v_mul_f32 v171, v171, v203
  v_cvt_pk_bf16_f32 v194, v168, v169
  v_cvt_pk_bf16_f32 v195, v170, v171
  buffer_store_dwordx4 v[192:195], v1, s[36:39], s63 offen offset:0 sc1
  v_mul_f32 v164, v164, v196
  v_mul_f32 v165, v165, v197
  v_mul_f32 v166, v166, v198
  v_mul_f32 v167, v167, v199
  v_cvt_pk_bf16_f32 v196, v164, v165
  v_cvt_pk_bf16_f32 v197, v166, v167
  v_mul_f32 v172, v172, v204
  v_mul_f32 v173, v173, v205
  v_mul_f32 v174, v174, v206
  v_mul_f32 v175, v175, v207
  v_cvt_pk_bf16_f32 v198, v172, v173
  v_cvt_pk_bf16_f32 v199, v174, v175
  buffer_store_dwordx4 v[196:199], v1, s[36:39], s63 offen offset:1024 sc1
  v_mul_f32 v176, v176, v208
  v_mul_f32 v177, v177, v209
  v_mul_f32 v178, v178, v210
  v_mul_f32 v179, v179, v211
  v_cvt_pk_bf16_f32 v208, v176, v177
  v_cvt_pk_bf16_f32 v209, v178, v179
  v_mul_f32 v184, v184, v216
  v_mul_f32 v185, v185, v217
  v_mul_f32 v186, v186, v218
  v_mul_f32 v187, v187, v219
  v_cvt_pk_bf16_f32 v210, v184, v185
  v_cvt_pk_bf16_f32 v211, v186, v187
  buffer_store_dwordx4 v[208:211], v1, s[36:39], s63 offen offset:2048 sc1
  v_mul_f32 v180, v180, v212
  v_mul_f32 v181, v181, v213
  v_mul_f32 v182, v182, v214
  v_mul_f32 v183, v183, v215
  v_cvt_pk_bf16_f32 v212, v180, v181
  v_cvt_pk_bf16_f32 v213, v182, v183
  v_mul_f32 v188, v188, v220
  v_mul_f32 v189, v189, v221
  v_mul_f32 v190, v190, v222
  v_mul_f32 v191, v191, v223
  v_cvt_pk_bf16_f32 v214, v188, v189
  v_cvt_pk_bf16_f32 v215, v190, v191
  buffer_store_dwordx4 v[212:215], v1, s[36:39], s63 offen offset:3072 sc1
  s_waitcnt lgkmcnt(8)
  v_mfma_f32_16x16x32_bf16 v[160:163], a[224:227], v[48:51], 0
  s_add_u32 s46, s57, 128
  ds_read_b64_tr_b16 a[248:249], v15 offset:0
  v_mul_f32 v7, v224, v224
  v_mfma_f32_16x16x32_bf16 v[160:163], a[228:231], v[56:59], v[160:163]
  s_add_u32 m0, s44, 65536
  ds_read_b64_tr_b16 a[250:251], v13 offset:512
  buffer_load_dwordx4 v20, s[16:19], s46 offen offset:0 lds
  v_mfma_f32_16x16x32_bf16 v[164:167], a[224:227], v[52:55], 0
  ds_read_b64_tr_b16 a[252:253], v15 offset:4096
  v_mul_f32 v8, v225, v225
  v_mfma_f32_16x16x32_bf16 v[164:167], a[228:231], v[60:63], v[164:167]
  s_waitcnt lgkmcnt(7)
  ds_read_b64_tr_b16 a[254:255], v13 offset:4608
  v_mul_f32 v9, v226, v226
  v_mfma_f32_16x16x32_bf16 v[168:171], a[232:235], v[48:51], 0
  ds_read_b64_tr_b16 a[224:225], v12 offset:8192
  buffer_load_dwordx4 v21, s[16:19], s46 offen offset:1024 lds
  v_mfma_f32_16x16x32_bf16 v[168:171], a[236:239], v[56:59], v[168:171]
  ds_read_b64_tr_b16 a[226:227], v14 offset:8704
  v_mul_f32 v10, v227, v227
  v_mfma_f32_16x16x32_bf16 v[172:175], a[232:235], v[52:55], 0
  ds_read_b64_tr_b16 a[228:229], v12 offset:12288
  v_fma_f32 v7, v7, v46, s62
  v_mfma_f32_16x16x32_bf16 v[172:175], a[236:239], v[60:63], v[172:175]
  s_waitcnt lgkmcnt(3)
  ds_read_b64_tr_b16 a[230:231], v14 offset:12800
  v_fma_f32 v8, v8, v46, s62
  v_mfma_f32_16x16x32_bf16 v[176:179], a[240:243], v[48:51], 0
  ds_read_b64_tr_b16 a[232:233], v13 offset:8192
  buffer_load_dwordx4 v22, s[16:19], s46 offen offset:2048 lds
  v_mfma_f32_16x16x32_bf16 v[176:179], a[244:247], v[56:59], v[176:179]
  ds_read_b64_tr_b16 a[234:235], v15 offset:8704
  v_fma_f32 v9, v9, v46, s62
  v_mfma_f32_16x16x32_bf16 v[180:183], a[240:243], v[52:55], 0
  ds_read_b64_tr_b16 a[236:237], v13 offset:12288
  v_fma_f32 v10, v10, v46, s62
  v_mfma_f32_16x16x32_bf16 v[180:183], a[244:247], v[60:63], v[180:183]
  ds_read_b64_tr_b16 a[238:239], v15 offset:12800
  v_mul_f32 v7, v224, v7
  v_mfma_f32_16x16x32_bf16 v[184:187], a[248:251], v[48:51], 0
  ds_read_b64_tr_b16 a[240:241], v14 offset:8192
  buffer_load_dwordx4 v23, s[16:19], s46 offen offset:3072 lds
  v_mfma_f32_16x16x32_bf16 v[184:187], a[252:255], v[56:59], v[184:187]
  s_add_u32 m0, s44, 69632
  ds_read_b64_tr_b16 a[242:243], v12 offset:8704
  v_mul_f32 v8, v225, v8
  v_mfma_f32_16x16x32_bf16 v[188:191], a[248:251], v[52:55], 0
  ds_read_b64_tr_b16 a[244:245], v14 offset:12288
  v_mul_f32 v9, v226, v9
  v_mfma_f32_16x16x32_bf16 v[188:191], a[252:255], v[60:63], v[188:191]
  s_waitcnt lgkmcnt(3)
  ds_read_b64_tr_b16 a[246:247], v12 offset:12800
  v_mul_f32 v10, v227, v10
  v_mfma_f32_16x16x32_bf16 v[160:163], a[224:227], v[64:67], v[160:163]
  ds_read_b64_tr_b16 a[248:249], v15 offset:8192
  buffer_load_dwordx4 v24, s[16:19], s46 offen offset:0 lds
  v_mfma_f32_16x16x32_bf16 v[160:163], a[228:231], v[72:75], v[160:163]
  ds_read_b64_tr_b16 a[250:251], v13 offset:8704
  ds_read_b64_tr_b16 a[252:253], v15 offset:12288
  v_mfma_f32_16x16x32_bf16 v[164:167], a[224:227], v[68:71], v[164:167]
  v_exp_f32 v7, v7
  v_mfma_f32_16x16x32_bf16 v[164:167], a[228:231], v[76:79], v[164:167]
  ds_read_b64_tr_b16 a[254:255], v13 offset:12800
  buffer_load_dwordx4 v25, s[16:19], s46 offen offset:1024 lds
  v_mfma_f32_16x16x32_bf16 v[168:171], a[232:235], v[64:67], v[168:171]
  ds_read_b64_tr_b16 a[224:225], v12 offset:16384
  ds_read_b64_tr_b16 a[226:227], v14 offset:16896
  v_mfma_f32_16x16x32_bf16 v[168:171], a[236:239], v[72:75], v[168:171]
  v_exp_f32 v8, v8
  v_mfma_f32_16x16x32_bf16 v[172:175], a[232:235], v[68:71], v[172:175]
  ds_read_b64_tr_b16 a[228:229], v12 offset:20480
  ds_read_b64_tr_b16 a[230:231], v14 offset:20992
  v_mfma_f32_16x16x32_bf16 v[172:175], a[236:239], v[76:79], v[172:175]
  s_waitcnt lgkmcnt(4)
  v_exp_f32 v9, v9
  v_mfma_f32_16x16x32_bf16 v[176:179], a[240:243], v[64:67], v[176:179]
  ds_read_b64_tr_b16 a[232:233], v13 offset:16384
  buffer_load_dwordx4 v26, s[16:19], s46 offen offset:2048 lds
  v_mfma_f32_16x16x32_bf16 v[176:179], a[244:247], v[72:75], v[176:179]
  ds_read_b64_tr_b16 a[234:235], v15 offset:16896
  ds_read_b64_tr_b16 a[236:237], v13 offset:20480
  v_mfma_f32_16x16x32_bf16 v[180:183], a[240:243], v[68:71], v[180:183]
  v_exp_f32 v10, v10
  v_mfma_f32_16x16x32_bf16 v[180:183], a[244:247], v[76:79], v[180:183]
  ds_read_b64_tr_b16 a[238:239], v15 offset:20992
  buffer_load_dwordx4 v27, s[16:19], s46 offen offset:3072 lds
  v_mfma_f32_16x16x32_bf16 v[184:187], a[248:251], v[64:67], v[184:187]
  s_add_u32 m0, s44, 73728
  ds_read_b64_tr_b16 a[240:241], v14 offset:16384
  v_fma_f32 v7, v7, v42, v42
  v_mfma_f32_16x16x32_bf16 v[184:187], a[252:255], v[72:75], v[184:187]
  ds_read_b64_tr_b16 a[242:243], v12 offset:16896
  v_fma_f32 v8, v8, v42, v42
  v_mfma_f32_16x16x32_bf16 v[188:191], a[248:251], v[68:71], v[188:191]
  ds_read_b64_tr_b16 a[244:245], v14 offset:20480
  v_fma_f32 v9, v9, v42, v42
  v_mfma_f32_16x16x32_bf16 v[188:191], a[252:255], v[76:79], v[188:191]
  s_waitcnt lgkmcnt(3)
  ds_read_b64_tr_b16 a[246:247], v12 offset:20992
  buffer_load_dwordx4 v28, s[16:19], s46 offen offset:0 lds
  v_mfma_f32_16x16x32_bf16 v[160:163], a[224:227], v[80:83], v[160:163]
  ds_read_b64_tr_b16 a[248:249], v15 offset:16384
  v_fma_f32 v10, v10, v42, v42
  v_mfma_f32_16x16x32_bf16 v[160:163], a[228:231], v[88:91], v[160:163]
  ds_read_b64_tr_b16 a[250:251], v13 offset:16896
  s_waitcnt vmcnt(14)
  ds_read_b128 a[96:99], v40 offset:0
  v_mfma_f32_16x16x32_bf16 v[164:167], a[224:227], v[84:87], v[164:167]
  ds_read_b64_tr_b16 a[252:253], v15 offset:20480
  ds_read_b128 a[100:103], v40 offset:2048
  v_mfma_f32_16x16x32_bf16 v[164:167], a[228:231], v[92:95], v[164:167]
  ds_read_b64_tr_b16 a[254:255], v13 offset:20992
  ds_read_b128 a[104:107], v41 offset:0
  v_mfma_f32_16x16x32_bf16 v[168:171], a[232:235], v[80:83], v[168:171]
  ds_read_b64_tr_b16 a[224:225], v12 offset:24576
  ds_read_b128 a[108:111], v41 offset:2048
  v_mfma_f32_16x16x32_bf16 v[168:171], a[236:239], v[88:91], v[168:171]
  ds_read_b64_tr_b16 a[226:227], v14 offset:25088
  ds_read_b128 a[112:115], v40 offset:4096
  v_mfma_f32_16x16x32_bf16 v[172:175], a[232:235], v[84:87], v[172:175]
  ds_read_b64_tr_b16 a[228:229], v12 offset:28672
  ds_read_b128 a[116:119], v40 offset:6144
  v_mfma_f32_16x16x32_bf16 v[172:175], a[236:239], v[92:95], v[172:175]
  s_waitcnt lgkmcnt(7)
  ds_read_b64_tr_b16 a[230:231], v14 offset:29184
  ds_read_b128 a[120:123], v41 offset:4096
  v_mfma_f32_16x16x32_bf16 v[176:179], a[240:243], v[80:83], v[176:179]
  ds_read_b64_tr_b16 a[232:233], v13 offset:24576
  ds_read_b128 a[124:127], v41 offset:6144
  v_mfma_f32_16x16x32_bf16 v[176:179], a[244:247], v[88:91], v[176:179]
  ds_read_b64_tr_b16 a[234:235], v15 offset:25088
  buffer_load_dwordx4 v29, s[16:19], s46 offen offset:1024 lds
  v_mfma_f32_16x16x32_bf16 v[180:183], a[240:243], v[84:87], v[180:183]
  ds_read_b64_tr_b16 a[236:237], v13 offset:28672
  ds_read_b64_tr_b16 a[238:239], v15 offset:29184
  v_mfma_f32_16x16x32_bf16 v[180:183], a[244:247], v[92:95], v[180:183]
  v_rcp_f32 v7, v7
  v_mfma_f32_16x16x32_bf16 v[184:187], a[248:251], v[80:83], v[184:187]
  ds_read_b64_tr_b16 a[240:241], v14 offset:24576
  buffer_load_dwordx4 v30, s[16:19], s46 offen offset:2048 lds
  v_mfma_f32_16x16x32_bf16 v[184:187], a[252:255], v[88:91], v[184:187]
  ds_read_b64_tr_b16 a[242:243], v12 offset:25088
  ds_read_b64_tr_b16 a[244:245], v14 offset:28672
  v_mfma_f32_16x16x32_bf16 v[188:191], a[248:251], v[84:87], v[188:191]
  v_rcp_f32 v8, v8
  v_mfma_f32_16x16x32_bf16 v[188:191], a[252:255], v[92:95], v[188:191]
  s_waitcnt lgkmcnt(3)
  ds_read_b64_tr_b16 a[246:247], v12 offset:29184
  ds_read_b64_tr_b16 a[248:249], v15 offset:24576
  v_mfma_f32_16x16x32_bf16 v[160:163], a[224:227], v[96:99], v[160:163]
  v_rcp_f32 v9, v9
  v_mfma_f32_16x16x32_bf16 v[160:163], a[228:231], v[104:107], v[160:163]
  ds_read_b64_tr_b16 a[250:251], v13 offset:25088
  buffer_load_dwordx4 v31, s[16:19], s46 offen offset:3072 lds
  v_mfma_f32_16x16x32_bf16 v[164:167], a[224:227], v[100:103], v[164:167]
  s_add_u32 m0, s44, 77824
  ds_read_b64_tr_b16 a[252:253], v15 offset:28672
  ds_read_b64_tr_b16 a[254:255], v13 offset:29184
  v_mfma_f32_16x16x32_bf16 v[164:167], a[228:231], v[108:111], v[164:167]
  v_rcp_f32 v10, v10
  v_mfma_f32_16x16x32_bf16 v[168:171], a[232:235], v[96:99], v[168:171]
  ds_read_b64_tr_b16 a[224:225], v12 offset:32768
  buffer_load_dwordx4 v32, s[16:19], s46 offen offset:0 lds
  v_mfma_f32_16x16x32_bf16 v[168:171], a[236:239], v[104:107], v[168:171]
  ds_read_b64_tr_b16 a[226:227], v14 offset:33280
  v_mul_f32 v224, v224, v7
  v_mfma_f32_16x16x32_bf16 v[172:175], a[232:235], v[100:103], v[172:175]
  ds_read_b64_tr_b16 a[228:229], v12 offset:36864
  v_mul_f32 v225, v225, v8
  v_mfma_f32_16x16x32_bf16 v[172:175], a[236:239], v[108:111], v[172:175]
  s_waitcnt lgkmcnt(3)
  ds_read_b64_tr_b16 a[230:231], v14 offset:37376
  v_mul_f32 v226, v226, v9
  v_mfma_f32_16x16x32_bf16 v[176:179], a[240:243], v[96:99], v[176:179]
  ds_read_b64_tr_b16 a[232:233], v13 offset:32768
  buffer_load_dwordx4 v33, s[16:19], s46 offen offset:1024 lds
  v_mfma_f32_16x16x32_bf16 v[176:179], a[244:247], v[104:107], v[176:179]
  s_add_u32 m0, s48, 0
  ds_read_b64_tr_b16 a[234:235], v15 offset:33280
  v_mul_f32 v227, v227, v10
  v_mfma_f32_16x16x32_bf16 v[180:183], a[240:243], v[100:103], v[180:183]
  s_movk_i32 s60, 1024
  ds_read_b64_tr_b16 a[236:237], v13 offset:36864
  v_mul_f32 v7, v228, v228
  v_mfma_f32_16x16x32_bf16 v[180:183], a[244:247], v[108:111], v[180:183]
  ds_read_b64_tr_b16 a[238:239], v15 offset:37376
  v_mul_f32 v8, v229, v229
  v_mfma_f32_16x16x32_bf16 v[184:187], a[248:251], v[96:99], v[184:187]
  ds_read_b64_tr_b16 a[240:241], v14 offset:32768
  buffer_load_dwordx4 v36, s[12:15], s60 offen offset:0 lds
  v_mfma_f32_16x16x32_bf16 v[184:187], a[252:255], v[104:107], v[184:187]
  ds_read_b64_tr_b16 a[242:243], v12 offset:33280
  v_mul_f32 v9, v230, v230
  v_mfma_f32_16x16x32_bf16 v[188:191], a[248:251], v[100:103], v[188:191]
  ds_read_b64_tr_b16 a[244:245], v14 offset:36864
  v_mul_f32 v10, v231, v231
  v_mfma_f32_16x16x32_bf16 v[188:191], a[252:255], v[108:111], v[188:191]
  s_waitcnt lgkmcnt(3)
  ds_read_b64_tr_b16 a[246:247], v12 offset:37376
  v_fma_f32 v7, v7, v46, s62
  v_mfma_f32_16x16x32_bf16 v[160:163], a[224:227], v[112:115], v[160:163]
  ds_read_b64_tr_b16 a[248:249], v15 offset:32768
  buffer_load_dwordx4 v37, s[12:15], s60 offen offset:1024 lds
  v_mfma_f32_16x16x32_bf16 v[160:163], a[228:231], v[120:123], v[160:163]
  ds_read_b64_tr_b16 a[250:251], v13 offset:33280
  v_fma_f32 v8, v8, v46, s62
  v_mfma_f32_16x16x32_bf16 v[164:167], a[224:227], v[116:119], v[164:167]
  ds_read_b64_tr_b16 a[252:253], v15 offset:36864
  v_fma_f32 v9, v9, v46, s62
  v_mfma_f32_16x16x32_bf16 v[164:167], a[228:231], v[124:127], v[164:167]
  ds_read_b64_tr_b16 a[254:255], v13 offset:37376
  buffer_load_dwordx4 v38, s[12:15], s60 offen offset:2048 lds
  v_mfma_f32_16x16x32_bf16 v[168:171], a[232:235], v[112:115], v[168:171]
  ds_read_b64_tr_b16 a[224:225], v12 offset:40960
  v_fma_f32 v10, v10, v46, s62
  v_mfma_f32_16x16x32_bf16 v[168:171], a[236:239], v[120:123], v[168:171]
  ds_read_b64_tr_b16 a[226:227], v14 offset:41472
  v_mul_f32 v7, v228, v7
  v_mfma_f32_16x16x32_bf16 v[172:175], a[232:235], v[116:119], v[172:175]
  ds_read_b64_tr_b16 a[228:229], v12 offset:45056
  v_mul_f32 v8, v229, v8
  v_mfma_f32_16x16x32_bf16 v[172:175], a[236:239], v[124:127], v[172:175]
  s_waitcnt lgkmcnt(3)
  ds_read_b64_tr_b16 a[230:231], v14 offset:45568
  buffer_load_dwordx4 v39, s[12:15], s60 offen offset:3072 lds
  v_mfma_f32_16x16x32_bf16 v[176:179], a[240:243], v[112:115], v[176:179]
  s_add_u32 m0, s48, 4096
  ds_read_b64_tr_b16 a[232:233], v13 offset:40960
  v_mul_f32 v9, v230, v9
  v_mfma_f32_16x16x32_bf16 v[176:179], a[244:247], v[120:123], v[176:179]
  s_movk_i32 s60, 1152
  ds_read_b64_tr_b16 a[234:235], v15 offset:41472
  v_mul_f32 v10, v231, v10
  v_mfma_f32_16x16x32_bf16 v[180:183], a[240:243], v[116:119], v[180:183]
  ds_read_b64_tr_b16 a[236:237], v13 offset:45056
  ds_read_b64_tr_b16 a[238:239], v15 offset:45568
  v_mfma_f32_16x16x32_bf16 v[180:183], a[244:247], v[124:127], v[180:183]
  v_exp_f32 v7, v7
  v_mfma_f32_16x16x32_bf16 v[184:187], a[248:251], v[112:115], v[184:187]
  ds_read_b64_tr_b16 a[240:241], v14 offset:40960
  buffer_load_dwordx4 v36, s[12:15], s60 offen offset:0 lds
  v_mfma_f32_16x16x32_bf16 v[184:187], a[252:255], v[120:123], v[184:187]
  ds_read_b64_tr_b16 a[242:243], v12 offset:41472
  ds_read_b64_tr_b16 a[244:245], v14 offset:45056
  v_mfma_f32_16x16x32_bf16 v[188:191], a[248:251], v[116:119], v[188:191]
  v_exp_f32 v8, v8
  v_mfma_f32_16x16x32_bf16 v[188:191], a[252:255], v[124:127], v[188:191]
  s_waitcnt lgkmcnt(3)
  ds_read_b64_tr_b16 a[246:247], v12 offset:45568
  buffer_load_dwordx4 v37, s[12:15], s60 offen offset:1024 lds
  v_mfma_f32_16x16x32_bf16 v[160:163], a[224:227], a[192:195], v[160:163]
  ds_read_b64_tr_b16 a[248:249], v15 offset:40960
  ds_read_b64_tr_b16 a[250:251], v13 offset:41472
  v_mfma_f32_16x16x32_bf16 v[160:163], a[228:231], a[200:203], v[160:163]
  v_exp_f32 v9, v9
  v_mfma_f32_16x16x32_bf16 v[164:167], a[224:227], a[196:199], v[164:167]
  ds_read_b64_tr_b16 a[252:253], v15 offset:45056
  ds_read_b64_tr_b16 a[254:255], v13 offset:45568
  v_mfma_f32_16x16x32_bf16 v[164:167], a[228:231], a[204:207], v[164:167]
  v_exp_f32 v10, v10
  v_mfma_f32_16x16x32_bf16 v[168:171], a[232:235], a[192:195], v[168:171]
  ds_read_b64_tr_b16 a[224:225], v12 offset:49152
  buffer_load_dwordx4 v38, s[12:15], s60 offen offset:2048 lds
  v_mfma_f32_16x16x32_bf16 v[168:171], a[236:239], a[200:203], v[168:171]
  ds_read_b64_tr_b16 a[226:227], v14 offset:49664
  v_fma_f32 v7, v7, v43, v43
  v_mfma_f32_16x16x32_bf16 v[172:175], a[232:235], a[196:199], v[172:175]
  ds_read_b64_tr_b16 a[228:229], v12 offset:53248
  v_fma_f32 v8, v8, v43, v43
  v_mfma_f32_16x16x32_bf16 v[172:175], a[236:239], a[204:207], v[172:175]
  s_waitcnt lgkmcnt(3)
  ds_read_b64_tr_b16 a[230:231], v14 offset:53760
  buffer_load_dwordx4 v39, s[12:15], s60 offen offset:3072 lds
  v_mfma_f32_16x16x32_bf16 v[176:179], a[240:243], a[192:195], v[176:179]
  s_add_u32 s100, s57, 384
  ds_read_b64_tr_b16 a[232:233], v13 offset:49152
  v_fma_f32 v9, v9, v43, v43
  v_mfma_f32_16x16x32_bf16 v[176:179], a[244:247], a[200:203], v[176:179]
  ds_read_b64_tr_b16 a[234:235], v15 offset:49664
  v_fma_f32 v10, v10, v43, v43
  v_mfma_f32_16x16x32_bf16 v[180:183], a[240:243], a[196:199], v[180:183]
  ds_read_b64_tr_b16 a[236:237], v13 offset:53248
  ds_read_b64_tr_b16 a[238:239], v15 offset:53760
  v_mfma_f32_16x16x32_bf16 v[180:183], a[244:247], a[204:207], v[180:183]
  v_rcp_f32 v7, v7
  v_mfma_f32_16x16x32_bf16 v[184:187], a[248:251], a[192:195], v[184:187]
  ds_read_b64_tr_b16 a[240:241], v14 offset:49152
  buffer_load_dword v47, v34, s[16:19], s100 offen
  v_mfma_f32_16x16x32_bf16 v[184:187], a[252:255], a[200:203], v[184:187]
  ds_read_b64_tr_b16 a[242:243], v12 offset:49664
  ds_read_b64_tr_b16 a[244:245], v14 offset:53248
  v_mfma_f32_16x16x32_bf16 v[188:191], a[248:251], a[196:199], v[188:191]
  v_rcp_f32 v8, v8
  v_mfma_f32_16x16x32_bf16 v[188:191], a[252:255], a[204:207], v[188:191]
  s_waitcnt lgkmcnt(3)
  ds_read_b64_tr_b16 a[246:247], v12 offset:53760
  ds_read_b64_tr_b16 a[248:249], v15 offset:49152
  v_mfma_f32_16x16x32_bf16 v[160:163], a[224:227], a[208:211], v[160:163]
  v_rcp_f32 v9, v9
  v_mfma_f32_16x16x32_bf16 v[192:195], a[228:231], a[216:219], v[160:163]
  ds_read_b64_tr_b16 a[250:251], v13 offset:49664
  ds_read_b64_tr_b16 a[252:253], v15 offset:53248
  v_mfma_f32_16x16x32_bf16 v[164:167], a[224:227], a[212:215], v[164:167]
  v_rcp_f32 v10, v10
  v_mfma_f32_16x16x32_bf16 v[196:199], a[228:231], a[220:223], v[164:167]
  ds_read_b64_tr_b16 a[254:255], v13 offset:53760
  v_mul_f32 v228, v228, v7
  v_mfma_f32_16x16x32_bf16 v[168:171], a[232:235], a[208:211], v[168:171]
  v_mul_f32 v229, v229, v8
  v_mul_f32 v230, v230, v9
  v_mfma_f32_16x16x32_bf16 v[200:203], a[236:239], a[216:219], v[168:171]
  v_mul_f32 v231, v231, v10
  v_mul_f32 v7, v232, v232
  v_mfma_f32_16x16x32_bf16 v[172:175], a[232:235], a[212:215], v[172:175]
  v_mul_f32 v8, v233, v233
  v_mul_f32 v9, v234, v234
  v_mfma_f32_16x16x32_bf16 v[204:207], a[236:239], a[220:223], v[172:175]
  s_waitcnt vmcnt(9) lgkmcnt(0)
  s_barrier
  v_mfma_f32_16x16x32_bf16 v[176:179], a[240:243], a[208:211], v[176:179]
  ds_read_b64_tr_b16 a[224:225], v16 offset:0
  ds_read_b64_tr_b16 a[226:227], v18 offset:512
  v_mfma_f32_16x16x32_bf16 v[208:211], a[244:247], a[216:219], v[176:179]
  ds_read_b64_tr_b16 a[228:229], v16 offset:4096
  ds_read_b64_tr_b16 a[230:231], v18 offset:4608
  v_mfma_f32_16x16x32_bf16 v[180:183], a[240:243], a[212:215], v[180:183]
  ds_read_b64_tr_b16 a[232:233], v17 offset:0
  ds_read_b64_tr_b16 a[234:235], v19 offset:512
  v_mfma_f32_16x16x32_bf16 v[212:215], a[244:247], a[220:223], v[180:183]
  ds_read_b64_tr_b16 a[236:237], v17 offset:4096
  ds_read_b64_tr_b16 a[238:239], v19 offset:4608
  ds_read_b64_tr_b16 a[240:241], v18 offset:0
  v_mfma_f32_16x16x32_bf16 v[184:187], a[248:251], a[208:211], v[184:187]
  ds_read_b64_tr_b16 a[242:243], v16 offset:512
  v_mul_f32 v10, v235, v235
  v_mfma_f32_16x16x32_bf16 v[216:219], a[252:255], a[216:219], v[184:187]
  ds_read_b64_tr_b16 a[244:245], v18 offset:4096
  v_fma_f32 v7, v7, v46, s62
  v_mfma_f32_16x16x32_bf16 v[188:191], a[248:251], a[212:215], v[188:191]
  ds_read_b64_tr_b16 a[246:247], v16 offset:4608
  v_fma_f32 v8, v8, v46, s62
  v_mfma_f32_16x16x32_bf16 v[220:223], a[252:255], a[220:223], v[188:191]
  v_fma_f32 v9, v9, v46, s62
  v_fma_f32 v10, v10, v46, s62
  s_waitcnt lgkmcnt(8)
  v_mfma_f32_16x16x32_bf16 v[160:163], a[224:227], v[48:51], 0
  s_add_u32 s46, s57, 256
  ds_read_b64_tr_b16 a[248:249], v19 offset:0
  v_mul_f32 v7, v232, v7
  v_mfma_f32_16x16x32_bf16 v[160:163], a[228:231], v[56:59], v[160:163]
  s_add_u32 m0, s44, 0
  ds_read_b64_tr_b16 a[250:251], v17 offset:512
  buffer_load_dwordx4 v20, s[16:19], s46 offen offset:0 lds
  v_mfma_f32_16x16x32_bf16 v[164:167], a[224:227], v[52:55], 0
  s_add_u32 s56, s53, 0
  ds_read_b64_tr_b16 a[252:253], v19 offset:4096
  v_cvt_pk_bf16_f32 v192, v192, v193
  v_mfma_f32_16x16x32_bf16 v[164:167], a[228:231], v[60:63], v[164:167]
  s_waitcnt lgkmcnt(7)
  ds_read_b64_tr_b16 a[254:255], v17 offset:4608
  v_cvt_pk_bf16_f32 v193, v194, v195
  v_mfma_f32_16x16x32_bf16 v[168:171], a[232:235], v[48:51], 0
  ds_read_b64_tr_b16 a[224:225], v16 offset:8192
  buffer_load_dwordx4 v21, s[16:19], s46 offen offset:1024 lds
  v_mfma_f32_16x16x32_bf16 v[168:171], a[236:239], v[56:59], v[168:171]
  ds_read_b64_tr_b16 a[226:227], v18 offset:8704
  v_cvt_pk_bf16_f32 v194, v200, v201
  v_mfma_f32_16x16x32_bf16 v[172:175], a[232:235], v[52:55], 0
  ds_read_b64_tr_b16 a[228:229], v16 offset:12288
  v_cvt_pk_bf16_f32 v195, v202, v203
  v_mfma_f32_16x16x32_bf16 v[172:175], a[236:239], v[60:63], v[172:175]
  s_waitcnt lgkmcnt(3)
  ds_read_b64_tr_b16 a[230:231], v18 offset:12800
  v_cvt_pk_bf16_f32 v196, v196, v197
  v_mfma_f32_16x16x32_bf16 v[176:179], a[240:243], v[48:51], 0
  ds_read_b64_tr_b16 a[232:233], v17 offset:8192
  buffer_load_dwordx4 v22, s[16:19], s46 offen offset:2048 lds
  v_mfma_f32_16x16x32_bf16 v[176:179], a[244:247], v[56:59], v[176:179]
  ds_read_b64_tr_b16 a[234:235], v19 offset:8704
  v_cvt_pk_bf16_f32 v197, v198, v199
  v_mfma_f32_16x16x32_bf16 v[180:183], a[240:243], v[52:55], 0
  ds_read_b64_tr_b16 a[236:237], v17 offset:12288
  v_cvt_pk_bf16_f32 v198, v204, v205
  v_mfma_f32_16x16x32_bf16 v[180:183], a[244:247], v[60:63], v[180:183]
  ds_read_b64_tr_b16 a[238:239], v19 offset:12800
  v_cvt_pk_bf16_f32 v199, v206, v207
  v_mfma_f32_16x16x32_bf16 v[184:187], a[248:251], v[48:51], 0
  ds_read_b64_tr_b16 a[240:241], v18 offset:8192
  buffer_load_dwordx4 v23, s[16:19], s46 offen offset:3072 lds
  v_mfma_f32_16x16x32_bf16 v[184:187], a[252:255], v[56:59], v[184:187]
  s_add_u32 m0, s44, 4096
  ds_read_b64_tr_b16 a[242:243], v16 offset:8704
  v_cvt_pk_bf16_f32 v208, v208, v209
  v_mfma_f32_16x16x32_bf16 v[188:191], a[248:251], v[52:55], 0
  ds_read_b64_tr_b16 a[244:245], v18 offset:12288
  v_cvt_pk_bf16_f32 v209, v210, v211
  v_mfma_f32_16x16x32_bf16 v[188:191], a[252:255], v[60:63], v[188:191]
  s_waitcnt lgkmcnt(3)
  ds_read_b64_tr_b16 a[246:247], v16 offset:12800
  v_cvt_pk_bf16_f32 v210, v216, v217
  v_mfma_f32_16x16x32_bf16 v[160:163], a[224:227], v[64:67], v[160:163]
  ds_read_b64_tr_b16 a[248:249], v19 offset:8192
  buffer_load_dwordx4 v24, s[16:19], s46 offen offset:0 lds
  v_mfma_f32_16x16x32_bf16 v[160:163], a[228:231], v[72:75], v[160:163]
  ds_read_b64_tr_b16 a[250:251], v17 offset:8704
  v_cvt_pk_bf16_f32 v211, v218, v219
  v_mfma_f32_16x16x32_bf16 v[164:167], a[224:227], v[68:71], v[164:167]
  ds_read_b64_tr_b16 a[252:253], v19 offset:12288
  v_cvt_pk_bf16_f32 v212, v212, v213
  v_mfma_f32_16x16x32_bf16 v[164:167], a[228:231], v[76:79], v[164:167]
  ds_read_b64_tr_b16 a[254:255], v17 offset:12800
  buffer_load_dwordx4 v25, s[16:19], s46 offen offset:1024 lds
  v_mfma_f32_16x16x32_bf16 v[168:171], a[232:235], v[64:67], v[168:171]
  ds_read_b64_tr_b16 a[224:225], v16 offset:16384
  v_cvt_pk_bf16_f32 v213, v214, v215
  v_mfma_f32_16x16x32_bf16 v[168:171], a[236:239], v[72:75], v[168:171]
  ds_read_b64_tr_b16 a[226:227], v18 offset:16896
  v_cvt_pk_bf16_f32 v214, v220, v221
  v_mfma_f32_16x16x32_bf16 v[172:175], a[232:235], v[68:71], v[172:175]
  ds_read_b64_tr_b16 a[228:229], v16 offset:20480
  v_cvt_pk_bf16_f32 v215, v222, v223
  v_mfma_f32_16x16x32_bf16 v[172:175], a[236:239], v[76:79], v[172:175]
  s_waitcnt lgkmcnt(3)
  ds_read_b64_tr_b16 a[230:231], v18 offset:20992
  buffer_load_dwordx4 v26, s[16:19], s46 offen offset:2048 lds
  v_mfma_f32_16x16x32_bf16 v[176:179], a[240:243], v[64:67], v[176:179]
  ds_read_b64_tr_b16 a[232:233], v17 offset:16384
  v_mul_f32 v8, v233, v8
  v_mfma_f32_16x16x32_bf16 v[176:179], a[244:247], v[72:75], v[176:179]
  ds_read_b64_tr_b16 a[234:235], v19 offset:16896
  v_mul_f32 v9, v234, v9
  v_mfma_f32_16x16x32_bf16 v[180:183], a[240:243], v[68:71], v[180:183]
  ds_read_b64_tr_b16 a[236:237], v17 offset:20480
  v_mul_f32 v10, v235, v10
  v_mfma_f32_16x16x32_bf16 v[180:183], a[244:247], v[76:79], v[180:183]
  ds_read_b64_tr_b16 a[238:239], v19 offset:20992
  buffer_load_dwordx4 v27, s[16:19], s46 offen offset:3072 lds
  v_mfma_f32_16x16x32_bf16 v[184:187], a[248:251], v[64:67], v[184:187]
  s_add_u32 m0, s44, 8192
  ds_read_b64_tr_b16 a[240:241], v18 offset:16384
  ds_read_b64_tr_b16 a[242:243], v16 offset:16896
  v_mfma_f32_16x16x32_bf16 v[184:187], a[252:255], v[72:75], v[184:187]
  v_exp_f32 v7, v7
  v_mfma_f32_16x16x32_bf16 v[188:191], a[248:251], v[68:71], v[188:191]
  ds_read_b64_tr_b16 a[244:245], v18 offset:20480
  ds_read_b64_tr_b16 a[246:247], v16 offset:20992
  v_mfma_f32_16x16x32_bf16 v[188:191], a[252:255], v[76:79], v[188:191]
  s_waitcnt lgkmcnt(4)
  v_exp_f32 v8, v8
  v_mfma_f32_16x16x32_bf16 v[160:163], a[224:227], v[80:83], v[160:163]
  ds_read_b64_tr_b16 a[248:249], v19 offset:16384
  buffer_load_dwordx4 v28, s[16:19], s46 offen offset:0 lds
  v_mfma_f32_16x16x32_bf16 v[160:163], a[228:231], v[88:91], v[160:163]
  ds_read_b64_tr_b16 a[250:251], v17 offset:16896
  s_waitcnt vmcnt(10)
  ds_read_b128 a[128:131], v40 offset:0
  v_mfma_f32_16x16x32_bf16 v[164:167], a[224:227], v[84:87], v[164:167]
  ds_read_b64_tr_b16 a[252:253], v19 offset:20480
  ds_read_b128 a[132:135], v40 offset:2048
  v_mfma_f32_16x16x32_bf16 v[164:167], a[228:231], v[92:95], v[164:167]
  ds_read_b64_tr_b16 a[254:255], v17 offset:20992
  ds_read_b128 a[136:139], v41 offset:0
  v_mfma_f32_16x16x32_bf16 v[168:171], a[232:235], v[80:83], v[168:171]
  ds_read_b64_tr_b16 a[224:225], v16 offset:24576
  ds_read_b128 a[140:143], v41 offset:2048
  v_mfma_f32_16x16x32_bf16 v[168:171], a[236:239], v[88:91], v[168:171]
  ds_read_b64_tr_b16 a[226:227], v18 offset:25088
  ds_read_b128 a[144:147], v40 offset:4096
  v_mfma_f32_16x16x32_bf16 v[172:175], a[232:235], v[84:87], v[172:175]
  ds_read_b64_tr_b16 a[228:229], v16 offset:28672
  ds_read_b128 a[148:151], v40 offset:6144
  v_mfma_f32_16x16x32_bf16 v[172:175], a[236:239], v[92:95], v[172:175]
  s_waitcnt lgkmcnt(7)
  ds_read_b64_tr_b16 a[230:231], v18 offset:29184
  ds_read_b128 a[152:155], v41 offset:4096
  v_mfma_f32_16x16x32_bf16 v[176:179], a[240:243], v[80:83], v[176:179]
  ds_read_b64_tr_b16 a[232:233], v17 offset:24576
  ds_read_b128 a[156:159], v41 offset:6144
  v_mfma_f32_16x16x32_bf16 v[176:179], a[244:247], v[88:91], v[176:179]
  ds_read_b64_tr_b16 a[234:235], v19 offset:25088
  buffer_load_dwordx4 v29, s[16:19], s46 offen offset:1024 lds
  v_mfma_f32_16x16x32_bf16 v[180:183], a[240:243], v[84:87], v[180:183]
  ds_read_b64_tr_b16 a[236:237], v17 offset:28672
  ds_read_b64_tr_b16 a[238:239], v19 offset:29184
  v_mfma_f32_16x16x32_bf16 v[180:183], a[244:247], v[92:95], v[180:183]
  v_exp_f32 v9, v9
  v_mfma_f32_16x16x32_bf16 v[184:187], a[248:251], v[80:83], v[184:187]
  ds_read_b64_tr_b16 a[240:241], v18 offset:24576
  buffer_load_dwordx4 v30, s[16:19], s46 offen offset:2048 lds
  v_mfma_f32_16x16x32_bf16 v[184:187], a[252:255], v[88:91], v[184:187]
  ds_read_b64_tr_b16 a[242:243], v16 offset:25088
  ds_read_b64_tr_b16 a[244:245], v18 offset:28672
  v_mfma_f32_16x16x32_bf16 v[188:191], a[248:251], v[84:87], v[188:191]
  v_exp_f32 v10, v10
  v_mfma_f32_16x16x32_bf16 v[188:191], a[252:255], v[92:95], v[188:191]
  s_waitcnt lgkmcnt(3)
  ds_read_b64_tr_b16 a[246:247], v16 offset:29184
  v_fma_f32 v7, v7, v42, v42
  v_mfma_f32_16x16x32_bf16 v[160:163], a[224:227], v[96:99], v[160:163]
  ds_read_b64_tr_b16 a[248:249], v19 offset:24576
  buffer_load_dwordx4 v31, s[16:19], s46 offen offset:3072 lds
  v_mfma_f32_16x16x32_bf16 v[160:163], a[228:231], v[104:107], v[160:163]
  s_add_u32 m0, s44, 12288
  ds_read_b64_tr_b16 a[250:251], v17 offset:25088
  v_fma_f32 v8, v8, v42, v42
  v_mfma_f32_16x16x32_bf16 v[164:167], a[224:227], v[100:103], v[164:167]
  ds_read_b64_tr_b16 a[252:253], v19 offset:28672
  v_fma_f32 v9, v9, v42, v42
  v_mfma_f32_16x16x32_bf16 v[164:167], a[228:231], v[108:111], v[164:167]
  ds_read_b64_tr_b16 a[254:255], v17 offset:29184
  v_fma_f32 v10, v10, v42, v42
  v_mfma_f32_16x16x32_bf16 v[168:171], a[232:235], v[96:99], v[168:171]
  ds_read_b64_tr_b16 a[224:225], v16 offset:32768
  buffer_load_dwordx4 v32, s[16:19], s46 offen offset:0 lds
  v_mfma_f32_16x16x32_bf16 v[168:171], a[236:239], v[104:107], v[168:171]
  ds_read_b64_tr_b16 a[226:227], v18 offset:33280
  ds_read_b64_tr_b16 a[228:229], v16 offset:36864
  v_mfma_f32_16x16x32_bf16 v[172:175], a[232:235], v[100:103], v[172:175]
  v_rcp_f32 v7, v7
  v_mfma_f32_16x16x32_bf16 v[172:175], a[236:239], v[108:111], v[172:175]
  s_waitcnt lgkmcnt(3)
  ds_read_b64_tr_b16 a[230:231], v18 offset:37376
  ds_read_b64_tr_b16 a[232:233], v17 offset:32768
  v_mfma_f32_16x16x32_bf16 v[176:179], a[240:243], v[96:99], v[176:179]
  v_rcp_f32 v8, v8
  v_mfma_f32_16x16x32_bf16 v[176:179], a[244:247], v[104:107], v[176:179]
  ds_read_b64_tr_b16 a[234:235], v19 offset:33280
  buffer_load_dwordx4 v33, s[16:19], s46 offen offset:1024 lds
  v_mfma_f32_16x16x32_bf16 v[180:183], a[240:243], v[100:103], v[180:183]
  s_add_u32 m0, s48, 0
  ds_read_b64_tr_b16 a[236:237], v17 offset:36864
  ds_read_b64_tr_b16 a[238:239], v19 offset:37376
  v_mfma_f32_16x16x32_bf16 v[180:183], a[244:247], v[108:111], v[180:183]
  s_movk_i32 s60, 1280
  ds_read_b64_tr_b16 a[240:241], v18 offset:32768
  v_mfma_f32_16x16x32_bf16 v[184:187], a[248:251], v[96:99], v[184:187]
  v_rcp_f32 v9, v9
  v_mfma_f32_16x16x32_bf16 v[184:187], a[252:255], v[104:107], v[184:187]
  ds_read_b64_tr_b16 a[242:243], v16 offset:33280
  buffer_store_dwordx4 v[192:195], v1, s[36:39], s56 offen offset:0 sc1
  v_mfma_f32_16x16x32_bf16 v[188:191], a[248:251], v[100:103], v[188:191]
  ds_read_b64_tr_b16 a[244:245], v18 offset:36864
  ds_read_b64_tr_b16 a[246:247], v16 offset:37376
  v_mfma_f32_16x16x32_bf16 v[188:191], a[252:255], v[108:111], v[188:191]
  s_waitcnt lgkmcnt(4)
  v_rcp_f32 v10, v10
  v_mfma_f32_16x16x32_bf16 v[160:163], a[224:227], v[112:115], v[160:163]
  ds_read_b64_tr_b16 a[248:249], v19 offset:32768
  buffer_store_dwordx4 v[196:199], v2, s[36:39], s56 offen offset:0 sc1
  v_mfma_f32_16x16x32_bf16 v[160:163], a[228:231], v[120:123], v[160:163]
  ds_read_b64_tr_b16 a[250:251], v17 offset:33280
  v_mul_f32 v232, v232, v7
  v_mfma_f32_16x16x32_bf16 v[164:167], a[224:227], v[116:119], v[164:167]
  ds_read_b64_tr_b16 a[252:253], v19 offset:36864
  v_mul_f32 v233, v233, v8
  v_mfma_f32_16x16x32_bf16 v[164:167], a[228:231], v[124:127], v[164:167]
  ds_read_b64_tr_b16 a[254:255], v17 offset:37376
  v_mul_f32 v234, v234, v9
  v_mfma_f32_16x16x32_bf16 v[168:171], a[232:235], v[112:115], v[168:171]
  ds_read_b64_tr_b16 a[224:225], v16 offset:40960
  buffer_store_dwordx4 v[208:211], v1, s[36:39], s56 offen offset:1024 sc1
  v_mfma_f32_16x16x32_bf16 v[168:171], a[236:239], v[120:123], v[168:171]
  ds_read_b64_tr_b16 a[226:227], v18 offset:41472
  v_mul_f32 v235, v235, v10
  v_mfma_f32_16x16x32_bf16 v[172:175], a[232:235], v[116:119], v[172:175]
  ds_read_b64_tr_b16 a[228:229], v16 offset:45056
  v_mul_f32 v7, v236, v236
  v_mfma_f32_16x16x32_bf16 v[172:175], a[236:239], v[124:127], v[172:175]
  s_waitcnt lgkmcnt(3)
  ds_read_b64_tr_b16 a[230:231], v18 offset:45568
  v_mul_f32 v8, v237, v237
  v_mfma_f32_16x16x32_bf16 v[176:179], a[240:243], v[112:115], v[176:179]
  ds_read_b64_tr_b16 a[232:233], v17 offset:40960
  buffer_store_dwordx4 v[212:215], v2, s[36:39], s56 offen offset:1024 sc1
  v_mfma_f32_16x16x32_bf16 v[176:179], a[244:247], v[120:123], v[176:179]
  ds_read_b64_tr_b16 a[234:235], v19 offset:41472
  v_mul_f32 v9, v238, v238
  v_mfma_f32_16x16x32_bf16 v[180:183], a[240:243], v[116:119], v[180:183]
  ds_read_b64_tr_b16 a[236:237], v17 offset:45056
  v_mul_f32 v10, v239, v239
  v_mfma_f32_16x16x32_bf16 v[180:183], a[244:247], v[124:127], v[180:183]
  ds_read_b64_tr_b16 a[238:239], v19 offset:45568
  v_fma_f32 v7, v7, v46, s62
  v_mfma_f32_16x16x32_bf16 v[184:187], a[248:251], v[112:115], v[184:187]
  ds_read_b64_tr_b16 a[240:241], v18 offset:40960
  buffer_load_dwordx4 v36, s[12:15], s60 offen offset:0 lds
  v_mfma_f32_16x16x32_bf16 v[184:187], a[252:255], v[120:123], v[184:187]
  ds_read_b64_tr_b16 a[242:243], v16 offset:41472
  v_fma_f32 v8, v8, v46, s62
  v_mfma_f32_16x16x32_bf16 v[188:191], a[248:251], v[116:119], v[188:191]
  ds_read_b64_tr_b16 a[244:245], v18 offset:45056
  v_fma_f32 v9, v9, v46, s62
  v_mfma_f32_16x16x32_bf16 v[188:191], a[252:255], v[124:127], v[188:191]
  s_waitcnt lgkmcnt(3)
  ds_read_b64_tr_b16 a[246:247], v16 offset:45568
  buffer_load_dwordx4 v37, s[12:15], s60 offen offset:1024 lds
  v_mfma_f32_16x16x32_bf16 v[160:163], a[224:227], a[192:195], v[160:163]
  ds_read_b64_tr_b16 a[248:249], v19 offset:40960
  v_fma_f32 v10, v10, v46, s62
  v_mfma_f32_16x16x32_bf16 v[160:163], a[228:231], a[200:203], v[160:163]
  ds_read_b64_tr_b16 a[250:251], v17 offset:41472
  v_mul_f32 v7, v236, v7
  v_mfma_f32_16x16x32_bf16 v[164:167], a[224:227], a[196:199], v[164:167]
  ds_read_b64_tr_b16 a[252:253], v19 offset:45056
  v_mul_f32 v8, v237, v8
  v_mfma_f32_16x16x32_bf16 v[164:167], a[228:231], a[204:207], v[164:167]
  ds_read_b64_tr_b16 a[254:255], v17 offset:45568
  buffer_load_dwordx4 v38, s[12:15], s60 offen offset:2048 lds
  v_mfma_f32_16x16x32_bf16 v[168:171], a[232:235], a[192:195], v[168:171]
  ds_read_b64_tr_b16 a[224:225], v16 offset:49152
  v_mul_f32 v9, v238, v9
  v_mfma_f32_16x16x32_bf16 v[168:171], a[236:239], a[200:203], v[168:171]
  ds_read_b64_tr_b16 a[226:227], v18 offset:49664
  v_mul_f32 v10, v239, v10
  v_mfma_f32_16x16x32_bf16 v[172:175], a[232:235], a[196:199], v[172:175]
  ds_read_b64_tr_b16 a[228:229], v16 offset:53248
  ds_read_b64_tr_b16 a[230:231], v18 offset:53760
  v_mfma_f32_16x16x32_bf16 v[172:175], a[236:239], a[204:207], v[172:175]
  s_waitcnt lgkmcnt(4)
  v_exp_f32 v7, v7
  v_mfma_f32_16x16x32_bf16 v[176:179], a[240:243], a[192:195], v[176:179]
  ds_read_b64_tr_b16 a[232:233], v17 offset:49152
  buffer_load_dwordx4 v39, s[12:15], s60 offen offset:3072 lds
  v_mfma_f32_16x16x32_bf16 v[176:179], a[244:247], a[200:203], v[176:179]
  s_add_u32 m0, s48, 4096
  ds_read_b64_tr_b16 a[234:235], v19 offset:49664
  ds_read_b64_tr_b16 a[236:237], v17 offset:53248
  v_mfma_f32_16x16x32_bf16 v[180:183], a[240:243], a[196:199], v[180:183]
  s_movk_i32 s60, 1408
  v_exp_f32 v8, v8
  v_mfma_f32_16x16x32_bf16 v[180:183], a[244:247], a[204:207], v[180:183]
  ds_read_b64_tr_b16 a[238:239], v19 offset:53760
  buffer_load_dwordx4 v36, s[12:15], s60 offen offset:0 lds
  v_mfma_f32_16x16x32_bf16 v[184:187], a[248:251], a[192:195], v[184:187]
  ds_read_b64_tr_b16 a[240:241], v18 offset:49152
  ds_read_b64_tr_b16 a[242:243], v16 offset:49664
  v_mfma_f32_16x16x32_bf16 v[184:187], a[252:255], a[200:203], v[184:187]
  v_exp_f32 v9, v9
  v_mfma_f32_16x16x32_bf16 v[188:191], a[248:251], a[196:199], v[188:191]
  ds_read_b64_tr_b16 a[244:245], v18 offset:53248
  ds_read_b64_tr_b16 a[246:247], v16 offset:53760
  v_mfma_f32_16x16x32_bf16 v[188:191], a[252:255], a[204:207], v[188:191]
  s_waitcnt lgkmcnt(4)
  v_exp_f32 v10, v10
  v_mfma_f32_16x16x32_bf16 v[160:163], a[224:227], a[208:211], v[160:163]
  ds_read_b64_tr_b16 a[248:249], v19 offset:49152
  buffer_load_dwordx4 v37, s[12:15], s60 offen offset:1024 lds
  v_mfma_f32_16x16x32_bf16 v[192:195], a[228:231], a[216:219], v[160:163]
  ds_read_b64_tr_b16 a[250:251], v17 offset:49664
  v_fma_f32 v7, v7, v43, v43
  v_mfma_f32_16x16x32_bf16 v[164:167], a[224:227], a[212:215], v[164:167]
  ds_read_b64_tr_b16 a[252:253], v19 offset:53248
  v_fma_f32 v8, v8, v43, v43
  v_mfma_f32_16x16x32_bf16 v[196:199], a[228:231], a[220:223], v[164:167]
  ds_read_b64_tr_b16 a[254:255], v17 offset:53760
  buffer_load_dwordx4 v38, s[12:15], s60 offen offset:2048 lds
  v_mfma_f32_16x16x32_bf16 v[168:171], a[232:235], a[208:211], v[168:171]
  v_fma_f32 v9, v9, v43, v43
  v_fma_f32 v10, v10, v43, v43
  v_mfma_f32_16x16x32_bf16 v[200:203], a[236:239], a[216:219], v[168:171]
  v_rcp_f32 v7, v7
  v_mfma_f32_16x16x32_bf16 v[172:175], a[232:235], a[212:215], v[172:175]
  buffer_load_dwordx4 v39, s[12:15], s60 offen offset:3072 lds
  v_mfma_f32_16x16x32_bf16 v[204:207], a[236:239], a[220:223], v[172:175]
  s_waitcnt vmcnt(12) lgkmcnt(0)
  s_barrier
  v_mfma_f32_16x16x32_bf16 v[176:179], a[240:243], a[208:211], v[176:179]
  ds_read_b64_tr_b16 a[224:225], v12 offset:0
  ds_read_b64_tr_b16 a[226:227], v14 offset:512
  v_mfma_f32_16x16x32_bf16 v[208:211], a[244:247], a[216:219], v[176:179]
  ds_read_b64_tr_b16 a[228:229], v12 offset:4096
  ds_read_b64_tr_b16 a[230:231], v14 offset:4608
  v_mfma_f32_16x16x32_bf16 v[180:183], a[240:243], a[212:215], v[180:183]
  ds_read_b64_tr_b16 a[232:233], v13 offset:0
  ds_read_b64_tr_b16 a[234:235], v15 offset:512
  v_mfma_f32_16x16x32_bf16 v[212:215], a[244:247], a[220:223], v[180:183]
  ds_read_b64_tr_b16 a[236:237], v13 offset:4096
  ds_read_b64_tr_b16 a[238:239], v15 offset:4608
  ds_read_b64_tr_b16 a[240:241], v14 offset:0
  v_mfma_f32_16x16x32_bf16 v[184:187], a[248:251], a[208:211], v[184:187]
  ds_read_b64_tr_b16 a[242:243], v12 offset:512
  v_mfma_f32_16x16x32_bf16 v[216:219], a[252:255], a[216:219], v[184:187]
  ds_read_b64_tr_b16 a[244:245], v14 offset:4096
  v_mfma_f32_16x16x32_bf16 v[188:191], a[248:251], a[212:215], v[188:191]
  ds_read_b64_tr_b16 a[246:247], v12 offset:4608
  v_mfma_f32_16x16x32_bf16 v[220:223], a[252:255], a[220:223], v[188:191]
  v_rcp_f32 v8, v8
  s_waitcnt lgkmcnt(8)
  v_mfma_f32_16x16x32_bf16 v[160:163], a[224:227], v[48:51], 0
  s_add_u32 s46, s57, 384
  ds_read_b64_tr_b16 a[248:249], v15 offset:0
  ds_read_b64_tr_b16 a[250:251], v13 offset:512
  v_mfma_f32_16x16x32_bf16 v[160:163], a[228:231], v[56:59], v[160:163]
  s_add_u32 m0, s44, 65536
  s_add_u32 s56, s53, 2048
  ds_read_b64_tr_b16 a[252:253], v15 offset:4096
  v_mfma_f32_16x16x32_bf16 v[164:167], a[224:227], v[52:55], 0
  v_rcp_f32 v9, v9
  v_mfma_f32_16x16x32_bf16 v[164:167], a[228:231], v[60:63], v[164:167]
  s_waitcnt lgkmcnt(7)
  ds_read_b64_tr_b16 a[254:255], v13 offset:4608
  buffer_load_dwordx4 v20, s[16:19], s46 offen offset:0 lds
  v_mfma_f32_16x16x32_bf16 v[168:171], a[232:235], v[48:51], 0
  ds_read_b64_tr_b16 a[224:225], v12 offset:8192
  ds_read_b64_tr_b16 a[226:227], v14 offset:8704
  v_mfma_f32_16x16x32_bf16 v[168:171], a[236:239], v[56:59], v[168:171]
  v_rcp_f32 v10, v10
  v_mfma_f32_16x16x32_bf16 v[172:175], a[232:235], v[52:55], 0
  ds_read_b64_tr_b16 a[228:229], v12 offset:12288
  buffer_load_dwordx4 v21, s[16:19], s46 offen offset:1024 lds
  v_mfma_f32_16x16x32_bf16 v[172:175], a[236:239], v[60:63], v[172:175]
  s_waitcnt lgkmcnt(3)
  ds_read_b64_tr_b16 a[230:231], v14 offset:12800
  v_cvt_pk_bf16_f32 v192, v192, v193
  v_mfma_f32_16x16x32_bf16 v[176:179], a[240:243], v[48:51], 0
  ds_read_b64_tr_b16 a[232:233], v13 offset:8192
  v_cvt_pk_bf16_f32 v193, v194, v195
  v_mfma_f32_16x16x32_bf16 v[176:179], a[244:247], v[56:59], v[176:179]
  ds_read_b64_tr_b16 a[234:235], v15 offset:8704
  v_cvt_pk_bf16_f32 v194, v200, v201
  v_mfma_f32_16x16x32_bf16 v[180:183], a[240:243], v[52:55], 0
  ds_read_b64_tr_b16 a[236:237], v13 offset:12288
  buffer_load_dwordx4 v22, s[16:19], s46 offen offset:2048 lds
  v_mfma_f32_16x16x32_bf16 v[180:183], a[244:247], v[60:63], v[180:183]
  ds_read_b64_tr_b16 a[238:239], v15 offset:12800
  v_cvt_pk_bf16_f32 v195, v202, v203
  v_mfma_f32_16x16x32_bf16 v[184:187], a[248:251], v[48:51], 0
  ds_read_b64_tr_b16 a[240:241], v14 offset:8192
  v_cvt_pk_bf16_f32 v196, v196, v197
  v_mfma_f32_16x16x32_bf16 v[184:187], a[252:255], v[56:59], v[184:187]
  ds_read_b64_tr_b16 a[242:243], v12 offset:8704
  v_cvt_pk_bf16_f32 v197, v198, v199
  v_mfma_f32_16x16x32_bf16 v[188:191], a[248:251], v[52:55], 0
  ds_read_b64_tr_b16 a[244:245], v14 offset:12288
  buffer_load_dwordx4 v23, s[16:19], s46 offen offset:3072 lds
  v_mfma_f32_16x16x32_bf16 v[188:191], a[252:255], v[60:63], v[188:191]
  s_waitcnt lgkmcnt(3)
  ds_read_b64_tr_b16 a[246:247], v12 offset:12800
  v_cvt_pk_bf16_f32 v198, v204, v205
  v_mfma_f32_16x16x32_bf16 v[160:163], a[224:227], v[64:67], v[160:163]
  s_add_u32 m0, s44, 69632
  ds_read_b64_tr_b16 a[248:249], v15 offset:8192
  v_cvt_pk_bf16_f32 v199, v206, v207
  v_mfma_f32_16x16x32_bf16 v[160:163], a[228:231], v[72:75], v[160:163]
  ds_read_b64_tr_b16 a[250:251], v13 offset:8704
  v_cvt_pk_bf16_f32 v208, v208, v209
  v_mfma_f32_16x16x32_bf16 v[164:167], a[224:227], v[68:71], v[164:167]
  ds_read_b64_tr_b16 a[252:253], v15 offset:12288
  buffer_load_dwordx4 v24, s[16:19], s46 offen offset:0 lds
  v_mfma_f32_16x16x32_bf16 v[164:167], a[228:231], v[76:79], v[164:167]
  ds_read_b64_tr_b16 a[254:255], v13 offset:12800
  v_cvt_pk_bf16_f32 v209, v210, v211
  v_mfma_f32_16x16x32_bf16 v[168:171], a[232:235], v[64:67], v[168:171]
  ds_read_b64_tr_b16 a[224:225], v12 offset:16384
  v_cvt_pk_bf16_f32 v210, v216, v217
  v_mfma_f32_16x16x32_bf16 v[168:171], a[236:239], v[72:75], v[168:171]
  ds_read_b64_tr_b16 a[226:227], v14 offset:16896
  buffer_load_dwordx4 v25, s[16:19], s46 offen offset:1024 lds
  v_mfma_f32_16x16x32_bf16 v[172:175], a[232:235], v[68:71], v[172:175]
  ds_read_b64_tr_b16 a[228:229], v12 offset:20480
  v_cvt_pk_bf16_f32 v211, v218, v219
  v_mfma_f32_16x16x32_bf16 v[172:175], a[236:239], v[76:79], v[172:175]
  s_waitcnt lgkmcnt(3)
  ds_read_b64_tr_b16 a[230:231], v14 offset:20992
  v_cvt_pk_bf16_f32 v212, v212, v213
  v_mfma_f32_16x16x32_bf16 v[176:179], a[240:243], v[64:67], v[176:179]
  ds_read_b64_tr_b16 a[232:233], v13 offset:16384
  v_cvt_pk_bf16_f32 v213, v214, v215
  v_mfma_f32_16x16x32_bf16 v[176:179], a[244:247], v[72:75], v[176:179]
  ds_read_b64_tr_b16 a[234:235], v15 offset:16896
  buffer_load_dwordx4 v26, s[16:19], s46 offen offset:2048 lds
  v_mfma_f32_16x16x32_bf16 v[180:183], a[240:243], v[68:71], v[180:183]
  ds_read_b64_tr_b16 a[236:237], v13 offset:20480
  v_cvt_pk_bf16_f32 v214, v220, v221
  v_mfma_f32_16x16x32_bf16 v[180:183], a[244:247], v[76:79], v[180:183]
  ds_read_b64_tr_b16 a[238:239], v15 offset:20992
  v_cvt_pk_bf16_f32 v215, v222, v223
  v_mfma_f32_16x16x32_bf16 v[184:187], a[248:251], v[64:67], v[184:187]
  ds_read_b64_tr_b16 a[240:241], v14 offset:16384
  v_mul_f32 v236, v236, v7
  v_mfma_f32_16x16x32_bf16 v[184:187], a[252:255], v[72:75], v[184:187]
  ds_read_b64_tr_b16 a[242:243], v12 offset:16896
  buffer_load_dwordx4 v27, s[16:19], s46 offen offset:3072 lds
  v_mfma_f32_16x16x32_bf16 v[188:191], a[248:251], v[68:71], v[188:191]
  s_add_u32 m0, s44, 73728
  ds_read_b64_tr_b16 a[244:245], v14 offset:20480
  v_mul_f32 v237, v237, v8
  v_mfma_f32_16x16x32_bf16 v[188:191], a[252:255], v[76:79], v[188:191]
  s_waitcnt lgkmcnt(3)
  ds_read_b64_tr_b16 a[246:247], v12 offset:20992
  v_mul_f32 v238, v238, v9
  v_mfma_f32_16x16x32_bf16 v[160:163], a[224:227], v[80:83], v[160:163]
  ds_read_b64_tr_b16 a[248:249], v15 offset:16384
  v_mul_f32 v239, v239, v10
  v_mfma_f32_16x16x32_bf16 v[160:163], a[228:231], v[88:91], v[160:163]
  ds_read_b64_tr_b16 a[250:251], v13 offset:16896
  s_waitcnt vmcnt(8)
  ds_read_b128 a[160:163], v40 offset:0
  v_mfma_f32_16x16x32_bf16 v[164:167], a[224:227], v[84:87], v[164:167]
  ds_read_b64_tr_b16 a[252:253], v15 offset:20480
  ds_read_b128 a[164:167], v40 offset:2048
  v_mfma_f32_16x16x32_bf16 v[164:167], a[228:231], v[92:95], v[164:167]
  ds_read_b64_tr_b16 a[254:255], v13 offset:20992
  ds_read_b128 a[168:171], v41 offset:0
  v_mfma_f32_16x16x32_bf16 v[168:171], a[232:235], v[80:83], v[168:171]
  ds_read_b64_tr_b16 a[224:225], v12 offset:24576
  ds_read_b128 a[172:175], v41 offset:2048
  v_mfma_f32_16x16x32_bf16 v[168:171], a[236:239], v[88:91], v[168:171]
  ds_read_b64_tr_b16 a[226:227], v14 offset:25088
  ds_read_b128 a[176:179], v40 offset:4096
  v_mfma_f32_16x16x32_bf16 v[172:175], a[232:235], v[84:87], v[172:175]
  ds_read_b64_tr_b16 a[228:229], v12 offset:28672
  ds_read_b128 a[180:183], v40 offset:6144
  v_mfma_f32_16x16x32_bf16 v[172:175], a[236:239], v[92:95], v[172:175]
  s_waitcnt lgkmcnt(7)
  ds_read_b64_tr_b16 a[230:231], v14 offset:29184
  ds_read_b128 a[184:187], v41 offset:4096
  v_mfma_f32_16x16x32_bf16 v[176:179], a[240:243], v[80:83], v[176:179]
  ds_read_b64_tr_b16 a[232:233], v13 offset:24576
  ds_read_b128 a[188:191], v41 offset:6144
  v_mfma_f32_16x16x32_bf16 v[176:179], a[244:247], v[88:91], v[176:179]
  ds_read_b64_tr_b16 a[234:235], v15 offset:25088
  buffer_load_dwordx4 v28, s[16:19], s46 offen offset:0 lds
  v_mfma_f32_16x16x32_bf16 v[180:183], a[240:243], v[84:87], v[180:183]
  ds_read_b64_tr_b16 a[236:237], v13 offset:28672
  v_mul_f32 v7, v240, v240
  v_mfma_f32_16x16x32_bf16 v[180:183], a[244:247], v[92:95], v[180:183]
  ds_read_b64_tr_b16 a[238:239], v15 offset:29184
  v_mul_f32 v8, v241, v241
  v_mfma_f32_16x16x32_bf16 v[184:187], a[248:251], v[80:83], v[184:187]
  ds_read_b64_tr_b16 a[240:241], v14 offset:24576
  buffer_load_dwordx4 v29, s[16:19], s46 offen offset:1024 lds
  v_mfma_f32_16x16x32_bf16 v[184:187], a[252:255], v[88:91], v[184:187]
  ds_read_b64_tr_b16 a[242:243], v12 offset:25088
  v_mul_f32 v9, v242, v242
  v_mfma_f32_16x16x32_bf16 v[188:191], a[248:251], v[84:87], v[188:191]
  ds_read_b64_tr_b16 a[244:245], v14 offset:28672
  v_mul_f32 v10, v243, v243
  v_mfma_f32_16x16x32_bf16 v[188:191], a[252:255], v[92:95], v[188:191]
  s_waitcnt lgkmcnt(3)
  ds_read_b64_tr_b16 a[246:247], v12 offset:29184
  v_fma_f32 v7, v7, v46, s62
  v_mfma_f32_16x16x32_bf16 v[160:163], a[224:227], v[96:99], v[160:163]
  ds_read_b64_tr_b16 a[248:249], v15 offset:24576
  buffer_load_dwordx4 v30, s[16:19], s46 offen offset:2048 lds
  v_mfma_f32_16x16x32_bf16 v[160:163], a[228:231], v[104:107], v[160:163]
  ds_read_b64_tr_b16 a[250:251], v13 offset:25088
  v_fma_f32 v8, v8, v46, s62
  v_mfma_f32_16x16x32_bf16 v[164:167], a[224:227], v[100:103], v[164:167]
  ds_read_b64_tr_b16 a[252:253], v15 offset:28672
  v_fma_f32 v9, v9, v46, s62
  v_mfma_f32_16x16x32_bf16 v[164:167], a[228:231], v[108:111], v[164:167]
  ds_read_b64_tr_b16 a[254:255], v13 offset:29184
  v_fma_f32 v10, v10, v46, s62
  v_mfma_f32_16x16x32_bf16 v[168:171], a[232:235], v[96:99], v[168:171]
  ds_read_b64_tr_b16 a[224:225], v12 offset:32768
  buffer_load_dwordx4 v31, s[16:19], s46 offen offset:3072 lds
  v_mfma_f32_16x16x32_bf16 v[168:171], a[236:239], v[104:107], v[168:171]
  s_add_u32 m0, s44, 77824
  ds_read_b64_tr_b16 a[226:227], v14 offset:33280
  v_mul_f32 v7, v240, v7
  v_mfma_f32_16x16x32_bf16 v[172:175], a[232:235], v[100:103], v[172:175]
  ds_read_b64_tr_b16 a[228:229], v12 offset:36864
  v_mul_f32 v8, v241, v8
  v_mfma_f32_16x16x32_bf16 v[172:175], a[236:239], v[108:111], v[172:175]
  s_waitcnt lgkmcnt(3)
  ds_read_b64_tr_b16 a[230:231], v14 offset:37376
  v_mul_f32 v9, v242, v9
  v_mfma_f32_16x16x32_bf16 v[176:179], a[240:243], v[96:99], v[176:179]
  ds_read_b64_tr_b16 a[232:233], v13 offset:32768
  buffer_load_dwordx4 v32, s[16:19], s46 offen offset:0 lds
  v_mfma_f32_16x16x32_bf16 v[176:179], a[244:247], v[104:107], v[176:179]
  ds_read_b64_tr_b16 a[234:235], v15 offset:33280
  v_mul_f32 v10, v243, v10
  v_mfma_f32_16x16x32_bf16 v[180:183], a[240:243], v[100:103], v[180:183]
  ds_read_b64_tr_b16 a[236:237], v13 offset:36864
  ds_read_b64_tr_b16 a[238:239], v15 offset:37376
  v_mfma_f32_16x16x32_bf16 v[180:183], a[244:247], v[108:111], v[180:183]
  v_exp_f32 v7, v7
  v_mfma_f32_16x16x32_bf16 v[184:187], a[248:251], v[96:99], v[184:187]
  ds_read_b64_tr_b16 a[240:241], v14 offset:32768
  buffer_load_dwordx4 v33, s[16:19], s46 offen offset:1024 lds
  v_mfma_f32_16x16x32_bf16 v[184:187], a[252:255], v[104:107], v[184:187]
  s_add_u32 m0, s48, 0
  ds_read_b64_tr_b16 a[242:243], v12 offset:33280
  ds_read_b64_tr_b16 a[244:245], v14 offset:36864
  v_mfma_f32_16x16x32_bf16 v[188:191], a[248:251], v[100:103], v[188:191]
  s_movk_i32 s60, 1536
  v_exp_f32 v8, v8
  v_mfma_f32_16x16x32_bf16 v[188:191], a[252:255], v[108:111], v[188:191]
  s_waitcnt lgkmcnt(3)
  ds_read_b64_tr_b16 a[246:247], v12 offset:37376
  buffer_store_dwordx4 v[192:195], v1, s[36:39], s56 offen offset:0 sc1
  v_mfma_f32_16x16x32_bf16 v[160:163], a[224:227], v[112:115], v[160:163]
  ds_read_b64_tr_b16 a[248:249], v15 offset:32768
  ds_read_b64_tr_b16 a[250:251], v13 offset:33280
  v_mfma_f32_16x16x32_bf16 v[160:163], a[228:231], v[120:123], v[160:163]
  v_exp_f32 v9, v9
  v_mfma_f32_16x16x32_bf16 v[164:167], a[224:227], v[116:119], v[164:167]
  ds_read_b64_tr_b16 a[252:253], v15 offset:36864
  ds_read_b64_tr_b16 a[254:255], v13 offset:37376
  v_mfma_f32_16x16x32_bf16 v[164:167], a[228:231], v[124:127], v[164:167]
  v_exp_f32 v10, v10
  v_mfma_f32_16x16x32_bf16 v[168:171], a[232:235], v[112:115], v[168:171]
  ds_read_b64_tr_b16 a[224:225], v12 offset:40960
  buffer_store_dwordx4 v[196:199], v2, s[36:39], s56 offen offset:0 sc1
  v_mfma_f32_16x16x32_bf16 v[168:171], a[236:239], v[120:123], v[168:171]
  ds_read_b64_tr_b16 a[226:227], v14 offset:41472
  v_lshrrev_b32 v3, 3, v0
  v_mfma_f32_16x16x32_bf16 v[172:175], a[232:235], v[116:119], v[172:175]
  s_mul_i32 s49, s4, 1048576
  ds_read_b64_tr_b16 a[228:229], v12 offset:45056
  v_mul_u32_u24 v4, 8192, v3
  v_mfma_f32_16x16x32_bf16 v[172:175], a[236:239], v[124:127], v[172:175]
  s_waitcnt lgkmcnt(3)
  ds_read_b64_tr_b16 a[230:231], v14 offset:45568
  buffer_store_dwordx4 v[208:211], v1, s[36:39], s56 offen offset:1024 sc1
  v_mfma_f32_16x16x32_bf16 v[176:179], a[240:243], v[112:115], v[176:179]
  ds_read_b64_tr_b16 a[232:233], v13 offset:40960
  v_add_u32 v4, s49, v4
  v_mfma_f32_16x16x32_bf16 v[176:179], a[244:247], v[120:123], v[176:179]
  ds_read_b64_tr_b16 a[234:235], v15 offset:41472
  v_bfe_u32 v5, v0, 4, 2
  v_mfma_f32_16x16x32_bf16 v[180:183], a[240:243], v[116:119], v[180:183]
  ds_read_b64_tr_b16 a[236:237], v13 offset:45056
  v_bfe_u32 v6, v0, 1, 2
  v_mfma_f32_16x16x32_bf16 v[180:183], a[244:247], v[124:127], v[180:183]
  ds_read_b64_tr_b16 a[238:239], v15 offset:45568
  buffer_store_dwordx4 v[212:215], v2, s[36:39], s56 offen offset:1024 sc1
  v_mfma_f32_16x16x32_bf16 v[184:187], a[248:251], v[112:115], v[184:187]
  ds_read_b64_tr_b16 a[240:241], v14 offset:40960
  v_xor_b32 v5, v5, v6
  v_mfma_f32_16x16x32_bf16 v[184:187], a[252:255], v[120:123], v[184:187]
  ds_read_b64_tr_b16 a[242:243], v12 offset:41472
  v_and_b32 v6, 1, v0
  v_mfma_f32_16x16x32_bf16 v[188:191], a[248:251], v[116:119], v[188:191]
  ds_read_b64_tr_b16 a[244:245], v14 offset:45056
  v_lshlrev_b32 v6, 4, v6
  v_mfma_f32_16x16x32_bf16 v[188:191], a[252:255], v[124:127], v[188:191]
  s_waitcnt lgkmcnt(3)
  ds_read_b64_tr_b16 a[246:247], v12 offset:45568
  buffer_load_dwordx4 v36, s[12:15], s60 offen offset:0 lds
  v_mfma_f32_16x16x32_bf16 v[160:163], a[224:227], a[192:195], v[160:163]
  ds_read_b64_tr_b16 a[248:249], v15 offset:40960
  v_add_u32 v4, v4, v6
  v_mfma_f32_16x16x32_bf16 v[160:163], a[228:231], a[200:203], v[160:163]
  ds_read_b64_tr_b16 a[250:251], v13 offset:41472
  v_lshl_add_u32 v44, v5, 5, v4
  v_mfma_f32_16x16x32_bf16 v[164:167], a[224:227], a[196:199], v[164:167]
  ds_read_b64_tr_b16 a[252:253], v15 offset:45056
  v_xor_b32 v5, 2, v5
  v_mfma_f32_16x16x32_bf16 v[164:167], a[228:231], a[204:207], v[164:167]
  ds_read_b64_tr_b16 a[254:255], v13 offset:45568
  buffer_load_dwordx4 v37, s[12:15], s60 offen offset:1024 lds
  v_mfma_f32_16x16x32_bf16 v[168:171], a[232:235], a[192:195], v[168:171]
  ds_read_b64_tr_b16 a[224:225], v12 offset:49152
  v_lshl_add_u32 v45, v5, 5, v4
  v_mfma_f32_16x16x32_bf16 v[168:171], a[236:239], a[200:203], v[168:171]
  ds_read_b64_tr_b16 a[226:227], v14 offset:49664
  v_add_u32 v20, 0x0, v44
  v_mfma_f32_16x16x32_bf16 v[172:175], a[232:235], a[196:199], v[172:175]
  ds_read_b64_tr_b16 a[228:229], v12 offset:53248
  buffer_load_dwordx4 v38, s[12:15], s60 offen offset:2048 lds
  v_mfma_f32_16x16x32_bf16 v[172:175], a[236:239], a[204:207], v[172:175]
  s_waitcnt lgkmcnt(3)
  ds_read_b64_tr_b16 a[230:231], v14 offset:53760
  v_add_u32 v21, 0xfc00, v45
  v_mfma_f32_16x16x32_bf16 v[176:179], a[240:243], a[192:195], v[176:179]
  ds_read_b64_tr_b16 a[232:233], v13 offset:49152
  v_add_u32 v22, 0x1f800, v44
  v_mfma_f32_16x16x32_bf16 v[176:179], a[244:247], a[200:203], v[176:179]
  ds_read_b64_tr_b16 a[234:235], v15 offset:49664
  v_add_u32 v23, 0x2f400, v45
  v_mfma_f32_16x16x32_bf16 v[180:183], a[240:243], a[196:199], v[180:183]
  ds_read_b64_tr_b16 a[236:237], v13 offset:53248
  buffer_load_dwordx4 v39, s[12:15], s60 offen offset:3072 lds
  v_mfma_f32_16x16x32_bf16 v[180:183], a[244:247], a[204:207], v[180:183]
  ds_read_b64_tr_b16 a[238:239], v15 offset:53760
  v_add_u32 v24, 0x40000, v44
  v_mfma_f32_16x16x32_bf16 v[184:187], a[248:251], a[192:195], v[184:187]
  s_add_u32 m0, s48, 4096
  ds_read_b64_tr_b16 a[240:241], v14 offset:49152
  v_add_u32 v25, 0x4fc00, v45
  v_mfma_f32_16x16x32_bf16 v[184:187], a[252:255], a[200:203], v[184:187]
  s_movk_i32 s60, 1664
  ds_read_b64_tr_b16 a[242:243], v12 offset:49664
  v_add_u32 v26, 0x5f800, v44
  v_mfma_f32_16x16x32_bf16 v[188:191], a[248:251], a[196:199], v[188:191]
  ds_read_b64_tr_b16 a[244:245], v14 offset:53248
  buffer_load_dwordx4 v36, s[12:15], s60 offen offset:0 lds
  v_mfma_f32_16x16x32_bf16 v[188:191], a[252:255], a[204:207], v[188:191]
  s_waitcnt lgkmcnt(3)
  ds_read_b64_tr_b16 a[246:247], v12 offset:53760
  v_add_u32 v27, 0x6f400, v45
  v_mfma_f32_16x16x32_bf16 v[160:163], a[224:227], a[208:211], v[160:163]
  ds_read_b64_tr_b16 a[248:249], v15 offset:49152
  v_add_u32 v28, 0x80000, v44
  v_mfma_f32_16x16x32_bf16 v[192:195], a[228:231], a[216:219], v[160:163]
  ds_read_b64_tr_b16 a[250:251], v13 offset:49664
  v_add_u32 v29, 0x8fc00, v45
  v_mfma_f32_16x16x32_bf16 v[164:167], a[224:227], a[212:215], v[164:167]
  ds_read_b64_tr_b16 a[252:253], v15 offset:53248
  buffer_load_dwordx4 v37, s[12:15], s60 offen offset:1024 lds
  v_mfma_f32_16x16x32_bf16 v[196:199], a[228:231], a[220:223], v[164:167]
  ds_read_b64_tr_b16 a[254:255], v13 offset:53760
  v_add_u32 v30, 0x9f800, v44
  v_mfma_f32_16x16x32_bf16 v[168:171], a[232:235], a[208:211], v[168:171]
  v_add_u32 v31, 0xaf400, v45
  v_add_u32 v32, 0xc0000, v44
  v_mfma_f32_16x16x32_bf16 v[200:203], a[236:239], a[216:219], v[168:171]
  v_add_u32 v33, 0xcfc00, v45
  v_add_u32 v34, 0xdf800, v44
  v_mfma_f32_16x16x32_bf16 v[172:175], a[232:235], a[212:215], v[172:175]
  buffer_load_dwordx4 v38, s[12:15], s60 offen offset:2048 lds
  buffer_load_dwordx4 v39, s[12:15], s60 offen offset:3072 lds
  v_mfma_f32_16x16x32_bf16 v[204:207], a[236:239], a[220:223], v[172:175]
  s_waitcnt vmcnt(12) lgkmcnt(0)
  s_barrier
  v_mfma_f32_16x16x32_bf16 v[176:179], a[240:243], a[208:211], v[176:179]
  ds_read_b64_tr_b16 a[224:225], v16 offset:0
  ds_read_b64_tr_b16 a[226:227], v18 offset:512
  v_mfma_f32_16x16x32_bf16 v[208:211], a[244:247], a[216:219], v[176:179]
  ds_read_b64_tr_b16 a[228:229], v16 offset:4096
  ds_read_b64_tr_b16 a[230:231], v18 offset:4608
  v_mfma_f32_16x16x32_bf16 v[180:183], a[240:243], a[212:215], v[180:183]
  ds_read_b64_tr_b16 a[232:233], v17 offset:0
  ds_read_b64_tr_b16 a[234:235], v19 offset:512
  v_add_u32 v35, 0xef400, v45
  v_mfma_f32_16x16x32_bf16 v[212:215], a[244:247], a[220:223], v[180:183]
  ds_read_b64_tr_b16 a[236:237], v17 offset:4096
  ds_read_b64_tr_b16 a[238:239], v19 offset:4608
  ds_read_b64_tr_b16 a[240:241], v18 offset:0
  v_mfma_f32_16x16x32_bf16 v[184:187], a[248:251], a[208:211], v[184:187]
  ds_read_b64_tr_b16 a[242:243], v16 offset:512
  v_fma_f32 v7, v7, v42, v42
  v_mfma_f32_16x16x32_bf16 v[216:219], a[252:255], a[216:219], v[184:187]
  ds_read_b64_tr_b16 a[244:245], v18 offset:4096
  v_fma_f32 v8, v8, v42, v42
  v_mfma_f32_16x16x32_bf16 v[188:191], a[248:251], a[212:215], v[188:191]
  ds_read_b64_tr_b16 a[246:247], v16 offset:4608
  v_fma_f32 v9, v9, v42, v42
  v_mfma_f32_16x16x32_bf16 v[220:223], a[252:255], a[220:223], v[188:191]
  v_fma_f32 v10, v10, v42, v42
  s_waitcnt lgkmcnt(8)
  v_mfma_f32_16x16x32_bf16 v[160:163], a[224:227], v[48:51], 0
  s_mov_b32 s46, s57
  ds_read_b64_tr_b16 a[248:249], v19 offset:0
  ds_read_b64_tr_b16 a[250:251], v17 offset:512
  v_mfma_f32_16x16x32_bf16 v[160:163], a[228:231], v[56:59], v[160:163]
  s_add_u32 m0, s45, 0
  s_add_u32 s56, s53, 4096
  ds_read_b64_tr_b16 a[252:253], v19 offset:4096
  v_mfma_f32_16x16x32_bf16 v[164:167], a[224:227], v[52:55], 0
  v_rcp_f32 v7, v7
  v_mfma_f32_16x16x32_bf16 v[164:167], a[228:231], v[60:63], v[164:167]
  s_waitcnt lgkmcnt(7)
  ds_read_b64_tr_b16 a[254:255], v17 offset:4608
  buffer_load_dwordx4 v20, s[28:31], s46 offen offset:0 lds
  v_mfma_f32_16x16x32_bf16 v[168:171], a[232:235], v[48:51], 0
  ds_read_b64_tr_b16 a[224:225], v16 offset:8192
  ds_read_b64_tr_b16 a[226:227], v18 offset:8704
  v_mfma_f32_16x16x32_bf16 v[168:171], a[236:239], v[56:59], v[168:171]
  v_rcp_f32 v8, v8
  v_mfma_f32_16x16x32_bf16 v[172:175], a[232:235], v[52:55], 0
  ds_read_b64_tr_b16 a[228:229], v16 offset:12288
  buffer_load_dwordx4 v21, s[28:31], s46 offen offset:1024 lds
  v_mfma_f32_16x16x32_bf16 v[172:175], a[236:239], v[60:63], v[172:175]
  s_waitcnt lgkmcnt(3)
  ds_read_b64_tr_b16 a[230:231], v18 offset:12800
  ds_read_b64_tr_b16 a[232:233], v17 offset:8192
  v_mfma_f32_16x16x32_bf16 v[176:179], a[240:243], v[48:51], 0
  v_rcp_f32 v9, v9
  v_mfma_f32_16x16x32_bf16 v[176:179], a[244:247], v[56:59], v[176:179]
  ds_read_b64_tr_b16 a[234:235], v19 offset:8704
  ds_read_b64_tr_b16 a[236:237], v17 offset:12288
  v_mfma_f32_16x16x32_bf16 v[180:183], a[240:243], v[52:55], 0
  v_rcp_f32 v10, v10
  v_mfma_f32_16x16x32_bf16 v[180:183], a[244:247], v[60:63], v[180:183]
  ds_read_b64_tr_b16 a[238:239], v19 offset:12800
  buffer_load_dwordx4 v22, s[28:31], s46 offen offset:2048 lds
  v_mfma_f32_16x16x32_bf16 v[184:187], a[248:251], v[48:51], 0
  ds_read_b64_tr_b16 a[240:241], v18 offset:8192
  v_cvt_pk_bf16_f32 v192, v192, v193
  v_mfma_f32_16x16x32_bf16 v[184:187], a[252:255], v[56:59], v[184:187]
  ds_read_b64_tr_b16 a[242:243], v16 offset:8704
  v_cvt_pk_bf16_f32 v193, v194, v195
  v_mfma_f32_16x16x32_bf16 v[188:191], a[248:251], v[52:55], 0
  ds_read_b64_tr_b16 a[244:245], v18 offset:12288
  buffer_load_dwordx4 v23, s[28:31], s46 offen offset:3072 lds
  v_mfma_f32_16x16x32_bf16 v[188:191], a[252:255], v[60:63], v[188:191]
  s_waitcnt lgkmcnt(3)
  ds_read_b64_tr_b16 a[246:247], v16 offset:12800
  v_cvt_pk_bf16_f32 v194, v200, v201
  v_mfma_f32_16x16x32_bf16 v[160:163], a[224:227], v[64:67], v[160:163]
  s_add_u32 m0, s45, 4096
  ds_read_b64_tr_b16 a[248:249], v19 offset:8192
  v_cvt_pk_bf16_f32 v195, v202, v203
  v_mfma_f32_16x16x32_bf16 v[160:163], a[228:231], v[72:75], v[160:163]
  ds_read_b64_tr_b16 a[250:251], v17 offset:8704
  v_cvt_pk_bf16_f32 v196, v196, v197
  v_mfma_f32_16x16x32_bf16 v[164:167], a[224:227], v[68:71], v[164:167]
  ds_read_b64_tr_b16 a[252:253], v19 offset:12288
  buffer_load_dwordx4 v24, s[28:31], s46 offen offset:0 lds
  v_mfma_f32_16x16x32_bf16 v[164:167], a[228:231], v[76:79], v[164:167]
  ds_read_b64_tr_b16 a[254:255], v17 offset:12800
  v_cvt_pk_bf16_f32 v197, v198, v199
  v_mfma_f32_16x16x32_bf16 v[168:171], a[232:235], v[64:67], v[168:171]
  ds_read_b64_tr_b16 a[224:225], v16 offset:16384
  v_cvt_pk_bf16_f32 v198, v204, v205
  v_mfma_f32_16x16x32_bf16 v[168:171], a[236:239], v[72:75], v[168:171]
  ds_read_b64_tr_b16 a[226:227], v18 offset:16896
  v_cvt_pk_bf16_f32 v199, v206, v207
  v_mfma_f32_16x16x32_bf16 v[172:175], a[232:235], v[68:71], v[172:175]
  ds_read_b64_tr_b16 a[228:229], v16 offset:20480
  buffer_load_dwordx4 v25, s[28:31], s46 offen offset:1024 lds
  v_mfma_f32_16x16x32_bf16 v[172:175], a[236:239], v[76:79], v[172:175]
  s_waitcnt lgkmcnt(3)
  ds_read_b64_tr_b16 a[230:231], v18 offset:20992
  v_cvt_pk_bf16_f32 v208, v208, v209
  v_mfma_f32_16x16x32_bf16 v[176:179], a[240:243], v[64:67], v[176:179]
  ds_read_b64_tr_b16 a[232:233], v17 offset:16384
  v_cvt_pk_bf16_f32 v209, v210, v211
  v_mfma_f32_16x16x32_bf16 v[176:179], a[244:247], v[72:75], v[176:179]
  ds_read_b64_tr_b16 a[234:235], v19 offset:16896
  v_cvt_pk_bf16_f32 v210, v216, v217
  v_mfma_f32_16x16x32_bf16 v[180:183], a[240:243], v[68:71], v[180:183]
  ds_read_b64_tr_b16 a[236:237], v17 offset:20480
  buffer_load_dwordx4 v26, s[28:31], s46 offen offset:2048 lds
  v_mfma_f32_16x16x32_bf16 v[180:183], a[244:247], v[76:79], v[180:183]
  ds_read_b64_tr_b16 a[238:239], v19 offset:20992
  v_cvt_pk_bf16_f32 v211, v218, v219
  v_mfma_f32_16x16x32_bf16 v[184:187], a[248:251], v[64:67], v[184:187]
  ds_read_b64_tr_b16 a[240:241], v18 offset:16384
  v_cvt_pk_bf16_f32 v212, v212, v213
  v_mfma_f32_16x16x32_bf16 v[184:187], a[252:255], v[72:75], v[184:187]
  ds_read_b64_tr_b16 a[242:243], v16 offset:16896
  v_cvt_pk_bf16_f32 v213, v214, v215
  v_mfma_f32_16x16x32_bf16 v[188:191], a[248:251], v[68:71], v[188:191]
  ds_read_b64_tr_b16 a[244:245], v18 offset:20480
  buffer_load_dwordx4 v27, s[28:31], s46 offen offset:3072 lds
  v_mfma_f32_16x16x32_bf16 v[188:191], a[252:255], v[76:79], v[188:191]
  s_waitcnt lgkmcnt(3)
  ds_read_b64_tr_b16 a[246:247], v16 offset:20992
  v_cvt_pk_bf16_f32 v214, v220, v221
  v_mfma_f32_16x16x32_bf16 v[160:163], a[224:227], v[80:83], v[160:163]
  s_add_u32 m0, s45, 8192
  ds_read_b64_tr_b16 a[248:249], v19 offset:16384
  v_cvt_pk_bf16_f32 v215, v222, v223
  v_mfma_f32_16x16x32_bf16 v[160:163], a[228:231], v[88:91], v[160:163]
  ds_read_b64_tr_b16 a[250:251], v17 offset:16896
  buffer_load_dwordx4 v28, s[28:31], s46 offen offset:0 lds
  v_mfma_f32_16x16x32_bf16 v[164:167], a[224:227], v[84:87], v[164:167]
  ds_read_b64_tr_b16 a[252:253], v19 offset:20480
  v_mul_f32 v240, v240, v7
  v_mfma_f32_16x16x32_bf16 v[164:167], a[228:231], v[92:95], v[164:167]
  ds_read_b64_tr_b16 a[254:255], v17 offset:20992
  v_mul_f32 v241, v241, v8
  v_mfma_f32_16x16x32_bf16 v[168:171], a[232:235], v[80:83], v[168:171]
  ds_read_b64_tr_b16 a[224:225], v16 offset:24576
  v_mul_f32 v242, v242, v9
  v_mfma_f32_16x16x32_bf16 v[168:171], a[236:239], v[88:91], v[168:171]
  ds_read_b64_tr_b16 a[226:227], v18 offset:25088
  buffer_load_dwordx4 v29, s[28:31], s46 offen offset:1024 lds
  v_mfma_f32_16x16x32_bf16 v[172:175], a[232:235], v[84:87], v[172:175]
  ds_read_b64_tr_b16 a[228:229], v16 offset:28672
  v_mul_f32 v243, v243, v10
  v_mfma_f32_16x16x32_bf16 v[172:175], a[236:239], v[92:95], v[172:175]
  s_waitcnt lgkmcnt(3)
  ds_read_b64_tr_b16 a[230:231], v18 offset:29184
  v_mul_f32 v7, v244, v244
  v_mfma_f32_16x16x32_bf16 v[176:179], a[240:243], v[80:83], v[176:179]
  ds_read_b64_tr_b16 a[232:233], v17 offset:24576
  v_mul_f32 v8, v245, v245
  v_mfma_f32_16x16x32_bf16 v[176:179], a[244:247], v[88:91], v[176:179]
  ds_read_b64_tr_b16 a[234:235], v19 offset:25088
  buffer_load_dwordx4 v30, s[28:31], s46 offen offset:2048 lds
  v_mfma_f32_16x16x32_bf16 v[180:183], a[240:243], v[84:87], v[180:183]
  ds_read_b64_tr_b16 a[236:237], v17 offset:28672
  v_mul_f32 v9, v246, v246
  v_mfma_f32_16x16x32_bf16 v[180:183], a[244:247], v[92:95], v[180:183]
  ds_read_b64_tr_b16 a[238:239], v19 offset:29184
  v_mul_f32 v10, v247, v247
  v_mfma_f32_16x16x32_bf16 v[184:187], a[248:251], v[80:83], v[184:187]
  ds_read_b64_tr_b16 a[240:241], v18 offset:24576
  v_fma_f32 v7, v7, v46, s62
  v_mfma_f32_16x16x32_bf16 v[184:187], a[252:255], v[88:91], v[184:187]
  ds_read_b64_tr_b16 a[242:243], v16 offset:25088
  buffer_load_dwordx4 v31, s[28:31], s46 offen offset:3072 lds
  v_mfma_f32_16x16x32_bf16 v[188:191], a[248:251], v[84:87], v[188:191]
  s_add_u32 m0, s45, 12288
  ds_read_b64_tr_b16 a[244:245], v18 offset:28672
  v_fma_f32 v8, v8, v46, s62
  v_mfma_f32_16x16x32_bf16 v[188:191], a[252:255], v[92:95], v[188:191]
  s_waitcnt lgkmcnt(3)
  ds_read_b64_tr_b16 a[246:247], v16 offset:29184
  v_fma_f32 v9, v9, v46, s62
  v_mfma_f32_16x16x32_bf16 v[160:163], a[224:227], v[96:99], v[160:163]
  ds_read_b64_tr_b16 a[248:249], v19 offset:24576
  buffer_load_dwordx4 v32, s[28:31], s46 offen offset:0 lds
  v_mfma_f32_16x16x32_bf16 v[160:163], a[228:231], v[104:107], v[160:163]
  ds_read_b64_tr_b16 a[250:251], v17 offset:25088
  v_fma_f32 v10, v10, v46, s62
  v_mfma_f32_16x16x32_bf16 v[164:167], a[224:227], v[100:103], v[164:167]
  ds_read_b64_tr_b16 a[252:253], v19 offset:28672
  v_mul_f32 v7, v244, v7
  v_mfma_f32_16x16x32_bf16 v[164:167], a[228:231], v[108:111], v[164:167]
  ds_read_b64_tr_b16 a[254:255], v17 offset:29184
  v_mul_f32 v8, v245, v8
  v_mfma_f32_16x16x32_bf16 v[168:171], a[232:235], v[96:99], v[168:171]
  ds_read_b64_tr_b16 a[224:225], v16 offset:32768
  buffer_load_dwordx4 v33, s[28:31], s46 offen offset:1024 lds
  v_mfma_f32_16x16x32_bf16 v[168:171], a[236:239], v[104:107], v[168:171]
  ds_read_b64_tr_b16 a[226:227], v18 offset:33280
  v_mul_f32 v9, v246, v9
  v_mfma_f32_16x16x32_bf16 v[172:175], a[232:235], v[100:103], v[172:175]
  ds_read_b64_tr_b16 a[228:229], v16 offset:36864
  v_mul_f32 v10, v247, v10
  v_mfma_f32_16x16x32_bf16 v[172:175], a[236:239], v[108:111], v[172:175]
  s_waitcnt lgkmcnt(3)
  ds_read_b64_tr_b16 a[230:231], v18 offset:37376
  ds_read_b64_tr_b16 a[232:233], v17 offset:32768
  v_mfma_f32_16x16x32_bf16 v[176:179], a[240:243], v[96:99], v[176:179]
  v_exp_f32 v7, v7
  v_mfma_f32_16x16x32_bf16 v[176:179], a[244:247], v[104:107], v[176:179]
  ds_read_b64_tr_b16 a[234:235], v19 offset:33280
  buffer_load_dwordx4 v34, s[28:31], s46 offen offset:2048 lds
  v_mfma_f32_16x16x32_bf16 v[180:183], a[240:243], v[100:103], v[180:183]
  ds_read_b64_tr_b16 a[236:237], v17 offset:36864
  ds_read_b64_tr_b16 a[238:239], v19 offset:37376
  v_mfma_f32_16x16x32_bf16 v[180:183], a[244:247], v[108:111], v[180:183]
  v_exp_f32 v8, v8
  v_mfma_f32_16x16x32_bf16 v[184:187], a[248:251], v[96:99], v[184:187]
  ds_read_b64_tr_b16 a[240:241], v18 offset:32768
  buffer_load_dwordx4 v35, s[28:31], s46 offen offset:3072 lds
  v_mfma_f32_16x16x32_bf16 v[184:187], a[252:255], v[104:107], v[184:187]
  ds_read_b64_tr_b16 a[242:243], v16 offset:33280
  ds_read_b64_tr_b16 a[244:245], v18 offset:36864
  v_mfma_f32_16x16x32_bf16 v[188:191], a[248:251], v[100:103], v[188:191]
  s_add_u32 s100, s57, 128
  v_exp_f32 v9, v9
  v_mfma_f32_16x16x32_bf16 v[188:191], a[252:255], v[108:111], v[188:191]
  s_waitcnt lgkmcnt(3)
  ds_read_b64_tr_b16 a[246:247], v16 offset:37376
  ds_read_b64_tr_b16 a[248:249], v19 offset:32768
  v_mfma_f32_16x16x32_bf16 v[160:163], a[224:227], v[112:115], v[160:163]
  v_exp_f32 v10, v10
  v_mfma_f32_16x16x32_bf16 v[160:163], a[228:231], v[120:123], v[160:163]
  ds_read_b64_tr_b16 a[250:251], v17 offset:33280
  buffer_load_dword v47, v11, s[28:31], s100 offen
  v_mfma_f32_16x16x32_bf16 v[164:167], a[224:227], v[116:119], v[164:167]
  ds_read_b64_tr_b16 a[252:253], v19 offset:36864
  v_fma_f32 v7, v7, v43, v43
  v_mfma_f32_16x16x32_bf16 v[164:167], a[228:231], v[124:127], v[164:167]
  ds_read_b64_tr_b16 a[254:255], v17 offset:37376
  v_fma_f32 v8, v8, v43, v43
  v_mfma_f32_16x16x32_bf16 v[168:171], a[232:235], v[112:115], v[168:171]
  ds_read_b64_tr_b16 a[224:225], v16 offset:40960
  buffer_store_dwordx4 v[192:195], v1, s[36:39], s56 offen offset:0 sc1
  v_mfma_f32_16x16x32_bf16 v[168:171], a[236:239], v[120:123], v[168:171]
  ds_read_b64_tr_b16 a[226:227], v18 offset:41472
  v_fma_f32 v9, v9, v43, v43
  v_mfma_f32_16x16x32_bf16 v[172:175], a[232:235], v[116:119], v[172:175]
  ds_read_b64_tr_b16 a[228:229], v16 offset:45056
  v_fma_f32 v10, v10, v43, v43
  v_mfma_f32_16x16x32_bf16 v[172:175], a[236:239], v[124:127], v[172:175]
  s_waitcnt lgkmcnt(3)
  ds_read_b64_tr_b16 a[230:231], v18 offset:45568
  ds_read_b64_tr_b16 a[232:233], v17 offset:40960
  v_mfma_f32_16x16x32_bf16 v[176:179], a[240:243], v[112:115], v[176:179]
  v_rcp_f32 v7, v7
  v_mfma_f32_16x16x32_bf16 v[176:179], a[244:247], v[120:123], v[176:179]
  ds_read_b64_tr_b16 a[234:235], v19 offset:41472
  buffer_store_dwordx4 v[196:199], v2, s[36:39], s56 offen offset:0 sc1
  v_mfma_f32_16x16x32_bf16 v[180:183], a[240:243], v[116:119], v[180:183]
  ds_read_b64_tr_b16 a[236:237], v17 offset:45056
  ds_read_b64_tr_b16 a[238:239], v19 offset:45568
  v_mfma_f32_16x16x32_bf16 v[180:183], a[244:247], v[124:127], v[180:183]
  v_rcp_f32 v8, v8
  v_mfma_f32_16x16x32_bf16 v[184:187], a[248:251], v[112:115], v[184:187]
  ds_read_b64_tr_b16 a[240:241], v18 offset:40960
  buffer_store_dwordx4 v[208:211], v1, s[36:39], s56 offen offset:1024 sc1
  v_mfma_f32_16x16x32_bf16 v[184:187], a[252:255], v[120:123], v[184:187]
  ds_read_b64_tr_b16 a[242:243], v16 offset:41472
  ds_read_b64_tr_b16 a[244:245], v18 offset:45056
  v_mfma_f32_16x16x32_bf16 v[188:191], a[248:251], v[116:119], v[188:191]
  v_rcp_f32 v9, v9
  v_mfma_f32_16x16x32_bf16 v[188:191], a[252:255], v[124:127], v[188:191]
  s_waitcnt lgkmcnt(3)
  ds_read_b64_tr_b16 a[246:247], v16 offset:45568
  ds_read_b64_tr_b16 a[248:249], v19 offset:40960
  v_mfma_f32_16x16x32_bf16 v[160:163], a[224:227], a[192:195], v[160:163]
  v_rcp_f32 v10, v10
  v_mfma_f32_16x16x32_bf16 v[160:163], a[228:231], a[200:203], v[160:163]
  ds_read_b64_tr_b16 a[250:251], v17 offset:41472
  buffer_store_dwordx4 v[212:215], v2, s[36:39], s56 offen offset:1024 sc1
  v_mfma_f32_16x16x32_bf16 v[164:167], a[224:227], a[196:199], v[164:167]
  ds_read_b64_tr_b16 a[252:253], v19 offset:45056
  v_mul_f32 v244, v244, v7
  v_mfma_f32_16x16x32_bf16 v[164:167], a[228:231], a[204:207], v[164:167]
  ds_read_b64_tr_b16 a[254:255], v17 offset:45568
  v_mul_f32 v245, v245, v8
  v_mfma_f32_16x16x32_bf16 v[168:171], a[232:235], a[192:195], v[168:171]
  ds_read_b64_tr_b16 a[224:225], v16 offset:49152
  v_mul_f32 v246, v246, v9
  v_mfma_f32_16x16x32_bf16 v[168:171], a[236:239], a[200:203], v[168:171]
  ds_read_b64_tr_b16 a[226:227], v18 offset:49664
  v_mul_f32 v247, v247, v10
  v_mfma_f32_16x16x32_bf16 v[172:175], a[232:235], a[196:199], v[172:175]
  ds_read_b64_tr_b16 a[228:229], v16 offset:53248
  v_mul_f32 v7, v248, v248
  v_mfma_f32_16x16x32_bf16 v[172:175], a[236:239], a[204:207], v[172:175]
  s_waitcnt lgkmcnt(3)
  ds_read_b64_tr_b16 a[230:231], v18 offset:53760
  v_mul_f32 v8, v249, v249
  v_mfma_f32_16x16x32_bf16 v[176:179], a[240:243], a[192:195], v[176:179]
  ds_read_b64_tr_b16 a[232:233], v17 offset:49152
  v_mul_f32 v9, v250, v250
  v_mfma_f32_16x16x32_bf16 v[176:179], a[244:247], a[200:203], v[176:179]
  ds_read_b64_tr_b16 a[234:235], v19 offset:49664
  v_mul_f32 v10, v251, v251
  v_mfma_f32_16x16x32_bf16 v[180:183], a[240:243], a[196:199], v[180:183]
  ds_read_b64_tr_b16 a[236:237], v17 offset:53248
  v_fma_f32 v7, v7, v46, s62
  v_mfma_f32_16x16x32_bf16 v[180:183], a[244:247], a[204:207], v[180:183]
  ds_read_b64_tr_b16 a[238:239], v19 offset:53760
  v_fma_f32 v8, v8, v46, s62
  v_mfma_f32_16x16x32_bf16 v[184:187], a[248:251], a[192:195], v[184:187]
  ds_read_b64_tr_b16 a[240:241], v18 offset:49152
  v_fma_f32 v9, v9, v46, s62
  v_mfma_f32_16x16x32_bf16 v[184:187], a[252:255], a[200:203], v[184:187]
  ds_read_b64_tr_b16 a[242:243], v16 offset:49664
  v_fma_f32 v10, v10, v46, s62
  v_mfma_f32_16x16x32_bf16 v[188:191], a[248:251], a[196:199], v[188:191]
  ds_read_b64_tr_b16 a[244:245], v18 offset:53248
  v_mul_f32 v7, v248, v7
  v_mfma_f32_16x16x32_bf16 v[188:191], a[252:255], a[204:207], v[188:191]
  s_waitcnt lgkmcnt(3)
  ds_read_b64_tr_b16 a[246:247], v16 offset:53760
  v_mul_f32 v8, v249, v8
  v_mfma_f32_16x16x32_bf16 v[160:163], a[224:227], a[208:211], v[160:163]
  ds_read_b64_tr_b16 a[248:249], v19 offset:49152
  v_mul_f32 v9, v250, v9
  v_mfma_f32_16x16x32_bf16 v[192:195], a[228:231], a[216:219], v[160:163]
  ds_read_b64_tr_b16 a[250:251], v17 offset:49664
  v_mul_f32 v10, v251, v10
  v_mfma_f32_16x16x32_bf16 v[164:167], a[224:227], a[212:215], v[164:167]
  ds_read_b64_tr_b16 a[252:253], v19 offset:53248
  ds_read_b64_tr_b16 a[254:255], v17 offset:53760
  v_mfma_f32_16x16x32_bf16 v[196:199], a[228:231], a[220:223], v[164:167]
  v_exp_f32 v7, v7
  v_mfma_f32_16x16x32_bf16 v[168:171], a[232:235], a[208:211], v[168:171]
  v_exp_f32 v8, v8
  v_mfma_f32_16x16x32_bf16 v[200:203], a[236:239], a[216:219], v[168:171]
  v_exp_f32 v9, v9
  v_mfma_f32_16x16x32_bf16 v[172:175], a[232:235], a[212:215], v[172:175]
  v_exp_f32 v10, v10
  v_mfma_f32_16x16x32_bf16 v[204:207], a[236:239], a[220:223], v[172:175]
  s_waitcnt vmcnt(5) lgkmcnt(0)
  s_barrier
  v_mfma_f32_16x16x32_bf16 v[176:179], a[240:243], a[208:211], v[176:179]
  ds_read_b64_tr_b16 v[48:49], v12 offset:0
  ds_read_b64_tr_b16 v[50:51], v14 offset:512
  v_mfma_f32_16x16x32_bf16 v[208:211], a[244:247], a[216:219], v[176:179]
  ds_read_b64_tr_b16 v[52:53], v12 offset:4096
  ds_read_b64_tr_b16 v[54:55], v14 offset:4608
  v_mfma_f32_16x16x32_bf16 v[180:183], a[240:243], a[212:215], v[180:183]
  ds_read_b64_tr_b16 v[56:57], v13 offset:0
  ds_read_b64_tr_b16 v[58:59], v15 offset:512
  v_mfma_f32_16x16x32_bf16 v[212:215], a[244:247], a[220:223], v[180:183]
  ds_read_b64_tr_b16 v[60:61], v13 offset:4096
  ds_read_b64_tr_b16 v[62:63], v15 offset:4608
  ds_read_b64_tr_b16 v[64:65], v14 offset:0
  v_mfma_f32_16x16x32_bf16 v[184:187], a[248:251], a[208:211], v[184:187]
  ds_read_b64_tr_b16 v[66:67], v12 offset:512
  v_fma_f32 v7, v7, v42, v42
  v_mfma_f32_16x16x32_bf16 v[216:219], a[252:255], a[216:219], v[184:187]
  ds_read_b64_tr_b16 v[68:69], v14 offset:4096
  v_fma_f32 v8, v8, v42, v42
  v_mfma_f32_16x16x32_bf16 v[188:191], a[248:251], a[212:215], v[188:191]
  ds_read_b64_tr_b16 v[70:71], v12 offset:4608
  v_fma_f32 v9, v9, v42, v42
  v_mfma_f32_16x16x32_bf16 v[220:223], a[252:255], a[220:223], v[188:191]
  v_fma_f32 v10, v10, v42, v42
  s_waitcnt lgkmcnt(8)
  v_mfma_f32_16x16x32_bf16 v[80:83], v[48:51], a[0:3], 0
  s_add_u32 s46, s57, 4194304
  ds_read_b64_tr_b16 v[72:73], v15 offset:0
  ds_read_b64_tr_b16 v[74:75], v13 offset:512
  v_mfma_f32_16x16x32_bf16 v[80:83], v[52:55], a[8:11], v[80:83]
  s_add_u32 m0, s45, 65536
  s_add_u32 s56, s53, 6144
  ds_read_b64_tr_b16 v[76:77], v15 offset:4096
  v_mfma_f32_16x16x32_bf16 v[84:87], v[48:51], a[4:7], 0
  v_rcp_f32 v7, v7
  v_mfma_f32_16x16x32_bf16 v[84:87], v[52:55], a[12:15], v[84:87]
  s_waitcnt lgkmcnt(7)
  ds_read_b64_tr_b16 v[78:79], v13 offset:4608
  buffer_load_dwordx4 v20, s[28:31], s46 offen offset:0 lds
  v_mfma_f32_16x16x32_bf16 v[88:91], v[56:59], a[0:3], 0
  ds_read_b64_tr_b16 v[48:49], v12 offset:8192
  ds_read_b64_tr_b16 v[50:51], v14 offset:8704
  v_mfma_f32_16x16x32_bf16 v[88:91], v[60:63], a[8:11], v[88:91]
  v_rcp_f32 v8, v8
  v_mfma_f32_16x16x32_bf16 v[92:95], v[56:59], a[4:7], 0
  ds_read_b64_tr_b16 v[52:53], v12 offset:12288
  buffer_load_dwordx4 v21, s[28:31], s46 offen offset:1024 lds
  v_mfma_f32_16x16x32_bf16 v[92:95], v[60:63], a[12:15], v[92:95]
  s_waitcnt lgkmcnt(3)
  ds_read_b64_tr_b16 v[54:55], v14 offset:12800
  ds_read_b64_tr_b16 v[56:57], v13 offset:8192
  v_mfma_f32_16x16x32_bf16 v[96:99], v[64:67], a[0:3], 0
  v_rcp_f32 v9, v9
  v_mfma_f32_16x16x32_bf16 v[96:99], v[68:71], a[8:11], v[96:99]
  ds_read_b64_tr_b16 v[58:59], v15 offset:8704
  ds_read_b64_tr_b16 v[60:61], v13 offset:12288
  v_mfma_f32_16x16x32_bf16 v[100:103], v[64:67], a[4:7], 0
  v_rcp_f32 v10, v10
  v_mfma_f32_16x16x32_bf16 v[100:103], v[68:71], a[12:15], v[100:103]
  ds_read_b64_tr_b16 v[62:63], v15 offset:12800
  buffer_load_dwordx4 v22, s[28:31], s46 offen offset:2048 lds
  v_mfma_f32_16x16x32_bf16 v[104:107], v[72:75], a[0:3], 0
  ds_read_b64_tr_b16 v[64:65], v14 offset:8192
  v_cvt_pk_bf16_f32 v192, v192, v193
  v_mfma_f32_16x16x32_bf16 v[104:107], v[76:79], a[8:11], v[104:107]
  ds_read_b64_tr_b16 v[66:67], v12 offset:8704
  v_cvt_pk_bf16_f32 v193, v194, v195
  v_mfma_f32_16x16x32_bf16 v[108:111], v[72:75], a[4:7], 0
  ds_read_b64_tr_b16 v[68:69], v14 offset:12288
  buffer_load_dwordx4 v23, s[28:31], s46 offen offset:3072 lds
  v_mfma_f32_16x16x32_bf16 v[108:111], v[76:79], a[12:15], v[108:111]
  s_waitcnt lgkmcnt(3)
  ds_read_b64_tr_b16 v[70:71], v12 offset:12800
  v_cvt_pk_bf16_f32 v194, v200, v201
  v_mfma_f32_16x16x32_bf16 v[80:83], v[48:51], a[16:19], v[80:83]
  s_add_u32 m0, s45, 69632
  ds_read_b64_tr_b16 v[72:73], v15 offset:8192
  v_cvt_pk_bf16_f32 v195, v202, v203
  v_mfma_f32_16x16x32_bf16 v[80:83], v[52:55], a[24:27], v[80:83]
  ds_read_b64_tr_b16 v[74:75], v13 offset:8704
  v_cvt_pk_bf16_f32 v196, v196, v197
  v_mfma_f32_16x16x32_bf16 v[84:87], v[48:51], a[20:23], v[84:87]
  ds_read_b64_tr_b16 v[76:77], v15 offset:12288
  buffer_load_dwordx4 v24, s[28:31], s46 offen offset:0 lds
  v_mfma_f32_16x16x32_bf16 v[84:87], v[52:55], a[28:31], v[84:87]
  ds_read_b64_tr_b16 v[78:79], v13 offset:12800
  v_cvt_pk_bf16_f32 v197, v198, v199
  v_mfma_f32_16x16x32_bf16 v[88:91], v[56:59], a[16:19], v[88:91]
  ds_read_b64_tr_b16 v[48:49], v12 offset:16384
  v_cvt_pk_bf16_f32 v198, v204, v205
  v_mfma_f32_16x16x32_bf16 v[88:91], v[60:63], a[24:27], v[88:91]
  ds_read_b64_tr_b16 v[50:51], v14 offset:16896
  v_cvt_pk_bf16_f32 v199, v206, v207
  v_mfma_f32_16x16x32_bf16 v[92:95], v[56:59], a[20:23], v[92:95]
  ds_read_b64_tr_b16 v[52:53], v12 offset:20480
  buffer_load_dwordx4 v25, s[28:31], s46 offen offset:1024 lds
  v_mfma_f32_16x16x32_bf16 v[92:95], v[60:63], a[28:31], v[92:95]
  s_waitcnt lgkmcnt(3)
  ds_read_b64_tr_b16 v[54:55], v14 offset:20992
  v_cvt_pk_bf16_f32 v208, v208, v209
  v_mfma_f32_16x16x32_bf16 v[96:99], v[64:67], a[16:19], v[96:99]
  ds_read_b64_tr_b16 v[56:57], v13 offset:16384
  v_cvt_pk_bf16_f32 v209, v210, v211
  v_mfma_f32_16x16x32_bf16 v[96:99], v[68:71], a[24:27], v[96:99]
  ds_read_b64_tr_b16 v[58:59], v15 offset:16896
  v_cvt_pk_bf16_f32 v210, v216, v217
  v_mfma_f32_16x16x32_bf16 v[100:103], v[64:67], a[20:23], v[100:103]
  ds_read_b64_tr_b16 v[60:61], v13 offset:20480
  buffer_load_dwordx4 v26, s[28:31], s46 offen offset:2048 lds
  v_mfma_f32_16x16x32_bf16 v[100:103], v[68:71], a[28:31], v[100:103]
  ds_read_b64_tr_b16 v[62:63], v15 offset:20992
  v_cvt_pk_bf16_f32 v211, v218, v219
  v_mfma_f32_16x16x32_bf16 v[104:107], v[72:75], a[16:19], v[104:107]
  ds_read_b64_tr_b16 v[64:65], v14 offset:16384
  v_cvt_pk_bf16_f32 v212, v212, v213
  v_mfma_f32_16x16x32_bf16 v[104:107], v[76:79], a[24:27], v[104:107]
  ds_read_b64_tr_b16 v[66:67], v12 offset:16896
  v_cvt_pk_bf16_f32 v213, v214, v215
  v_mfma_f32_16x16x32_bf16 v[108:111], v[72:75], a[20:23], v[108:111]
  ds_read_b64_tr_b16 v[68:69], v14 offset:20480
  buffer_load_dwordx4 v27, s[28:31], s46 offen offset:3072 lds
  v_mfma_f32_16x16x32_bf16 v[108:111], v[76:79], a[28:31], v[108:111]
  s_waitcnt lgkmcnt(3)
  ds_read_b64_tr_b16 v[70:71], v12 offset:20992
  v_cvt_pk_bf16_f32 v214, v220, v221
  v_mfma_f32_16x16x32_bf16 v[80:83], v[48:51], a[32:35], v[80:83]
  s_add_u32 m0, s45, 73728
  ds_read_b64_tr_b16 v[72:73], v15 offset:16384
  v_cvt_pk_bf16_f32 v215, v222, v223
  v_mfma_f32_16x16x32_bf16 v[80:83], v[52:55], a[40:43], v[80:83]
  ds_read_b64_tr_b16 v[74:75], v13 offset:16896
  buffer_load_dwordx4 v28, s[28:31], s46 offen offset:0 lds
  v_mfma_f32_16x16x32_bf16 v[84:87], v[48:51], a[36:39], v[84:87]
  ds_read_b64_tr_b16 v[76:77], v15 offset:20480
  v_mul_f32 v248, v248, v7
  v_mfma_f32_16x16x32_bf16 v[84:87], v[52:55], a[44:47], v[84:87]
  ds_read_b64_tr_b16 v[78:79], v13 offset:20992
  v_mul_f32 v249, v249, v8
  v_mfma_f32_16x16x32_bf16 v[88:91], v[56:59], a[32:35], v[88:91]
  ds_read_b64_tr_b16 v[48:49], v12 offset:24576
  v_mul_f32 v250, v250, v9
  v_mfma_f32_16x16x32_bf16 v[88:91], v[60:63], a[40:43], v[88:91]
  ds_read_b64_tr_b16 v[50:51], v14 offset:25088
  buffer_load_dwordx4 v29, s[28:31], s46 offen offset:1024 lds
  v_mfma_f32_16x16x32_bf16 v[92:95], v[56:59], a[36:39], v[92:95]
  ds_read_b64_tr_b16 v[52:53], v12 offset:28672
  s_waitcnt vmcnt(31)
  ds_read_b128 a[192:195], v40 offset:0
  v_mfma_f32_16x16x32_bf16 v[92:95], v[60:63], a[44:47], v[92:95]
  s_waitcnt lgkmcnt(4)
  ds_read_b64_tr_b16 v[54:55], v14 offset:29184
  ds_read_b128 a[196:199], v40 offset:2048
  v_mfma_f32_16x16x32_bf16 v[96:99], v[64:67], a[32:35], v[96:99]
  ds_read_b64_tr_b16 v[56:57], v13 offset:24576
  ds_read_b128 a[200:203], v41 offset:0
  v_mfma_f32_16x16x32_bf16 v[96:99], v[68:71], a[40:43], v[96:99]
  ds_read_b64_tr_b16 v[58:59], v15 offset:25088
  ds_read_b128 a[204:207], v41 offset:2048
  v_mfma_f32_16x16x32_bf16 v[100:103], v[64:67], a[36:39], v[100:103]
  ds_read_b64_tr_b16 v[60:61], v13 offset:28672
  ds_read_b128 a[208:211], v40 offset:4096
  v_mfma_f32_16x16x32_bf16 v[100:103], v[68:71], a[44:47], v[100:103]
  ds_read_b64_tr_b16 v[62:63], v15 offset:29184
  ds_read_b128 a[212:215], v40 offset:6144
  v_mfma_f32_16x16x32_bf16 v[104:107], v[72:75], a[32:35], v[104:107]
  ds_read_b64_tr_b16 v[64:65], v14 offset:24576
  ds_read_b128 a[216:219], v41 offset:4096
  v_mfma_f32_16x16x32_bf16 v[104:107], v[76:79], a[40:43], v[104:107]
  ds_read_b64_tr_b16 v[66:67], v12 offset:25088
  ds_read_b128 a[220:223], v41 offset:6144
  v_mfma_f32_16x16x32_bf16 v[108:111], v[72:75], a[36:39], v[108:111]
  ds_read_b64_tr_b16 v[68:69], v14 offset:28672
  buffer_load_dwordx4 v30, s[28:31], s46 offen offset:2048 lds
  v_mfma_f32_16x16x32_bf16 v[108:111], v[76:79], a[44:47], v[108:111]
  s_waitcnt lgkmcnt(6)
  ds_read_b64_tr_b16 v[70:71], v12 offset:29184
  v_mul_f32 v251, v251, v10
  v_mfma_f32_16x16x32_bf16 v[80:83], v[48:51], a[48:51], v[80:83]
  ds_read_b64_tr_b16 v[72:73], v15 offset:24576
  v_mul_f32 v7, v252, v252
  v_mfma_f32_16x16x32_bf16 v[80:83], v[52:55], a[56:59], v[80:83]
  ds_read_b64_tr_b16 v[74:75], v13 offset:25088
  buffer_load_dwordx4 v31, s[28:31], s46 offen offset:3072 lds
  v_mfma_f32_16x16x32_bf16 v[84:87], v[48:51], a[52:55], v[84:87]
  s_add_u32 m0, s45, 77824
  ds_read_b64_tr_b16 v[76:77], v15 offset:28672
  v_mul_f32 v8, v253, v253
  v_mfma_f32_16x16x32_bf16 v[84:87], v[52:55], a[60:63], v[84:87]
  ds_read_b64_tr_b16 v[78:79], v13 offset:29184
  v_mul_f32 v9, v254, v254
  v_mfma_f32_16x16x32_bf16 v[88:91], v[56:59], a[48:51], v[88:91]
  ds_read_b64_tr_b16 v[48:49], v12 offset:32768
  v_mul_f32 v10, v255, v255
  v_mfma_f32_16x16x32_bf16 v[88:91], v[60:63], a[56:59], v[88:91]
  ds_read_b64_tr_b16 v[50:51], v14 offset:33280
  buffer_load_dwordx4 v32, s[28:31], s46 offen offset:0 lds
  v_mfma_f32_16x16x32_bf16 v[92:95], v[56:59], a[52:55], v[92:95]
  ds_read_b64_tr_b16 v[52:53], v12 offset:36864
  v_fma_f32 v7, v7, v46, s62
  v_mfma_f32_16x16x32_bf16 v[92:95], v[60:63], a[60:63], v[92:95]
  s_waitcnt lgkmcnt(3)
  ds_read_b64_tr_b16 v[54:55], v14 offset:37376
  v_fma_f32 v8, v8, v46, s62
  v_mfma_f32_16x16x32_bf16 v[96:99], v[64:67], a[48:51], v[96:99]
  ds_read_b64_tr_b16 v[56:57], v13 offset:32768
  v_fma_f32 v9, v9, v46, s62
  v_mfma_f32_16x16x32_bf16 v[96:99], v[68:71], a[56:59], v[96:99]
  ds_read_b64_tr_b16 v[58:59], v15 offset:33280
  buffer_load_dwordx4 v33, s[28:31], s46 offen offset:1024 lds
  v_mfma_f32_16x16x32_bf16 v[100:103], v[64:67], a[52:55], v[100:103]
  ds_read_b64_tr_b16 v[60:61], v13 offset:36864
  v_fma_f32 v10, v10, v46, s62
  v_mfma_f32_16x16x32_bf16 v[100:103], v[68:71], a[60:63], v[100:103]
  ds_read_b64_tr_b16 v[62:63], v15 offset:37376
  v_mul_f32 v7, v252, v7
  v_mfma_f32_16x16x32_bf16 v[104:107], v[72:75], a[48:51], v[104:107]
  ds_read_b64_tr_b16 v[64:65], v14 offset:32768
  v_mul_f32 v8, v253, v8
  v_mfma_f32_16x16x32_bf16 v[104:107], v[76:79], a[56:59], v[104:107]
  ds_read_b64_tr_b16 v[66:67], v12 offset:33280
  buffer_load_dwordx4 v34, s[28:31], s46 offen offset:2048 lds
  v_mfma_f32_16x16x32_bf16 v[108:111], v[72:75], a[52:55], v[108:111]
  ds_read_b64_tr_b16 v[68:69], v14 offset:36864
  v_mul_f32 v9, v254, v9
  v_mfma_f32_16x16x32_bf16 v[108:111], v[76:79], a[60:63], v[108:111]
  s_waitcnt lgkmcnt(3)
  ds_read_b64_tr_b16 v[70:71], v12 offset:37376
  v_mul_f32 v10, v255, v10
  v_mfma_f32_16x16x32_bf16 v[80:83], v[48:51], a[64:67], v[80:83]
  ds_read_b64_tr_b16 v[72:73], v15 offset:32768
  buffer_load_dwordx4 v35, s[28:31], s46 offen offset:3072 lds
  v_mfma_f32_16x16x32_bf16 v[80:83], v[52:55], a[72:75], v[80:83]
  s_add_u32 m0, s48, 0
  ds_read_b64_tr_b16 v[74:75], v13 offset:33280
  ds_read_b64_tr_b16 v[76:77], v15 offset:36864
  v_mfma_f32_16x16x32_bf16 v[84:87], v[48:51], a[68:71], v[84:87]
  s_movk_i32 s60, 1792
  v_exp_f32 v7, v7
  v_mfma_f32_16x16x32_bf16 v[84:87], v[52:55], a[76:79], v[84:87]
  ds_read_b64_tr_b16 v[78:79], v13 offset:37376
  ds_read_b64_tr_b16 v[48:49], v12 offset:40960
  v_mfma_f32_16x16x32_bf16 v[88:91], v[56:59], a[64:67], v[88:91]
  v_exp_f32 v8, v8
  v_mfma_f32_16x16x32_bf16 v[88:91], v[60:63], a[72:75], v[88:91]
  ds_read_b64_tr_b16 v[50:51], v14 offset:41472
  buffer_store_dwordx4 v[192:195], v1, s[36:39], s56 offen offset:0 sc1
  v_mfma_f32_16x16x32_bf16 v[92:95], v[56:59], a[68:71], v[92:95]
  ds_read_b64_tr_b16 v[52:53], v12 offset:45056
  ds_read_b64_tr_b16 v[54:55], v14 offset:45568
  v_mfma_f32_16x16x32_bf16 v[92:95], v[60:63], a[76:79], v[92:95]
  s_waitcnt lgkmcnt(4)
  v_exp_f32 v9, v9
  v_mfma_f32_16x16x32_bf16 v[96:99], v[64:67], a[64:67], v[96:99]
  ds_read_b64_tr_b16 v[56:57], v13 offset:40960
  buffer_store_dwordx4 v[196:199], v2, s[36:39], s56 offen offset:0 sc1
  v_mfma_f32_16x16x32_bf16 v[96:99], v[68:71], a[72:75], v[96:99]
  ds_read_b64_tr_b16 v[58:59], v15 offset:41472
  ds_read_b64_tr_b16 v[60:61], v13 offset:45056
  v_mfma_f32_16x16x32_bf16 v[100:103], v[64:67], a[68:71], v[100:103]
  v_exp_f32 v10, v10
  v_mfma_f32_16x16x32_bf16 v[100:103], v[68:71], a[76:79], v[100:103]
  ds_read_b64_tr_b16 v[62:63], v15 offset:45568
  v_fma_f32 v7, v7, v43, v43
  v_mfma_f32_16x16x32_bf16 v[104:107], v[72:75], a[64:67], v[104:107]
  ds_read_b64_tr_b16 v[64:65], v14 offset:40960
  buffer_store_dwordx4 v[208:211], v1, s[36:39], s56 offen offset:1024 sc1
  v_mfma_f32_16x16x32_bf16 v[104:107], v[76:79], a[72:75], v[104:107]
  ds_read_b64_tr_b16 v[66:67], v12 offset:41472
  v_fma_f32 v8, v8, v43, v43
  v_mfma_f32_16x16x32_bf16 v[108:111], v[72:75], a[68:71], v[108:111]
  ds_read_b64_tr_b16 v[68:69], v14 offset:45056
  v_fma_f32 v9, v9, v43, v43
  v_mfma_f32_16x16x32_bf16 v[108:111], v[76:79], a[76:79], v[108:111]
  s_waitcnt lgkmcnt(3)
  ds_read_b64_tr_b16 v[70:71], v12 offset:45568
  v_fma_f32 v10, v10, v43, v43
  v_mfma_f32_16x16x32_bf16 v[80:83], v[48:51], a[80:83], v[80:83]
  ds_read_b64_tr_b16 v[72:73], v15 offset:40960
  buffer_store_dwordx4 v[212:215], v2, s[36:39], s56 offen offset:1024 sc1
  v_mfma_f32_16x16x32_bf16 v[80:83], v[52:55], a[88:91], v[80:83]
  ds_read_b64_tr_b16 v[74:75], v13 offset:41472
  ds_read_b64_tr_b16 v[76:77], v15 offset:45056
  v_mfma_f32_16x16x32_bf16 v[84:87], v[48:51], a[84:87], v[84:87]
  v_rcp_f32 v7, v7
  v_mfma_f32_16x16x32_bf16 v[84:87], v[52:55], a[92:95], v[84:87]
  ds_read_b64_tr_b16 v[78:79], v13 offset:45568
  ds_read_b64_tr_b16 v[48:49], v12 offset:49152
  v_mfma_f32_16x16x32_bf16 v[88:91], v[56:59], a[80:83], v[88:91]
  v_rcp_f32 v8, v8
  v_mfma_f32_16x16x32_bf16 v[88:91], v[60:63], a[88:91], v[88:91]
  ds_read_b64_tr_b16 v[50:51], v14 offset:49664
  buffer_load_dwordx4 v36, s[12:15], s60 offen offset:0 lds
  v_mfma_f32_16x16x32_bf16 v[92:95], v[56:59], a[84:87], v[92:95]
  ds_read_b64_tr_b16 v[52:53], v12 offset:53248
  ds_read_b64_tr_b16 v[54:55], v14 offset:53760
  v_mfma_f32_16x16x32_bf16 v[92:95], v[60:63], a[92:95], v[92:95]
  s_waitcnt lgkmcnt(4)
  v_rcp_f32 v9, v9
  v_mfma_f32_16x16x32_bf16 v[96:99], v[64:67], a[80:83], v[96:99]
  ds_read_b64_tr_b16 v[56:57], v13 offset:49152
  buffer_load_dwordx4 v37, s[12:15], s60 offen offset:1024 lds
  v_mfma_f32_16x16x32_bf16 v[96:99], v[68:71], a[88:91], v[96:99]
  ds_read_b64_tr_b16 v[58:59], v15 offset:49664
  ds_read_b64_tr_b16 v[60:61], v13 offset:53248
  v_mfma_f32_16x16x32_bf16 v[100:103], v[64:67], a[84:87], v[100:103]
  v_rcp_f32 v10, v10
  v_mfma_f32_16x16x32_bf16 v[100:103], v[68:71], a[92:95], v[100:103]
  ds_read_b64_tr_b16 v[62:63], v15 offset:53760
  v_mul_f32 v252, v252, v7
  v_mfma_f32_16x16x32_bf16 v[104:107], v[72:75], a[80:83], v[104:107]
  ds_read_b64_tr_b16 v[64:65], v14 offset:49152
  buffer_load_dwordx4 v38, s[12:15], s60 offen offset:2048 lds
  v_mfma_f32_16x16x32_bf16 v[104:107], v[76:79], a[88:91], v[104:107]
  ds_read_b64_tr_b16 v[66:67], v12 offset:49664
  v_mul_f32 v253, v253, v8
  v_mfma_f32_16x16x32_bf16 v[108:111], v[72:75], a[84:87], v[108:111]
  ds_read_b64_tr_b16 v[68:69], v14 offset:53248
  v_mul_f32 v254, v254, v9
  v_mfma_f32_16x16x32_bf16 v[108:111], v[76:79], a[92:95], v[108:111]
  s_waitcnt lgkmcnt(3)
  ds_read_b64_tr_b16 v[70:71], v12 offset:53760
  v_mul_f32 v255, v255, v10
  v_mfma_f32_16x16x32_bf16 v[80:83], v[48:51], a[96:99], v[80:83]
  s_add_u32 s63, s54, 4096
  ds_read_b64_tr_b16 v[72:73], v15 offset:49152
  buffer_load_dwordx4 v39, s[12:15], s60 offen offset:3072 lds
  v_mfma_f32_16x16x32_bf16 v[80:83], v[52:55], a[104:107], v[80:83]
  s_add_u32 m0, s48, 4096
  ds_read_b64_tr_b16 v[74:75], v13 offset:49664
  v_mul_f32 v224, v224, v128
  v_mfma_f32_16x16x32_bf16 v[84:87], v[48:51], a[100:103], v[84:87]
  s_movk_i32 s60, 1920
  ds_read_b64_tr_b16 v[76:77], v15 offset:53248
  v_mul_f32 v225, v225, v129
  v_mfma_f32_16x16x32_bf16 v[84:87], v[52:55], a[108:111], v[84:87]
  ds_read_b64_tr_b16 v[78:79], v13 offset:53760
  v_mul_f32 v226, v226, v130
  v_mfma_f32_16x16x32_bf16 v[88:91], v[56:59], a[96:99], v[88:91]
  ds_read_b64_tr_b16 v[48:49], v12 offset:57344
  buffer_load_dwordx4 v36, s[12:15], s60 offen offset:0 lds
  v_mfma_f32_16x16x32_bf16 v[88:91], v[60:63], a[104:107], v[88:91]
  ds_read_b64_tr_b16 v[50:51], v14 offset:57856
  v_mul_f32 v227, v227, v131
  v_mfma_f32_16x16x32_bf16 v[92:95], v[56:59], a[100:103], v[92:95]
  ds_read_b64_tr_b16 v[52:53], v12 offset:61440
  v_cvt_pk_bf16_f32 v128, v224, v225
  v_mfma_f32_16x16x32_bf16 v[92:95], v[60:63], a[108:111], v[92:95]
  s_waitcnt lgkmcnt(3)
  ds_read_b64_tr_b16 v[54:55], v14 offset:61952
  buffer_load_dwordx4 v37, s[12:15], s60 offen offset:1024 lds
  v_mfma_f32_16x16x32_bf16 v[96:99], v[64:67], a[96:99], v[96:99]
  ds_read_b64_tr_b16 v[56:57], v13 offset:57344
  v_cvt_pk_bf16_f32 v129, v226, v227
  v_mfma_f32_16x16x32_bf16 v[96:99], v[68:71], a[104:107], v[96:99]
  ds_read_b64_tr_b16 v[58:59], v15 offset:57856
  v_mul_f32 v232, v232, v136
  v_mfma_f32_16x16x32_bf16 v[100:103], v[64:67], a[100:103], v[100:103]
  ds_read_b64_tr_b16 v[60:61], v13 offset:61440
  v_mul_f32 v233, v233, v137
  v_mfma_f32_16x16x32_bf16 v[100:103], v[68:71], a[108:111], v[100:103]
  ds_read_b64_tr_b16 v[62:63], v15 offset:61952
  buffer_load_dwordx4 v38, s[12:15], s60 offen offset:2048 lds
  v_mfma_f32_16x16x32_bf16 v[104:107], v[72:75], a[96:99], v[104:107]
  ds_read_b64_tr_b16 v[64:65], v14 offset:57344
  v_mul_f32 v234, v234, v138
  v_mfma_f32_16x16x32_bf16 v[104:107], v[76:79], a[104:107], v[104:107]
  ds_read_b64_tr_b16 v[66:67], v12 offset:57856
  v_mul_f32 v235, v235, v139
  v_mfma_f32_16x16x32_bf16 v[108:111], v[72:75], a[100:103], v[108:111]
  ds_read_b64_tr_b16 v[68:69], v14 offset:61440
  v_cvt_pk_bf16_f32 v130, v232, v233
  v_mfma_f32_16x16x32_bf16 v[108:111], v[76:79], a[108:111], v[108:111]
  s_waitcnt lgkmcnt(3)
  ds_read_b64_tr_b16 v[70:71], v12 offset:61952
  buffer_load_dwordx4 v39, s[12:15], s60 offen offset:3072 lds
  v_mfma_f32_16x16x32_bf16 v[80:83], v[48:51], a[112:115], v[80:83]
  ds_read_b64_tr_b16 v[72:73], v15 offset:57344
  v_cvt_pk_bf16_f32 v131, v234, v235
  v_mfma_f32_16x16x32_bf16 v[80:83], v[52:55], a[120:123], v[80:83]
  ds_read_b64_tr_b16 v[74:75], v13 offset:57856
  v_mfma_f32_16x16x32_bf16 v[84:87], v[48:51], a[116:119], v[84:87]
  ds_read_b64_tr_b16 v[76:77], v15 offset:61440
  v_mfma_f32_16x16x32_bf16 v[84:87], v[52:55], a[124:127], v[84:87]
  ds_read_b64_tr_b16 v[78:79], v13 offset:61952
  buffer_store_dwordx4 v[128:131], v1, s[36:39], s63 offen offset:0 sc1
  v_mfma_f32_16x16x32_bf16 v[88:91], v[56:59], a[112:115], v[88:91]
  v_mul_f32 v228, v228, v132
  v_mul_f32 v229, v229, v133
  v_mfma_f32_16x16x32_bf16 v[88:91], v[60:63], a[120:123], v[88:91]
  v_mul_f32 v230, v230, v134
  v_mul_f32 v231, v231, v135
  v_mfma_f32_16x16x32_bf16 v[92:95], v[56:59], a[116:119], v[92:95]
  v_cvt_pk_bf16_f32 v132, v228, v229
  v_cvt_pk_bf16_f32 v133, v230, v231
  v_mfma_f32_16x16x32_bf16 v[92:95], v[60:63], a[124:127], v[92:95]
  s_waitcnt vmcnt(13) lgkmcnt(0)
  s_barrier
  v_mfma_f32_16x16x32_bf16 v[96:99], v[64:67], a[112:115], v[96:99]
  ds_read_b64_tr_b16 v[48:49], v16 offset:0
  ds_read_b64_tr_b16 v[50:51], v18 offset:512
  v_mfma_f32_16x16x32_bf16 v[96:99], v[68:71], a[120:123], v[96:99]
  ds_read_b64_tr_b16 v[52:53], v16 offset:4096
  ds_read_b64_tr_b16 v[54:55], v18 offset:4608
  v_mfma_f32_16x16x32_bf16 v[100:103], v[64:67], a[116:119], v[100:103]
  ds_read_b64_tr_b16 v[56:57], v17 offset:0
  ds_read_b64_tr_b16 v[58:59], v19 offset:512
  v_mfma_f32_16x16x32_bf16 v[100:103], v[68:71], a[124:127], v[100:103]
  ds_read_b64_tr_b16 v[60:61], v17 offset:4096
  ds_read_b64_tr_b16 v[62:63], v19 offset:4608
  ds_read_b64_tr_b16 v[64:65], v18 offset:0
  v_mfma_f32_16x16x32_bf16 v[104:107], v[72:75], a[112:115], v[104:107]
  ds_read_b64_tr_b16 v[66:67], v16 offset:512
  v_mul_f32 v236, v236, v140
  v_mfma_f32_16x16x32_bf16 v[104:107], v[76:79], a[120:123], v[104:107]
  ds_read_b64_tr_b16 v[68:69], v18 offset:4096
  v_mul_f32 v237, v237, v141
  v_mfma_f32_16x16x32_bf16 v[108:111], v[72:75], a[116:119], v[108:111]
  ds_read_b64_tr_b16 v[70:71], v16 offset:4608
  v_mul_f32 v238, v238, v142
  v_mfma_f32_16x16x32_bf16 v[108:111], v[76:79], a[124:127], v[108:111]
  v_mul_f32 v239, v239, v143
  v_cvt_pk_bf16_f32 v134, v236, v237
  s_waitcnt lgkmcnt(8)
  v_mfma_f32_16x16x32_bf16 v[80:83], v[48:51], a[128:131], v[80:83]
  s_add_u32 s46, s57, 128
  ds_read_b64_tr_b16 v[72:73], v19 offset:0
  v_cvt_pk_bf16_f32 v135, v238, v239
  v_mfma_f32_16x16x32_bf16 v[80:83], v[52:55], a[136:139], v[80:83]
  s_add_u32 m0, s45, 0
  ds_read_b64_tr_b16 v[74:75], v17 offset:512
  buffer_load_dwordx4 v20, s[96:99], s46 offen offset:0 lds
  v_mfma_f32_16x16x32_bf16 v[84:87], v[48:51], a[132:135], v[84:87]
  ds_read_b64_tr_b16 v[76:77], v19 offset:4096
  v_mfma_f32_16x16x32_bf16 v[84:87], v[52:55], a[140:143], v[84:87]
  s_waitcnt lgkmcnt(7)
  ds_read_b64_tr_b16 v[78:79], v17 offset:4608
  v_mfma_f32_16x16x32_bf16 v[88:91], v[56:59], a[128:131], v[88:91]
  ds_read_b64_tr_b16 v[48:49], v16 offset:8192
  buffer_load_dwordx4 v21, s[96:99], s46 offen offset:1024 lds
  v_mfma_f32_16x16x32_bf16 v[88:91], v[60:63], a[136:139], v[88:91]
  ds_read_b64_tr_b16 v[50:51], v18 offset:8704
  v_mfma_f32_16x16x32_bf16 v[92:95], v[56:59], a[132:135], v[92:95]
  ds_read_b64_tr_b16 v[52:53], v16 offset:12288
  v_mfma_f32_16x16x32_bf16 v[92:95], v[60:63], a[140:143], v[92:95]
  s_waitcnt lgkmcnt(3)
  ds_read_b64_tr_b16 v[54:55], v18 offset:12800
  v_mfma_f32_16x16x32_bf16 v[96:99], v[64:67], a[128:131], v[96:99]
  ds_read_b64_tr_b16 v[56:57], v17 offset:8192
  buffer_load_dwordx4 v22, s[96:99], s46 offen offset:2048 lds
  v_mfma_f32_16x16x32_bf16 v[96:99], v[68:71], a[136:139], v[96:99]
  ds_read_b64_tr_b16 v[58:59], v19 offset:8704
  v_mfma_f32_16x16x32_bf16 v[100:103], v[64:67], a[132:135], v[100:103]
  ds_read_b64_tr_b16 v[60:61], v17 offset:12288
  v_mfma_f32_16x16x32_bf16 v[100:103], v[68:71], a[140:143], v[100:103]
  ds_read_b64_tr_b16 v[62:63], v19 offset:12800
  v_mfma_f32_16x16x32_bf16 v[104:107], v[72:75], a[128:131], v[104:107]
  ds_read_b64_tr_b16 v[64:65], v18 offset:8192
  buffer_load_dwordx4 v23, s[96:99], s46 offen offset:3072 lds
  v_mfma_f32_16x16x32_bf16 v[104:107], v[76:79], a[136:139], v[104:107]
  s_add_u32 m0, s45, 4096
  ds_read_b64_tr_b16 v[66:67], v16 offset:8704
  v_mfma_f32_16x16x32_bf16 v[108:111], v[72:75], a[132:135], v[108:111]
  ds_read_b64_tr_b16 v[68:69], v18 offset:12288
  v_mfma_f32_16x16x32_bf16 v[108:111], v[76:79], a[140:143], v[108:111]
  s_waitcnt lgkmcnt(3)
  ds_read_b64_tr_b16 v[70:71], v16 offset:12800
  v_mfma_f32_16x16x32_bf16 v[80:83], v[48:51], a[144:147], v[80:83]
  ds_read_b64_tr_b16 v[72:73], v19 offset:8192
  buffer_load_dwordx4 v24, s[96:99], s46 offen offset:0 lds
  v_mfma_f32_16x16x32_bf16 v[80:83], v[52:55], a[152:155], v[80:83]
  ds_read_b64_tr_b16 v[74:75], v17 offset:8704
  v_mfma_f32_16x16x32_bf16 v[84:87], v[48:51], a[148:151], v[84:87]
  ds_read_b64_tr_b16 v[76:77], v19 offset:12288
  v_mfma_f32_16x16x32_bf16 v[84:87], v[52:55], a[156:159], v[84:87]
  ds_read_b64_tr_b16 v[78:79], v17 offset:12800
  buffer_load_dwordx4 v25, s[96:99], s46 offen offset:1024 lds
  v_mfma_f32_16x16x32_bf16 v[88:91], v[56:59], a[144:147], v[88:91]
  ds_read_b64_tr_b16 v[48:49], v16 offset:16384
  v_mfma_f32_16x16x32_bf16 v[88:91], v[60:63], a[152:155], v[88:91]
  ds_read_b64_tr_b16 v[50:51], v18 offset:16896
  v_mfma_f32_16x16x32_bf16 v[92:95], v[56:59], a[148:151], v[92:95]
  ds_read_b64_tr_b16 v[52:53], v16 offset:20480
  v_mfma_f32_16x16x32_bf16 v[92:95], v[60:63], a[156:159], v[92:95]
  s_waitcnt lgkmcnt(3)
  ds_read_b64_tr_b16 v[54:55], v18 offset:20992
  buffer_load_dwordx4 v26, s[96:99], s46 offen offset:2048 lds
  v_mfma_f32_16x16x32_bf16 v[96:99], v[64:67], a[144:147], v[96:99]
  ds_read_b64_tr_b16 v[56:57], v17 offset:16384
  v_mfma_f32_16x16x32_bf16 v[96:99], v[68:71], a[152:155], v[96:99]
  ds_read_b64_tr_b16 v[58:59], v19 offset:16896
  v_mfma_f32_16x16x32_bf16 v[100:103], v[64:67], a[148:151], v[100:103]
  ds_read_b64_tr_b16 v[60:61], v17 offset:20480
  v_mfma_f32_16x16x32_bf16 v[100:103], v[68:71], a[156:159], v[100:103]
  ds_read_b64_tr_b16 v[62:63], v19 offset:20992
  buffer_load_dwordx4 v27, s[96:99], s46 offen offset:3072 lds
  v_mfma_f32_16x16x32_bf16 v[104:107], v[72:75], a[144:147], v[104:107]
  s_add_u32 m0, s45, 8192
  ds_read_b64_tr_b16 v[64:65], v18 offset:16384
  v_mfma_f32_16x16x32_bf16 v[104:107], v[76:79], a[152:155], v[104:107]
  ds_read_b64_tr_b16 v[66:67], v16 offset:16896
  v_mfma_f32_16x16x32_bf16 v[108:111], v[72:75], a[148:151], v[108:111]
  ds_read_b64_tr_b16 v[68:69], v18 offset:20480
  v_mfma_f32_16x16x32_bf16 v[108:111], v[76:79], a[156:159], v[108:111]
  s_waitcnt lgkmcnt(3)
  ds_read_b64_tr_b16 v[70:71], v16 offset:20992
  buffer_load_dwordx4 v28, s[96:99], s46 offen offset:0 lds
  v_mfma_f32_16x16x32_bf16 v[80:83], v[48:51], a[160:163], v[80:83]
  ds_read_b64_tr_b16 v[72:73], v19 offset:16384
  v_mfma_f32_16x16x32_bf16 v[80:83], v[52:55], a[168:171], v[80:83]
  ds_read_b64_tr_b16 v[74:75], v17 offset:16896
  v_mfma_f32_16x16x32_bf16 v[84:87], v[48:51], a[164:167], v[84:87]
  ds_read_b64_tr_b16 v[76:77], v19 offset:20480
  v_mfma_f32_16x16x32_bf16 v[84:87], v[52:55], a[172:175], v[84:87]
  ds_read_b64_tr_b16 v[78:79], v17 offset:20992
  buffer_load_dwordx4 v29, s[96:99], s46 offen offset:1024 lds
  v_mfma_f32_16x16x32_bf16 v[88:91], v[56:59], a[160:163], v[88:91]
  ds_read_b64_tr_b16 v[48:49], v16 offset:24576
  v_mfma_f32_16x16x32_bf16 v[88:91], v[60:63], a[168:171], v[88:91]
  ds_read_b64_tr_b16 v[50:51], v18 offset:25088
  v_mfma_f32_16x16x32_bf16 v[92:95], v[56:59], a[164:167], v[92:95]
  ds_read_b64_tr_b16 v[52:53], v16 offset:28672
  s_waitcnt vmcnt(11)
  ds_read_b128 a[224:227], v40 offset:0
  v_mfma_f32_16x16x32_bf16 v[92:95], v[60:63], a[172:175], v[92:95]
  s_waitcnt lgkmcnt(4)
  ds_read_b64_tr_b16 v[54:55], v18 offset:29184
  ds_read_b128 a[228:231], v40 offset:2048
  v_mfma_f32_16x16x32_bf16 v[96:99], v[64:67], a[160:163], v[96:99]
  ds_read_b64_tr_b16 v[56:57], v17 offset:24576
  ds_read_b128 a[232:235], v41 offset:0
  v_mfma_f32_16x16x32_bf16 v[96:99], v[68:71], a[168:171], v[96:99]
  ds_read_b64_tr_b16 v[58:59], v19 offset:25088
  ds_read_b128 a[236:239], v41 offset:2048
  v_mfma_f32_16x16x32_bf16 v[100:103], v[64:67], a[164:167], v[100:103]
  ds_read_b64_tr_b16 v[60:61], v17 offset:28672
  ds_read_b128 a[240:243], v40 offset:4096
  v_mfma_f32_16x16x32_bf16 v[100:103], v[68:71], a[172:175], v[100:103]
  ds_read_b64_tr_b16 v[62:63], v19 offset:29184
  ds_read_b128 a[244:247], v40 offset:6144
  v_mfma_f32_16x16x32_bf16 v[104:107], v[72:75], a[160:163], v[104:107]
  ds_read_b64_tr_b16 v[64:65], v18 offset:24576
  ds_read_b128 a[248:251], v41 offset:4096
  v_mfma_f32_16x16x32_bf16 v[104:107], v[76:79], a[168:171], v[104:107]
  ds_read_b64_tr_b16 v[66:67], v16 offset:25088
  ds_read_b128 a[252:255], v41 offset:6144
  v_mfma_f32_16x16x32_bf16 v[108:111], v[72:75], a[164:167], v[108:111]
  ds_read_b64_tr_b16 v[68:69], v18 offset:28672
  buffer_load_dwordx4 v30, s[96:99], s46 offen offset:2048 lds
  v_mfma_f32_16x16x32_bf16 v[108:111], v[76:79], a[172:175], v[108:111]
  s_waitcnt lgkmcnt(6)
  ds_read_b64_tr_b16 v[70:71], v16 offset:29184
  v_mfma_f32_16x16x32_bf16 v[80:83], v[48:51], a[176:179], v[80:83]
  ds_read_b64_tr_b16 v[72:73], v19 offset:24576
  v_mfma_f32_16x16x32_bf16 v[80:83], v[52:55], a[184:187], v[80:83]
  ds_read_b64_tr_b16 v[74:75], v17 offset:25088
  buffer_load_dwordx4 v31, s[96:99], s46 offen offset:3072 lds
  v_mfma_f32_16x16x32_bf16 v[84:87], v[48:51], a[180:183], v[84:87]
  s_add_u32 m0, s45, 12288
  ds_read_b64_tr_b16 v[76:77], v19 offset:28672
  v_mfma_f32_16x16x32_bf16 v[84:87], v[52:55], a[188:191], v[84:87]
  ds_read_b64_tr_b16 v[78:79], v17 offset:29184
  v_mfma_f32_16x16x32_bf16 v[88:91], v[56:59], a[176:179], v[88:91]
  ds_read_b64_tr_b16 v[48:49], v16 offset:32768
  v_mfma_f32_16x16x32_bf16 v[88:91], v[60:63], a[184:187], v[88:91]
  ds_read_b64_tr_b16 v[50:51], v18 offset:33280
  buffer_load_dwordx4 v32, s[96:99], s46 offen offset:0 lds
  v_mfma_f32_16x16x32_bf16 v[92:95], v[56:59], a[180:183], v[92:95]
  ds_read_b64_tr_b16 v[52:53], v16 offset:36864
  v_mfma_f32_16x16x32_bf16 v[92:95], v[60:63], a[188:191], v[92:95]
  s_waitcnt lgkmcnt(3)
  ds_read_b64_tr_b16 v[54:55], v18 offset:37376
  v_mfma_f32_16x16x32_bf16 v[96:99], v[64:67], a[176:179], v[96:99]
  ds_read_b64_tr_b16 v[56:57], v17 offset:32768
  v_mfma_f32_16x16x32_bf16 v[96:99], v[68:71], a[184:187], v[96:99]
  ds_read_b64_tr_b16 v[58:59], v19 offset:33280
  buffer_load_dwordx4 v33, s[96:99], s46 offen offset:1024 lds
  v_mfma_f32_16x16x32_bf16 v[100:103], v[64:67], a[180:183], v[100:103]
  ds_read_b64_tr_b16 v[60:61], v17 offset:36864
  v_mfma_f32_16x16x32_bf16 v[100:103], v[68:71], a[188:191], v[100:103]
  ds_read_b64_tr_b16 v[62:63], v19 offset:37376
  v_mfma_f32_16x16x32_bf16 v[104:107], v[72:75], a[176:179], v[104:107]
  ds_read_b64_tr_b16 v[64:65], v18 offset:32768
  v_mfma_f32_16x16x32_bf16 v[104:107], v[76:79], a[184:187], v[104:107]
  ds_read_b64_tr_b16 v[66:67], v16 offset:33280
  buffer_load_dwordx4 v34, s[96:99], s46 offen offset:2048 lds
  v_mfma_f32_16x16x32_bf16 v[108:111], v[72:75], a[180:183], v[108:111]
  ds_read_b64_tr_b16 v[68:69], v18 offset:36864
  v_mfma_f32_16x16x32_bf16 v[108:111], v[76:79], a[188:191], v[108:111]
  s_waitcnt lgkmcnt(3)
  ds_read_b64_tr_b16 v[70:71], v16 offset:37376
  v_mfma_f32_16x16x32_bf16 v[80:83], v[48:51], a[192:195], v[80:83]
  ds_read_b64_tr_b16 v[72:73], v19 offset:32768
  buffer_load_dwordx4 v35, s[96:99], s46 offen offset:3072 lds
  v_mfma_f32_16x16x32_bf16 v[80:83], v[52:55], a[200:203], v[80:83]
  s_add_u32 s100, s57, 256
  ds_read_b64_tr_b16 v[74:75], v17 offset:33280
  v_mfma_f32_16x16x32_bf16 v[84:87], v[48:51], a[196:199], v[84:87]
  ds_read_b64_tr_b16 v[76:77], v19 offset:36864
  v_mfma_f32_16x16x32_bf16 v[84:87], v[52:55], a[204:207], v[84:87]
  ds_read_b64_tr_b16 v[78:79], v17 offset:37376
  v_mfma_f32_16x16x32_bf16 v[88:91], v[56:59], a[192:195], v[88:91]
  ds_read_b64_tr_b16 v[48:49], v16 offset:40960
  buffer_load_dword v47, v11, s[28:31], s100 offen
  v_mfma_f32_16x16x32_bf16 v[88:91], v[60:63], a[200:203], v[88:91]
  ds_read_b64_tr_b16 v[50:51], v18 offset:41472
  v_mfma_f32_16x16x32_bf16 v[92:95], v[56:59], a[196:199], v[92:95]
  ds_read_b64_tr_b16 v[52:53], v16 offset:45056
  v_mfma_f32_16x16x32_bf16 v[92:95], v[60:63], a[204:207], v[92:95]
  s_waitcnt lgkmcnt(3)
  ds_read_b64_tr_b16 v[54:55], v18 offset:45568
  v_mfma_f32_16x16x32_bf16 v[96:99], v[64:67], a[192:195], v[96:99]
  ds_read_b64_tr_b16 v[56:57], v17 offset:40960
  buffer_store_dwordx4 v[132:135], v1, s[36:39], s63 offen offset:1024 sc1
  v_mfma_f32_16x16x32_bf16 v[96:99], v[68:71], a[200:203], v[96:99]
  ds_read_b64_tr_b16 v[58:59], v19 offset:41472
  v_mul_f32 v240, v240, v144
  v_mfma_f32_16x16x32_bf16 v[100:103], v[64:67], a[196:199], v[100:103]
  ds_read_b64_tr_b16 v[60:61], v17 offset:45056
  v_mul_f32 v241, v241, v145
  v_mfma_f32_16x16x32_bf16 v[100:103], v[68:71], a[204:207], v[100:103]
  ds_read_b64_tr_b16 v[62:63], v19 offset:45568
  v_mul_f32 v242, v242, v146
  v_mfma_f32_16x16x32_bf16 v[104:107], v[72:75], a[192:195], v[104:107]
  ds_read_b64_tr_b16 v[64:65], v18 offset:40960
  v_mul_f32 v243, v243, v147
  v_mfma_f32_16x16x32_bf16 v[104:107], v[76:79], a[200:203], v[104:107]
  ds_read_b64_tr_b16 v[66:67], v16 offset:41472
  v_cvt_pk_bf16_f32 v144, v240, v241
  v_mfma_f32_16x16x32_bf16 v[108:111], v[72:75], a[196:199], v[108:111]
  ds_read_b64_tr_b16 v[68:69], v18 offset:45056
  v_cvt_pk_bf16_f32 v145, v242, v243
  v_mfma_f32_16x16x32_bf16 v[108:111], v[76:79], a[204:207], v[108:111]
  s_waitcnt lgkmcnt(3)
  ds_read_b64_tr_b16 v[70:71], v16 offset:45568
  v_mul_f32 v248, v248, v152
  v_mfma_f32_16x16x32_bf16 v[80:83], v[48:51], a[208:211], v[80:83]
  ds_read_b64_tr_b16 v[72:73], v19 offset:40960
  v_mul_f32 v249, v249, v153
  v_mfma_f32_16x16x32_bf16 v[80:83], v[52:55], a[216:219], v[80:83]
  ds_read_b64_tr_b16 v[74:75], v17 offset:41472
  v_mul_f32 v250, v250, v154
  v_mfma_f32_16x16x32_bf16 v[84:87], v[48:51], a[212:215], v[84:87]
  ds_read_b64_tr_b16 v[76:77], v19 offset:45056
  v_mul_f32 v251, v251, v155
  v_mfma_f32_16x16x32_bf16 v[84:87], v[52:55], a[220:223], v[84:87]
  ds_read_b64_tr_b16 v[78:79], v17 offset:45568
  v_cvt_pk_bf16_f32 v146, v248, v249
  v_mfma_f32_16x16x32_bf16 v[88:91], v[56:59], a[208:211], v[88:91]
  ds_read_b64_tr_b16 v[48:49], v16 offset:49152
  v_cvt_pk_bf16_f32 v147, v250, v251
  v_mfma_f32_16x16x32_bf16 v[88:91], v[60:63], a[216:219], v[88:91]
  ds_read_b64_tr_b16 v[50:51], v18 offset:49664
  buffer_store_dwordx4 v[144:147], v1, s[36:39], s63 offen offset:2048 sc1
  v_mfma_f32_16x16x32_bf16 v[92:95], v[56:59], a[212:215], v[92:95]
  ds_read_b64_tr_b16 v[52:53], v16 offset:53248
  v_mul_f32 v244, v244, v148
  v_mfma_f32_16x16x32_bf16 v[92:95], v[60:63], a[220:223], v[92:95]
  s_waitcnt lgkmcnt(3)
  ds_read_b64_tr_b16 v[54:55], v18 offset:53760
  v_mul_f32 v245, v245, v149
  v_mfma_f32_16x16x32_bf16 v[96:99], v[64:67], a[208:211], v[96:99]
  ds_read_b64_tr_b16 v[56:57], v17 offset:49152
  v_mul_f32 v246, v246, v150
  v_mfma_f32_16x16x32_bf16 v[96:99], v[68:71], a[216:219], v[96:99]
  ds_read_b64_tr_b16 v[58:59], v19 offset:49664
  v_mul_f32 v247, v247, v151
  v_mfma_f32_16x16x32_bf16 v[100:103], v[64:67], a[212:215], v[100:103]
  ds_read_b64_tr_b16 v[60:61], v17 offset:53248
  v_cvt_pk_bf16_f32 v148, v244, v245
  v_mfma_f32_16x16x32_bf16 v[100:103], v[68:71], a[220:223], v[100:103]
  ds_read_b64_tr_b16 v[62:63], v19 offset:53760
  v_cvt_pk_bf16_f32 v149, v246, v247
  v_mfma_f32_16x16x32_bf16 v[104:107], v[72:75], a[208:211], v[104:107]
  ds_read_b64_tr_b16 v[64:65], v18 offset:49152
  v_mul_f32 v252, v252, v156
  v_mfma_f32_16x16x32_bf16 v[104:107], v[76:79], a[216:219], v[104:107]
  ds_read_b64_tr_b16 v[66:67], v16 offset:49664
  v_mul_f32 v253, v253, v157
  v_mfma_f32_16x16x32_bf16 v[108:111], v[72:75], a[212:215], v[108:111]
  ds_read_b64_tr_b16 v[68:69], v18 offset:53248
  v_mul_f32 v254, v254, v158
  v_mfma_f32_16x16x32_bf16 v[108:111], v[76:79], a[220:223], v[108:111]
  s_waitcnt lgkmcnt(3)
  ds_read_b64_tr_b16 v[70:71], v16 offset:53760
  v_mul_f32 v255, v255, v159
  v_mfma_f32_16x16x32_bf16 v[80:83], v[48:51], a[224:227], v[80:83]
  ds_read_b64_tr_b16 v[72:73], v19 offset:49152
  v_cvt_pk_bf16_f32 v150, v252, v253
  v_mfma_f32_16x16x32_bf16 v[80:83], v[52:55], a[232:235], v[80:83]
  ds_read_b64_tr_b16 v[74:75], v17 offset:49664
  v_cvt_pk_bf16_f32 v151, v254, v255
  v_mfma_f32_16x16x32_bf16 v[84:87], v[48:51], a[228:231], v[84:87]
  ds_read_b64_tr_b16 v[76:77], v19 offset:53248
  buffer_store_dwordx4 v[148:151], v1, s[36:39], s63 offen offset:3072 sc1
  v_mfma_f32_16x16x32_bf16 v[84:87], v[52:55], a[236:239], v[84:87]
  ds_read_b64_tr_b16 v[78:79], v17 offset:53760
  v_mfma_f32_16x16x32_bf16 v[88:91], v[56:59], a[224:227], v[88:91]
  ds_read_b64_tr_b16 v[48:49], v16 offset:57344
  v_mfma_f32_16x16x32_bf16 v[88:91], v[60:63], a[232:235], v[88:91]
  ds_read_b64_tr_b16 v[50:51], v18 offset:57856
  v_mfma_f32_16x16x32_bf16 v[92:95], v[56:59], a[228:231], v[92:95]
  ds_read_b64_tr_b16 v[52:53], v16 offset:61440
  v_mfma_f32_16x16x32_bf16 v[92:95], v[60:63], a[236:239], v[92:95]
  s_waitcnt lgkmcnt(3)
  ds_read_b64_tr_b16 v[54:55], v18 offset:61952
  v_mfma_f32_16x16x32_bf16 v[96:99], v[64:67], a[224:227], v[96:99]
  ds_read_b64_tr_b16 v[56:57], v17 offset:57344
  v_mfma_f32_16x16x32_bf16 v[96:99], v[68:71], a[232:235], v[96:99]
  ds_read_b64_tr_b16 v[58:59], v19 offset:57856
  v_mfma_f32_16x16x32_bf16 v[100:103], v[64:67], a[228:231], v[100:103]
  ds_read_b64_tr_b16 v[60:61], v17 offset:61440
  v_mfma_f32_16x16x32_bf16 v[100:103], v[68:71], a[236:239], v[100:103]
  ds_read_b64_tr_b16 v[62:63], v19 offset:61952
  v_mfma_f32_16x16x32_bf16 v[104:107], v[72:75], a[224:227], v[104:107]
  ds_read_b64_tr_b16 v[64:65], v18 offset:57344
  v_mfma_f32_16x16x32_bf16 v[104:107], v[76:79], a[232:235], v[104:107]
  ds_read_b64_tr_b16 v[66:67], v16 offset:57856
  v_mfma_f32_16x16x32_bf16 v[108:111], v[72:75], a[228:231], v[108:111]
  ds_read_b64_tr_b16 v[68:69], v18 offset:61440
  v_mfma_f32_16x16x32_bf16 v[108:111], v[76:79], a[236:239], v[108:111]
  s_waitcnt lgkmcnt(3)
  ds_read_b64_tr_b16 v[70:71], v16 offset:61952
  v_mfma_f32_16x16x32_bf16 v[80:83], v[48:51], a[240:243], v[80:83]
  ds_read_b64_tr_b16 v[72:73], v19 offset:57344
  v_mfma_f32_16x16x32_bf16 v[112:115], v[52:55], a[248:251], v[80:83]
  ds_read_b64_tr_b16 v[74:75], v17 offset:57856
  v_mfma_f32_16x16x32_bf16 v[84:87], v[48:51], a[244:247], v[84:87]
  ds_read_b64_tr_b16 v[76:77], v19 offset:61440
  v_mfma_f32_16x16x32_bf16 v[116:119], v[52:55], a[252:255], v[84:87]
  ds_read_b64_tr_b16 v[78:79], v17 offset:61952
  v_mfma_f32_16x16x32_bf16 v[88:91], v[56:59], a[240:243], v[88:91]
  v_mfma_f32_16x16x32_bf16 v[120:123], v[60:63], a[248:251], v[88:91]
  v_mfma_f32_16x16x32_bf16 v[92:95], v[56:59], a[244:247], v[92:95]
  v_mfma_f32_16x16x32_bf16 v[124:127], v[60:63], a[252:255], v[92:95]
  s_waitcnt vmcnt(4) lgkmcnt(0)
  s_barrier
  v_mfma_f32_16x16x32_bf16 v[96:99], v[64:67], a[240:243], v[96:99]
  ds_read_b64_tr_b16 v[48:49], v12 offset:0
  ds_read_b64_tr_b16 v[50:51], v14 offset:512
  v_mfma_f32_16x16x32_bf16 v[128:131], v[68:71], a[248:251], v[96:99]
  ds_read_b64_tr_b16 v[52:53], v12 offset:4096
  ds_read_b64_tr_b16 v[54:55], v14 offset:4608
  v_mfma_f32_16x16x32_bf16 v[100:103], v[64:67], a[244:247], v[100:103]
  ds_read_b64_tr_b16 v[56:57], v13 offset:0
  ds_read_b64_tr_b16 v[58:59], v15 offset:512
  v_mfma_f32_16x16x32_bf16 v[132:135], v[68:71], a[252:255], v[100:103]
  ds_read_b64_tr_b16 v[60:61], v13 offset:4096
  ds_read_b64_tr_b16 v[62:63], v15 offset:4608
  ds_read_b64_tr_b16 v[64:65], v14 offset:0
  v_mfma_f32_16x16x32_bf16 v[104:107], v[72:75], a[240:243], v[104:107]
  ds_read_b64_tr_b16 v[66:67], v12 offset:512
  v_mfma_f32_16x16x32_bf16 v[136:139], v[76:79], a[248:251], v[104:107]
  ds_read_b64_tr_b16 v[68:69], v14 offset:4096
  v_mfma_f32_16x16x32_bf16 v[108:111], v[72:75], a[244:247], v[108:111]
  ds_read_b64_tr_b16 v[70:71], v12 offset:4608
  v_mfma_f32_16x16x32_bf16 v[140:143], v[76:79], a[252:255], v[108:111]
  s_mov_b32 s66, 0x800000
  s_mov_b32 s67, 0x20000
  s_mov_b32 s64, s28
  s_mov_b32 s65, s29
  s_movk_i32 s101, 1
  s_mov_b32 s56, s55
  s_movk_i32 s61, 128
  s_movk_i32 s59, 3
L_k1_kloop:
  s_waitcnt lgkmcnt(8)
  v_mfma_f32_16x16x32_bf16 v[80:83], v[48:51], a[0:3], 0
  s_add_u32 s46, s57, s61
  ds_read_b64_tr_b16 v[72:73], v15 offset:0
  v_mul_f32 v112, s52, v112
  v_mfma_f32_16x16x32_bf16 v[80:83], v[52:55], a[8:11], v[80:83]
  s_add_u32 s46, s46, 4194304
  ds_read_b64_tr_b16 v[74:75], v13 offset:512
  v_mul_f32 v113, s52, v113
  v_mfma_f32_16x16x32_bf16 v[84:87], v[48:51], a[4:7], 0
  s_add_u32 m0, s45, 65536
  ds_read_b64_tr_b16 v[76:77], v15 offset:4096
  buffer_load_dwordx4 v20, s[28:31], s46 offen offset:0 lds
  v_mfma_f32_16x16x32_bf16 v[84:87], v[52:55], a[12:15], v[84:87]
  s_waitcnt lgkmcnt(7)
  ds_read_b64_tr_b16 v[78:79], v13 offset:4608
  v_mul_f32 v114, s52, v114
  v_mfma_f32_16x16x32_bf16 v[88:91], v[56:59], a[0:3], 0
  ds_read_b64_tr_b16 v[48:49], v12 offset:8192
  v_mul_f32 v115, s52, v115
  v_mfma_f32_16x16x32_bf16 v[88:91], v[60:63], a[8:11], v[88:91]
  ds_read_b64_tr_b16 v[50:51], v14 offset:8704
  buffer_load_dwordx4 v21, s[28:31], s46 offen offset:1024 lds
  v_mfma_f32_16x16x32_bf16 v[92:95], v[56:59], a[4:7], 0
  ds_read_b64_tr_b16 v[52:53], v12 offset:12288
  v_cvt_pk_bf16_f32 v112, v112, v113
  v_mfma_f32_16x16x32_bf16 v[92:95], v[60:63], a[12:15], v[92:95]
  s_waitcnt lgkmcnt(3)
  ds_read_b64_tr_b16 v[54:55], v14 offset:12800
  v_cvt_pk_bf16_f32 v113, v114, v115
  v_mfma_f32_16x16x32_bf16 v[96:99], v[64:67], a[0:3], 0
  ds_read_b64_tr_b16 v[56:57], v13 offset:8192
  v_mul_f32 v120, s52, v120
  v_mfma_f32_16x16x32_bf16 v[96:99], v[68:71], a[8:11], v[96:99]
  ds_read_b64_tr_b16 v[58:59], v15 offset:8704
  buffer_load_dwordx4 v22, s[28:31], s46 offen offset:2048 lds
  v_mfma_f32_16x16x32_bf16 v[100:103], v[64:67], a[4:7], 0
  ds_read_b64_tr_b16 v[60:61], v13 offset:12288
  v_mul_f32 v121, s52, v121
  v_mfma_f32_16x16x32_bf16 v[100:103], v[68:71], a[12:15], v[100:103]
  ds_read_b64_tr_b16 v[62:63], v15 offset:12800
  v_mul_f32 v122, s52, v122
  v_mfma_f32_16x16x32_bf16 v[104:107], v[72:75], a[0:3], 0
  ds_read_b64_tr_b16 v[64:65], v14 offset:8192
  v_mul_f32 v123, s52, v123
  v_mfma_f32_16x16x32_bf16 v[104:107], v[76:79], a[8:11], v[104:107]
  ds_read_b64_tr_b16 v[66:67], v12 offset:8704
  buffer_load_dwordx4 v23, s[28:31], s46 offen offset:3072 lds
  v_mfma_f32_16x16x32_bf16 v[108:111], v[72:75], a[4:7], 0
  s_add_u32 m0, s45, 69632
  ds_read_b64_tr_b16 v[68:69], v14 offset:12288
  v_cvt_pk_bf16_f32 v114, v120, v121
  v_mfma_f32_16x16x32_bf16 v[108:111], v[76:79], a[12:15], v[108:111]
  s_waitcnt lgkmcnt(3)
  ds_read_b64_tr_b16 v[70:71], v12 offset:12800
  v_cvt_pk_bf16_f32 v115, v122, v123
  v_mfma_f32_16x16x32_bf16 v[80:83], v[48:51], a[16:19], v[80:83]
  ds_read_b64_tr_b16 v[72:73], v15 offset:8192
  v_mul_f32 v116, s52, v116
  v_mfma_f32_16x16x32_bf16 v[80:83], v[52:55], a[24:27], v[80:83]
  ds_read_b64_tr_b16 v[74:75], v13 offset:8704
  buffer_load_dwordx4 v24, s[28:31], s46 offen offset:0 lds
  v_mfma_f32_16x16x32_bf16 v[84:87], v[48:51], a[20:23], v[84:87]
  ds_read_b64_tr_b16 v[76:77], v15 offset:12288
  v_mul_f32 v117, s52, v117
  v_mfma_f32_16x16x32_bf16 v[84:87], v[52:55], a[28:31], v[84:87]
  ds_read_b64_tr_b16 v[78:79], v13 offset:12800
  v_mul_f32 v118, s52, v118
  v_mfma_f32_16x16x32_bf16 v[88:91], v[56:59], a[16:19], v[88:91]
  ds_read_b64_tr_b16 v[48:49], v12 offset:16384
  buffer_load_dwordx4 v25, s[28:31], s46 offen offset:1024 lds
  v_mfma_f32_16x16x32_bf16 v[88:91], v[60:63], a[24:27], v[88:91]
  ds_read_b64_tr_b16 v[50:51], v14 offset:16896
  v_mul_f32 v119, s52, v119
  v_mfma_f32_16x16x32_bf16 v[92:95], v[56:59], a[20:23], v[92:95]
  ds_read_b64_tr_b16 v[52:53], v12 offset:20480
  v_cvt_pk_bf16_f32 v116, v116, v117
  v_mfma_f32_16x16x32_bf16 v[92:95], v[60:63], a[28:31], v[92:95]
  s_waitcnt lgkmcnt(3)
  ds_read_b64_tr_b16 v[54:55], v14 offset:20992
  v_cvt_pk_bf16_f32 v117, v118, v119
  v_mfma_f32_16x16x32_bf16 v[96:99], v[64:67], a[16:19], v[96:99]
  ds_read_b64_tr_b16 v[56:57], v13 offset:16384
  buffer_load_dwordx4 v26, s[28:31], s46 offen offset:2048 lds
  v_mfma_f32_16x16x32_bf16 v[96:99], v[68:71], a[24:27], v[96:99]
  ds_read_b64_tr_b16 v[58:59], v15 offset:16896
  v_mul_f32 v124, s52, v124
  v_mfma_f32_16x16x32_bf16 v[100:103], v[64:67], a[20:23], v[100:103]
  ds_read_b64_tr_b16 v[60:61], v13 offset:20480
  v_mul_f32 v125, s52, v125
  v_mfma_f32_16x16x32_bf16 v[100:103], v[68:71], a[28:31], v[100:103]
  ds_read_b64_tr_b16 v[62:63], v15 offset:20992
  v_mul_f32 v126, s52, v126
  v_mfma_f32_16x16x32_bf16 v[104:107], v[72:75], a[16:19], v[104:107]
  ds_read_b64_tr_b16 v[64:65], v14 offset:16384
  buffer_load_dwordx4 v27, s[28:31], s46 offen offset:3072 lds
  v_mfma_f32_16x16x32_bf16 v[104:107], v[76:79], a[24:27], v[104:107]
  s_add_u32 m0, s45, 73728
  ds_read_b64_tr_b16 v[66:67], v12 offset:16896
  v_mul_f32 v127, s52, v127
  v_mfma_f32_16x16x32_bf16 v[108:111], v[72:75], a[20:23], v[108:111]
  ds_read_b64_tr_b16 v[68:69], v14 offset:20480
  v_cvt_pk_bf16_f32 v118, v124, v125
  v_mfma_f32_16x16x32_bf16 v[108:111], v[76:79], a[28:31], v[108:111]
  s_waitcnt lgkmcnt(3)
  ds_read_b64_tr_b16 v[70:71], v12 offset:20992
  v_cvt_pk_bf16_f32 v119, v126, v127
  v_mfma_f32_16x16x32_bf16 v[80:83], v[48:51], a[32:35], v[80:83]
  ds_read_b64_tr_b16 v[72:73], v15 offset:16384
  buffer_load_dwordx4 v28, s[28:31], s46 offen offset:0 lds
  v_mfma_f32_16x16x32_bf16 v[80:83], v[52:55], a[40:43], v[80:83]
  ds_read_b64_tr_b16 v[74:75], v13 offset:16896
  v_mul_f32 v128, s52, v128
  v_mfma_f32_16x16x32_bf16 v[84:87], v[48:51], a[36:39], v[84:87]
  ds_read_b64_tr_b16 v[76:77], v15 offset:20480
  v_mul_f32 v129, s52, v129
  v_mfma_f32_16x16x32_bf16 v[84:87], v[52:55], a[44:47], v[84:87]
  ds_read_b64_tr_b16 v[78:79], v13 offset:20992
  v_mul_f32 v130, s52, v130
  v_mfma_f32_16x16x32_bf16 v[88:91], v[56:59], a[32:35], v[88:91]
  ds_read_b64_tr_b16 v[48:49], v12 offset:24576
  buffer_load_dwordx4 v29, s[28:31], s46 offen offset:1024 lds
  v_mfma_f32_16x16x32_bf16 v[88:91], v[60:63], a[40:43], v[88:91]
  ds_read_b64_tr_b16 v[50:51], v14 offset:25088
  v_mul_f32 v131, s52, v131
  v_mfma_f32_16x16x32_bf16 v[92:95], v[56:59], a[36:39], v[92:95]
  ds_read_b64_tr_b16 v[52:53], v12 offset:28672
  v_cvt_pk_bf16_f32 v128, v128, v129
  v_mfma_f32_16x16x32_bf16 v[92:95], v[60:63], a[44:47], v[92:95]
  s_waitcnt lgkmcnt(3)
  ds_read_b64_tr_b16 v[54:55], v14 offset:29184
  buffer_load_dwordx4 v30, s[28:31], s46 offen offset:2048 lds
  v_mfma_f32_16x16x32_bf16 v[96:99], v[64:67], a[32:35], v[96:99]
  ds_read_b64_tr_b16 v[56:57], v13 offset:24576
  v_cvt_pk_bf16_f32 v129, v130, v131
  v_mfma_f32_16x16x32_bf16 v[96:99], v[68:71], a[40:43], v[96:99]
  ds_read_b64_tr_b16 v[58:59], v15 offset:25088
  v_mul_f32 v136, s52, v136
  v_mfma_f32_16x16x32_bf16 v[100:103], v[64:67], a[36:39], v[100:103]
  ds_read_b64_tr_b16 v[60:61], v13 offset:28672
  v_mul_f32 v137, s52, v137
  v_mfma_f32_16x16x32_bf16 v[100:103], v[68:71], a[44:47], v[100:103]
  ds_read_b64_tr_b16 v[62:63], v15 offset:29184
  buffer_load_dwordx4 v31, s[28:31], s46 offen offset:3072 lds
  v_mfma_f32_16x16x32_bf16 v[104:107], v[72:75], a[32:35], v[104:107]
  s_add_u32 m0, s45, 77824
  ds_read_b64_tr_b16 v[64:65], v14 offset:24576
  v_mul_f32 v138, s52, v138
  v_mfma_f32_16x16x32_bf16 v[104:107], v[76:79], a[40:43], v[104:107]
  ds_read_b64_tr_b16 v[66:67], v12 offset:25088
  v_mul_f32 v139, s52, v139
  v_mfma_f32_16x16x32_bf16 v[108:111], v[72:75], a[36:39], v[108:111]
  ds_read_b64_tr_b16 v[68:69], v14 offset:28672
  v_cvt_pk_bf16_f32 v130, v136, v137
  v_mfma_f32_16x16x32_bf16 v[108:111], v[76:79], a[44:47], v[108:111]
  s_waitcnt lgkmcnt(3)
  ds_read_b64_tr_b16 v[70:71], v12 offset:29184
  buffer_load_dwordx4 v32, s[28:31], s46 offen offset:0 lds
  v_mfma_f32_16x16x32_bf16 v[80:83], v[48:51], a[48:51], v[80:83]
  ds_read_b64_tr_b16 v[72:73], v15 offset:24576
  v_cvt_pk_bf16_f32 v131, v138, v139
  v_mfma_f32_16x16x32_bf16 v[80:83], v[52:55], a[56:59], v[80:83]
  ds_read_b64_tr_b16 v[74:75], v13 offset:25088
  v_mul_f32 v132, s52, v132
  v_mfma_f32_16x16x32_bf16 v[84:87], v[48:51], a[52:55], v[84:87]
  ds_read_b64_tr_b16 v[76:77], v15 offset:28672
  v_mul_f32 v133, s52, v133
  v_mfma_f32_16x16x32_bf16 v[84:87], v[52:55], a[60:63], v[84:87]
  ds_read_b64_tr_b16 v[78:79], v13 offset:29184
  buffer_load_dwordx4 v33, s[28:31], s46 offen offset:1024 lds
  v_mfma_f32_16x16x32_bf16 v[88:91], v[56:59], a[48:51], v[88:91]
  ds_read_b64_tr_b16 v[48:49], v12 offset:32768
  v_mul_f32 v134, s52, v134
  v_mfma_f32_16x16x32_bf16 v[88:91], v[60:63], a[56:59], v[88:91]
  ds_read_b64_tr_b16 v[50:51], v14 offset:33280
  v_mul_f32 v135, s52, v135
  v_mfma_f32_16x16x32_bf16 v[92:95], v[56:59], a[52:55], v[92:95]
  ds_read_b64_tr_b16 v[52:53], v12 offset:36864
  v_cvt_pk_bf16_f32 v132, v132, v133
  v_mfma_f32_16x16x32_bf16 v[92:95], v[60:63], a[60:63], v[92:95]
  s_waitcnt lgkmcnt(3)
  ds_read_b64_tr_b16 v[54:55], v14 offset:37376
  buffer_load_dwordx4 v34, s[28:31], s46 offen offset:2048 lds
  v_mfma_f32_16x16x32_bf16 v[96:99], v[64:67], a[48:51], v[96:99]
  ds_read_b64_tr_b16 v[56:57], v13 offset:32768
  v_cvt_pk_bf16_f32 v133, v134, v135
  v_mfma_f32_16x16x32_bf16 v[96:99], v[68:71], a[56:59], v[96:99]
  ds_read_b64_tr_b16 v[58:59], v15 offset:33280
  v_mul_f32 v140, s52, v140
  v_mfma_f32_16x16x32_bf16 v[100:103], v[64:67], a[52:55], v[100:103]
  ds_read_b64_tr_b16 v[60:61], v13 offset:36864
  buffer_load_dwordx4 v35, s[28:31], s46 offen offset:3072 lds
  v_mfma_f32_16x16x32_bf16 v[100:103], v[68:71], a[60:63], v[100:103]
  ds_read_b64_tr_b16 v[62:63], v15 offset:37376
  v_mul_f32 v141, s52, v141
  v_mfma_f32_16x16x32_bf16 v[104:107], v[72:75], a[48:51], v[104:107]
  s_add_u32 s49, s101, 2
  ds_read_b64_tr_b16 v[64:65], v14 offset:32768
  v_mul_f32 v142, s52, v142
  v_mfma_f32_16x16x32_bf16 v[104:107], v[76:79], a[56:59], v[104:107]
  s_cmp_lt_u32 s49, 4
  s_cselect_b32 s64, s28, s32
  s_cselect_b32 s65, s29, s33
  ds_read_b64_tr_b16 v[66:67], v12 offset:33280
  v_mfma_f32_16x16x32_bf16 v[108:111], v[72:75], a[52:55], v[108:111]
  s_and_b32 s50, s49, 3
  ds_read_b64_tr_b16 v[68:69], v14 offset:36864
  v_mul_f32 v143, s52, v143
  v_mfma_f32_16x16x32_bf16 v[108:111], v[76:79], a[60:63], v[108:111]
  s_waitcnt lgkmcnt(3)
  ds_read_b64_tr_b16 v[70:71], v12 offset:37376
  v_cvt_pk_bf16_f32 v134, v140, v141
  v_mfma_f32_16x16x32_bf16 v[80:83], v[48:51], a[64:67], v[80:83]
  s_lshl_b32 s50, s50, 7
  ds_read_b64_tr_b16 v[72:73], v15 offset:32768
  v_cvt_pk_bf16_f32 v135, v142, v143
  v_mfma_f32_16x16x32_bf16 v[80:83], v[52:55], a[72:75], v[80:83]
  s_add_u32 s100, s57, s50
  ds_read_b64_tr_b16 v[74:75], v13 offset:33280
  v_mfma_f32_16x16x32_bf16 v[84:87], v[48:51], a[68:71], v[84:87]
  s_cmp_lt_u32 s49, 8
  s_cselect_b32 s100, s100, 0x10000000
  ds_read_b64_tr_b16 v[76:77], v15 offset:36864
  v_mfma_f32_16x16x32_bf16 v[84:87], v[52:55], a[76:79], v[84:87]
  ds_read_b64_tr_b16 v[78:79], v13 offset:37376
  buffer_load_dword v47, v11, s[64:67], s100 offen
  v_mfma_f32_16x16x32_bf16 v[88:91], v[56:59], a[64:67], v[88:91]
  ds_read_b64_tr_b16 v[48:49], v12 offset:40960
  v_mfma_f32_16x16x32_bf16 v[88:91], v[60:63], a[72:75], v[88:91]
  ds_read_b64_tr_b16 v[50:51], v14 offset:41472
  v_mfma_f32_16x16x32_bf16 v[92:95], v[56:59], a[68:71], v[92:95]
  ds_read_b64_tr_b16 v[52:53], v12 offset:45056
  v_mfma_f32_16x16x32_bf16 v[92:95], v[60:63], a[76:79], v[92:95]
  s_waitcnt lgkmcnt(3)
  ds_read_b64_tr_b16 v[54:55], v14 offset:45568
  v_mfma_f32_16x16x32_bf16 v[96:99], v[64:67], a[64:67], v[96:99]
  ds_read_b64_tr_b16 v[56:57], v13 offset:40960
  v_mfma_f32_16x16x32_bf16 v[96:99], v[68:71], a[72:75], v[96:99]
  ds_read_b64_tr_b16 v[58:59], v15 offset:41472
  v_mfma_f32_16x16x32_bf16 v[100:103], v[64:67], a[68:71], v[100:103]
  ds_read_b64_tr_b16 v[60:61], v13 offset:45056
  buffer_store_dwordx4 v[112:115], v1, s[36:39], s56 offen offset:0 sc1
  v_mfma_f32_16x16x32_bf16 v[100:103], v[68:71], a[76:79], v[100:103]
  ds_read_b64_tr_b16 v[62:63], v15 offset:45568
  v_mfma_f32_16x16x32_bf16 v[104:107], v[72:75], a[64:67], v[104:107]
  ds_read_b64_tr_b16 v[64:65], v14 offset:40960
  v_mfma_f32_16x16x32_bf16 v[104:107], v[76:79], a[72:75], v[104:107]
  ds_read_b64_tr_b16 v[66:67], v12 offset:41472
  buffer_store_dwordx4 v[116:119], v2, s[36:39], s56 offen offset:0 sc1
  v_mfma_f32_16x16x32_bf16 v[108:111], v[72:75], a[68:71], v[108:111]
  ds_read_b64_tr_b16 v[68:69], v14 offset:45056
  v_mfma_f32_16x16x32_bf16 v[108:111], v[76:79], a[76:79], v[108:111]
  s_waitcnt lgkmcnt(3)
  ds_read_b64_tr_b16 v[70:71], v12 offset:45568
  v_mfma_f32_16x16x32_bf16 v[80:83], v[48:51], a[80:83], v[80:83]
  ds_read_b64_tr_b16 v[72:73], v15 offset:40960
  v_mfma_f32_16x16x32_bf16 v[80:83], v[52:55], a[88:91], v[80:83]
  ds_read_b64_tr_b16 v[74:75], v13 offset:41472
  buffer_store_dwordx4 v[128:131], v1, s[36:39], s56 offen offset:1024 sc1
  v_mfma_f32_16x16x32_bf16 v[84:87], v[48:51], a[84:87], v[84:87]
  ds_read_b64_tr_b16 v[76:77], v15 offset:45056
  v_mfma_f32_16x16x32_bf16 v[84:87], v[52:55], a[92:95], v[84:87]
  ds_read_b64_tr_b16 v[78:79], v13 offset:45568
  v_mfma_f32_16x16x32_bf16 v[88:91], v[56:59], a[80:83], v[88:91]
  ds_read_b64_tr_b16 v[48:49], v12 offset:49152
  v_mfma_f32_16x16x32_bf16 v[88:91], v[60:63], a[88:91], v[88:91]
  ds_read_b64_tr_b16 v[50:51], v14 offset:49664
  buffer_store_dwordx4 v[132:135], v2, s[36:39], s56 offen offset:1024 sc1
  v_mfma_f32_16x16x32_bf16 v[92:95], v[56:59], a[84:87], v[92:95]
  ds_read_b64_tr_b16 v[52:53], v12 offset:53248
  v_mfma_f32_16x16x32_bf16 v[92:95], v[60:63], a[92:95], v[92:95]
  s_waitcnt lgkmcnt(3)
  ds_read_b64_tr_b16 v[54:55], v14 offset:53760
  v_mfma_f32_16x16x32_bf16 v[96:99], v[64:67], a[80:83], v[96:99]
  ds_read_b64_tr_b16 v[56:57], v13 offset:49152
  v_mfma_f32_16x16x32_bf16 v[96:99], v[68:71], a[88:91], v[96:99]
  ds_read_b64_tr_b16 v[58:59], v15 offset:49664
  v_mfma_f32_16x16x32_bf16 v[100:103], v[64:67], a[84:87], v[100:103]
  ds_read_b64_tr_b16 v[60:61], v13 offset:53248
  v_mfma_f32_16x16x32_bf16 v[100:103], v[68:71], a[92:95], v[100:103]
  ds_read_b64_tr_b16 v[62:63], v15 offset:53760
  v_mfma_f32_16x16x32_bf16 v[104:107], v[72:75], a[80:83], v[104:107]
  ds_read_b64_tr_b16 v[64:65], v14 offset:49152
  v_mfma_f32_16x16x32_bf16 v[104:107], v[76:79], a[88:91], v[104:107]
  ds_read_b64_tr_b16 v[66:67], v12 offset:49664
  v_mfma_f32_16x16x32_bf16 v[108:111], v[72:75], a[84:87], v[108:111]
  ds_read_b64_tr_b16 v[68:69], v14 offset:53248
  v_mfma_f32_16x16x32_bf16 v[108:111], v[76:79], a[92:95], v[108:111]
  s_waitcnt lgkmcnt(3)
  ds_read_b64_tr_b16 v[70:71], v12 offset:53760
  v_mfma_f32_16x16x32_bf16 v[80:83], v[48:51], a[96:99], v[80:83]
  ds_read_b64_tr_b16 v[72:73], v15 offset:49152
  v_mfma_f32_16x16x32_bf16 v[80:83], v[52:55], a[104:107], v[80:83]
  ds_read_b64_tr_b16 v[74:75], v13 offset:49664
  v_mfma_f32_16x16x32_bf16 v[84:87], v[48:51], a[100:103], v[84:87]
  ds_read_b64_tr_b16 v[76:77], v15 offset:53248
  v_mfma_f32_16x16x32_bf16 v[84:87], v[52:55], a[108:111], v[84:87]
  ds_read_b64_tr_b16 v[78:79], v13 offset:53760
  v_mfma_f32_16x16x32_bf16 v[88:91], v[56:59], a[96:99], v[88:91]
  ds_read_b64_tr_b16 v[48:49], v12 offset:57344
  v_mfma_f32_16x16x32_bf16 v[88:91], v[60:63], a[104:107], v[88:91]
  ds_read_b64_tr_b16 v[50:51], v14 offset:57856
  v_mfma_f32_16x16x32_bf16 v[92:95], v[56:59], a[100:103], v[92:95]
  ds_read_b64_tr_b16 v[52:53], v12 offset:61440
  v_mfma_f32_16x16x32_bf16 v[92:95], v[60:63], a[108:111], v[92:95]
  s_waitcnt lgkmcnt(3)
  ds_read_b64_tr_b16 v[54:55], v14 offset:61952
  v_mfma_f32_16x16x32_bf16 v[96:99], v[64:67], a[96:99], v[96:99]
  ds_read_b64_tr_b16 v[56:57], v13 offset:57344
  v_mfma_f32_16x16x32_bf16 v[96:99], v[68:71], a[104:107], v[96:99]
  ds_read_b64_tr_b16 v[58:59], v15 offset:57856
  v_mfma_f32_16x16x32_bf16 v[100:103], v[64:67], a[100:103], v[100:103]
  ds_read_b64_tr_b16 v[60:61], v13 offset:61440
  v_mfma_f32_16x16x32_bf16 v[100:103], v[68:71], a[108:111], v[100:103]
  ds_read_b64_tr_b16 v[62:63], v15 offset:61952
  v_mfma_f32_16x16x32_bf16 v[104:107], v[72:75], a[96:99], v[104:107]
  ds_read_b64_tr_b16 v[64:65], v14 offset:57344
  v_mfma_f32_16x16x32_bf16 v[104:107], v[76:79], a[104:107], v[104:107]
  ds_read_b64_tr_b16 v[66:67], v12 offset:57856
  v_mfma_f32_16x16x32_bf16 v[108:111], v[72:75], a[100:103], v[108:111]
  ds_read_b64_tr_b16 v[68:69], v14 offset:61440
  v_mfma_f32_16x16x32_bf16 v[108:111], v[76:79], a[108:111], v[108:111]
  s_waitcnt lgkmcnt(3)
  ds_read_b64_tr_b16 v[70:71], v12 offset:61952
  v_mfma_f32_16x16x32_bf16 v[80:83], v[48:51], a[112:115], v[80:83]
  ds_read_b64_tr_b16 v[72:73], v15 offset:57344
  v_mfma_f32_16x16x32_bf16 v[80:83], v[52:55], a[120:123], v[80:83]
  ds_read_b64_tr_b16 v[74:75], v13 offset:57856
  v_mfma_f32_16x16x32_bf16 v[84:87], v[48:51], a[116:119], v[84:87]
  ds_read_b64_tr_b16 v[76:77], v15 offset:61440
  v_mfma_f32_16x16x32_bf16 v[84:87], v[52:55], a[124:127], v[84:87]
  ds_read_b64_tr_b16 v[78:79], v13 offset:61952
  v_mfma_f32_16x16x32_bf16 v[88:91], v[56:59], a[112:115], v[88:91]
  v_mfma_f32_16x16x32_bf16 v[88:91], v[60:63], a[120:123], v[88:91]
  v_mfma_f32_16x16x32_bf16 v[92:95], v[56:59], a[116:119], v[92:95]
  v_mfma_f32_16x16x32_bf16 v[92:95], v[60:63], a[124:127], v[92:95]
  s_waitcnt vmcnt(5) lgkmcnt(0)
  s_barrier
  v_mfma_f32_16x16x32_bf16 v[96:99], v[64:67], a[112:115], v[96:99]
  ds_read_b64_tr_b16 v[48:49], v16 offset:0
  ds_read_b64_tr_b16 v[50:51], v18 offset:512
  v_mfma_f32_16x16x32_bf16 v[96:99], v[68:71], a[120:123], v[96:99]
  ds_read_b64_tr_b16 v[52:53], v16 offset:4096
  ds_read_b64_tr_b16 v[54:55], v18 offset:4608
  v_mfma_f32_16x16x32_bf16 v[100:103], v[64:67], a[116:119], v[100:103]
  ds_read_b64_tr_b16 v[56:57], v17 offset:0
  ds_read_b64_tr_b16 v[58:59], v19 offset:512
  v_mfma_f32_16x16x32_bf16 v[100:103], v[68:71], a[124:127], v[100:103]
  ds_read_b64_tr_b16 v[60:61], v17 offset:4096
  ds_read_b64_tr_b16 v[62:63], v19 offset:4608
  ds_read_b64_tr_b16 v[64:65], v18 offset:0
  v_mfma_f32_16x16x32_bf16 v[104:107], v[72:75], a[112:115], v[104:107]
  ds_read_b64_tr_b16 v[66:67], v16 offset:512
  v_mfma_f32_16x16x32_bf16 v[104:107], v[76:79], a[120:123], v[104:107]
  ds_read_b64_tr_b16 v[68:69], v18 offset:4096
  v_mfma_f32_16x16x32_bf16 v[108:111], v[72:75], a[116:119], v[108:111]
  ds_read_b64_tr_b16 v[70:71], v16 offset:4608
  v_mfma_f32_16x16x32_bf16 v[108:111], v[76:79], a[124:127], v[108:111]
  s_waitcnt lgkmcnt(8)
  v_mfma_f32_16x16x32_bf16 v[80:83], v[48:51], a[128:131], v[80:83]
  s_add_u32 s3, s61, 128
  ds_read_b64_tr_b16 v[72:73], v19 offset:0
  v_mfma_f32_16x16x32_bf16 v[80:83], v[52:55], a[136:139], v[80:83]
  s_add_u32 s3, s3, s57
  ds_read_b64_tr_b16 v[74:75], v17 offset:512
  v_mfma_f32_16x16x32_bf16 v[84:87], v[48:51], a[132:135], v[84:87]
  s_cmp_eq_u32 s59, 1
  s_cselect_b32 s46, s57, s3
  s_cselect_b32 s96, s32, s28
  s_cselect_b32 s97, s33, s29
  ds_read_b64_tr_b16 v[76:77], v19 offset:4096
  v_mfma_f32_16x16x32_bf16 v[84:87], v[52:55], a[140:143], v[84:87]
  s_waitcnt lgkmcnt(7)
  ds_read_b64_tr_b16 v[78:79], v17 offset:4608
  v_mfma_f32_16x16x32_bf16 v[88:91], v[56:59], a[128:131], v[88:91]
  s_add_u32 m0, s45, 0
  ds_read_b64_tr_b16 v[48:49], v16 offset:8192
  buffer_load_dwordx4 v20, s[96:99], s46 offen offset:0 lds
  v_mfma_f32_16x16x32_bf16 v[88:91], v[60:63], a[136:139], v[88:91]
  ds_read_b64_tr_b16 v[50:51], v18 offset:8704
  v_mfma_f32_16x16x32_bf16 v[92:95], v[56:59], a[132:135], v[92:95]
  ds_read_b64_tr_b16 v[52:53], v16 offset:12288
  v_mfma_f32_16x16x32_bf16 v[92:95], v[60:63], a[140:143], v[92:95]
  s_waitcnt lgkmcnt(3)
  ds_read_b64_tr_b16 v[54:55], v18 offset:12800
  buffer_load_dwordx4 v21, s[96:99], s46 offen offset:1024 lds
  v_mfma_f32_16x16x32_bf16 v[96:99], v[64:67], a[128:131], v[96:99]
  ds_read_b64_tr_b16 v[56:57], v17 offset:8192
  v_mfma_f32_16x16x32_bf16 v[96:99], v[68:71], a[136:139], v[96:99]
  ds_read_b64_tr_b16 v[58:59], v19 offset:8704
  v_mfma_f32_16x16x32_bf16 v[100:103], v[64:67], a[132:135], v[100:103]
  ds_read_b64_tr_b16 v[60:61], v17 offset:12288
  v_mfma_f32_16x16x32_bf16 v[100:103], v[68:71], a[140:143], v[100:103]
  ds_read_b64_tr_b16 v[62:63], v19 offset:12800
  buffer_load_dwordx4 v22, s[96:99], s46 offen offset:2048 lds
  v_mfma_f32_16x16x32_bf16 v[104:107], v[72:75], a[128:131], v[104:107]
  ds_read_b64_tr_b16 v[64:65], v18 offset:8192
  v_mfma_f32_16x16x32_bf16 v[104:107], v[76:79], a[136:139], v[104:107]
  ds_read_b64_tr_b16 v[66:67], v16 offset:8704
  v_mfma_f32_16x16x32_bf16 v[108:111], v[72:75], a[132:135], v[108:111]
  ds_read_b64_tr_b16 v[68:69], v18 offset:12288
  v_mfma_f32_16x16x32_bf16 v[108:111], v[76:79], a[140:143], v[108:111]
  s_waitcnt lgkmcnt(3)
  ds_read_b64_tr_b16 v[70:71], v16 offset:12800
  buffer_load_dwordx4 v23, s[96:99], s46 offen offset:3072 lds
  v_mfma_f32_16x16x32_bf16 v[80:83], v[48:51], a[144:147], v[80:83]
  s_add_u32 m0, s45, 4096
  ds_read_b64_tr_b16 v[72:73], v19 offset:8192
  v_mfma_f32_16x16x32_bf16 v[80:83], v[52:55], a[152:155], v[80:83]
  ds_read_b64_tr_b16 v[74:75], v17 offset:8704
  v_mfma_f32_16x16x32_bf16 v[84:87], v[48:51], a[148:151], v[84:87]
  ds_read_b64_tr_b16 v[76:77], v19 offset:12288
  v_mfma_f32_16x16x32_bf16 v[84:87], v[52:55], a[156:159], v[84:87]
  ds_read_b64_tr_b16 v[78:79], v17 offset:12800
  buffer_load_dwordx4 v24, s[96:99], s46 offen offset:0 lds
  v_mfma_f32_16x16x32_bf16 v[88:91], v[56:59], a[144:147], v[88:91]
  ds_read_b64_tr_b16 v[48:49], v16 offset:16384
  v_mfma_f32_16x16x32_bf16 v[88:91], v[60:63], a[152:155], v[88:91]
  ds_read_b64_tr_b16 v[50:51], v18 offset:16896
  v_mfma_f32_16x16x32_bf16 v[92:95], v[56:59], a[148:151], v[92:95]
  ds_read_b64_tr_b16 v[52:53], v16 offset:20480
  buffer_load_dwordx4 v25, s[96:99], s46 offen offset:1024 lds
  v_mfma_f32_16x16x32_bf16 v[92:95], v[60:63], a[156:159], v[92:95]
  s_waitcnt lgkmcnt(3)
  ds_read_b64_tr_b16 v[54:55], v18 offset:20992
  v_mfma_f32_16x16x32_bf16 v[96:99], v[64:67], a[144:147], v[96:99]
  ds_read_b64_tr_b16 v[56:57], v17 offset:16384
  v_mfma_f32_16x16x32_bf16 v[96:99], v[68:71], a[152:155], v[96:99]
  ds_read_b64_tr_b16 v[58:59], v19 offset:16896
  v_mfma_f32_16x16x32_bf16 v[100:103], v[64:67], a[148:151], v[100:103]
  ds_read_b64_tr_b16 v[60:61], v17 offset:20480
  buffer_load_dwordx4 v26, s[96:99], s46 offen offset:2048 lds
  v_mfma_f32_16x16x32_bf16 v[100:103], v[68:71], a[156:159], v[100:103]
  ds_read_b64_tr_b16 v[62:63], v19 offset:20992
  v_mfma_f32_16x16x32_bf16 v[104:107], v[72:75], a[144:147], v[104:107]
  ds_read_b64_tr_b16 v[64:65], v18 offset:16384
  v_mfma_f32_16x16x32_bf16 v[104:107], v[76:79], a[152:155], v[104:107]
  ds_read_b64_tr_b16 v[66:67], v16 offset:16896
  v_mfma_f32_16x16x32_bf16 v[108:111], v[72:75], a[148:151], v[108:111]
  ds_read_b64_tr_b16 v[68:69], v18 offset:20480
  buffer_load_dwordx4 v27, s[96:99], s46 offen offset:3072 lds
  v_mfma_f32_16x16x32_bf16 v[108:111], v[76:79], a[156:159], v[108:111]
  s_waitcnt lgkmcnt(3)
  ds_read_b64_tr_b16 v[70:71], v16 offset:20992
  v_mfma_f32_16x16x32_bf16 v[80:83], v[48:51], a[160:163], v[80:83]
  s_add_u32 m0, s45, 8192
  ds_read_b64_tr_b16 v[72:73], v19 offset:16384
  v_mfma_f32_16x16x32_bf16 v[80:83], v[52:55], a[168:171], v[80:83]
  ds_read_b64_tr_b16 v[74:75], v17 offset:16896
  v_mfma_f32_16x16x32_bf16 v[84:87], v[48:51], a[164:167], v[84:87]
  ds_read_b64_tr_b16 v[76:77], v19 offset:20480
  buffer_load_dwordx4 v28, s[96:99], s46 offen offset:0 lds
  v_mfma_f32_16x16x32_bf16 v[84:87], v[52:55], a[172:175], v[84:87]
  ds_read_b64_tr_b16 v[78:79], v17 offset:20992
  v_mfma_f32_16x16x32_bf16 v[88:91], v[56:59], a[160:163], v[88:91]
  ds_read_b64_tr_b16 v[48:49], v16 offset:24576
  v_mfma_f32_16x16x32_bf16 v[88:91], v[60:63], a[168:171], v[88:91]
  ds_read_b64_tr_b16 v[50:51], v18 offset:25088
  v_mfma_f32_16x16x32_bf16 v[92:95], v[56:59], a[164:167], v[92:95]
  ds_read_b64_tr_b16 v[52:53], v16 offset:28672
  buffer_load_dwordx4 v29, s[96:99], s46 offen offset:1024 lds
  v_mfma_f32_16x16x32_bf16 v[92:95], v[60:63], a[172:175], v[92:95]
  s_waitcnt lgkmcnt(3)
  ds_read_b64_tr_b16 v[54:55], v18 offset:29184
  v_mfma_f32_16x16x32_bf16 v[96:99], v[64:67], a[160:163], v[96:99]
  ds_read_b64_tr_b16 v[56:57], v17 offset:24576
  v_mfma_f32_16x16x32_bf16 v[96:99], v[68:71], a[168:171], v[96:99]
  ds_read_b64_tr_b16 v[58:59], v19 offset:25088
  buffer_load_dwordx4 v30, s[96:99], s46 offen offset:2048 lds
  v_mfma_f32_16x16x32_bf16 v[100:103], v[64:67], a[164:167], v[100:103]
  ds_read_b64_tr_b16 v[60:61], v17 offset:28672
  v_mfma_f32_16x16x32_bf16 v[100:103], v[68:71], a[172:175], v[100:103]
  ds_read_b64_tr_b16 v[62:63], v19 offset:29184
  v_mfma_f32_16x16x32_bf16 v[104:107], v[72:75], a[160:163], v[104:107]
  ds_read_b64_tr_b16 v[64:65], v18 offset:24576
  v_mfma_f32_16x16x32_bf16 v[104:107], v[76:79], a[168:171], v[104:107]
  ds_read_b64_tr_b16 v[66:67], v16 offset:25088
  buffer_load_dwordx4 v31, s[96:99], s46 offen offset:3072 lds
  v_mfma_f32_16x16x32_bf16 v[108:111], v[72:75], a[164:167], v[108:111]
  s_add_u32 m0, s45, 12288
  ds_read_b64_tr_b16 v[68:69], v18 offset:28672
  v_mfma_f32_16x16x32_bf16 v[108:111], v[76:79], a[172:175], v[108:111]
  s_waitcnt lgkmcnt(3)
  ds_read_b64_tr_b16 v[70:71], v16 offset:29184
  v_mfma_f32_16x16x32_bf16 v[80:83], v[48:51], a[176:179], v[80:83]
  ds_read_b64_tr_b16 v[72:73], v19 offset:24576
  v_mfma_f32_16x16x32_bf16 v[80:83], v[52:55], a[184:187], v[80:83]
  ds_read_b64_tr_b16 v[74:75], v17 offset:25088
  buffer_load_dwordx4 v32, s[96:99], s46 offen offset:0 lds
  v_mfma_f32_16x16x32_bf16 v[84:87], v[48:51], a[180:183], v[84:87]
  ds_read_b64_tr_b16 v[76:77], v19 offset:28672
  v_mfma_f32_16x16x32_bf16 v[84:87], v[52:55], a[188:191], v[84:87]
  ds_read_b64_tr_b16 v[78:79], v17 offset:29184
  v_mfma_f32_16x16x32_bf16 v[88:91], v[56:59], a[176:179], v[88:91]
  ds_read_b64_tr_b16 v[48:49], v16 offset:32768
  v_mfma_f32_16x16x32_bf16 v[88:91], v[60:63], a[184:187], v[88:91]
  ds_read_b64_tr_b16 v[50:51], v18 offset:33280
  buffer_load_dwordx4 v33, s[96:99], s46 offen offset:1024 lds
  v_mfma_f32_16x16x32_bf16 v[92:95], v[56:59], a[180:183], v[92:95]
  ds_read_b64_tr_b16 v[52:53], v16 offset:36864
  v_mfma_f32_16x16x32_bf16 v[92:95], v[60:63], a[188:191], v[92:95]
  s_waitcnt lgkmcnt(3)
  ds_read_b64_tr_b16 v[54:55], v18 offset:37376
  v_mfma_f32_16x16x32_bf16 v[96:99], v[64:67], a[176:179], v[96:99]
  ds_read_b64_tr_b16 v[56:57], v17 offset:32768
  v_mfma_f32_16x16x32_bf16 v[96:99], v[68:71], a[184:187], v[96:99]
  ds_read_b64_tr_b16 v[58:59], v19 offset:33280
  buffer_load_dwordx4 v34, s[96:99], s46 offen offset:2048 lds
  v_mfma_f32_16x16x32_bf16 v[100:103], v[64:67], a[180:183], v[100:103]
  ds_read_b64_tr_b16 v[60:61], v17 offset:36864
  v_mfma_f32_16x16x32_bf16 v[100:103], v[68:71], a[188:191], v[100:103]
  ds_read_b64_tr_b16 v[62:63], v19 offset:37376
  v_mfma_f32_16x16x32_bf16 v[104:107], v[72:75], a[176:179], v[104:107]
  ds_read_b64_tr_b16 v[64:65], v18 offset:32768
  buffer_load_dwordx4 v35, s[96:99], s46 offen offset:3072 lds
  v_mfma_f32_16x16x32_bf16 v[104:107], v[76:79], a[184:187], v[104:107]
  ds_read_b64_tr_b16 v[66:67], v16 offset:33280
  v_mfma_f32_16x16x32_bf16 v[108:111], v[72:75], a[180:183], v[108:111]
  ds_read_b64_tr_b16 v[68:69], v18 offset:36864
  v_mfma_f32_16x16x32_bf16 v[108:111], v[76:79], a[188:191], v[108:111]
  s_waitcnt lgkmcnt(3)
  ds_read_b64_tr_b16 v[70:71], v16 offset:37376
  v_mfma_f32_16x16x32_bf16 v[80:83], v[48:51], a[192:195], v[80:83]
  ds_read_b64_tr_b16 v[72:73], v19 offset:32768
  v_mfma_f32_16x16x32_bf16 v[80:83], v[52:55], a[200:203], v[80:83]
  ds_read_b64_tr_b16 v[74:75], v17 offset:33280
  v_mfma_f32_16x16x32_bf16 v[84:87], v[48:51], a[196:199], v[84:87]
  ds_read_b64_tr_b16 v[76:77], v19 offset:36864
  v_mfma_f32_16x16x32_bf16 v[84:87], v[52:55], a[204:207], v[84:87]
  ds_read_b64_tr_b16 v[78:79], v17 offset:37376
  v_mfma_f32_16x16x32_bf16 v[88:91], v[56:59], a[192:195], v[88:91]
  ds_read_b64_tr_b16 v[48:49], v16 offset:40960
  v_mfma_f32_16x16x32_bf16 v[88:91], v[60:63], a[200:203], v[88:91]
  ds_read_b64_tr_b16 v[50:51], v18 offset:41472
  v_mfma_f32_16x16x32_bf16 v[92:95], v[56:59], a[196:199], v[92:95]
  s_lshl_b32 s56, s61, 4
  ds_read_b64_tr_b16 v[52:53], v16 offset:45056
  v_mfma_f32_16x16x32_bf16 v[92:95], v[60:63], a[204:207], v[92:95]
  s_waitcnt lgkmcnt(3)
  ds_read_b64_tr_b16 v[54:55], v18 offset:45568
  v_mfma_f32_16x16x32_bf16 v[96:99], v[64:67], a[192:195], v[96:99]
  s_add_u32 s56, s56, s55
  ds_read_b64_tr_b16 v[56:57], v17 offset:40960
  v_mfma_f32_16x16x32_bf16 v[96:99], v[68:71], a[200:203], v[96:99]
  ds_read_b64_tr_b16 v[58:59], v19 offset:41472
  v_mfma_f32_16x16x32_bf16 v[100:103], v[64:67], a[196:199], v[100:103]
  ds_read_b64_tr_b16 v[60:61], v17 offset:45056
  v_mfma_f32_16x16x32_bf16 v[100:103], v[68:71], a[204:207], v[100:103]
  ds_read_b64_tr_b16 v[62:63], v19 offset:45568
  v_mfma_f32_16x16x32_bf16 v[104:107], v[72:75], a[192:195], v[104:107]
  ds_read_b64_tr_b16 v[64:65], v18 offset:40960
  v_mfma_f32_16x16x32_bf16 v[104:107], v[76:79], a[200:203], v[104:107]
  ds_read_b64_tr_b16 v[66:67], v16 offset:41472
  v_mfma_f32_16x16x32_bf16 v[108:111], v[72:75], a[196:199], v[108:111]
  ds_read_b64_tr_b16 v[68:69], v18 offset:45056
  v_mfma_f32_16x16x32_bf16 v[108:111], v[76:79], a[204:207], v[108:111]
  s_waitcnt lgkmcnt(3)
  ds_read_b64_tr_b16 v[70:71], v16 offset:45568
  v_mfma_f32_16x16x32_bf16 v[80:83], v[48:51], a[208:211], v[80:83]
  ds_read_b64_tr_b16 v[72:73], v19 offset:40960
  v_mfma_f32_16x16x32_bf16 v[80:83], v[52:55], a[216:219], v[80:83]
  ds_read_b64_tr_b16 v[74:75], v17 offset:41472
  v_mfma_f32_16x16x32_bf16 v[84:87], v[48:51], a[212:215], v[84:87]
  ds_read_b64_tr_b16 v[76:77], v19 offset:45056
  v_mfma_f32_16x16x32_bf16 v[84:87], v[52:55], a[220:223], v[84:87]
  ds_read_b64_tr_b16 v[78:79], v17 offset:45568
  v_mfma_f32_16x16x32_bf16 v[88:91], v[56:59], a[208:211], v[88:91]
  ds_read_b64_tr_b16 v[48:49], v16 offset:49152
  v_mfma_f32_16x16x32_bf16 v[88:91], v[60:63], a[216:219], v[88:91]
  ds_read_b64_tr_b16 v[50:51], v18 offset:49664
  v_mfma_f32_16x16x32_bf16 v[92:95], v[56:59], a[212:215], v[92:95]
  ds_read_b64_tr_b16 v[52:53], v16 offset:53248
  v_mfma_f32_16x16x32_bf16 v[92:95], v[60:63], a[220:223], v[92:95]
  s_waitcnt lgkmcnt(3)
  ds_read_b64_tr_b16 v[54:55], v18 offset:53760
  v_mfma_f32_16x16x32_bf16 v[96:99], v[64:67], a[208:211], v[96:99]
  ds_read_b64_tr_b16 v[56:57], v17 offset:49152
  v_mfma_f32_16x16x32_bf16 v[96:99], v[68:71], a[216:219], v[96:99]
  ds_read_b64_tr_b16 v[58:59], v19 offset:49664
  v_mfma_f32_16x16x32_bf16 v[100:103], v[64:67], a[212:215], v[100:103]
  ds_read_b64_tr_b16 v[60:61], v17 offset:53248
  v_mfma_f32_16x16x32_bf16 v[100:103], v[68:71], a[220:223], v[100:103]
  ds_read_b64_tr_b16 v[62:63], v19 offset:53760
  v_mfma_f32_16x16x32_bf16 v[104:107], v[72:75], a[208:211], v[104:107]
  ds_read_b64_tr_b16 v[64:65], v18 offset:49152
  v_mfma_f32_16x16x32_bf16 v[104:107], v[76:79], a[216:219], v[104:107]
  ds_read_b64_tr_b16 v[66:67], v16 offset:49664
  v_mfma_f32_16x16x32_bf16 v[108:111], v[72:75], a[212:215], v[108:111]
  ds_read_b64_tr_b16 v[68:69], v18 offset:53248
  v_mfma_f32_16x16x32_bf16 v[108:111], v[76:79], a[220:223], v[108:111]
  s_waitcnt lgkmcnt(3)
  ds_read_b64_tr_b16 v[70:71], v16 offset:53760
  v_mfma_f32_16x16x32_bf16 v[80:83], v[48:51], a[224:227], v[80:83]
  ds_read_b64_tr_b16 v[72:73], v19 offset:49152
  v_mfma_f32_16x16x32_bf16 v[80:83], v[52:55], a[232:235], v[80:83]
  ds_read_b64_tr_b16 v[74:75], v17 offset:49664
  v_mfma_f32_16x16x32_bf16 v[84:87], v[48:51], a[228:231], v[84:87]
  ds_read_b64_tr_b16 v[76:77], v19 offset:53248
  v_mfma_f32_16x16x32_bf16 v[84:87], v[52:55], a[236:239], v[84:87]
  ds_read_b64_tr_b16 v[78:79], v17 offset:53760
  v_mfma_f32_16x16x32_bf16 v[88:91], v[56:59], a[224:227], v[88:91]
  ds_read_b64_tr_b16 v[48:49], v16 offset:57344
  v_mfma_f32_16x16x32_bf16 v[88:91], v[60:63], a[232:235], v[88:91]
  ds_read_b64_tr_b16 v[50:51], v18 offset:57856
  v_mfma_f32_16x16x32_bf16 v[92:95], v[56:59], a[228:231], v[92:95]
  ds_read_b64_tr_b16 v[52:53], v16 offset:61440
  v_mfma_f32_16x16x32_bf16 v[92:95], v[60:63], a[236:239], v[92:95]
  s_waitcnt lgkmcnt(3)
  ds_read_b64_tr_b16 v[54:55], v18 offset:61952
  v_mfma_f32_16x16x32_bf16 v[96:99], v[64:67], a[224:227], v[96:99]
  ds_read_b64_tr_b16 v[56:57], v17 offset:57344
  v_mfma_f32_16x16x32_bf16 v[96:99], v[68:71], a[232:235], v[96:99]
  ds_read_b64_tr_b16 v[58:59], v19 offset:57856
  v_mfma_f32_16x16x32_bf16 v[100:103], v[64:67], a[228:231], v[100:103]
  ds_read_b64_tr_b16 v[60:61], v17 offset:61440
  v_mfma_f32_16x16x32_bf16 v[100:103], v[68:71], a[236:239], v[100:103]
  ds_read_b64_tr_b16 v[62:63], v19 offset:61952
  v_mfma_f32_16x16x32_bf16 v[104:107], v[72:75], a[224:227], v[104:107]
  ds_read_b64_tr_b16 v[64:65], v18 offset:57344
  v_mfma_f32_16x16x32_bf16 v[104:107], v[76:79], a[232:235], v[104:107]
  ds_read_b64_tr_b16 v[66:67], v16 offset:57856
  v_mfma_f32_16x16x32_bf16 v[108:111], v[72:75], a[228:231], v[108:111]
  ds_read_b64_tr_b16 v[68:69], v18 offset:61440
  v_mfma_f32_16x16x32_bf16 v[108:111], v[76:79], a[236:239], v[108:111]
  s_waitcnt lgkmcnt(3)
  ds_read_b64_tr_b16 v[70:71], v16 offset:61952
  v_mfma_f32_16x16x32_bf16 v[80:83], v[48:51], a[240:243], v[80:83]
  ds_read_b64_tr_b16 v[72:73], v19 offset:57344
  v_mfma_f32_16x16x32_bf16 v[112:115], v[52:55], a[248:251], v[80:83]
  ds_read_b64_tr_b16 v[74:75], v17 offset:57856
  v_mfma_f32_16x16x32_bf16 v[84:87], v[48:51], a[244:247], v[84:87]
  ds_read_b64_tr_b16 v[76:77], v19 offset:61440
  v_mfma_f32_16x16x32_bf16 v[116:119], v[52:55], a[252:255], v[84:87]
  ds_read_b64_tr_b16 v[78:79], v17 offset:61952
  v_mfma_f32_16x16x32_bf16 v[88:91], v[56:59], a[240:243], v[88:91]
  v_mfma_f32_16x16x32_bf16 v[120:123], v[60:63], a[248:251], v[88:91]
  v_mfma_f32_16x16x32_bf16 v[92:95], v[56:59], a[244:247], v[92:95]
  v_mfma_f32_16x16x32_bf16 v[124:127], v[60:63], a[252:255], v[92:95]
  s_waitcnt vmcnt(0) lgkmcnt(0)
  s_barrier
  v_mfma_f32_16x16x32_bf16 v[96:99], v[64:67], a[240:243], v[96:99]
  ds_read_b64_tr_b16 v[48:49], v12 offset:0
  ds_read_b64_tr_b16 v[50:51], v14 offset:512
  v_mfma_f32_16x16x32_bf16 v[128:131], v[68:71], a[248:251], v[96:99]
  ds_read_b64_tr_b16 v[52:53], v12 offset:4096
  ds_read_b64_tr_b16 v[54:55], v14 offset:4608
  v_mfma_f32_16x16x32_bf16 v[100:103], v[64:67], a[244:247], v[100:103]
  ds_read_b64_tr_b16 v[56:57], v13 offset:0
  ds_read_b64_tr_b16 v[58:59], v15 offset:512
  v_mfma_f32_16x16x32_bf16 v[132:135], v[68:71], a[252:255], v[100:103]
  ds_read_b64_tr_b16 v[60:61], v13 offset:4096
  ds_read_b64_tr_b16 v[62:63], v15 offset:4608
  ds_read_b64_tr_b16 v[64:65], v14 offset:0
  v_mfma_f32_16x16x32_bf16 v[104:107], v[72:75], a[240:243], v[104:107]
  ds_read_b64_tr_b16 v[66:67], v12 offset:512
  v_mfma_f32_16x16x32_bf16 v[136:139], v[76:79], a[248:251], v[104:107]
  ds_read_b64_tr_b16 v[68:69], v14 offset:4096
  v_mfma_f32_16x16x32_bf16 v[108:111], v[72:75], a[244:247], v[108:111]
  ds_read_b64_tr_b16 v[70:71], v12 offset:4608
  v_mfma_f32_16x16x32_bf16 v[140:143], v[76:79], a[252:255], v[108:111]
  s_add_u32 s101, s101, 1
  s_add_u32 s61, s61, 128
  s_sub_u32 s59, s59, 1
  s_cmp_lg_u32 s59, 0
  s_cbranch_scc1 L_k1_kloop
  s_nop 7
  v_mul_f32 v112, s52, v112
  v_mul_f32 v113, s52, v113
  v_mul_f32 v114, s52, v114
  v_mul_f32 v115, s52, v115
  v_cvt_pk_bf16_f32 v112, v112, v113
  v_cvt_pk_bf16_f32 v113, v114, v115
  v_mul_f32 v120, s52, v120
  v_mul_f32 v121, s52, v121
  v_mul_f32 v122, s52, v122
  v_mul_f32 v123, s52, v123
  v_cvt_pk_bf16_f32 v114, v120, v121
  v_cvt_pk_bf16_f32 v115, v122, v123
  buffer_store_dwordx4 v[112:115], v1, s[36:39], s56 offen offset:0 sc1
  v_mul_f32 v116, s52, v116
  v_mul_f32 v117, s52, v117
  v_mul_f32 v118, s52, v118
  v_mul_f32 v119, s52, v119
  v_cvt_pk_bf16_f32 v116, v116, v117
  v_cvt_pk_bf16_f32 v117, v118, v119
  v_mul_f32 v124, s52, v124
  v_mul_f32 v125, s52, v125
  v_mul_f32 v126, s52, v126
  v_mul_f32 v127, s52, v127
  v_cvt_pk_bf16_f32 v118, v124, v125
  v_cvt_pk_bf16_f32 v119, v126, v127
  buffer_store_dwordx4 v[116:119], v2, s[36:39], s56 offen offset:0 sc1
  v_mul_f32 v128, s52, v128
  v_mul_f32 v129, s52, v129
  v_mul_f32 v130, s52, v130
  v_mul_f32 v131, s52, v131
  v_cvt_pk_bf16_f32 v128, v128, v129
  v_cvt_pk_bf16_f32 v129, v130, v131
  v_mul_f32 v136, s52, v136
  v_mul_f32 v137, s52, v137
  v_mul_f32 v138, s52, v138
  v_mul_f32 v139, s52, v139
  v_cvt_pk_bf16_f32 v130, v136, v137
  v_cvt_pk_bf16_f32 v131, v138, v139
  buffer_store_dwordx4 v[128:131], v1, s[36:39], s56 offen offset:1024 sc1
  v_mul_f32 v132, s52, v132
  v_mul_f32 v133, s52, v133
  v_mul_f32 v134, s52, v134
  v_mul_f32 v135, s52, v135
  v_cvt_pk_bf16_f32 v132, v132, v133
  v_cvt_pk_bf16_f32 v133, v134, v135
  v_mul_f32 v140, s52, v140
  v_mul_f32 v141, s52, v141
  v_mul_f32 v142, s52, v142
  v_mul_f32 v143, s52, v143
  v_cvt_pk_bf16_f32 v134, v140, v141
  v_cvt_pk_bf16_f32 v135, v142, v143
  buffer_store_dwordx4 v[132:135], v2, s[36:39], s56 offen offset:1024 sc1
  s_mov_b32 s56, 0x10000000
  s_movk_i32 s61, 0
  s_mov_b32 s16, s74
  s_and_b32 s17, s75, 0xffff
  s_mov_b32 s18, 0x380000
  s_mov_b32 s19, 0x20000
  s_mov_b32 s20, s82
  s_and_b32 s21, s83, 0xffff
  s_mov_b32 s22, 0x188000
  s_mov_b32 s23, 0x20000
  s_mul_i32 s49, s2, 14336
  s_mul_i32 s50, s4, 3584
  s_add_u32 s49, s49, s50
  v_lshlrev_b32 v3, 7, v0
  v_mov_b32 v6, 0x7ff00000
  v_cmp_gt_u32 vcc, 28, v0
  s_mul_i32 s51, s2, 6272
  s_mul_i32 s50, s4, 1568
  v_cndmask_b32 v4, v6, v3, vcc
  s_add_u32 s51, s51, s50
  v_cmp_gt_u32 vcc, 14, v0
  buffer_load_dword v47, v4, s[16:19], s49 offen
  s_nop 0
  v_cndmask_b32 v4, v6, v3, vcc
  buffer_load_dword v47, v4, s[20:23], s51 offen
  s_movk_i32 s59, 4
L_k1_vloop:
  s_waitcnt lgkmcnt(8)
  v_mfma_f32_16x16x32_bf16 v[80:83], a[0:3], v[48:51], 0
  s_add_u32 s46, s57, s61
  ds_read_b64_tr_b16 v[72:73], v15 offset:0
  v_cvt_pk_bf16_f32 v112, v112, v113
  v_mfma_f32_16x16x32_bf16 v[80:83], a[8:11], v[52:55], v[80:83]
  s_add_u32 s46, s46, 4194304
  ds_read_b64_tr_b16 v[74:75], v13 offset:512
  v_cvt_pk_bf16_f32 v113, v114, v115
  v_mfma_f32_16x16x32_bf16 v[84:87], a[4:7], v[48:51], 0
  s_add_u32 m0, s45, 65536
  ds_read_b64_tr_b16 v[76:77], v15 offset:4096
  buffer_load_dwordx4 v20, s[32:35], s46 offen offset:0 lds
  v_mfma_f32_16x16x32_bf16 v[84:87], a[12:15], v[52:55], v[84:87]
  s_waitcnt lgkmcnt(7)
  ds_read_b64_tr_b16 v[78:79], v13 offset:4608
  v_cvt_pk_bf16_f32 v114, v116, v117
  v_mfma_f32_16x16x32_bf16 v[88:91], a[0:3], v[56:59], 0
  ds_read_b64_tr_b16 v[48:49], v12 offset:8192
  v_cvt_pk_bf16_f32 v115, v118, v119
  v_mfma_f32_16x16x32_bf16 v[88:91], a[8:11], v[60:63], v[88:91]
  ds_read_b64_tr_b16 v[50:51], v14 offset:8704
  buffer_load_dwordx4 v21, s[32:35], s46 offen offset:1024 lds
  v_mfma_f32_16x16x32_bf16 v[92:95], a[4:7], v[56:59], 0
  ds_read_b64_tr_b16 v[52:53], v12 offset:12288
  v_cvt_pk_bf16_f32 v120, v120, v121
  v_mfma_f32_16x16x32_bf16 v[92:95], a[12:15], v[60:63], v[92:95]
  s_waitcnt lgkmcnt(3)
  ds_read_b64_tr_b16 v[54:55], v14 offset:12800
  v_cvt_pk_bf16_f32 v121, v122, v123
  v_mfma_f32_16x16x32_bf16 v[96:99], a[0:3], v[64:67], 0
  ds_read_b64_tr_b16 v[56:57], v13 offset:8192
  v_cvt_pk_bf16_f32 v122, v124, v125
  v_mfma_f32_16x16x32_bf16 v[96:99], a[8:11], v[68:71], v[96:99]
  ds_read_b64_tr_b16 v[58:59], v15 offset:8704
  buffer_load_dwordx4 v22, s[32:35], s46 offen offset:2048 lds
  v_mfma_f32_16x16x32_bf16 v[100:103], a[4:7], v[64:67], 0
  ds_read_b64_tr_b16 v[60:61], v13 offset:12288
  v_cvt_pk_bf16_f32 v123, v126, v127
  v_mfma_f32_16x16x32_bf16 v[100:103], a[12:15], v[68:71], v[100:103]
  ds_read_b64_tr_b16 v[62:63], v15 offset:12800
  v_cvt_pk_bf16_f32 v128, v128, v129
  v_mfma_f32_16x16x32_bf16 v[104:107], a[0:3], v[72:75], 0
  ds_read_b64_tr_b16 v[64:65], v14 offset:8192
  v_cvt_pk_bf16_f32 v129, v130, v131
  v_mfma_f32_16x16x32_bf16 v[104:107], a[8:11], v[76:79], v[104:107]
  ds_read_b64_tr_b16 v[66:67], v12 offset:8704
  buffer_load_dwordx4 v23, s[32:35], s46 offen offset:3072 lds
  v_mfma_f32_16x16x32_bf16 v[108:111], a[4:7], v[72:75], 0
  s_add_u32 m0, s45, 69632
  ds_read_b64_tr_b16 v[68:69], v14 offset:12288
  v_cvt_pk_bf16_f32 v130, v132, v133
  v_mfma_f32_16x16x32_bf16 v[108:111], a[12:15], v[76:79], v[108:111]
  s_waitcnt lgkmcnt(3)
  ds_read_b64_tr_b16 v[70:71], v12 offset:12800
  v_cvt_pk_bf16_f32 v131, v134, v135
  v_mfma_f32_16x16x32_bf16 v[80:83], a[16:19], v[48:51], v[80:83]
  ds_read_b64_tr_b16 v[72:73], v15 offset:8192
  v_cvt_pk_bf16_f32 v136, v136, v137
  v_mfma_f32_16x16x32_bf16 v[80:83], a[24:27], v[52:55], v[80:83]
  ds_read_b64_tr_b16 v[74:75], v13 offset:8704
  buffer_load_dwordx4 v24, s[32:35], s46 offen offset:0 lds
  v_mfma_f32_16x16x32_bf16 v[84:87], a[20:23], v[48:51], v[84:87]
  ds_read_b64_tr_b16 v[76:77], v15 offset:12288
  v_cvt_pk_bf16_f32 v137, v138, v139
  v_mfma_f32_16x16x32_bf16 v[84:87], a[28:31], v[52:55], v[84:87]
  ds_read_b64_tr_b16 v[78:79], v13 offset:12800
  v_cvt_pk_bf16_f32 v138, v140, v141
  v_mfma_f32_16x16x32_bf16 v[88:91], a[16:19], v[56:59], v[88:91]
  ds_read_b64_tr_b16 v[48:49], v12 offset:16384
  buffer_load_dwordx4 v25, s[32:35], s46 offen offset:1024 lds
  v_mfma_f32_16x16x32_bf16 v[88:91], a[24:27], v[60:63], v[88:91]
  ds_read_b64_tr_b16 v[50:51], v14 offset:16896
  v_cvt_pk_bf16_f32 v139, v142, v143
  v_mfma_f32_16x16x32_bf16 v[92:95], a[20:23], v[56:59], v[92:95]
  ds_read_b64_tr_b16 v[52:53], v12 offset:20480
  v_mfma_f32_16x16x32_bf16 v[92:95], a[28:31], v[60:63], v[92:95]
  s_waitcnt lgkmcnt(3)
  ds_read_b64_tr_b16 v[54:55], v14 offset:20992
  v_mfma_f32_16x16x32_bf16 v[96:99], a[16:19], v[64:67], v[96:99]
  ds_read_b64_tr_b16 v[56:57], v13 offset:16384
  buffer_load_dwordx4 v26, s[32:35], s46 offen offset:2048 lds
  v_mfma_f32_16x16x32_bf16 v[96:99], a[24:27], v[68:71], v[96:99]
  ds_read_b64_tr_b16 v[58:59], v15 offset:16896
  v_mfma_f32_16x16x32_bf16 v[100:103], a[20:23], v[64:67], v[100:103]
  ds_read_b64_tr_b16 v[60:61], v13 offset:20480
  v_mfma_f32_16x16x32_bf16 v[100:103], a[28:31], v[68:71], v[100:103]
  ds_read_b64_tr_b16 v[62:63], v15 offset:20992
  v_mfma_f32_16x16x32_bf16 v[104:107], a[16:19], v[72:75], v[104:107]
  ds_read_b64_tr_b16 v[64:65], v14 offset:16384
  buffer_load_dwordx4 v27, s[32:35], s46 offen offset:3072 lds
  v_mfma_f32_16x16x32_bf16 v[104:107], a[24:27], v[76:79], v[104:107]
  s_add_u32 m0, s45, 73728
  ds_read_b64_tr_b16 v[66:67], v12 offset:16896
  v_mfma_f32_16x16x32_bf16 v[108:111], a[20:23], v[72:75], v[108:111]
  ds_read_b64_tr_b16 v[68:69], v14 offset:20480
  v_mfma_f32_16x16x32_bf16 v[108:111], a[28:31], v[76:79], v[108:111]
  s_waitcnt lgkmcnt(3)
  ds_read_b64_tr_b16 v[70:71], v12 offset:20992
  v_mfma_f32_16x16x32_bf16 v[80:83], a[32:35], v[48:51], v[80:83]
  ds_read_b64_tr_b16 v[72:73], v15 offset:16384
  buffer_load_dwordx4 v28, s[32:35], s46 offen offset:0 lds
  v_mfma_f32_16x16x32_bf16 v[80:83], a[40:43], v[52:55], v[80:83]
  ds_read_b64_tr_b16 v[74:75], v13 offset:16896
  v_mfma_f32_16x16x32_bf16 v[84:87], a[36:39], v[48:51], v[84:87]
  ds_read_b64_tr_b16 v[76:77], v15 offset:20480
  v_mfma_f32_16x16x32_bf16 v[84:87], a[44:47], v[52:55], v[84:87]
  ds_read_b64_tr_b16 v[78:79], v13 offset:20992
  v_mfma_f32_16x16x32_bf16 v[88:91], a[32:35], v[56:59], v[88:91]
  ds_read_b64_tr_b16 v[48:49], v12 offset:24576
  buffer_load_dwordx4 v29, s[32:35], s46 offen offset:1024 lds
  v_mfma_f32_16x16x32_bf16 v[88:91], a[40:43], v[60:63], v[88:91]
  ds_read_b64_tr_b16 v[50:51], v14 offset:25088
  v_mfma_f32_16x16x32_bf16 v[92:95], a[36:39], v[56:59], v[92:95]
  ds_read_b64_tr_b16 v[52:53], v12 offset:28672
  v_mfma_f32_16x16x32_bf16 v[92:95], a[44:47], v[60:63], v[92:95]
  s_waitcnt lgkmcnt(3)
  ds_read_b64_tr_b16 v[54:55], v14 offset:29184
  buffer_load_dwordx4 v30, s[32:35], s46 offen offset:2048 lds
  v_mfma_f32_16x16x32_bf16 v[96:99], a[32:35], v[64:67], v[96:99]
  ds_read_b64_tr_b16 v[56:57], v13 offset:24576
  v_mfma_f32_16x16x32_bf16 v[96:99], a[40:43], v[68:71], v[96:99]
  ds_read_b64_tr_b16 v[58:59], v15 offset:25088
  v_mfma_f32_16x16x32_bf16 v[100:103], a[36:39], v[64:67], v[100:103]
  ds_read_b64_tr_b16 v[60:61], v13 offset:28672
  v_mfma_f32_16x16x32_bf16 v[100:103], a[44:47], v[68:71], v[100:103]
  ds_read_b64_tr_b16 v[62:63], v15 offset:29184
  buffer_load_dwordx4 v31, s[32:35], s46 offen offset:3072 lds
  v_mfma_f32_16x16x32_bf16 v[104:107], a[32:35], v[72:75], v[104:107]
  s_add_u32 m0, s45, 77824
  ds_read_b64_tr_b16 v[64:65], v14 offset:24576
  v_mfma_f32_16x16x32_bf16 v[104:107], a[40:43], v[76:79], v[104:107]
  ds_read_b64_tr_b16 v[66:67], v12 offset:25088
  v_mfma_f32_16x16x32_bf16 v[108:111], a[36:39], v[72:75], v[108:111]
  ds_read_b64_tr_b16 v[68:69], v14 offset:28672
  v_mfma_f32_16x16x32_bf16 v[108:111], a[44:47], v[76:79], v[108:111]
  s_waitcnt lgkmcnt(3)
  ds_read_b64_tr_b16 v[70:71], v12 offset:29184
  buffer_load_dwordx4 v32, s[32:35], s46 offen offset:0 lds
  v_mfma_f32_16x16x32_bf16 v[80:83], a[48:51], v[48:51], v[80:83]
  ds_read_b64_tr_b16 v[72:73], v15 offset:24576
  v_mfma_f32_16x16x32_bf16 v[80:83], a[56:59], v[52:55], v[80:83]
  ds_read_b64_tr_b16 v[74:75], v13 offset:25088
  v_mfma_f32_16x16x32_bf16 v[84:87], a[52:55], v[48:51], v[84:87]
  ds_read_b64_tr_b16 v[76:77], v15 offset:28672
  v_mfma_f32_16x16x32_bf16 v[84:87], a[60:63], v[52:55], v[84:87]
  ds_read_b64_tr_b16 v[78:79], v13 offset:29184
  buffer_load_dwordx4 v33, s[32:35], s46 offen offset:1024 lds
  v_mfma_f32_16x16x32_bf16 v[88:91], a[48:51], v[56:59], v[88:91]
  ds_read_b64_tr_b16 v[48:49], v12 offset:32768
  v_mfma_f32_16x16x32_bf16 v[88:91], a[56:59], v[60:63], v[88:91]
  ds_read_b64_tr_b16 v[50:51], v14 offset:33280
  v_mfma_f32_16x16x32_bf16 v[92:95], a[52:55], v[56:59], v[92:95]
  ds_read_b64_tr_b16 v[52:53], v12 offset:36864
  v_mfma_f32_16x16x32_bf16 v[92:95], a[60:63], v[60:63], v[92:95]
  s_waitcnt lgkmcnt(3)
  ds_read_b64_tr_b16 v[54:55], v14 offset:37376
  buffer_load_dwordx4 v34, s[32:35], s46 offen offset:2048 lds
  v_mfma_f32_16x16x32_bf16 v[96:99], a[48:51], v[64:67], v[96:99]
  ds_read_b64_tr_b16 v[56:57], v13 offset:32768
  v_mfma_f32_16x16x32_bf16 v[96:99], a[56:59], v[68:71], v[96:99]
  ds_read_b64_tr_b16 v[58:59], v15 offset:33280
  v_mfma_f32_16x16x32_bf16 v[100:103], a[52:55], v[64:67], v[100:103]
  ds_read_b64_tr_b16 v[60:61], v13 offset:36864
  buffer_load_dwordx4 v35, s[32:35], s46 offen offset:3072 lds
  v_mfma_f32_16x16x32_bf16 v[100:103], a[60:63], v[68:71], v[100:103]
  ds_read_b64_tr_b16 v[62:63], v15 offset:37376
  v_mfma_f32_16x16x32_bf16 v[104:107], a[48:51], v[72:75], v[104:107]
  s_add_u32 s49, s101, 2
  ds_read_b64_tr_b16 v[64:65], v14 offset:32768
  v_mfma_f32_16x16x32_bf16 v[104:107], a[56:59], v[76:79], v[104:107]
  s_cmp_lt_u32 s49, 4
  s_cselect_b32 s64, s28, s32
  s_cselect_b32 s65, s29, s33
  ds_read_b64_tr_b16 v[66:67], v12 offset:33280
  v_mfma_f32_16x16x32_bf16 v[108:111], a[52:55], v[72:75], v[108:111]
  s_and_b32 s50, s49, 3
  ds_read_b64_tr_b16 v[68:69], v14 offset:36864
  v_mfma_f32_16x16x32_bf16 v[108:111], a[60:63], v[76:79], v[108:111]
  s_waitcnt lgkmcnt(3)
  ds_read_b64_tr_b16 v[70:71], v12 offset:37376
  v_mfma_f32_16x16x32_bf16 v[80:83], a[64:67], v[48:51], v[80:83]
  s_lshl_b32 s50, s50, 7
  ds_read_b64_tr_b16 v[72:73], v15 offset:32768
  v_mfma_f32_16x16x32_bf16 v[80:83], a[72:75], v[52:55], v[80:83]
  s_add_u32 s100, s57, s50
  ds_read_b64_tr_b16 v[74:75], v13 offset:33280
  v_mfma_f32_16x16x32_bf16 v[84:87], a[68:71], v[48:51], v[84:87]
  s_cmp_lt_u32 s49, 8
  s_cselect_b32 s100, s100, 0x10000000
  ds_read_b64_tr_b16 v[76:77], v15 offset:36864
  v_mfma_f32_16x16x32_bf16 v[84:87], a[76:79], v[52:55], v[84:87]
  ds_read_b64_tr_b16 v[78:79], v13 offset:37376
  buffer_load_dword v47, v11, s[64:67], s100 offen
  v_mfma_f32_16x16x32_bf16 v[88:91], a[64:67], v[56:59], v[88:91]
  ds_read_b64_tr_b16 v[48:49], v12 offset:40960
  v_mfma_f32_16x16x32_bf16 v[88:91], a[72:75], v[60:63], v[88:91]
  ds_read_b64_tr_b16 v[50:51], v14 offset:41472
  v_mfma_f32_16x16x32_bf16 v[92:95], a[68:71], v[56:59], v[92:95]
  ds_read_b64_tr_b16 v[52:53], v12 offset:45056
  v_mfma_f32_16x16x32_bf16 v[92:95], a[76:79], v[60:63], v[92:95]
  s_waitcnt lgkmcnt(3)
  ds_read_b64_tr_b16 v[54:55], v14 offset:45568
  v_mfma_f32_16x16x32_bf16 v[96:99], a[64:67], v[64:67], v[96:99]
  ds_read_b64_tr_b16 v[56:57], v13 offset:40960
  v_mfma_f32_16x16x32_bf16 v[96:99], a[72:75], v[68:71], v[96:99]
  ds_read_b64_tr_b16 v[58:59], v15 offset:41472
  v_mfma_f32_16x16x32_bf16 v[100:103], a[68:71], v[64:67], v[100:103]
  ds_read_b64_tr_b16 v[60:61], v13 offset:45056
  buffer_store_dwordx4 v[112:115], v1, s[36:39], s56 offen offset:0 sc1
  v_mfma_f32_16x16x32_bf16 v[100:103], a[76:79], v[68:71], v[100:103]
  ds_read_b64_tr_b16 v[62:63], v15 offset:45568
  v_mfma_f32_16x16x32_bf16 v[104:107], a[64:67], v[72:75], v[104:107]
  ds_read_b64_tr_b16 v[64:65], v14 offset:40960
  v_mfma_f32_16x16x32_bf16 v[104:107], a[72:75], v[76:79], v[104:107]
  ds_read_b64_tr_b16 v[66:67], v12 offset:41472
  buffer_store_dwordx4 v[120:123], v1, s[36:39], s56 offen offset:1024 sc1
  v_mfma_f32_16x16x32_bf16 v[108:111], a[68:71], v[72:75], v[108:111]
  ds_read_b64_tr_b16 v[68:69], v14 offset:45056
  v_mfma_f32_16x16x32_bf16 v[108:111], a[76:79], v[76:79], v[108:111]
  s_waitcnt lgkmcnt(3)
  ds_read_b64_tr_b16 v[70:71], v12 offset:45568
  v_mfma_f32_16x16x32_bf16 v[80:83], a[80:83], v[48:51], v[80:83]
  ds_read_b64_tr_b16 v[72:73], v15 offset:40960
  v_mfma_f32_16x16x32_bf16 v[80:83], a[88:91], v[52:55], v[80:83]
  ds_read_b64_tr_b16 v[74:75], v13 offset:41472
  buffer_store_dwordx4 v[128:131], v1, s[36:39], s56 offen offset:2048 sc1
  v_mfma_f32_16x16x32_bf16 v[84:87], a[84:87], v[48:51], v[84:87]
  ds_read_b64_tr_b16 v[76:77], v15 offset:45056
  v_mfma_f32_16x16x32_bf16 v[84:87], a[92:95], v[52:55], v[84:87]
  ds_read_b64_tr_b16 v[78:79], v13 offset:45568
  v_mfma_f32_16x16x32_bf16 v[88:91], a[80:83], v[56:59], v[88:91]
  ds_read_b64_tr_b16 v[48:49], v12 offset:49152
  v_mfma_f32_16x16x32_bf16 v[88:91], a[88:91], v[60:63], v[88:91]
  ds_read_b64_tr_b16 v[50:51], v14 offset:49664
  buffer_store_dwordx4 v[136:139], v1, s[36:39], s56 offen offset:3072 sc1
  v_mfma_f32_16x16x32_bf16 v[92:95], a[84:87], v[56:59], v[92:95]
  ds_read_b64_tr_b16 v[52:53], v12 offset:53248
  v_mfma_f32_16x16x32_bf16 v[92:95], a[92:95], v[60:63], v[92:95]
  s_waitcnt lgkmcnt(3)
  ds_read_b64_tr_b16 v[54:55], v14 offset:53760
  v_mfma_f32_16x16x32_bf16 v[96:99], a[80:83], v[64:67], v[96:99]
  ds_read_b64_tr_b16 v[56:57], v13 offset:49152
  v_mfma_f32_16x16x32_bf16 v[96:99], a[88:91], v[68:71], v[96:99]
  ds_read_b64_tr_b16 v[58:59], v15 offset:49664
  v_mfma_f32_16x16x32_bf16 v[100:103], a[84:87], v[64:67], v[100:103]
  ds_read_b64_tr_b16 v[60:61], v13 offset:53248
  v_mfma_f32_16x16x32_bf16 v[100:103], a[92:95], v[68:71], v[100:103]
  ds_read_b64_tr_b16 v[62:63], v15 offset:53760
  v_mfma_f32_16x16x32_bf16 v[104:107], a[80:83], v[72:75], v[104:107]
  ds_read_b64_tr_b16 v[64:65], v14 offset:49152
  v_mfma_f32_16x16x32_bf16 v[104:107], a[88:91], v[76:79], v[104:107]
  ds_read_b64_tr_b16 v[66:67], v12 offset:49664
  v_mfma_f32_16x16x32_bf16 v[108:111], a[84:87], v[72:75], v[108:111]
  ds_read_b64_tr_b16 v[68:69], v14 offset:53248
  v_mfma_f32_16x16x32_bf16 v[108:111], a[92:95], v[76:79], v[108:111]
  s_waitcnt lgkmcnt(3)
  ds_read_b64_tr_b16 v[70:71], v12 offset:53760
  v_mfma_f32_16x16x32_bf16 v[80:83], a[96:99], v[48:51], v[80:83]
  ds_read_b64_tr_b16 v[72:73], v15 offset:49152
  v_mfma_f32_16x16x32_bf16 v[80:83], a[104:107], v[52:55], v[80:83]
  ds_read_b64_tr_b16 v[74:75], v13 offset:49664
  v_mfma_f32_16x16x32_bf16 v[84:87], a[100:103], v[48:51], v[84:87]
  ds_read_b64_tr_b16 v[76:77], v15 offset:53248
  v_mfma_f32_16x16x32_bf16 v[84:87], a[108:111], v[52:55], v[84:87]
  ds_read_b64_tr_b16 v[78:79], v13 offset:53760
  v_mfma_f32_16x16x32_bf16 v[88:91], a[96:99], v[56:59], v[88:91]
  ds_read_b64_tr_b16 v[48:49], v12 offset:57344
  v_mfma_f32_16x16x32_bf16 v[88:91], a[104:107], v[60:63], v[88:91]
  ds_read_b64_tr_b16 v[50:51], v14 offset:57856
  v_mfma_f32_16x16x32_bf16 v[92:95], a[100:103], v[56:59], v[92:95]
  ds_read_b64_tr_b16 v[52:53], v12 offset:61440
  v_mfma_f32_16x16x32_bf16 v[92:95], a[108:111], v[60:63], v[92:95]
  s_waitcnt lgkmcnt(3)
  ds_read_b64_tr_b16 v[54:55], v14 offset:61952
  v_mfma_f32_16x16x32_bf16 v[96:99], a[96:99], v[64:67], v[96:99]
  ds_read_b64_tr_b16 v[56:57], v13 offset:57344
  v_mfma_f32_16x16x32_bf16 v[96:99], a[104:107], v[68:71], v[96:99]
  ds_read_b64_tr_b16 v[58:59], v15 offset:57856
  v_mfma_f32_16x16x32_bf16 v[100:103], a[100:103], v[64:67], v[100:103]
  ds_read_b64_tr_b16 v[60:61], v13 offset:61440
  v_mfma_f32_16x16x32_bf16 v[100:103], a[108:111], v[68:71], v[100:103]
  ds_read_b64_tr_b16 v[62:63], v15 offset:61952
  v_mfma_f32_16x16x32_bf16 v[104:107], a[96:99], v[72:75], v[104:107]
  ds_read_b64_tr_b16 v[64:65], v14 offset:57344
  v_mfma_f32_16x16x32_bf16 v[104:107], a[104:107], v[76:79], v[104:107]
  ds_read_b64_tr_b16 v[66:67], v12 offset:57856
  v_mfma_f32_16x16x32_bf16 v[108:111], a[100:103], v[72:75], v[108:111]
  ds_read_b64_tr_b16 v[68:69], v14 offset:61440
  v_mfma_f32_16x16x32_bf16 v[108:111], a[108:111], v[76:79], v[108:111]
  s_waitcnt lgkmcnt(3)
  ds_read_b64_tr_b16 v[70:71], v12 offset:61952
  v_mfma_f32_16x16x32_bf16 v[80:83], a[112:115], v[48:51], v[80:83]
  ds_read_b64_tr_b16 v[72:73], v15 offset:57344
  v_mfma_f32_16x16x32_bf16 v[80:83], a[120:123], v[52:55], v[80:83]
  ds_read_b64_tr_b16 v[74:75], v13 offset:57856
  v_mfma_f32_16x16x32_bf16 v[84:87], a[116:119], v[48:51], v[84:87]
  ds_read_b64_tr_b16 v[76:77], v15 offset:61440
  v_mfma_f32_16x16x32_bf16 v[84:87], a[124:127], v[52:55], v[84:87]
  ds_read_b64_tr_b16 v[78:79], v13 offset:61952
  v_mfma_f32_16x16x32_bf16 v[88:91], a[112:115], v[56:59], v[88:91]
  v_mfma_f32_16x16x32_bf16 v[88:91], a[120:123], v[60:63], v[88:91]
  v_mfma_f32_16x16x32_bf16 v[92:95], a[116:119], v[56:59], v[92:95]
  v_mfma_f32_16x16x32_bf16 v[92:95], a[124:127], v[60:63], v[92:95]
  s_waitcnt vmcnt(5) lgkmcnt(0)
  s_barrier
  v_mfma_f32_16x16x32_bf16 v[96:99], a[112:115], v[64:67], v[96:99]
  ds_read_b64_tr_b16 v[48:49], v16 offset:0
  ds_read_b64_tr_b16 v[50:51], v18 offset:512
  v_mfma_f32_16x16x32_bf16 v[96:99], a[120:123], v[68:71], v[96:99]
  ds_read_b64_tr_b16 v[52:53], v16 offset:4096
  ds_read_b64_tr_b16 v[54:55], v18 offset:4608
  v_mfma_f32_16x16x32_bf16 v[100:103], a[116:119], v[64:67], v[100:103]
  ds_read_b64_tr_b16 v[56:57], v17 offset:0
  ds_read_b64_tr_b16 v[58:59], v19 offset:512
  v_mfma_f32_16x16x32_bf16 v[100:103], a[124:127], v[68:71], v[100:103]
  ds_read_b64_tr_b16 v[60:61], v17 offset:4096
  ds_read_b64_tr_b16 v[62:63], v19 offset:4608
  ds_read_b64_tr_b16 v[64:65], v18 offset:0
  v_mfma_f32_16x16x32_bf16 v[104:107], a[112:115], v[72:75], v[104:107]
  ds_read_b64_tr_b16 v[66:67], v16 offset:512
  v_mfma_f32_16x16x32_bf16 v[104:107], a[120:123], v[76:79], v[104:107]
  ds_read_b64_tr_b16 v[68:69], v18 offset:4096
  v_mfma_f32_16x16x32_bf16 v[108:111], a[116:119], v[72:75], v[108:111]
  ds_read_b64_tr_b16 v[70:71], v16 offset:4608
  v_mfma_f32_16x16x32_bf16 v[108:111], a[124:127], v[76:79], v[108:111]
  s_waitcnt lgkmcnt(8)
  v_mfma_f32_16x16x32_bf16 v[80:83], a[128:131], v[48:51], v[80:83]
  s_add_u32 s3, s61, 128
  ds_read_b64_tr_b16 v[72:73], v19 offset:0
  v_mfma_f32_16x16x32_bf16 v[80:83], a[136:139], v[52:55], v[80:83]
  s_add_u32 s3, s3, s57
  ds_read_b64_tr_b16 v[74:75], v17 offset:512
  v_mfma_f32_16x16x32_bf16 v[84:87], a[132:135], v[48:51], v[84:87]
  s_cmp_eq_u32 s59, 1
  s_cselect_b32 s46, 0x10000000, s3
  ds_read_b64_tr_b16 v[76:77], v19 offset:4096
  v_mfma_f32_16x16x32_bf16 v[84:87], a[140:143], v[52:55], v[84:87]
  s_waitcnt lgkmcnt(7)
  ds_read_b64_tr_b16 v[78:79], v17 offset:4608
  v_mfma_f32_16x16x32_bf16 v[88:91], a[128:131], v[56:59], v[88:91]
  s_add_u32 m0, s45, 0
  ds_read_b64_tr_b16 v[48:49], v16 offset:8192
  buffer_load_dwordx4 v20, s[96:99], s46 offen offset:0 lds
  v_mfma_f32_16x16x32_bf16 v[88:91], a[136:139], v[60:63], v[88:91]
  ds_read_b64_tr_b16 v[50:51], v18 offset:8704
  v_mfma_f32_16x16x32_bf16 v[92:95], a[132:135], v[56:59], v[92:95]
  ds_read_b64_tr_b16 v[52:53], v16 offset:12288
  v_mfma_f32_16x16x32_bf16 v[92:95], a[140:143], v[60:63], v[92:95]
  s_waitcnt lgkmcnt(3)
  ds_read_b64_tr_b16 v[54:55], v18 offset:12800
  buffer_load_dwordx4 v21, s[96:99], s46 offen offset:1024 lds
  v_mfma_f32_16x16x32_bf16 v[96:99], a[128:131], v[64:67], v[96:99]
  ds_read_b64_tr_b16 v[56:57], v17 offset:8192
  v_mfma_f32_16x16x32_bf16 v[96:99], a[136:139], v[68:71], v[96:99]
  ds_read_b64_tr_b16 v[58:59], v19 offset:8704
  v_mfma_f32_16x16x32_bf16 v[100:103], a[132:135], v[64:67], v[100:103]
  ds_read_b64_tr_b16 v[60:61], v17 offset:12288
  v_mfma_f32_16x16x32_bf16 v[100:103], a[140:143], v[68:71], v[100:103]
  ds_read_b64_tr_b16 v[62:63], v19 offset:12800
  buffer_load_dwordx4 v22, s[96:99], s46 offen offset:2048 lds
  v_mfma_f32_16x16x32_bf16 v[104:107], a[128:131], v[72:75], v[104:107]
  ds_read_b64_tr_b16 v[64:65], v18 offset:8192
  v_mfma_f32_16x16x32_bf16 v[104:107], a[136:139], v[76:79], v[104:107]
  ds_read_b64_tr_b16 v[66:67], v16 offset:8704
  v_mfma_f32_16x16x32_bf16 v[108:111], a[132:135], v[72:75], v[108:111]
  ds_read_b64_tr_b16 v[68:69], v18 offset:12288
  v_mfma_f32_16x16x32_bf16 v[108:111], a[140:143], v[76:79], v[108:111]
  s_waitcnt lgkmcnt(3)
  ds_read_b64_tr_b16 v[70:71], v16 offset:12800
  buffer_load_dwordx4 v23, s[96:99], s46 offen offset:3072 lds
  v_mfma_f32_16x16x32_bf16 v[80:83], a[144:147], v[48:51], v[80:83]
  s_add_u32 m0, s45, 4096
  ds_read_b64_tr_b16 v[72:73], v19 offset:8192
  v_mfma_f32_16x16x32_bf16 v[80:83], a[152:155], v[52:55], v[80:83]
  ds_read_b64_tr_b16 v[74:75], v17 offset:8704
  v_mfma_f32_16x16x32_bf16 v[84:87], a[148:151], v[48:51], v[84:87]
  ds_read_b64_tr_b16 v[76:77], v19 offset:12288
  v_mfma_f32_16x16x32_bf16 v[84:87], a[156:159], v[52:55], v[84:87]
  ds_read_b64_tr_b16 v[78:79], v17 offset:12800
  buffer_load_dwordx4 v24, s[96:99], s46 offen offset:0 lds
  v_mfma_f32_16x16x32_bf16 v[88:91], a[144:147], v[56:59], v[88:91]
  ds_read_b64_tr_b16 v[48:49], v16 offset:16384
  v_mfma_f32_16x16x32_bf16 v[88:91], a[152:155], v[60:63], v[88:91]
  ds_read_b64_tr_b16 v[50:51], v18 offset:16896
  v_mfma_f32_16x16x32_bf16 v[92:95], a[148:151], v[56:59], v[92:95]
  ds_read_b64_tr_b16 v[52:53], v16 offset:20480
  buffer_load_dwordx4 v25, s[96:99], s46 offen offset:1024 lds
  v_mfma_f32_16x16x32_bf16 v[92:95], a[156:159], v[60:63], v[92:95]
  s_waitcnt lgkmcnt(3)
  ds_read_b64_tr_b16 v[54:55], v18 offset:20992
  v_mfma_f32_16x16x32_bf16 v[96:99], a[144:147], v[64:67], v[96:99]
  ds_read_b64_tr_b16 v[56:57], v17 offset:16384
  v_mfma_f32_16x16x32_bf16 v[96:99], a[152:155], v[68:71], v[96:99]
  ds_read_b64_tr_b16 v[58:59], v19 offset:16896
  v_mfma_f32_16x16x32_bf16 v[100:103], a[148:151], v[64:67], v[100:103]
  ds_read_b64_tr_b16 v[60:61], v17 offset:20480
  buffer_load_dwordx4 v26, s[96:99], s46 offen offset:2048 lds
  v_mfma_f32_16x16x32_bf16 v[100:103], a[156:159], v[68:71], v[100:103]
  ds_read_b64_tr_b16 v[62:63], v19 offset:20992
  v_mfma_f32_16x16x32_bf16 v[104:107], a[144:147], v[72:75], v[104:107]
  ds_read_b64_tr_b16 v[64:65], v18 offset:16384
  v_mfma_f32_16x16x32_bf16 v[104:107], a[152:155], v[76:79], v[104:107]
  ds_read_b64_tr_b16 v[66:67], v16 offset:16896
  v_mfma_f32_16x16x32_bf16 v[108:111], a[148:151], v[72:75], v[108:111]
  ds_read_b64_tr_b16 v[68:69], v18 offset:20480
  buffer_load_dwordx4 v27, s[96:99], s46 offen offset:3072 lds
  v_mfma_f32_16x16x32_bf16 v[108:111], a[156:159], v[76:79], v[108:111]
  s_waitcnt lgkmcnt(3)
  ds_read_b64_tr_b16 v[70:71], v16 offset:20992
  v_mfma_f32_16x16x32_bf16 v[80:83], a[160:163], v[48:51], v[80:83]
  s_add_u32 m0, s45, 8192
  ds_read_b64_tr_b16 v[72:73], v19 offset:16384
  v_mfma_f32_16x16x32_bf16 v[80:83], a[168:171], v[52:55], v[80:83]
  ds_read_b64_tr_b16 v[74:75], v17 offset:16896
  v_mfma_f32_16x16x32_bf16 v[84:87], a[164:167], v[48:51], v[84:87]
  ds_read_b64_tr_b16 v[76:77], v19 offset:20480
  buffer_load_dwordx4 v28, s[96:99], s46 offen offset:0 lds
  v_mfma_f32_16x16x32_bf16 v[84:87], a[172:175], v[52:55], v[84:87]
  ds_read_b64_tr_b16 v[78:79], v17 offset:20992
  v_mfma_f32_16x16x32_bf16 v[88:91], a[160:163], v[56:59], v[88:91]
  ds_read_b64_tr_b16 v[48:49], v16 offset:24576
  v_mfma_f32_16x16x32_bf16 v[88:91], a[168:171], v[60:63], v[88:91]
  ds_read_b64_tr_b16 v[50:51], v18 offset:25088
  v_mfma_f32_16x16x32_bf16 v[92:95], a[164:167], v[56:59], v[92:95]
  ds_read_b64_tr_b16 v[52:53], v16 offset:28672
  buffer_load_dwordx4 v29, s[96:99], s46 offen offset:1024 lds
  v_mfma_f32_16x16x32_bf16 v[92:95], a[172:175], v[60:63], v[92:95]
  s_waitcnt lgkmcnt(3)
  ds_read_b64_tr_b16 v[54:55], v18 offset:29184
  v_mfma_f32_16x16x32_bf16 v[96:99], a[160:163], v[64:67], v[96:99]
  ds_read_b64_tr_b16 v[56:57], v17 offset:24576
  v_mfma_f32_16x16x32_bf16 v[96:99], a[168:171], v[68:71], v[96:99]
  ds_read_b64_tr_b16 v[58:59], v19 offset:25088
  buffer_load_dwordx4 v30, s[96:99], s46 offen offset:2048 lds
  v_mfma_f32_16x16x32_bf16 v[100:103], a[164:167], v[64:67], v[100:103]
  ds_read_b64_tr_b16 v[60:61], v17 offset:28672
  v_mfma_f32_16x16x32_bf16 v[100:103], a[172:175], v[68:71], v[100:103]
  ds_read_b64_tr_b16 v[62:63], v19 offset:29184
  v_mfma_f32_16x16x32_bf16 v[104:107], a[160:163], v[72:75], v[104:107]
  ds_read_b64_tr_b16 v[64:65], v18 offset:24576
  v_mfma_f32_16x16x32_bf16 v[104:107], a[168:171], v[76:79], v[104:107]
  ds_read_b64_tr_b16 v[66:67], v16 offset:25088
  buffer_load_dwordx4 v31, s[96:99], s46 offen offset:3072 lds
  v_mfma_f32_16x16x32_bf16 v[108:111], a[164:167], v[72:75], v[108:111]
  s_add_u32 m0, s45, 12288
  ds_read_b64_tr_b16 v[68:69], v18 offset:28672
  v_mfma_f32_16x16x32_bf16 v[108:111], a[172:175], v[76:79], v[108:111]
  s_waitcnt lgkmcnt(3)
  ds_read_b64_tr_b16 v[70:71], v16 offset:29184
  v_mfma_f32_16x16x32_bf16 v[80:83], a[176:179], v[48:51], v[80:83]
  ds_read_b64_tr_b16 v[72:73], v19 offset:24576
  v_mfma_f32_16x16x32_bf16 v[80:83], a[184:187], v[52:55], v[80:83]
  ds_read_b64_tr_b16 v[74:75], v17 offset:25088
  buffer_load_dwordx4 v32, s[96:99], s46 offen offset:0 lds
  v_mfma_f32_16x16x32_bf16 v[84:87], a[180:183], v[48:51], v[84:87]
  ds_read_b64_tr_b16 v[76:77], v19 offset:28672
  v_mfma_f32_16x16x32_bf16 v[84:87], a[188:191], v[52:55], v[84:87]
  ds_read_b64_tr_b16 v[78:79], v17 offset:29184
  v_mfma_f32_16x16x32_bf16 v[88:91], a[176:179], v[56:59], v[88:91]
  ds_read_b64_tr_b16 v[48:49], v16 offset:32768
  v_mfma_f32_16x16x32_bf16 v[88:91], a[184:187], v[60:63], v[88:91]
  ds_read_b64_tr_b16 v[50:51], v18 offset:33280
  buffer_load_dwordx4 v33, s[96:99], s46 offen offset:1024 lds
  v_mfma_f32_16x16x32_bf16 v[92:95], a[180:183], v[56:59], v[92:95]
  ds_read_b64_tr_b16 v[52:53], v16 offset:36864
  v_mfma_f32_16x16x32_bf16 v[92:95], a[188:191], v[60:63], v[92:95]
  s_waitcnt lgkmcnt(3)
  ds_read_b64_tr_b16 v[54:55], v18 offset:37376
  v_mfma_f32_16x16x32_bf16 v[96:99], a[176:179], v[64:67], v[96:99]
  ds_read_b64_tr_b16 v[56:57], v17 offset:32768
  v_mfma_f32_16x16x32_bf16 v[96:99], a[184:187], v[68:71], v[96:99]
  ds_read_b64_tr_b16 v[58:59], v19 offset:33280
  buffer_load_dwordx4 v34, s[96:99], s46 offen offset:2048 lds
  v_mfma_f32_16x16x32_bf16 v[100:103], a[180:183], v[64:67], v[100:103]
  ds_read_b64_tr_b16 v[60:61], v17 offset:36864
  v_mfma_f32_16x16x32_bf16 v[100:103], a[188:191], v[68:71], v[100:103]
  ds_read_b64_tr_b16 v[62:63], v19 offset:37376
  v_mfma_f32_16x16x32_bf16 v[104:107], a[176:179], v[72:75], v[104:107]
  ds_read_b64_tr_b16 v[64:65], v18 offset:32768
  buffer_load_dwordx4 v35, s[96:99], s46 offen offset:3072 lds
  v_mfma_f32_16x16x32_bf16 v[104:107], a[184:187], v[76:79], v[104:107]
  ds_read_b64_tr_b16 v[66:67], v16 offset:33280
  v_mfma_f32_16x16x32_bf16 v[108:111], a[180:183], v[72:75], v[108:111]
  ds_read_b64_tr_b16 v[68:69], v18 offset:36864
  v_mfma_f32_16x16x32_bf16 v[108:111], a[188:191], v[76:79], v[108:111]
  s_waitcnt lgkmcnt(3)
  ds_read_b64_tr_b16 v[70:71], v16 offset:37376
  v_mfma_f32_16x16x32_bf16 v[80:83], a[192:195], v[48:51], v[80:83]
  ds_read_b64_tr_b16 v[72:73], v19 offset:32768
  v_mfma_f32_16x16x32_bf16 v[80:83], a[200:203], v[52:55], v[80:83]
  ds_read_b64_tr_b16 v[74:75], v17 offset:33280
  v_mfma_f32_16x16x32_bf16 v[84:87], a[196:199], v[48:51], v[84:87]
  ds_read_b64_tr_b16 v[76:77], v19 offset:36864
  v_mfma_f32_16x16x32_bf16 v[84:87], a[204:207], v[52:55], v[84:87]
  ds_read_b64_tr_b16 v[78:79], v17 offset:37376
  v_mfma_f32_16x16x32_bf16 v[88:91], a[192:195], v[56:59], v[88:91]
  ds_read_b64_tr_b16 v[48:49], v16 offset:40960
  v_mfma_f32_16x16x32_bf16 v[88:91], a[200:203], v[60:63], v[88:91]
  ds_read_b64_tr_b16 v[50:51], v18 offset:41472
  v_mfma_f32_16x16x32_bf16 v[92:95], a[196:199], v[56:59], v[92:95]
  s_lshl_b32 s56, s61, 5
  ds_read_b64_tr_b16 v[52:53], v16 offset:45056
  v_mfma_f32_16x16x32_bf16 v[92:95], a[204:207], v[60:63], v[92:95]
  s_waitcnt lgkmcnt(3)
  ds_read_b64_tr_b16 v[54:55], v18 offset:45568
  v_mfma_f32_16x16x32_bf16 v[96:99], a[192:195], v[64:67], v[96:99]
  s_add_u32 s56, s56, s55
  ds_read_b64_tr_b16 v[56:57], v17 offset:40960
  v_mfma_f32_16x16x32_bf16 v[96:99], a[200:203], v[68:71], v[96:99]
  s_add_u32 s56, s56, 0x4000
  ds_read_b64_tr_b16 v[58:59], v19 offset:41472
  v_mfma_f32_16x16x32_bf16 v[100:103], a[196:199], v[64:67], v[100:103]
  ds_read_b64_tr_b16 v[60:61], v17 offset:45056
  v_mfma_f32_16x16x32_bf16 v[100:103], a[204:207], v[68:71], v[100:103]
  ds_read_b64_tr_b16 v[62:63], v19 offset:45568
  v_mfma_f32_16x16x32_bf16 v[104:107], a[192:195], v[72:75], v[104:107]
  ds_read_b64_tr_b16 v[64:65], v18 offset:40960
  v_mfma_f32_16x16x32_bf16 v[104:107], a[200:203], v[76:79], v[104:107]
  ds_read_b64_tr_b16 v[66:67], v16 offset:41472
  v_mfma_f32_16x16x32_bf16 v[108:111], a[196:199], v[72:75], v[108:111]
  ds_read_b64_tr_b16 v[68:69], v18 offset:45056
  v_mfma_f32_16x16x32_bf16 v[108:111], a[204:207], v[76:79], v[108:111]
  s_waitcnt lgkmcnt(3)
  ds_read_b64_tr_b16 v[70:71], v16 offset:45568
  v_mfma_f32_16x16x32_bf16 v[80:83], a[208:211], v[48:51], v[80:83]
  ds_read_b64_tr_b16 v[72:73], v19 offset:40960
  v_mfma_f32_16x16x32_bf16 v[80:83], a[216:219], v[52:55], v[80:83]
  ds_read_b64_tr_b16 v[74:75], v17 offset:41472
  v_mfma_f32_16x16x32_bf16 v[84:87], a[212:215], v[48:51], v[84:87]
  ds_read_b64_tr_b16 v[76:77], v19 offset:45056
  v_mfma_f32_16x16x32_bf16 v[84:87], a[220:223], v[52:55], v[84:87]
  ds_read_b64_tr_b16 v[78:79], v17 offset:45568
  v_mfma_f32_16x16x32_bf16 v[88:91], a[208:211], v[56:59], v[88:91]
  ds_read_b64_tr_b16 v[48:49], v16 offset:49152
  v_mfma_f32_16x16x32_bf16 v[88:91], a[216:219], v[60:63], v[88:91]
  ds_read_b64_tr_b16 v[50:51], v18 offset:49664
  v_mfma_f32_16x16x32_bf16 v[92:95], a[212:215], v[56:59], v[92:95]
  ds_read_b64_tr_b16 v[52:53], v16 offset:53248
  v_mfma_f32_16x16x32_bf16 v[92:95], a[220:223], v[60:63], v[92:95]
  s_waitcnt lgkmcnt(3)
  ds_read_b64_tr_b16 v[54:55], v18 offset:53760
  v_mfma_f32_16x16x32_bf16 v[96:99], a[208:211], v[64:67], v[96:99]
  ds_read_b64_tr_b16 v[56:57], v17 offset:49152
  v_mfma_f32_16x16x32_bf16 v[96:99], a[216:219], v[68:71], v[96:99]
  ds_read_b64_tr_b16 v[58:59], v19 offset:49664
  v_mfma_f32_16x16x32_bf16 v[100:103], a[212:215], v[64:67], v[100:103]
  ds_read_b64_tr_b16 v[60:61], v17 offset:53248
  v_mfma_f32_16x16x32_bf16 v[100:103], a[220:223], v[68:71], v[100:103]
  ds_read_b64_tr_b16 v[62:63], v19 offset:53760
  v_mfma_f32_16x16x32_bf16 v[104:107], a[208:211], v[72:75], v[104:107]
  ds_read_b64_tr_b16 v[64:65], v18 offset:49152
  v_mfma_f32_16x16x32_bf16 v[104:107], a[216:219], v[76:79], v[104:107]
  ds_read_b64_tr_b16 v[66:67], v16 offset:49664
  v_mfma_f32_16x16x32_bf16 v[108:111], a[212:215], v[72:75], v[108:111]
  ds_read_b64_tr_b16 v[68:69], v18 offset:53248
  v_mfma_f32_16x16x32_bf16 v[108:111], a[220:223], v[76:79], v[108:111]
  s_waitcnt lgkmcnt(3)
  ds_read_b64_tr_b16 v[70:71], v16 offset:53760
  v_mfma_f32_16x16x32_bf16 v[80:83], a[224:227], v[48:51], v[80:83]
  ds_read_b64_tr_b16 v[72:73], v19 offset:49152
  v_mfma_f32_16x16x32_bf16 v[80:83], a[232:235], v[52:55], v[80:83]
  ds_read_b64_tr_b16 v[74:75], v17 offset:49664
  v_mfma_f32_16x16x32_bf16 v[84:87], a[228:231], v[48:51], v[84:87]
  ds_read_b64_tr_b16 v[76:77], v19 offset:53248
  v_mfma_f32_16x16x32_bf16 v[84:87], a[236:239], v[52:55], v[84:87]
  ds_read_b64_tr_b16 v[78:79], v17 offset:53760
  v_mfma_f32_16x16x32_bf16 v[88:91], a[224:227], v[56:59], v[88:91]
  ds_read_b64_tr_b16 v[48:49], v16 offset:57344
  v_mfma_f32_16x16x32_bf16 v[88:91], a[232:235], v[60:63], v[88:91]
  ds_read_b64_tr_b16 v[50:51], v18 offset:57856
  v_mfma_f32_16x16x32_bf16 v[92:95], a[228:231], v[56:59], v[92:95]
  ds_read_b64_tr_b16 v[52:53], v16 offset:61440
  v_mfma_f32_16x16x32_bf16 v[92:95], a[236:239], v[60:63], v[92:95]
  s_waitcnt lgkmcnt(3)
  ds_read_b64_tr_b16 v[54:55], v18 offset:61952
  v_mfma_f32_16x16x32_bf16 v[96:99], a[224:227], v[64:67], v[96:99]
  ds_read_b64_tr_b16 v[56:57], v17 offset:57344
  v_mfma_f32_16x16x32_bf16 v[96:99], a[232:235], v[68:71], v[96:99]
  ds_read_b64_tr_b16 v[58:59], v19 offset:57856
  v_mfma_f32_16x16x32_bf16 v[100:103], a[228:231], v[64:67], v[100:103]
  ds_read_b64_tr_b16 v[60:61], v17 offset:61440
  v_mfma_f32_16x16x32_bf16 v[100:103], a[236:239], v[68:71], v[100:103]
  ds_read_b64_tr_b16 v[62:63], v19 offset:61952
  v_mfma_f32_16x16x32_bf16 v[104:107], a[224:227], v[72:75], v[104:107]
  ds_read_b64_tr_b16 v[64:65], v18 offset:57344
  v_mfma_f32_16x16x32_bf16 v[104:107], a[232:235], v[76:79], v[104:107]
  ds_read_b64_tr_b16 v[66:67], v16 offset:57856
  v_mfma_f32_16x16x32_bf16 v[108:111], a[228:231], v[72:75], v[108:111]
  ds_read_b64_tr_b16 v[68:69], v18 offset:61440
  v_mfma_f32_16x16x32_bf16 v[108:111], a[236:239], v[76:79], v[108:111]
  s_waitcnt lgkmcnt(3)
  ds_read_b64_tr_b16 v[70:71], v16 offset:61952
  v_mfma_f32_16x16x32_bf16 v[80:83], a[240:243], v[48:51], v[80:83]
  ds_read_b64_tr_b16 v[72:73], v19 offset:57344
  v_mfma_f32_16x16x32_bf16 v[112:115], a[248:251], v[52:55], v[80:83]
  ds_read_b64_tr_b16 v[74:75], v17 offset:57856
  v_mfma_f32_16x16x32_bf16 v[84:87], a[244:247], v[48:51], v[84:87]
  ds_read_b64_tr_b16 v[76:77], v19 offset:61440
  v_mfma_f32_16x16x32_bf16 v[116:119], a[252:255], v[52:55], v[84:87]
  ds_read_b64_tr_b16 v[78:79], v17 offset:61952
  v_mfma_f32_16x16x32_bf16 v[88:91], a[240:243], v[56:59], v[88:91]
  v_mfma_f32_16x16x32_bf16 v[120:123], a[248:251], v[60:63], v[88:91]
  v_mfma_f32_16x16x32_bf16 v[92:95], a[244:247], v[56:59], v[92:95]
  v_mfma_f32_16x16x32_bf16 v[124:127], a[252:255], v[60:63], v[92:95]
  s_waitcnt vmcnt(0) lgkmcnt(0)
  s_barrier
  v_mfma_f32_16x16x32_bf16 v[96:99], a[240:243], v[64:67], v[96:99]
  ds_read_b64_tr_b16 v[48:49], v12 offset:0
  ds_read_b64_tr_b16 v[50:51], v14 offset:512
  v_mfma_f32_16x16x32_bf16 v[128:131], a[248:251], v[68:71], v[96:99]
  ds_read_b64_tr_b16 v[52:53], v12 offset:4096
  ds_read_b64_tr_b16 v[54:55], v14 offset:4608
  v_mfma_f32_16x16x32_bf16 v[100:103], a[244:247], v[64:67], v[100:103]
  ds_read_b64_tr_b16 v[56:57], v13 offset:0
  ds_read_b64_tr_b16 v[58:59], v15 offset:512
  v_mfma_f32_16x16x32_bf16 v[132:135], a[252:255], v[68:71], v[100:103]
  ds_read_b64_tr_b16 v[60:61], v13 offset:4096
  ds_read_b64_tr_b16 v[62:63], v15 offset:4608
  ds_read_b64_tr_b16 v[64:65], v14 offset:0
  v_mfma_f32_16x16x32_bf16 v[104:107], a[240:243], v[72:75], v[104:107]
  ds_read_b64_tr_b16 v[66:67], v12 offset:512
  v_mfma_f32_16x16x32_bf16 v[136:139], a[248:251], v[76:79], v[104:107]
  ds_read_b64_tr_b16 v[68:69], v14 offset:4096
  v_mfma_f32_16x16x32_bf16 v[108:111], a[244:247], v[72:75], v[108:111]
  ds_read_b64_tr_b16 v[70:71], v12 offset:4608
  v_mfma_f32_16x16x32_bf16 v[140:143], a[252:255], v[76:79], v[108:111]
  s_add_u32 s101, s101, 1
  s_add_u32 s61, s61, 128
  s_sub_u32 s59, s59, 1
  s_cmp_lg_u32 s59, 0
  s_cbranch_scc1 L_k1_vloop
  s_nop 7
  v_cvt_pk_bf16_f32 v112, v112, v113
  v_cvt_pk_bf16_f32 v113, v114, v115
  v_cvt_pk_bf16_f32 v114, v116, v117
  v_cvt_pk_bf16_f32 v115, v118, v119
  buffer_store_dwordx4 v[112:115], v1, s[36:39], s56 offen offset:0 sc1
  v_cvt_pk_bf16_f32 v120, v120, v121
  v_cvt_pk_bf16_f32 v121, v122, v123
  v_cvt_pk_bf16_f32 v122, v124, v125
  v_cvt_pk_bf16_f32 v123, v126, v127
  buffer_store_dwordx4 v[120:123], v1, s[36:39], s56 offen offset:1024 sc1
  v_cvt_pk_bf16_f32 v128, v128, v129
  v_cvt_pk_bf16_f32 v129, v130, v131
  v_cvt_pk_bf16_f32 v130, v132, v133
  v_cvt_pk_bf16_f32 v131, v134, v135
  buffer_store_dwordx4 v[128:131], v1, s[36:39], s56 offen offset:2048 sc1
  v_cvt_pk_bf16_f32 v136, v136, v137
  v_cvt_pk_bf16_f32 v137, v138, v139
  v_cvt_pk_bf16_f32 v138, v140, v141
  v_cvt_pk_bf16_f32 v139, v142, v143
  buffer_store_dwordx4 v[136:139], v1, s[36:39], s56 offen offset:3072 sc1
L_k1_end:
  s_endpgm
.globl k2_attn_kernel
.p2align 8
.type k2_attn_kernel,@function
k2_attn_kernel:
  s_cmp_ge_u32 s2, 256
  s_cbranch_scc1 L_k2_end
  s_load_dwordx16 s[64:79], s[0:1], 0
  s_load_dwordx8 s[80:87], s[0:1], 64
  s_load_dwordx4 s[88:91], s[0:1], 96
  s_getpc_b64 s[92:93]
  s_mov_b32 s94, 0xc000
  s_mov_b32 s95, 0x20000
  s_lshr_b32 s3, s2, 3
  s_lshl_b32 s3, s3, 11
  v_lshlrev_b32 v3, 7, v0
  v_mov_b32 v4, 0x7ff00000
  v_cmp_gt_u32 vcc, 16, v0
  s_nop 1
  v_cndmask_b32 v3, v4, v3, vcc
  buffer_load_dword v255, v3, s[92:95], s3 offen
  v_lshrrev_b32 v3, 6, v0
  v_and_b32 v210, 63, v0
  v_readfirstlane_b32 s4, v3
  s_and_b32 s3, s2, 7
  s_lshr_b32 s26, s2, 3
  s_and_b32 s27, s26, 1
  s_lshl_b32 s3, s3, 1
  s_add_u32 s5, s3, s27
  s_lshr_b32 s26, s26, 1
  s_lshr_b32 s7, s26, 3
  s_and_b32 s6, s26, 7
  s_mov_b32 s58, s26
  v_lshlrev_b32 v208, 4, v210
  s_lshl_b32 s25, s4, 12
  v_add_u32 v209, s25, v208
  s_lshl_b32 s50, s4, 13
  s_lshl_b32 s20, s5, 21
  v_and_b32 v215, 15, v210
  v_lshrrev_b32 v216, 4, v210
  v_lshlrev_b32 v217, 2, v216
  v_sub_u32 v211, v215, v217
  v_mov_b32 v212, 0xff800000
  s_mov_b32 s32, 0x49800000
  s_sub_u32 s24, 15, s6
  s_lshl_b32 s26, s6, 2
  s_sub_u32 s26, 28, s26
  s_cmp_eq_u32 s7, 0
  s_cselect_b32 s35, 36, 0
  s_cselect_b32 s22, s26, 36
  s_cselect_b32 s57, 0xffff, 3
  s_cselect_b32 s60, s20, 0x10000000
  s_mov_b32 s30, 0
  s_mov_b32 s61, 0
  s_cmp_eq_u32 s6, 7
  s_cbranch_scc0 L_k2_split
  s_add_u32 s24, s7, 7
  s_add_u32 s22, s24, 1
  s_lshl_b32 s22, s22, 2
  s_mov_b32 s35, 0
  s_mov_b32 s7, 0
  s_mov_b32 s30, 1
  s_mov_b32 s57, 3
  s_mov_b32 s60, 0x10000000
L_k2_split:
  s_lshl_b32 s33, s24, 2
  s_add_u32 s33, s33, s4
  s_sub_u32 s23, s33, s35
  s_lshl_b32 s21, s35, 15
  s_add_u32 s21, s21, s20
  s_lshr_b32 s36, s22, 1
  v_add_u32 v221, 0x10000, v209
  v_add_u32 v222, 0x4000, v209
  v_add_u32 v223, 0x18000, v209
  v_add_u32 v224, 0xc000, v209
  s_waitcnt lgkmcnt(0)
  s_mov_b32 s8, s90
  s_and_b32 s9, s91, 0xffff
  s_mov_b32 s10, 0x10000000
  s_mov_b32 s11, 0x20000
  s_add_u32 m0, s25, 131072
  s_add_u32 s34, s21, 0
  buffer_load_dwordx4 v209, s[8:11], s34 offen offset:0 lds
  buffer_load_dwordx4 v209, s[8:11], s34 offen offset:1024 lds
  buffer_load_dwordx4 v209, s[8:11], s34 offen offset:2048 lds
  buffer_load_dwordx4 v209, s[8:11], s34 offen offset:3072 lds
  s_lshl_b32 s26, s5, 6
  s_add_u32 s26, s26, s33
  s_lshl_b32 s26, s26, 14
  s_add_u32 s26, s26, 0x2000000
  buffer_load_dwordx4 a[0:3], v208, s[8:11], s26 offen offset:0
  buffer_load_dwordx4 a[4:7], v208, s[8:11], s26 offen offset:1024
  buffer_load_dwordx4 a[8:11], v208, s[8:11], s26 offen offset:2048
  buffer_load_dwordx4 a[12:15], v208, s[8:11], s26 offen offset:3072
  s_add_u32 s26, s26, 4096
  buffer_load_dwordx4 a[16:19], v208, s[8:11], s26 offen offset:0
  buffer_load_dwordx4 a[20:23], v208, s[8:11], s26 offen offset:1024
  buffer_load_dwordx4 a[24:27], v208, s[8:11], s26 offen offset:2048
  buffer_load_dwordx4 a[28:31], v208, s[8:11], s26 offen offset:3072
  s_add_u32 s26, s26, 4096
  buffer_load_dwordx4 a[32:35], v208, s[8:11], s26 offen offset:0
  buffer_load_dwordx4 a[36:39], v208, s[8:11], s26 offen offset:1024
  buffer_load_dwordx4 a[40:43], v208, s[8:11], s26 offen offset:2048
  buffer_load_dwordx4 a[44:47], v208, s[8:11], s26 offen offset:3072
  s_add_u32 s26, s26, 4096
  buffer_load_dwordx4 a[48:51], v208, s[8:11], s26 offen offset:0
  buffer_load_dwordx4 a[52:55], v208, s[8:11], s26 offen offset:1024
  buffer_load_dwordx4 a[56:59], v208, s[8:11], s26 offen offset:2048
  buffer_load_dwordx4 a[60:63], v208, s[8:11], s26 offen offset:3072
  s_mov_b32 s27, s33
  s_add_u32 s28, s7, s30
  s_cmp_lg_u32 s28, 0
  s_cbranch_scc1 L_k2_g0
  s_lshl_b32 s27, s6, 2
  s_add_u32 s27, s27, s4
L_k2_g0:
  v_and_b32 v216, 15, v210
  v_lshlrev_b32 v216, 2, v216
  s_lshl_b32 s26, s27, 7
  s_add_u32 s26, s26, 0x5c80000
  buffer_load_dword v213, v216, s[8:11], s26 offen offset:0
  buffer_load_dword v214, v216, s[8:11], s26 offen offset:64
  v_mov_b32 v206, v208
  s_mov_b32 s12, s74
  s_and_b32 s13, s75, 0xffff
  s_mov_b32 s14, 0x380000
  s_mov_b32 s15, 0x20000
  s_mov_b32 s16, s82
  s_and_b32 s17, s83, 0xffff
  s_mov_b32 s18, 0x188000
  s_mov_b32 s19, 0x20000
  v_lshrrev_b32 v216, 4, v210
  v_bfe_u32 v217, v210, 2, 2
  v_and_b32 v218, 3, v210
  v_lshl_add_u32 v219, v216, 2, v217
  v_bfe_u32 v220, v219, 1, 2
  v_bfe_u32 v215, v219, 3, 1
  v_lshlrev_b32 v215, 1, v215
  v_xor_b32 v220, v220, v215
  v_lshlrev_b32 v219, 7, v219
  v_lshl_add_u32 v219, v218, 3, v219
  v_xor_b32 v215, 0, v220
  v_lshl_add_u32 v231, v215, 5, v219
  v_add_u32 v235, 49152, v231
  v_xor_b32 v215, 1, v220
  v_lshl_add_u32 v232, v215, 5, v219
  v_add_u32 v236, 49152, v232
  v_xor_b32 v215, 2, v220
  v_lshl_add_u32 v233, v215, 5, v219
  v_add_u32 v237, 49152, v233
  v_xor_b32 v215, 3, v220
  v_lshl_add_u32 v234, v215, 5, v219
  v_add_u32 v238, 49152, v234
  v_lshrrev_b32 v215, 3, v210
  v_mul_u32_u24 v216, 896, v215
  v_bfe_u32 v217, v210, 4, 2
  v_bfe_u32 v218, v210, 1, 2
  v_xor_b32 v217, v217, v218
  v_and_b32 v218, 1, v210
  v_lshl_add_u32 v216, v218, 4, v216
  v_lshl_add_u32 v219, v217, 5, v216
  v_xor_b32 v217, 2, v217
  v_lshl_add_u32 v220, v217, 5, v216
  s_mul_i32 s26, s4, 57344
  s_mul_i32 s27, s4, 28672
  v_add_u32 v239, 0x0, v219
  v_add_u32 v239, s26, v239
  v_add_u32 v240, 0x1800, v220
  v_add_u32 v240, s26, v240
  v_add_u32 v241, 0x3000, v219
  v_add_u32 v241, s26, v241
  v_add_u32 v242, 0x4800, v220
  v_add_u32 v242, s26, v242
  v_add_u32 v243, 0x7000, v219
  v_add_u32 v243, s26, v243
  v_add_u32 v244, 0x8800, v220
  v_add_u32 v244, s26, v244
  v_add_u32 v245, 0xa000, v219
  v_add_u32 v245, s26, v245
  v_add_u32 v246, 0xb800, v220
  v_add_u32 v246, s26, v246
  v_add_u32 v247, 0x0, v219
  v_add_u32 v247, s27, v247
  v_add_u32 v248, 0x1800, v220
  v_add_u32 v248, s27, v248
  v_add_u32 v249, 0x3000, v219
  v_add_u32 v249, s27, v249
  v_add_u32 v250, 0x4800, v220
  v_add_u32 v250, s27, v250
  v_add_u32 v251, 0x0, v208
  v_add_u32 v252, 0x4000, v208
  v_add_u32 v253, 0x8000, v208
  v_add_u32 v254, 0xc000, v208
  v_cmp_gt_i32 s[64:65], 0, v211
  v_cmp_gt_i32 s[66:67], 1, v211
  v_cmp_gt_i32 s[68:69], 2, v211
  v_cmp_gt_i32 s[70:71], 3, v211
  s_lshl_b32 s26, s5, 3
  s_add_u32 s26, s26, s6
  s_lshl_b32 s38, s26, 7
  s_add_u32 s38, s38, 0x5c82000
  s_lshl_b32 s26, s26, 2
  s_add_u32 s26, s26, s4
  s_mul_i32 s37, s26, 17408
  s_add_u32 s37, s37, 0x5400000
  s_lshl_b32 s26, s58, 2
  s_add_u32 s26, s26, s4
  s_mul_i32 s27, s26, 3584
  v_lshlrev_b32 v215, 7, v210
  v_mov_b32 v216, 0x7ff00000
  v_cmp_gt_u32 vcc, 28, v210
  v_add_u32 v217, s27, v215
  s_mul_i32 s27, s26, 1792
  v_cndmask_b32 v225, v216, v217, vcc
  v_cmp_gt_u32 vcc, 14, v210
  v_add_u32 v217, s27, v215
  s_nop 0
  v_cndmask_b32 v230, v216, v217, vcc
  v_mov_b64 v[0:1], 0
  v_mov_b64 v[2:3], 0
  v_mov_b64 v[4:5], 0
  v_mov_b64 v[6:7], 0
  v_mov_b64 v[8:9], 0
  v_mov_b64 v[10:11], 0
  v_mov_b64 v[12:13], 0
  v_mov_b64 v[14:15], 0
  v_mov_b64 v[16:17], 0
  v_mov_b64 v[18:19], 0
  v_mov_b64 v[20:21], 0
  v_mov_b64 v[22:23], 0
  v_mov_b64 v[24:25], 0
  v_mov_b64 v[26:27], 0
  v_mov_b64 v[28:29], 0
  v_mov_b64 v[30:31], 0
  v_mov_b64 v[32:33], 0
  v_mov_b64 v[34:35], 0
  v_mov_b64 v[36:37], 0
  v_mov_b64 v[38:39], 0
  v_mov_b64 v[40:41], 0
  v_mov_b64 v[42:43], 0
  v_mov_b64 v[44:45], 0
  v_mov_b64 v[46:47], 0
  v_mov_b64 v[48:49], 0
  v_mov_b64 v[50:51], 0
  v_mov_b64 v[52:53], 0
  v_mov_b64 v[54:55], 0
  v_mov_b64 v[56:57], 0
  v_mov_b64 v[58:59], 0
  v_mov_b64 v[60:61], 0
  v_mov_b64 v[62:63], 0
  v_mov_b64 v[64:65], 0
  v_mov_b64 v[66:67], 0
  v_mov_b64 v[68:69], 0
  v_mov_b64 v[70:71], 0
  v_mov_b64 v[72:73], 0
  v_mov_b64 v[74:75], 0
  v_mov_b64 v[76:77], 0
  v_mov_b64 v[78:79], 0
  v_mov_b64 v[80:81], 0
  v_mov_b64 v[82:83], 0
  v_mov_b64 v[84:85], 0
  v_mov_b64 v[86:87], 0
  v_mov_b64 v[88:89], 0
  v_mov_b64 v[90:91], 0
  v_mov_b64 v[92:93], 0
  v_mov_b64 v[94:95], 0
  v_mov_b64 v[96:97], 0
  v_mov_b64 v[98:99], 0
  v_mov_b64 v[100:101], 0
  v_mov_b64 v[102:103], 0
  v_mov_b64 v[104:105], 0
  v_mov_b64 v[106:107], 0
  v_mov_b64 v[108:109], 0
  v_mov_b64 v[110:111], 0
  v_mov_b64 v[112:113], 0
  v_mov_b64 v[114:115], 0
  v_mov_b64 v[116:117], 0
  v_mov_b64 v[118:119], 0
  v_mov_b64 v[120:121], 0
  v_mov_b64 v[122:123], 0
  v_mov_b64 v[124:125], 0
  v_mov_b64 v[126:127], 0
  v_mov_b64 v[192:193], 0
  v_mov_b64 v[194:195], 0
  v_mov_b64 v[196:197], 0
  v_mov_b64 v[198:199], 0
  v_mov_b32 v200, 0
  v_mov_b32 v204, 0
  v_mov_b32 v201, 0
  v_mov_b32 v205, 0
  v_add_u32 v207, 0x1c000, v208
  s_waitcnt vmcnt(0)
  s_barrier
  v_add_u32 v215, 0x20000, v208
  ds_read_b128 a[64:67], v215 offset:0
  ds_read_b128 a[68:71], v215 offset:1024
  ds_read_b128 a[72:75], v215 offset:2048
  ds_read_b128 a[76:79], v215 offset:3072
  ds_read_b128 a[80:83], v215 offset:4096
  ds_read_b128 a[84:87], v215 offset:5120
  ds_read_b128 a[88:91], v215 offset:6144
  ds_read_b128 a[92:95], v215 offset:7168
  ds_read_b128 a[96:99], v215 offset:8192
  ds_read_b128 a[100:103], v215 offset:9216
  ds_read_b128 a[104:107], v215 offset:10240
  ds_read_b128 a[108:111], v215 offset:11264
  ds_read_b128 a[112:115], v215 offset:12288
  ds_read_b128 a[116:119], v215 offset:13312
  ds_read_b128 a[120:123], v215 offset:14336
  ds_read_b128 a[124:127], v215 offset:15360
  s_mov_b32 s54, s25
  s_mov_b32 s28, s21
  s_waitcnt lgkmcnt(8)
  v_mfma_f32_16x16x32_bf16 v[128:131], a[64:67], a[0:3], v[192:195]
  s_add_u32 s34, s21, 32768
  s_add_u32 m0, s25, 147456
  v_mfma_f32_16x16x32_bf16 v[128:131], a[68:71], a[4:7], v[128:131]
  buffer_load_dwordx4 v209, s[8:11], s34 offen offset:0 lds
  v_mfma_f32_16x16x32_bf16 v[128:131], a[72:75], a[8:11], v[128:131]
  buffer_load_dwordx4 v209, s[8:11], s34 offen offset:1024 lds
  v_mfma_f32_16x16x32_bf16 v[128:131], a[76:79], a[12:15], v[128:131]
  buffer_load_dwordx4 v209, s[8:11], s34 offen offset:2048 lds
  v_mfma_f32_16x16x32_bf16 v[128:131], a[80:83], a[16:19], v[128:131]
  buffer_load_dwordx4 v209, s[8:11], s34 offen offset:3072 lds
  v_mfma_f32_16x16x32_bf16 v[128:131], a[84:87], a[20:23], v[128:131]
  s_add_u32 m0, s54, 16384
  v_mfma_f32_16x16x32_bf16 v[128:131], a[88:91], a[24:27], v[128:131]
  buffer_load_dwordx4 v222, s[8:11], s28 offen offset:0 lds
  v_mfma_f32_16x16x32_bf16 v[128:131], a[92:95], a[28:31], v[128:131]
  buffer_load_dwordx4 v222, s[8:11], s28 offen offset:1024 lds
  v_mfma_f32_16x16x32_bf16 v[132:135], a[64:67], a[32:35], v[196:199]
  buffer_load_dwordx4 v222, s[8:11], s28 offen offset:2048 lds
  v_mfma_f32_16x16x32_bf16 v[132:135], a[68:71], a[36:39], v[132:135]
  buffer_load_dwordx4 v222, s[8:11], s28 offen offset:3072 lds
  v_mfma_f32_16x16x32_bf16 v[132:135], a[72:75], a[40:43], v[132:135]
  s_add_u32 m0, s54, 0
  v_mfma_f32_16x16x32_bf16 v[132:135], a[76:79], a[44:47], v[132:135]
  buffer_load_dwordx4 v221, s[8:11], s28 offen offset:0 lds
  v_mfma_f32_16x16x32_bf16 v[132:135], a[80:83], a[48:51], v[132:135]
  buffer_load_dwordx4 v221, s[8:11], s28 offen offset:1024 lds
  v_mfma_f32_16x16x32_bf16 v[132:135], a[84:87], a[52:55], v[132:135]
  buffer_load_dwordx4 v221, s[8:11], s28 offen offset:2048 lds
  v_mfma_f32_16x16x32_bf16 v[132:135], a[88:91], a[56:59], v[132:135]
  buffer_load_dwordx4 v221, s[8:11], s28 offen offset:3072 lds
  v_mfma_f32_16x16x32_bf16 v[132:135], a[92:95], a[60:63], v[132:135]
  s_add_u32 m0, s54, 49152
  s_waitcnt lgkmcnt(0)
  v_mfma_f32_16x16x32_bf16 v[136:139], a[96:99], a[0:3], v[192:195]
  buffer_load_dwordx4 v224, s[8:11], s28 offen offset:0 lds
  v_mfma_f32_16x16x32_bf16 v[136:139], a[100:103], a[4:7], v[136:139]
  buffer_load_dwordx4 v224, s[8:11], s28 offen offset:1024 lds
  v_mfma_f32_16x16x32_bf16 v[136:139], a[104:107], a[8:11], v[136:139]
  buffer_load_dwordx4 v224, s[8:11], s28 offen offset:2048 lds
  v_mfma_f32_16x16x32_bf16 v[136:139], a[108:111], a[12:15], v[136:139]
  buffer_load_dwordx4 v224, s[8:11], s28 offen offset:3072 lds
  v_mfma_f32_16x16x32_bf16 v[136:139], a[112:115], a[16:19], v[136:139]
  s_add_u32 m0, s54, 32768
  v_mfma_f32_16x16x32_bf16 v[136:139], a[116:119], a[20:23], v[136:139]
  buffer_load_dwordx4 v223, s[8:11], s28 offen offset:0 lds
  v_mfma_f32_16x16x32_bf16 v[136:139], a[120:123], a[24:27], v[136:139]
  buffer_load_dwordx4 v223, s[8:11], s28 offen offset:1024 lds
  v_mfma_f32_16x16x32_bf16 v[136:139], a[124:127], a[28:31], v[136:139]
  buffer_load_dwordx4 v223, s[8:11], s28 offen offset:2048 lds
  v_mfma_f32_16x16x32_bf16 v[140:143], a[96:99], a[32:35], v[196:199]
  buffer_load_dwordx4 v223, s[8:11], s28 offen offset:3072 lds
  v_mfma_f32_16x16x32_bf16 v[140:143], a[100:103], a[36:39], v[140:143]
  v_mfma_f32_16x16x32_bf16 v[140:143], a[104:107], a[40:43], v[140:143]
  v_mfma_f32_16x16x32_bf16 v[140:143], a[108:111], a[44:47], v[140:143]
  v_mfma_f32_16x16x32_bf16 v[140:143], a[112:115], a[48:51], v[140:143]
  v_mfma_f32_16x16x32_bf16 v[140:143], a[116:119], a[52:55], v[140:143]
  v_mfma_f32_16x16x32_bf16 v[140:143], a[120:123], a[56:59], v[140:143]
  v_mfma_f32_16x16x32_bf16 v[140:143], a[124:127], a[60:63], v[140:143]
  s_add_u32 s54, s25, 0x10000
  s_waitcnt vmcnt(16)
  s_barrier
  ds_read_b128 a[64:67], v215 offset:16384
  ds_read_b128 a[68:71], v215 offset:17408
  ds_read_b128 a[72:75], v215 offset:18432
  ds_read_b128 a[76:79], v215 offset:19456
  ds_read_b128 a[80:83], v215 offset:20480
  ds_read_b128 a[84:87], v215 offset:21504
  ds_read_b128 a[88:91], v215 offset:22528
  ds_read_b128 a[92:95], v215 offset:23552
  s_branch L_k2_pm
L_k2_pc:
  v_add_u32 v215, 0x20000, v208
  ds_read_b128 a[64:67], v215 offset:0
  ds_read_b128 a[68:71], v215 offset:1024
  ds_read_b128 a[72:75], v215 offset:2048
  ds_read_b128 a[76:79], v215 offset:3072
  ds_read_b128 a[80:83], v215 offset:4096
  ds_read_b128 a[84:87], v215 offset:5120
  ds_read_b128 a[88:91], v215 offset:6144
  ds_read_b128 a[92:95], v215 offset:7168
  ds_read_b128 a[96:99], v215 offset:8192
  ds_read_b128 a[100:103], v215 offset:9216
  ds_read_b128 a[104:107], v215 offset:10240
  ds_read_b128 a[108:111], v215 offset:11264
  ds_read_b128 a[112:115], v215 offset:12288
  ds_read_b128 a[116:119], v215 offset:13312
  ds_read_b128 a[120:123], v215 offset:14336
  ds_read_b128 a[124:127], v215 offset:15360
  s_waitcnt lgkmcnt(8)
  v_mfma_f32_16x16x32_bf16 v[128:131], a[64:67], a[0:3], v[192:195]
  v_mfma_f32_16x16x32_bf16 v[128:131], a[68:71], a[4:7], v[128:131]
  v_mfma_f32_16x16x32_bf16 v[128:131], a[72:75], a[8:11], v[128:131]
  v_mfma_f32_16x16x32_bf16 v[128:131], a[76:79], a[12:15], v[128:131]
  v_mfma_f32_16x16x32_bf16 v[128:131], a[80:83], a[16:19], v[128:131]
  v_mfma_f32_16x16x32_bf16 v[128:131], a[84:87], a[20:23], v[128:131]
  v_mfma_f32_16x16x32_bf16 v[128:131], a[88:91], a[24:27], v[128:131]
  v_mfma_f32_16x16x32_bf16 v[128:131], a[92:95], a[28:31], v[128:131]
  v_mfma_f32_16x16x32_bf16 v[132:135], a[64:67], a[32:35], v[196:199]
  v_mfma_f32_16x16x32_bf16 v[132:135], a[68:71], a[36:39], v[132:135]
  v_mfma_f32_16x16x32_bf16 v[132:135], a[72:75], a[40:43], v[132:135]
  v_mfma_f32_16x16x32_bf16 v[132:135], a[76:79], a[44:47], v[132:135]
  v_mfma_f32_16x16x32_bf16 v[132:135], a[80:83], a[48:51], v[132:135]
  v_mfma_f32_16x16x32_bf16 v[132:135], a[84:87], a[52:55], v[132:135]
  v_mfma_f32_16x16x32_bf16 v[132:135], a[88:91], a[56:59], v[132:135]
  v_mfma_f32_16x16x32_bf16 v[132:135], a[92:95], a[60:63], v[132:135]
  s_waitcnt lgkmcnt(0)
  ds_read_b128 a[64:67], v215 offset:16384
  ds_read_b128 a[68:71], v215 offset:17408
  ds_read_b128 a[72:75], v215 offset:18432
  ds_read_b128 a[76:79], v215 offset:19456
  ds_read_b128 a[80:83], v215 offset:20480
  ds_read_b128 a[84:87], v215 offset:21504
  ds_read_b128 a[88:91], v215 offset:22528
  ds_read_b128 a[92:95], v215 offset:23552
  v_mfma_f32_16x16x32_bf16 v[136:139], a[96:99], a[0:3], v[192:195]
  v_mfma_f32_16x16x32_bf16 v[136:139], a[100:103], a[4:7], v[136:139]
  v_mfma_f32_16x16x32_bf16 v[136:139], a[104:107], a[8:11], v[136:139]
  v_mfma_f32_16x16x32_bf16 v[136:139], a[108:111], a[12:15], v[136:139]
  v_mfma_f32_16x16x32_bf16 v[136:139], a[112:115], a[16:19], v[136:139]
  v_mfma_f32_16x16x32_bf16 v[136:139], a[116:119], a[20:23], v[136:139]
  v_mfma_f32_16x16x32_bf16 v[136:139], a[120:123], a[24:27], v[136:139]
  v_mfma_f32_16x16x32_bf16 v[136:139], a[124:127], a[28:31], v[136:139]
  v_mfma_f32_16x16x32_bf16 v[140:143], a[96:99], a[32:35], v[196:199]
  v_mfma_f32_16x16x32_bf16 v[140:143], a[100:103], a[36:39], v[140:143]
  v_mfma_f32_16x16x32_bf16 v[140:143], a[104:107], a[40:43], v[140:143]
  v_mfma_f32_16x16x32_bf16 v[140:143], a[108:111], a[44:47], v[140:143]
  v_mfma_f32_16x16x32_bf16 v[140:143], a[112:115], a[48:51], v[140:143]
  v_mfma_f32_16x16x32_bf16 v[140:143], a[116:119], a[52:55], v[140:143]
  v_mfma_f32_16x16x32_bf16 v[140:143], a[120:123], a[56:59], v[140:143]
  v_mfma_f32_16x16x32_bf16 v[140:143], a[124:127], a[60:63], v[140:143]
L_k2_pm:
  s_cmp_le_i32 s23, 0
  s_cbranch_scc1 L_k2_maskp
L_k2_maskp_back:
  s_mov_b32 s31, 0xf149f2ca
  s_mov_b32 s29, 1
  s_branch L_k2_slow0
L_k2_pro_back:
  s_mov_b32 s31, 0
  s_mov_b32 s29, 0
  s_waitcnt lgkmcnt(0)
  s_mov_b32 s62, 0
L_k2_loop:
  s_waitcnt lgkmcnt(4)
  v_mfma_f32_16x16x32_bf16 v[144:147], a[64:67], a[0:3], v[192:195]
  v_exp_f32 v168, v136
  v_mfma_f32_16x16x32_bf16 v[144:147], a[68:71], a[4:7], v[144:147]
  v_exp_f32 v169, v137
  v_mfma_f32_16x16x32_bf16 v[144:147], a[72:75], a[8:11], v[144:147]
  ds_read_b128 a[96:99], v207 offset:40960
  v_add_f32 v202, v202, v162
  v_mfma_f32_16x16x32_bf16 v[144:147], a[76:79], a[12:15], v[144:147]
  s_waitcnt lgkmcnt(1)
  v_exp_f32 v170, v138
  v_mfma_f32_16x16x32_bf16 v[144:147], a[80:83], a[16:19], v[144:147]
  ds_read_b128 a[100:103], v207 offset:41984
  v_mfma_f32_16x16x32_bf16 v[144:147], a[84:87], a[20:23], v[144:147]
  ds_read_b128 a[104:107], v207 offset:43008
  v_mfma_f32_16x16x32_bf16 v[144:147], a[88:91], a[24:27], v[144:147]
  ds_read_b128 a[108:111], v207 offset:44032
  v_mfma_f32_16x16x32_bf16 v[144:147], a[92:95], a[28:31], v[144:147]
  ds_read_b128 a[112:115], v207 offset:45056
  v_mfma_f32_16x16x32_bf16 v[148:151], a[64:67], a[32:35], v[196:199]
  ds_read_b128 a[116:119], v207 offset:46080
  v_mfma_f32_16x16x32_bf16 v[148:151], a[68:71], a[36:39], v[148:151]
  ds_read_b128 a[120:123], v207 offset:47104
  v_mfma_f32_16x16x32_bf16 v[148:151], a[72:75], a[40:43], v[148:151]
  ds_read_b128 a[124:127], v207 offset:48128
  v_mfma_f32_16x16x32_bf16 v[148:151], a[76:79], a[44:47], v[148:151]
  v_exp_f32 v171, v139
  v_mfma_f32_16x16x32_bf16 v[148:151], a[80:83], a[48:51], v[148:151]
  v_add_f32 v202, v202, v163
  v_mfma_f32_16x16x32_bf16 v[148:151], a[84:87], a[52:55], v[148:151]
  v_exp_f32 v172, v140
  v_mfma_f32_16x16x32_bf16 v[148:151], a[88:91], a[56:59], v[148:151]
  v_exp_f32 v173, v141
  v_mfma_f32_16x16x32_bf16 v[148:151], a[92:95], a[60:63], v[148:151]
  s_waitcnt lgkmcnt(0)
  v_add_f32 v203, v203, v166
  v_mfma_f32_16x16x32_bf16 v[152:155], a[96:99], a[0:3], v[192:195]
  v_exp_f32 v174, v142
  v_mfma_f32_16x16x32_bf16 v[152:155], a[100:103], a[4:7], v[152:155]
  v_exp_f32 v175, v143
  v_mfma_f32_16x16x32_bf16 v[152:155], a[104:107], a[8:11], v[152:155]
  v_add_f32 v203, v203, v167
  v_add_f32 v202, v202, v168
  v_mfma_f32_16x16x32_bf16 v[152:155], a[108:111], a[12:15], v[152:155]
  v_add_f32 v202, v202, v169
  v_add_f32 v202, v202, v170
  v_mfma_f32_16x16x32_bf16 v[152:155], a[112:115], a[16:19], v[152:155]
  s_waitcnt vmcnt(0) lgkmcnt(0)
  s_barrier
  v_add_f32 v202, v202, v171
  v_mfma_f32_16x16x32_bf16 v[152:155], a[116:119], a[20:23], v[152:155]
  s_cmp_eq_u32 s36, s57
  s_cbranch_scc1 L_k2_evt
L_k2_evt_back:
  v_cvt_pk_bf16_f32 v178, v168, v169
  v_mfma_f32_16x16x32_bf16 v[152:155], a[120:123], a[24:27], v[152:155]
  ds_read_b128 a[128:131], v206 offset:16384
  v_cvt_pk_bf16_f32 v179, v170, v171
  v_mfma_f32_16x16x32_bf16 v[152:155], a[124:127], a[28:31], v[152:155]
  ds_read_b128 a[132:135], v206 offset:17408
  v_add_f32 v203, v203, v172
  v_mfma_f32_16x16x32_bf16 v[156:159], a[96:99], a[32:35], v[196:199]
  ds_read_b128 a[136:139], v206 offset:18432
  v_add_f32 v203, v203, v173
  v_mfma_f32_16x16x32_bf16 v[156:159], a[100:103], a[36:39], v[156:159]
  ds_read_b128 a[140:143], v206 offset:19456
  v_add_f32 v203, v203, v174
  v_mfma_f32_16x16x32_bf16 v[156:159], a[104:107], a[40:43], v[156:159]
  ds_read_b128 a[144:147], v206 offset:20480
  v_add_f32 v203, v203, v175
  v_mfma_f32_16x16x32_bf16 v[156:159], a[108:111], a[44:47], v[156:159]
  ds_read_b128 a[148:151], v206 offset:21504
  v_cvt_pk_bf16_f32 v182, v172, v173
  v_mfma_f32_16x16x32_bf16 v[156:159], a[112:115], a[48:51], v[156:159]
  v_cvt_pk_bf16_f32 v183, v174, v175
  v_max_f32 v215, v202, v203
  v_mfma_f32_16x16x32_bf16 v[156:159], a[116:119], a[52:55], v[156:159]
  v_cmp_lt_f32 vcc, s32, v215
  v_mfma_f32_16x16x32_bf16 v[156:159], a[120:123], a[56:59], v[156:159]
  v_mfma_f32_16x16x32_bf16 v[156:159], a[124:127], a[60:63], v[156:159]
  s_cbranch_vccnz L_k2_slow0
L_k2_slow0_back:
  s_waitcnt lgkmcnt(2)
  v_mfma_f32_16x16x32_bf16 v[0:3], a[128:131], v[176:179], v[0:3]
  ds_read_b128 a[152:155], v206 offset:22528
  v_add_f32 v200, v200, v202
  v_mfma_f32_16x16x32_bf16 v[4:7], a[128:131], v[180:183], v[4:7]
  ds_read_b128 a[156:159], v206 offset:23552
  v_add_f32 v201, v201, v203
  v_mfma_f32_16x16x32_bf16 v[8:11], a[132:135], v[176:179], v[8:11]
  s_sub_i32 s23, s23, 1
  ds_read_b128 a[128:131], v206 offset:24576
  v_mfma_f32_16x16x32_bf16 v[12:15], a[132:135], v[180:183], v[12:15]
  s_cmp_le_i32 s23, 0
  s_cbranch_scc1 L_k2_mask1
L_k2_mask1_back:
  ds_read_b128 a[132:135], v206 offset:25600
  v_mfma_f32_16x16x32_bf16 v[16:19], a[136:139], v[176:179], v[16:19]
  s_add_u32 s21, s21, 65536
  s_cmp_eq_u32 s36, 1
  s_cselect_b32 s28, s60, s21
  s_add_u32 m0, s54, 0
  v_mfma_f32_16x16x32_bf16 v[20:23], a[136:139], v[180:183], v[20:23]
  v_exp_f32 v160, v144
  v_mfma_f32_16x16x32_bf16 v[24:27], a[140:143], v[176:179], v[24:27]
  v_exp_f32 v161, v145
  v_mfma_f32_16x16x32_bf16 v[28:31], a[140:143], v[180:183], v[28:31]
  s_waitcnt lgkmcnt(2)
  ds_read_b128 a[136:139], v206 offset:26624
  buffer_load_dwordx4 v221, s[8:11], s28 offen offset:0 lds
  v_mfma_f32_16x16x32_bf16 v[32:35], a[144:147], v[176:179], v[32:35]
  v_exp_f32 v162, v146
  v_mfma_f32_16x16x32_bf16 v[36:39], a[144:147], v[180:183], v[36:39]
  ds_read_b128 a[140:143], v206 offset:27648
  buffer_load_dwordx4 v221, s[8:11], s28 offen offset:1024 lds
  v_mfma_f32_16x16x32_bf16 v[40:43], a[148:151], v[176:179], v[40:43]
  v_exp_f32 v163, v147
  v_mfma_f32_16x16x32_bf16 v[44:47], a[148:151], v[180:183], v[44:47]
  ds_read_b128 a[144:147], v206 offset:28672
  v_mfma_f32_16x16x32_bf16 v[48:51], a[152:155], v[176:179], v[48:51]
  v_exp_f32 v164, v148
  v_mfma_f32_16x16x32_bf16 v[52:55], a[152:155], v[180:183], v[52:55]
  ds_read_b128 a[148:151], v206 offset:29696
  buffer_load_dwordx4 v221, s[8:11], s28 offen offset:2048 lds
  v_mfma_f32_16x16x32_bf16 v[56:59], a[156:159], v[176:179], v[56:59]
  v_exp_f32 v165, v149
  v_mfma_f32_16x16x32_bf16 v[60:63], a[156:159], v[180:183], v[60:63]
  s_waitcnt lgkmcnt(2)
  ds_read_b128 a[152:155], v206 offset:30720
  ds_read_b128 a[64:67], v206 offset:0
  v_mfma_f32_16x16x32_bf16 v[64:67], a[128:131], v[176:179], v[64:67]
  v_exp_f32 v166, v150
  v_mfma_f32_16x16x32_bf16 v[68:71], a[128:131], v[180:183], v[68:71]
  ds_read_b128 a[156:159], v206 offset:31744
  ds_read_b128 a[68:71], v206 offset:1024
  v_mfma_f32_16x16x32_bf16 v[72:75], a[132:135], v[176:179], v[72:75]
  v_exp_f32 v167, v151
  v_mfma_f32_16x16x32_bf16 v[76:79], a[132:135], v[180:183], v[76:79]
  ds_read_b128 a[72:75], v206 offset:2048
  buffer_load_dwordx4 v221, s[8:11], s28 offen offset:3072 lds
  v_mfma_f32_16x16x32_bf16 v[80:83], a[136:139], v[176:179], v[80:83]
  ds_read_b128 a[76:79], v206 offset:3072
  v_add_f32 v202, v160, v161
  v_mfma_f32_16x16x32_bf16 v[84:87], a[136:139], v[180:183], v[84:87]
  s_add_u32 m0, s54, 16384
  ds_read_b128 a[80:83], v206 offset:4096
  v_add_f32 v203, v164, v165
  v_mfma_f32_16x16x32_bf16 v[88:91], a[140:143], v[176:179], v[88:91]
  buffer_load_dwordx4 v222, s[8:11], s28 offen offset:0 lds
  v_cvt_pk_bf16_f32 v184, v160, v161
  v_mfma_f32_16x16x32_bf16 v[92:95], a[140:143], v[180:183], v[92:95]
  s_waitcnt lgkmcnt(4)
  ds_read_b128 a[84:87], v206 offset:5120
  v_cvt_pk_bf16_f32 v185, v162, v163
  v_mfma_f32_16x16x32_bf16 v[96:99], a[144:147], v[176:179], v[96:99]
  v_cvt_pk_bf16_f32 v188, v164, v165
  v_cvt_pk_bf16_f32 v189, v166, v167
  v_mfma_f32_16x16x32_bf16 v[100:103], a[144:147], v[180:183], v[100:103]
  ds_read_b128 a[88:91], v206 offset:6144
  v_mfma_f32_16x16x32_bf16 v[104:107], a[148:151], v[176:179], v[104:107]
  v_mfma_f32_16x16x32_bf16 v[108:111], a[148:151], v[180:183], v[108:111]
  ds_read_b128 a[92:95], v206 offset:7168
  buffer_load_dwordx4 v222, s[8:11], s28 offen offset:1024 lds
  v_mfma_f32_16x16x32_bf16 v[112:115], a[152:155], v[176:179], v[112:115]
  v_mfma_f32_16x16x32_bf16 v[116:119], a[152:155], v[180:183], v[116:119]
  v_mfma_f32_16x16x32_bf16 v[120:123], a[156:159], v[176:179], v[120:123]
  v_mfma_f32_16x16x32_bf16 v[124:127], a[156:159], v[180:183], v[124:127]
  s_waitcnt lgkmcnt(4)
  buffer_load_dwordx4 v222, s[8:11], s28 offen offset:2048 lds
  v_mfma_f32_16x16x32_bf16 v[128:131], a[64:67], a[0:3], v[192:195]
  v_exp_f32 v168, v152
  v_mfma_f32_16x16x32_bf16 v[128:131], a[68:71], a[4:7], v[128:131]
  v_exp_f32 v169, v153
  v_mfma_f32_16x16x32_bf16 v[128:131], a[72:75], a[8:11], v[128:131]
  ds_read_b128 a[96:99], v206 offset:8192
  v_add_f32 v202, v202, v162
  v_mfma_f32_16x16x32_bf16 v[128:131], a[76:79], a[12:15], v[128:131]
  s_waitcnt lgkmcnt(1)
  v_exp_f32 v170, v154
  v_mfma_f32_16x16x32_bf16 v[128:131], a[80:83], a[16:19], v[128:131]
  ds_read_b128 a[100:103], v206 offset:9216
  buffer_load_dwordx4 v222, s[8:11], s28 offen offset:3072 lds
  v_mfma_f32_16x16x32_bf16 v[128:131], a[84:87], a[20:23], v[128:131]
  ds_read_b128 a[104:107], v206 offset:10240
  v_mfma_f32_16x16x32_bf16 v[128:131], a[88:91], a[24:27], v[128:131]
  ds_read_b128 a[108:111], v206 offset:11264
  v_mfma_f32_16x16x32_bf16 v[128:131], a[92:95], a[28:31], v[128:131]
  s_add_u32 m0, s54, 32768
  ds_read_b128 a[112:115], v206 offset:12288
  v_mfma_f32_16x16x32_bf16 v[132:135], a[64:67], a[32:35], v[196:199]
  ds_read_b128 a[116:119], v206 offset:13312
  buffer_load_dwordx4 v223, s[8:11], s28 offen offset:0 lds
  v_mfma_f32_16x16x32_bf16 v[132:135], a[68:71], a[36:39], v[132:135]
  ds_read_b128 a[120:123], v206 offset:14336
  v_mfma_f32_16x16x32_bf16 v[132:135], a[72:75], a[40:43], v[132:135]
  ds_read_b128 a[124:127], v206 offset:15360
  v_mfma_f32_16x16x32_bf16 v[132:135], a[76:79], a[44:47], v[132:135]
  v_exp_f32 v171, v155
  v_mfma_f32_16x16x32_bf16 v[132:135], a[80:83], a[48:51], v[132:135]
  v_add_f32 v202, v202, v163
  v_mfma_f32_16x16x32_bf16 v[132:135], a[84:87], a[52:55], v[132:135]
  v_exp_f32 v172, v156
  v_mfma_f32_16x16x32_bf16 v[132:135], a[88:91], a[56:59], v[132:135]
  v_exp_f32 v173, v157
  v_mfma_f32_16x16x32_bf16 v[132:135], a[92:95], a[60:63], v[132:135]
  s_waitcnt lgkmcnt(0)
  buffer_load_dwordx4 v223, s[8:11], s28 offen offset:1024 lds
  v_add_f32 v203, v203, v166
  v_mfma_f32_16x16x32_bf16 v[136:139], a[96:99], a[0:3], v[192:195]
  v_exp_f32 v174, v158
  v_mfma_f32_16x16x32_bf16 v[136:139], a[100:103], a[4:7], v[136:139]
  v_exp_f32 v175, v159
  v_mfma_f32_16x16x32_bf16 v[136:139], a[104:107], a[8:11], v[136:139]
  buffer_load_dwordx4 v223, s[8:11], s28 offen offset:2048 lds
  v_add_f32 v203, v203, v167
  v_mfma_f32_16x16x32_bf16 v[136:139], a[108:111], a[12:15], v[136:139]
  v_add_f32 v202, v202, v168
  v_add_f32 v202, v202, v169
  v_mfma_f32_16x16x32_bf16 v[136:139], a[112:115], a[16:19], v[136:139]
  v_add_f32 v202, v202, v170
  v_add_f32 v202, v202, v171
  v_mfma_f32_16x16x32_bf16 v[136:139], a[116:119], a[20:23], v[136:139]
  v_cvt_pk_bf16_f32 v186, v168, v169
  v_cvt_pk_bf16_f32 v187, v170, v171
  v_mfma_f32_16x16x32_bf16 v[136:139], a[120:123], a[24:27], v[136:139]
  ds_read_b128 a[128:131], v206 offset:49152
  buffer_load_dwordx4 v223, s[8:11], s28 offen offset:3072 lds
  v_mfma_f32_16x16x32_bf16 v[136:139], a[124:127], a[28:31], v[136:139]
  ds_read_b128 a[132:135], v206 offset:50176
  v_add_f32 v203, v203, v172
  v_mfma_f32_16x16x32_bf16 v[140:143], a[96:99], a[32:35], v[196:199]
  ds_read_b128 a[136:139], v206 offset:51200
  v_add_f32 v203, v203, v173
  v_mfma_f32_16x16x32_bf16 v[140:143], a[100:103], a[36:39], v[140:143]
  ds_read_b128 a[140:143], v206 offset:52224
  v_add_f32 v203, v203, v174
  v_mfma_f32_16x16x32_bf16 v[140:143], a[104:107], a[40:43], v[140:143]
  s_add_u32 m0, s54, 49152
  ds_read_b128 a[144:147], v206 offset:53248
  v_add_f32 v203, v203, v175
  v_mfma_f32_16x16x32_bf16 v[140:143], a[108:111], a[44:47], v[140:143]
  ds_read_b128 a[148:151], v206 offset:54272
  buffer_load_dwordx4 v224, s[8:11], s28 offen offset:0 lds
  v_mfma_f32_16x16x32_bf16 v[140:143], a[112:115], a[48:51], v[140:143]
  v_cvt_pk_bf16_f32 v190, v172, v173
  v_cvt_pk_bf16_f32 v191, v174, v175
  v_mfma_f32_16x16x32_bf16 v[140:143], a[116:119], a[52:55], v[140:143]
  v_max_f32 v215, v202, v203
  v_cmp_lt_f32 vcc, s32, v215
  v_mfma_f32_16x16x32_bf16 v[140:143], a[120:123], a[56:59], v[140:143]
  v_mfma_f32_16x16x32_bf16 v[140:143], a[124:127], a[60:63], v[140:143]
  buffer_load_dwordx4 v224, s[8:11], s28 offen offset:1024 lds
  s_cbranch_vccnz L_k2_slow1
L_k2_slow1_back:
  s_waitcnt lgkmcnt(2)
  v_mfma_f32_16x16x32_bf16 v[0:3], a[128:131], v[184:187], v[0:3]
  ds_read_b128 a[152:155], v206 offset:55296
  v_add_f32 v200, v200, v202
  v_mfma_f32_16x16x32_bf16 v[4:7], a[128:131], v[188:191], v[4:7]
  ds_read_b128 a[156:159], v206 offset:56320
  v_add_f32 v201, v201, v203
  v_mfma_f32_16x16x32_bf16 v[8:11], a[132:135], v[184:187], v[8:11]
  s_sub_i32 s23, s23, 1
  ds_read_b128 a[128:131], v206 offset:57344
  v_mfma_f32_16x16x32_bf16 v[12:15], a[132:135], v[188:191], v[12:15]
  s_cmp_le_i32 s23, 0
  s_cbranch_scc1 L_k2_mask0
L_k2_mask0_back:
  ds_read_b128 a[132:135], v206 offset:58368
  v_mfma_f32_16x16x32_bf16 v[16:19], a[136:139], v[184:187], v[16:19]
  v_exp_f32 v160, v128
  v_mfma_f32_16x16x32_bf16 v[20:23], a[136:139], v[188:191], v[20:23]
  v_exp_f32 v161, v129
  v_mfma_f32_16x16x32_bf16 v[24:27], a[140:143], v[184:187], v[24:27]
  v_exp_f32 v162, v130
  v_mfma_f32_16x16x32_bf16 v[28:31], a[140:143], v[188:191], v[28:31]
  s_waitcnt lgkmcnt(2)
  ds_read_b128 a[136:139], v206 offset:59392
  buffer_load_dwordx4 v224, s[8:11], s28 offen offset:2048 lds
  v_mfma_f32_16x16x32_bf16 v[32:35], a[144:147], v[184:187], v[32:35]
  v_exp_f32 v163, v131
  v_mfma_f32_16x16x32_bf16 v[36:39], a[144:147], v[188:191], v[36:39]
  ds_read_b128 a[140:143], v206 offset:60416
  buffer_load_dwordx4 v224, s[8:11], s28 offen offset:3072 lds
  v_mfma_f32_16x16x32_bf16 v[40:43], a[148:151], v[184:187], v[40:43]
  v_exp_f32 v164, v132
  v_mfma_f32_16x16x32_bf16 v[44:47], a[148:151], v[188:191], v[44:47]
  ds_read_b128 a[144:147], v206 offset:61440
  v_mfma_f32_16x16x32_bf16 v[48:51], a[152:155], v[184:187], v[48:51]
  v_exp_f32 v165, v133
  v_mfma_f32_16x16x32_bf16 v[52:55], a[152:155], v[188:191], v[52:55]
  ds_read_b128 a[148:151], v206 offset:62464
  v_mfma_f32_16x16x32_bf16 v[56:59], a[156:159], v[184:187], v[56:59]
  v_exp_f32 v166, v134
  v_mfma_f32_16x16x32_bf16 v[60:63], a[156:159], v[188:191], v[60:63]
  s_waitcnt lgkmcnt(2)
  ds_read_b128 a[152:155], v206 offset:63488
  ds_read_b128 a[64:67], v206 offset:32768
  v_mfma_f32_16x16x32_bf16 v[64:67], a[128:131], v[184:187], v[64:67]
  v_exp_f32 v167, v135
  v_mfma_f32_16x16x32_bf16 v[68:71], a[128:131], v[188:191], v[68:71]
  ds_read_b128 a[156:159], v206 offset:64512
  ds_read_b128 a[68:71], v206 offset:33792
  v_mfma_f32_16x16x32_bf16 v[72:75], a[132:135], v[184:187], v[72:75]
  ds_read_b128 a[72:75], v206 offset:34816
  v_add_f32 v202, v160, v161
  v_mfma_f32_16x16x32_bf16 v[76:79], a[132:135], v[188:191], v[76:79]
  ds_read_b128 a[76:79], v206 offset:35840
  v_add_f32 v203, v164, v165
  v_mfma_f32_16x16x32_bf16 v[80:83], a[136:139], v[184:187], v[80:83]
  v_cvt_pk_bf16_f32 v176, v160, v161
  v_cvt_pk_bf16_f32 v177, v162, v163
  v_mfma_f32_16x16x32_bf16 v[84:87], a[136:139], v[188:191], v[84:87]
  ds_read_b128 a[80:83], v206 offset:36864
  v_cvt_pk_bf16_f32 v180, v164, v165
  v_mfma_f32_16x16x32_bf16 v[88:91], a[140:143], v[184:187], v[88:91]
  s_xor_b32 s54, s54, 0x10000
  s_sub_u32 s36, s36, 1
  v_cvt_pk_bf16_f32 v181, v166, v167
  v_mfma_f32_16x16x32_bf16 v[92:95], a[140:143], v[188:191], v[92:95]
  s_waitcnt lgkmcnt(4)
  ds_read_b128 a[84:87], v206 offset:37888
  v_mfma_f32_16x16x32_bf16 v[96:99], a[144:147], v[184:187], v[96:99]
  v_mfma_f32_16x16x32_bf16 v[100:103], a[144:147], v[188:191], v[100:103]
  ds_read_b128 a[88:91], v206 offset:38912
  v_mfma_f32_16x16x32_bf16 v[104:107], a[148:151], v[184:187], v[104:107]
  v_mfma_f32_16x16x32_bf16 v[108:111], a[148:151], v[188:191], v[108:111]
  ds_read_b128 a[92:95], v206 offset:39936
  v_mfma_f32_16x16x32_bf16 v[112:115], a[152:155], v[184:187], v[112:115]
  v_mfma_f32_16x16x32_bf16 v[116:119], a[152:155], v[188:191], v[116:119]
  v_mfma_f32_16x16x32_bf16 v[120:123], a[156:159], v[184:187], v[120:123]
  v_mov_b32 v207, v206
  v_xor_b32 v206, 0x10000, v206
  v_mfma_f32_16x16x32_bf16 v[124:127], a[156:159], v[188:191], v[124:127]
  s_cmp_eq_u32 s36, 0
  s_cbranch_scc1 L_k2_exit
  s_cmp_le_u32 s36, 3
  s_cbranch_scc1 L_k2_loop
  s_mov_b32 s62, 1
L_k2_main:
  s_waitcnt lgkmcnt(4)
  v_mfma_f32_16x16x32_bf16 v[144:147], a[64:67], a[0:3], v[192:195]
  v_exp_f32 v168, v136
  v_mfma_f32_16x16x32_bf16 v[144:147], a[68:71], a[4:7], v[144:147]
  v_exp_f32 v169, v137
  v_mfma_f32_16x16x32_bf16 v[144:147], a[72:75], a[8:11], v[144:147]
  ds_read_b128 a[96:99], v207 offset:40960
  v_add_f32 v202, v202, v162
  v_mfma_f32_16x16x32_bf16 v[144:147], a[76:79], a[12:15], v[144:147]
  s_waitcnt lgkmcnt(1)
  v_exp_f32 v170, v138
  v_mfma_f32_16x16x32_bf16 v[144:147], a[80:83], a[16:19], v[144:147]
  ds_read_b128 a[100:103], v207 offset:41984
  v_mfma_f32_16x16x32_bf16 v[144:147], a[84:87], a[20:23], v[144:147]
  ds_read_b128 a[104:107], v207 offset:43008
  v_mfma_f32_16x16x32_bf16 v[144:147], a[88:91], a[24:27], v[144:147]
  ds_read_b128 a[108:111], v207 offset:44032
  v_mfma_f32_16x16x32_bf16 v[144:147], a[92:95], a[28:31], v[144:147]
  ds_read_b128 a[112:115], v207 offset:45056
  v_mfma_f32_16x16x32_bf16 v[148:151], a[64:67], a[32:35], v[196:199]
  s_add_u32 s21, s21, 65536
  ds_read_b128 a[116:119], v207 offset:46080
  v_mfma_f32_16x16x32_bf16 v[148:151], a[68:71], a[36:39], v[148:151]
  s_mov_b32 s28, s21
  ds_read_b128 a[120:123], v207 offset:47104
  v_mfma_f32_16x16x32_bf16 v[148:151], a[72:75], a[40:43], v[148:151]
  ds_read_b128 a[124:127], v207 offset:48128
  v_mfma_f32_16x16x32_bf16 v[148:151], a[76:79], a[44:47], v[148:151]
  v_exp_f32 v171, v139
  v_mfma_f32_16x16x32_bf16 v[148:151], a[80:83], a[48:51], v[148:151]
  v_add_f32 v202, v202, v163
  v_mfma_f32_16x16x32_bf16 v[148:151], a[84:87], a[52:55], v[148:151]
  v_exp_f32 v172, v140
  v_mfma_f32_16x16x32_bf16 v[148:151], a[88:91], a[56:59], v[148:151]
  v_exp_f32 v173, v141
  v_mfma_f32_16x16x32_bf16 v[148:151], a[92:95], a[60:63], v[148:151]
  s_waitcnt lgkmcnt(0)
  v_add_f32 v203, v203, v166
  v_mfma_f32_16x16x32_bf16 v[152:155], a[96:99], a[0:3], v[192:195]
  v_exp_f32 v174, v142
  v_mfma_f32_16x16x32_bf16 v[152:155], a[100:103], a[4:7], v[152:155]
  v_exp_f32 v175, v143
  v_mfma_f32_16x16x32_bf16 v[152:155], a[104:107], a[8:11], v[152:155]
  v_add_f32 v203, v203, v167
  v_add_f32 v202, v202, v168
  v_mfma_f32_16x16x32_bf16 v[152:155], a[108:111], a[12:15], v[152:155]
  v_add_f32 v202, v202, v169
  v_add_f32 v202, v202, v170
  v_mfma_f32_16x16x32_bf16 v[152:155], a[112:115], a[16:19], v[152:155]
  s_waitcnt vmcnt(0) lgkmcnt(0)
  s_barrier
  v_add_f32 v202, v202, v171
  v_mfma_f32_16x16x32_bf16 v[152:155], a[116:119], a[20:23], v[152:155]
  v_cvt_pk_bf16_f32 v178, v168, v169
  v_cvt_pk_bf16_f32 v179, v170, v171
  v_mfma_f32_16x16x32_bf16 v[152:155], a[120:123], a[24:27], v[152:155]
  s_add_u32 m0, s54, 0
  ds_read_b128 a[128:131], v206 offset:16384
  v_add_f32 v203, v203, v172
  v_mfma_f32_16x16x32_bf16 v[152:155], a[124:127], a[28:31], v[152:155]
  ds_read_b128 a[132:135], v206 offset:17408
  buffer_load_dwordx4 v221, s[8:11], s28 offen offset:0 lds
  v_mfma_f32_16x16x32_bf16 v[156:159], a[96:99], a[32:35], v[196:199]
  ds_read_b128 a[136:139], v206 offset:18432
  v_add_f32 v203, v203, v173
  v_mfma_f32_16x16x32_bf16 v[156:159], a[100:103], a[36:39], v[156:159]
  ds_read_b128 a[140:143], v206 offset:19456
  v_add_f32 v203, v203, v174
  v_mfma_f32_16x16x32_bf16 v[156:159], a[104:107], a[40:43], v[156:159]
  ds_read_b128 a[144:147], v206 offset:20480
  v_add_f32 v203, v203, v175
  v_mfma_f32_16x16x32_bf16 v[156:159], a[108:111], a[44:47], v[156:159]
  ds_read_b128 a[148:151], v206 offset:21504
  buffer_load_dwordx4 v221, s[8:11], s28 offen offset:1024 lds
  v_mfma_f32_16x16x32_bf16 v[156:159], a[112:115], a[48:51], v[156:159]
  v_cvt_pk_bf16_f32 v182, v172, v173
  v_cvt_pk_bf16_f32 v183, v174, v175
  v_mfma_f32_16x16x32_bf16 v[156:159], a[116:119], a[52:55], v[156:159]
  v_max_f32 v215, v202, v203
  v_cmp_lt_f32 vcc, s32, v215
  v_mfma_f32_16x16x32_bf16 v[156:159], a[120:123], a[56:59], v[156:159]
  v_mfma_f32_16x16x32_bf16 v[156:159], a[124:127], a[60:63], v[156:159]
  s_cbranch_vccnz L_k2_slow0
L_k2m_slow0_back:
  s_waitcnt lgkmcnt(2)
  v_mfma_f32_16x16x32_bf16 v[0:3], a[128:131], v[176:179], v[0:3]
  ds_read_b128 a[152:155], v206 offset:22528
  buffer_load_dwordx4 v221, s[8:11], s28 offen offset:2048 lds
  v_mfma_f32_16x16x32_bf16 v[4:7], a[128:131], v[180:183], v[4:7]
  ds_read_b128 a[156:159], v206 offset:23552
  v_add_f32 v200, v200, v202
  v_mfma_f32_16x16x32_bf16 v[8:11], a[132:135], v[176:179], v[8:11]
  v_add_f32 v201, v201, v203
  v_mfma_f32_16x16x32_bf16 v[12:15], a[132:135], v[180:183], v[12:15]
  ds_read_b128 a[128:131], v206 offset:24576
  v_mfma_f32_16x16x32_bf16 v[16:19], a[136:139], v[176:179], v[16:19]
  v_exp_f32 v160, v144
  v_mfma_f32_16x16x32_bf16 v[20:23], a[136:139], v[180:183], v[20:23]
  ds_read_b128 a[132:135], v206 offset:25600
  buffer_load_dwordx4 v221, s[8:11], s28 offen offset:3072 lds
  v_mfma_f32_16x16x32_bf16 v[24:27], a[140:143], v[176:179], v[24:27]
  v_exp_f32 v161, v145
  v_mfma_f32_16x16x32_bf16 v[28:31], a[140:143], v[180:183], v[28:31]
  s_waitcnt lgkmcnt(2)
  ds_read_b128 a[136:139], v206 offset:26624
  v_mfma_f32_16x16x32_bf16 v[32:35], a[144:147], v[176:179], v[32:35]
  s_add_u32 m0, s54, 16384
  v_exp_f32 v162, v146
  v_mfma_f32_16x16x32_bf16 v[36:39], a[144:147], v[180:183], v[36:39]
  ds_read_b128 a[140:143], v206 offset:27648
  buffer_load_dwordx4 v222, s[8:11], s28 offen offset:0 lds
  v_mfma_f32_16x16x32_bf16 v[40:43], a[148:151], v[176:179], v[40:43]
  v_exp_f32 v163, v147
  v_mfma_f32_16x16x32_bf16 v[44:47], a[148:151], v[180:183], v[44:47]
  ds_read_b128 a[144:147], v206 offset:28672
  v_mfma_f32_16x16x32_bf16 v[48:51], a[152:155], v[176:179], v[48:51]
  v_exp_f32 v164, v148
  v_mfma_f32_16x16x32_bf16 v[52:55], a[152:155], v[180:183], v[52:55]
  ds_read_b128 a[148:151], v206 offset:29696
  v_mfma_f32_16x16x32_bf16 v[56:59], a[156:159], v[176:179], v[56:59]
  v_exp_f32 v165, v149
  v_mfma_f32_16x16x32_bf16 v[60:63], a[156:159], v[180:183], v[60:63]
  s_waitcnt lgkmcnt(2)
  ds_read_b128 a[152:155], v206 offset:30720
  ds_read_b128 a[64:67], v206 offset:0
  v_mfma_f32_16x16x32_bf16 v[64:67], a[128:131], v[176:179], v[64:67]
  v_exp_f32 v166, v150
  v_mfma_f32_16x16x32_bf16 v[68:71], a[128:131], v[180:183], v[68:71]
  ds_read_b128 a[156:159], v206 offset:31744
  ds_read_b128 a[68:71], v206 offset:1024
  buffer_load_dwordx4 v222, s[8:11], s28 offen offset:1024 lds
  v_mfma_f32_16x16x32_bf16 v[72:75], a[132:135], v[176:179], v[72:75]
  v_exp_f32 v167, v151
  v_mfma_f32_16x16x32_bf16 v[76:79], a[132:135], v[180:183], v[76:79]
  ds_read_b128 a[72:75], v206 offset:2048
  buffer_load_dwordx4 v222, s[8:11], s28 offen offset:2048 lds
  v_mfma_f32_16x16x32_bf16 v[80:83], a[136:139], v[176:179], v[80:83]
  ds_read_b128 a[76:79], v206 offset:3072
  v_add_f32 v202, v160, v161
  v_mfma_f32_16x16x32_bf16 v[84:87], a[136:139], v[180:183], v[84:87]
  ds_read_b128 a[80:83], v206 offset:4096
  v_add_f32 v203, v164, v165
  v_mfma_f32_16x16x32_bf16 v[88:91], a[140:143], v[176:179], v[88:91]
  v_cvt_pk_bf16_f32 v184, v160, v161
  v_cvt_pk_bf16_f32 v185, v162, v163
  v_mfma_f32_16x16x32_bf16 v[92:95], a[140:143], v[180:183], v[92:95]
  s_waitcnt lgkmcnt(4)
  ds_read_b128 a[84:87], v206 offset:5120
  buffer_load_dwordx4 v222, s[8:11], s28 offen offset:3072 lds
  v_mfma_f32_16x16x32_bf16 v[96:99], a[144:147], v[176:179], v[96:99]
  v_cvt_pk_bf16_f32 v188, v164, v165
  v_cvt_pk_bf16_f32 v189, v166, v167
  v_mfma_f32_16x16x32_bf16 v[100:103], a[144:147], v[180:183], v[100:103]
  ds_read_b128 a[88:91], v206 offset:6144
  v_mfma_f32_16x16x32_bf16 v[104:107], a[148:151], v[176:179], v[104:107]
  s_add_u32 m0, s54, 32768
  v_mfma_f32_16x16x32_bf16 v[108:111], a[148:151], v[180:183], v[108:111]
  ds_read_b128 a[92:95], v206 offset:7168
  buffer_load_dwordx4 v223, s[8:11], s28 offen offset:0 lds
  v_mfma_f32_16x16x32_bf16 v[112:115], a[152:155], v[176:179], v[112:115]
  v_mfma_f32_16x16x32_bf16 v[116:119], a[152:155], v[180:183], v[116:119]
  v_mfma_f32_16x16x32_bf16 v[120:123], a[156:159], v[176:179], v[120:123]
  v_mfma_f32_16x16x32_bf16 v[124:127], a[156:159], v[180:183], v[124:127]
  s_waitcnt lgkmcnt(4)
  v_mfma_f32_16x16x32_bf16 v[128:131], a[64:67], a[0:3], v[192:195]
  v_exp_f32 v168, v152
  v_mfma_f32_16x16x32_bf16 v[128:131], a[68:71], a[4:7], v[128:131]
  v_exp_f32 v169, v153
  v_mfma_f32_16x16x32_bf16 v[128:131], a[72:75], a[8:11], v[128:131]
  ds_read_b128 a[96:99], v206 offset:8192
  buffer_load_dwordx4 v223, s[8:11], s28 offen offset:1024 lds
  v_mfma_f32_16x16x32_bf16 v[128:131], a[76:79], a[12:15], v[128:131]
  s_waitcnt lgkmcnt(1)
  ds_read_b128 a[100:103], v206 offset:9216
  v_add_f32 v202, v202, v162
  v_mfma_f32_16x16x32_bf16 v[128:131], a[80:83], a[16:19], v[128:131]
  v_exp_f32 v170, v154
  v_mfma_f32_16x16x32_bf16 v[128:131], a[84:87], a[20:23], v[128:131]
  ds_read_b128 a[104:107], v206 offset:10240
  buffer_load_dwordx4 v223, s[8:11], s28 offen offset:2048 lds
  v_mfma_f32_16x16x32_bf16 v[128:131], a[88:91], a[24:27], v[128:131]
  ds_read_b128 a[108:111], v206 offset:11264
  v_mfma_f32_16x16x32_bf16 v[128:131], a[92:95], a[28:31], v[128:131]
  ds_read_b128 a[112:115], v206 offset:12288
  v_mfma_f32_16x16x32_bf16 v[132:135], a[64:67], a[32:35], v[196:199]
  ds_read_b128 a[116:119], v206 offset:13312
  v_mfma_f32_16x16x32_bf16 v[132:135], a[68:71], a[36:39], v[132:135]
  ds_read_b128 a[120:123], v206 offset:14336
  buffer_load_dwordx4 v223, s[8:11], s28 offen offset:3072 lds
  v_mfma_f32_16x16x32_bf16 v[132:135], a[72:75], a[40:43], v[132:135]
  ds_read_b128 a[124:127], v206 offset:15360
  v_mfma_f32_16x16x32_bf16 v[132:135], a[76:79], a[44:47], v[132:135]
  v_exp_f32 v171, v155
  v_mfma_f32_16x16x32_bf16 v[132:135], a[80:83], a[48:51], v[132:135]
  v_add_f32 v202, v202, v163
  v_mfma_f32_16x16x32_bf16 v[132:135], a[84:87], a[52:55], v[132:135]
  s_add_u32 m0, s54, 49152
  v_exp_f32 v172, v156
  v_mfma_f32_16x16x32_bf16 v[132:135], a[88:91], a[56:59], v[132:135]
  v_exp_f32 v173, v157
  v_mfma_f32_16x16x32_bf16 v[132:135], a[92:95], a[60:63], v[132:135]
  s_waitcnt lgkmcnt(0)
  buffer_load_dwordx4 v224, s[8:11], s28 offen offset:0 lds
  v_add_f32 v203, v203, v166
  v_mfma_f32_16x16x32_bf16 v[136:139], a[96:99], a[0:3], v[192:195]
  v_exp_f32 v174, v158
  v_mfma_f32_16x16x32_bf16 v[136:139], a[100:103], a[4:7], v[136:139]
  v_exp_f32 v175, v159
  v_mfma_f32_16x16x32_bf16 v[136:139], a[104:107], a[8:11], v[136:139]
  buffer_load_dwordx4 v224, s[8:11], s28 offen offset:1024 lds
  v_add_f32 v203, v203, v167
  v_mfma_f32_16x16x32_bf16 v[136:139], a[108:111], a[12:15], v[136:139]
  v_add_f32 v202, v202, v168
  v_add_f32 v202, v202, v169
  v_mfma_f32_16x16x32_bf16 v[136:139], a[112:115], a[16:19], v[136:139]
  v_add_f32 v202, v202, v170
  v_add_f32 v202, v202, v171
  v_mfma_f32_16x16x32_bf16 v[136:139], a[116:119], a[20:23], v[136:139]
  v_cvt_pk_bf16_f32 v186, v168, v169
  v_cvt_pk_bf16_f32 v187, v170, v171
  v_mfma_f32_16x16x32_bf16 v[136:139], a[120:123], a[24:27], v[136:139]
  ds_read_b128 a[128:131], v206 offset:49152
  v_add_f32 v203, v203, v172
  v_mfma_f32_16x16x32_bf16 v[136:139], a[124:127], a[28:31], v[136:139]
  ds_read_b128 a[132:135], v206 offset:50176
  buffer_load_dwordx4 v224, s[8:11], s28 offen offset:2048 lds
  v_mfma_f32_16x16x32_bf16 v[140:143], a[96:99], a[32:35], v[196:199]
  ds_read_b128 a[136:139], v206 offset:51200
  v_add_f32 v203, v203, v173
  v_mfma_f32_16x16x32_bf16 v[140:143], a[100:103], a[36:39], v[140:143]
  ds_read_b128 a[140:143], v206 offset:52224
  v_add_f32 v203, v203, v174
  v_mfma_f32_16x16x32_bf16 v[140:143], a[104:107], a[40:43], v[140:143]
  ds_read_b128 a[144:147], v206 offset:53248
  v_add_f32 v203, v203, v175
  v_mfma_f32_16x16x32_bf16 v[140:143], a[108:111], a[44:47], v[140:143]
  ds_read_b128 a[148:151], v206 offset:54272
  v_cvt_pk_bf16_f32 v190, v172, v173
  v_mfma_f32_16x16x32_bf16 v[140:143], a[112:115], a[48:51], v[140:143]
  buffer_load_dwordx4 v224, s[8:11], s28 offen offset:3072 lds
  v_cvt_pk_bf16_f32 v191, v174, v175
  v_mfma_f32_16x16x32_bf16 v[140:143], a[116:119], a[52:55], v[140:143]
  v_max_f32 v215, v202, v203
  v_cmp_lt_f32 vcc, s32, v215
  v_mfma_f32_16x16x32_bf16 v[140:143], a[120:123], a[56:59], v[140:143]
  v_mfma_f32_16x16x32_bf16 v[140:143], a[124:127], a[60:63], v[140:143]
  s_cbranch_vccnz L_k2_slow1
L_k2m_slow1_back:
  s_waitcnt lgkmcnt(2)
  v_mfma_f32_16x16x32_bf16 v[0:3], a[128:131], v[184:187], v[0:3]
  ds_read_b128 a[152:155], v206 offset:55296
  v_add_f32 v200, v200, v202
  v_mfma_f32_16x16x32_bf16 v[4:7], a[128:131], v[188:191], v[4:7]
  ds_read_b128 a[156:159], v206 offset:56320
  v_add_f32 v201, v201, v203
  v_mfma_f32_16x16x32_bf16 v[8:11], a[132:135], v[184:187], v[8:11]
  ds_read_b128 a[128:131], v206 offset:57344
  v_mfma_f32_16x16x32_bf16 v[12:15], a[132:135], v[188:191], v[12:15]
  ds_read_b128 a[132:135], v206 offset:58368
  v_mfma_f32_16x16x32_bf16 v[16:19], a[136:139], v[184:187], v[16:19]
  v_exp_f32 v160, v128
  v_mfma_f32_16x16x32_bf16 v[20:23], a[136:139], v[188:191], v[20:23]
  v_exp_f32 v161, v129
  v_mfma_f32_16x16x32_bf16 v[24:27], a[140:143], v[184:187], v[24:27]
  v_exp_f32 v162, v130
  v_mfma_f32_16x16x32_bf16 v[28:31], a[140:143], v[188:191], v[28:31]
  s_waitcnt lgkmcnt(2)
  ds_read_b128 a[136:139], v206 offset:59392
  v_mfma_f32_16x16x32_bf16 v[32:35], a[144:147], v[184:187], v[32:35]
  v_exp_f32 v163, v131
  v_mfma_f32_16x16x32_bf16 v[36:39], a[144:147], v[188:191], v[36:39]
  ds_read_b128 a[140:143], v206 offset:60416
  v_mfma_f32_16x16x32_bf16 v[40:43], a[148:151], v[184:187], v[40:43]
  v_exp_f32 v164, v132
  v_mfma_f32_16x16x32_bf16 v[44:47], a[148:151], v[188:191], v[44:47]
  ds_read_b128 a[144:147], v206 offset:61440
  v_mfma_f32_16x16x32_bf16 v[48:51], a[152:155], v[184:187], v[48:51]
  v_exp_f32 v165, v133
  v_mfma_f32_16x16x32_bf16 v[52:55], a[152:155], v[188:191], v[52:55]
  ds_read_b128 a[148:151], v206 offset:62464
  v_mfma_f32_16x16x32_bf16 v[56:59], a[156:159], v[184:187], v[56:59]
  v_exp_f32 v166, v134
  v_mfma_f32_16x16x32_bf16 v[60:63], a[156:159], v[188:191], v[60:63]
  s_waitcnt lgkmcnt(2)
  ds_read_b128 a[152:155], v206 offset:63488
  ds_read_b128 a[64:67], v206 offset:32768
  v_mfma_f32_16x16x32_bf16 v[64:67], a[128:131], v[184:187], v[64:67]
  v_exp_f32 v167, v135
  v_mfma_f32_16x16x32_bf16 v[68:71], a[128:131], v[188:191], v[68:71]
  ds_read_b128 a[156:159], v206 offset:64512
  ds_read_b128 a[68:71], v206 offset:33792
  v_mfma_f32_16x16x32_bf16 v[72:75], a[132:135], v[184:187], v[72:75]
  ds_read_b128 a[72:75], v206 offset:34816
  v_add_f32 v202, v160, v161
  v_mfma_f32_16x16x32_bf16 v[76:79], a[132:135], v[188:191], v[76:79]
  ds_read_b128 a[76:79], v206 offset:35840
  v_add_f32 v203, v164, v165
  v_mfma_f32_16x16x32_bf16 v[80:83], a[136:139], v[184:187], v[80:83]
  v_cvt_pk_bf16_f32 v176, v160, v161
  v_cvt_pk_bf16_f32 v177, v162, v163
  v_mfma_f32_16x16x32_bf16 v[84:87], a[136:139], v[188:191], v[84:87]
  ds_read_b128 a[80:83], v206 offset:36864
  v_cvt_pk_bf16_f32 v180, v164, v165
  v_mfma_f32_16x16x32_bf16 v[88:91], a[140:143], v[184:187], v[88:91]
  s_xor_b32 s54, s54, 0x10000
  s_sub_u32 s36, s36, 1
  s_sub_i32 s23, s23, 2
  v_mfma_f32_16x16x32_bf16 v[92:95], a[140:143], v[188:191], v[92:95]
  s_waitcnt lgkmcnt(4)
  ds_read_b128 a[84:87], v206 offset:37888
  v_cvt_pk_bf16_f32 v181, v166, v167
  v_mfma_f32_16x16x32_bf16 v[96:99], a[144:147], v[184:187], v[96:99]
  v_mfma_f32_16x16x32_bf16 v[100:103], a[144:147], v[188:191], v[100:103]
  ds_read_b128 a[88:91], v206 offset:38912
  v_mfma_f32_16x16x32_bf16 v[104:107], a[148:151], v[184:187], v[104:107]
  v_mfma_f32_16x16x32_bf16 v[108:111], a[148:151], v[188:191], v[108:111]
  ds_read_b128 a[92:95], v206 offset:39936
  v_mfma_f32_16x16x32_bf16 v[112:115], a[152:155], v[184:187], v[112:115]
  v_mfma_f32_16x16x32_bf16 v[116:119], a[152:155], v[188:191], v[116:119]
  v_mfma_f32_16x16x32_bf16 v[120:123], a[156:159], v[184:187], v[120:123]
  v_mov_b32 v207, v206
  v_xor_b32 v206, 0x10000, v206
  v_mfma_f32_16x16x32_bf16 v[124:127], a[156:159], v[188:191], v[124:127]
  s_cmp_gt_u32 s36, 3
  s_cbranch_scc1 L_k2_main
  s_mov_b32 s62, 0
  s_branch L_k2_loop
L_k2_exit:
  v_mov_b32 v215, v200
  v_mov_b32 v216, v201
  s_nop 1
  v_permlane32_swap_b32 v200, v215
  v_permlane32_swap_b32 v201, v216
  s_nop 1
  v_add_f32 v200, v200, v215
  v_add_f32 v201, v201, v216
  v_mov_b32 v215, v200
  v_mov_b32 v216, v201
  s_nop 1
  v_permlane16_swap_b32 v200, v215
  v_permlane16_swap_b32 v201, v216
  s_nop 1
  v_add_f32 v200, v200, v215
  v_add_f32 v201, v201, v216
  s_cmp_eq_u32 s7, 1
  s_cbranch_scc1 L_k2_fin
  s_cmp_eq_u32 s30, 1
  s_cbranch_scc1 L_k2_fin
  s_waitcnt lgkmcnt(0)
  v_rcp_f32 v216, v200
  v_rcp_f32 v217, v201
  v_cmp_lt_f32 s[40:41], 0, v200
  v_cmp_lt_f32 s[42:43], 0, v201
  s_nop 1
  v_cndmask_b32 v216, 0, v216, s[40:41]
  v_cndmask_b32 v217, 0, v217, s[42:43]
  v_mov_b32 v226, v204
  v_mov_b32 v227, v205
  v_mov_b32 v228, v200
  v_mov_b32 v229, v201
  s_lshl_b32 s27, s6, 2
  s_add_u32 s27, s27, s4
  v_pk_mul_f32 v[0:1], v[0:1], v[216:217] op_sel_hi:[1,0]
  v_pk_mul_f32 v[2:3], v[2:3], v[216:217] op_sel_hi:[1,0]
  v_pk_mul_f32 v[8:9], v[8:9], v[216:217] op_sel_hi:[1,0]
  v_pk_mul_f32 v[10:11], v[10:11], v[216:217] op_sel_hi:[1,0]
  v_cvt_pk_bf16_f32 v0, v0, v1
  v_cvt_pk_bf16_f32 v1, v2, v3
  v_cvt_pk_bf16_f32 v2, v8, v9
  v_cvt_pk_bf16_f32 v3, v10, v11
  s_add_u32 s34, s20, 0
  s_add_u32 m0, s25, 131072
  v_pk_mul_f32 v[4:5], v[4:5], v[216:217] op_sel:[0,1] op_sel_hi:[1,1]
  v_pk_mul_f32 v[6:7], v[6:7], v[216:217] op_sel:[0,1] op_sel_hi:[1,1]
  v_pk_mul_f32 v[12:13], v[12:13], v[216:217] op_sel:[0,1] op_sel_hi:[1,1]
  v_pk_mul_f32 v[14:15], v[14:15], v[216:217] op_sel:[0,1] op_sel_hi:[1,1]
  v_cvt_pk_bf16_f32 v4, v4, v5
  v_cvt_pk_bf16_f32 v5, v6, v7
  v_cvt_pk_bf16_f32 v6, v12, v13
  v_cvt_pk_bf16_f32 v7, v14, v15
  buffer_load_dwordx4 v209, s[8:11], s34 offen offset:0 lds
  buffer_load_dwordx4 v209, s[8:11], s34 offen offset:1024 lds
  v_pk_mul_f32 v[16:17], v[16:17], v[216:217] op_sel_hi:[1,0]
  v_pk_mul_f32 v[18:19], v[18:19], v[216:217] op_sel_hi:[1,0]
  v_pk_mul_f32 v[24:25], v[24:25], v[216:217] op_sel_hi:[1,0]
  v_pk_mul_f32 v[26:27], v[26:27], v[216:217] op_sel_hi:[1,0]
  v_cvt_pk_bf16_f32 v16, v16, v17
  v_cvt_pk_bf16_f32 v17, v18, v19
  v_cvt_pk_bf16_f32 v18, v24, v25
  v_cvt_pk_bf16_f32 v19, v26, v27
  buffer_load_dwordx4 v209, s[8:11], s34 offen offset:2048 lds
  buffer_load_dwordx4 v209, s[8:11], s34 offen offset:3072 lds
  v_pk_mul_f32 v[20:21], v[20:21], v[216:217] op_sel:[0,1] op_sel_hi:[1,1]
  v_pk_mul_f32 v[22:23], v[22:23], v[216:217] op_sel:[0,1] op_sel_hi:[1,1]
  v_pk_mul_f32 v[28:29], v[28:29], v[216:217] op_sel:[0,1] op_sel_hi:[1,1]
  v_pk_mul_f32 v[30:31], v[30:31], v[216:217] op_sel:[0,1] op_sel_hi:[1,1]
  v_cvt_pk_bf16_f32 v20, v20, v21
  v_cvt_pk_bf16_f32 v21, v22, v23
  v_cvt_pk_bf16_f32 v22, v28, v29
  v_cvt_pk_bf16_f32 v23, v30, v31
  s_lshl_b32 s28, s5, 6
  s_add_u32 s28, s28, s27
  v_pk_mul_f32 v[32:33], v[32:33], v[216:217] op_sel_hi:[1,0]
  v_pk_mul_f32 v[34:35], v[34:35], v[216:217] op_sel_hi:[1,0]
  v_pk_mul_f32 v[40:41], v[40:41], v[216:217] op_sel_hi:[1,0]
  v_pk_mul_f32 v[42:43], v[42:43], v[216:217] op_sel_hi:[1,0]
  v_cvt_pk_bf16_f32 v32, v32, v33
  v_cvt_pk_bf16_f32 v33, v34, v35
  v_cvt_pk_bf16_f32 v34, v40, v41
  v_cvt_pk_bf16_f32 v35, v42, v43
  s_lshl_b32 s28, s28, 14
  s_add_u32 s28, s28, 0x2000000
  v_pk_mul_f32 v[36:37], v[36:37], v[216:217] op_sel:[0,1] op_sel_hi:[1,1]
  v_pk_mul_f32 v[38:39], v[38:39], v[216:217] op_sel:[0,1] op_sel_hi:[1,1]
  v_pk_mul_f32 v[44:45], v[44:45], v[216:217] op_sel:[0,1] op_sel_hi:[1,1]
  v_pk_mul_f32 v[46:47], v[46:47], v[216:217] op_sel:[0,1] op_sel_hi:[1,1]
  v_cvt_pk_bf16_f32 v36, v36, v37
  v_cvt_pk_bf16_f32 v37, v38, v39
  v_cvt_pk_bf16_f32 v38, v44, v45
  v_cvt_pk_bf16_f32 v39, v46, v47
  buffer_load_dwordx4 a[0:3], v208, s[8:11], s28 offen offset:0
  buffer_load_dwordx4 a[4:7], v208, s[8:11], s28 offen offset:1024
  buffer_load_dwordx4 a[8:11], v208, s[8:11], s28 offen offset:2048
  v_pk_mul_f32 v[48:49], v[48:49], v[216:217] op_sel_hi:[1,0]
  v_pk_mul_f32 v[50:51], v[50:51], v[216:217] op_sel_hi:[1,0]
  v_pk_mul_f32 v[56:57], v[56:57], v[216:217] op_sel_hi:[1,0]
  v_pk_mul_f32 v[58:59], v[58:59], v[216:217] op_sel_hi:[1,0]
  v_cvt_pk_bf16_f32 v48, v48, v49
  v_cvt_pk_bf16_f32 v49, v50, v51
  v_cvt_pk_bf16_f32 v50, v56, v57
  v_cvt_pk_bf16_f32 v51, v58, v59
  buffer_load_dwordx4 a[12:15], v208, s[8:11], s28 offen offset:3072
  s_add_u32 s28, s28, 4096
  v_pk_mul_f32 v[52:53], v[52:53], v[216:217] op_sel:[0,1] op_sel_hi:[1,1]
  v_pk_mul_f32 v[54:55], v[54:55], v[216:217] op_sel:[0,1] op_sel_hi:[1,1]
  v_pk_mul_f32 v[60:61], v[60:61], v[216:217] op_sel:[0,1] op_sel_hi:[1,1]
  v_pk_mul_f32 v[62:63], v[62:63], v[216:217] op_sel:[0,1] op_sel_hi:[1,1]
  v_cvt_pk_bf16_f32 v52, v52, v53
  v_cvt_pk_bf16_f32 v53, v54, v55
  v_cvt_pk_bf16_f32 v54, v60, v61
  v_cvt_pk_bf16_f32 v55, v62, v63
  buffer_load_dwordx4 a[16:19], v208, s[8:11], s28 offen offset:0
  buffer_load_dwordx4 a[20:23], v208, s[8:11], s28 offen offset:1024
  v_pk_mul_f32 v[64:65], v[64:65], v[216:217] op_sel_hi:[1,0]
  v_pk_mul_f32 v[66:67], v[66:67], v[216:217] op_sel_hi:[1,0]
  v_pk_mul_f32 v[72:73], v[72:73], v[216:217] op_sel_hi:[1,0]
  v_pk_mul_f32 v[74:75], v[74:75], v[216:217] op_sel_hi:[1,0]
  v_cvt_pk_bf16_f32 v64, v64, v65
  v_cvt_pk_bf16_f32 v65, v66, v67
  v_cvt_pk_bf16_f32 v66, v72, v73
  v_cvt_pk_bf16_f32 v67, v74, v75
  buffer_load_dwordx4 a[24:27], v208, s[8:11], s28 offen offset:2048
  buffer_load_dwordx4 a[28:31], v208, s[8:11], s28 offen offset:3072
  v_pk_mul_f32 v[68:69], v[68:69], v[216:217] op_sel:[0,1] op_sel_hi:[1,1]
  v_pk_mul_f32 v[70:71], v[70:71], v[216:217] op_sel:[0,1] op_sel_hi:[1,1]
  v_pk_mul_f32 v[76:77], v[76:77], v[216:217] op_sel:[0,1] op_sel_hi:[1,1]
  v_pk_mul_f32 v[78:79], v[78:79], v[216:217] op_sel:[0,1] op_sel_hi:[1,1]
  v_cvt_pk_bf16_f32 v68, v68, v69
  v_cvt_pk_bf16_f32 v69, v70, v71
  v_cvt_pk_bf16_f32 v70, v76, v77
  v_cvt_pk_bf16_f32 v71, v78, v79
  s_add_u32 s28, s28, 4096
  buffer_load_dwordx4 a[32:35], v208, s[8:11], s28 offen offset:0
  v_pk_mul_f32 v[80:81], v[80:81], v[216:217] op_sel_hi:[1,0]
  v_pk_mul_f32 v[82:83], v[82:83], v[216:217] op_sel_hi:[1,0]
  v_pk_mul_f32 v[88:89], v[88:89], v[216:217] op_sel_hi:[1,0]
  v_pk_mul_f32 v[90:91], v[90:91], v[216:217] op_sel_hi:[1,0]
  v_cvt_pk_bf16_f32 v80, v80, v81
  v_cvt_pk_bf16_f32 v81, v82, v83
  v_cvt_pk_bf16_f32 v82, v88, v89
  v_cvt_pk_bf16_f32 v83, v90, v91
  buffer_load_dwordx4 a[36:39], v208, s[8:11], s28 offen offset:1024
  buffer_load_dwordx4 a[40:43], v208, s[8:11], s28 offen offset:2048
  buffer_load_dwordx4 a[44:47], v208, s[8:11], s28 offen offset:3072
  v_pk_mul_f32 v[84:85], v[84:85], v[216:217] op_sel:[0,1] op_sel_hi:[1,1]
  v_pk_mul_f32 v[86:87], v[86:87], v[216:217] op_sel:[0,1] op_sel_hi:[1,1]
  v_pk_mul_f32 v[92:93], v[92:93], v[216:217] op_sel:[0,1] op_sel_hi:[1,1]
  v_pk_mul_f32 v[94:95], v[94:95], v[216:217] op_sel:[0,1] op_sel_hi:[1,1]
  v_cvt_pk_bf16_f32 v84, v84, v85
  v_cvt_pk_bf16_f32 v85, v86, v87
  v_cvt_pk_bf16_f32 v86, v92, v93
  v_cvt_pk_bf16_f32 v87, v94, v95
  s_add_u32 s28, s28, 4096
  buffer_load_dwordx4 a[48:51], v208, s[8:11], s28 offen offset:0
  v_pk_mul_f32 v[96:97], v[96:97], v[216:217] op_sel_hi:[1,0]
  v_pk_mul_f32 v[98:99], v[98:99], v[216:217] op_sel_hi:[1,0]
  v_pk_mul_f32 v[104:105], v[104:105], v[216:217] op_sel_hi:[1,0]
  v_pk_mul_f32 v[106:107], v[106:107], v[216:217] op_sel_hi:[1,0]
  v_cvt_pk_bf16_f32 v96, v96, v97
  v_cvt_pk_bf16_f32 v97, v98, v99
  v_cvt_pk_bf16_f32 v98, v104, v105
  v_cvt_pk_bf16_f32 v99, v106, v107
  buffer_load_dwordx4 a[52:55], v208, s[8:11], s28 offen offset:1024
  buffer_load_dwordx4 a[56:59], v208, s[8:11], s28 offen offset:2048
  v_pk_mul_f32 v[100:101], v[100:101], v[216:217] op_sel:[0,1] op_sel_hi:[1,1]
  v_pk_mul_f32 v[102:103], v[102:103], v[216:217] op_sel:[0,1] op_sel_hi:[1,1]
  v_pk_mul_f32 v[108:109], v[108:109], v[216:217] op_sel:[0,1] op_sel_hi:[1,1]
  v_pk_mul_f32 v[110:111], v[110:111], v[216:217] op_sel:[0,1] op_sel_hi:[1,1]
  v_cvt_pk_bf16_f32 v100, v100, v101
  v_cvt_pk_bf16_f32 v101, v102, v103
  v_cvt_pk_bf16_f32 v102, v108, v109
  v_cvt_pk_bf16_f32 v103, v110, v111
  buffer_load_dwordx4 a[60:63], v208, s[8:11], s28 offen offset:3072
  s_add_u32 s34, s20, 32768
  v_pk_mul_f32 v[112:113], v[112:113], v[216:217] op_sel_hi:[1,0]
  v_pk_mul_f32 v[114:115], v[114:115], v[216:217] op_sel_hi:[1,0]
  v_pk_mul_f32 v[120:121], v[120:121], v[216:217] op_sel_hi:[1,0]
  v_pk_mul_f32 v[122:123], v[122:123], v[216:217] op_sel_hi:[1,0]
  v_cvt_pk_bf16_f32 v112, v112, v113
  v_cvt_pk_bf16_f32 v113, v114, v115
  v_cvt_pk_bf16_f32 v114, v120, v121
  s_add_u32 m0, s25, 147456
  v_cvt_pk_bf16_f32 v115, v122, v123
  buffer_load_dwordx4 v209, s[8:11], s34 offen offset:0 lds
  v_pk_mul_f32 v[116:117], v[116:117], v[216:217] op_sel:[0,1] op_sel_hi:[1,1]
  v_pk_mul_f32 v[118:119], v[118:119], v[216:217] op_sel:[0,1] op_sel_hi:[1,1]
  v_pk_mul_f32 v[124:125], v[124:125], v[216:217] op_sel:[0,1] op_sel_hi:[1,1]
  v_pk_mul_f32 v[126:127], v[126:127], v[216:217] op_sel:[0,1] op_sel_hi:[1,1]
  v_cvt_pk_bf16_f32 v116, v116, v117
  v_cvt_pk_bf16_f32 v117, v118, v119
  v_cvt_pk_bf16_f32 v118, v124, v125
  v_cvt_pk_bf16_f32 v119, v126, v127
  buffer_load_dwordx4 v209, s[8:11], s34 offen offset:1024 lds
  buffer_load_dwordx4 v209, s[8:11], s34 offen offset:2048 lds
  buffer_load_dwordx4 v209, s[8:11], s34 offen offset:3072 lds
  s_add_u32 s26, s37, 16384
  buffer_store_dwordx4 v[226:229], v208, s[8:11], s26 offen sc1
  s_mov_b32 s26, s37
  buffer_store_dwordx4 v[0:3], v208, s[8:11], s26 offen offset:0 sc1
  v_mov_b64 v[8:9], 0
  v_mov_b64 v[10:11], 0
  buffer_store_dwordx4 v[4:7], v208, s[8:11], s26 offen offset:1024 sc1
  v_mov_b64 v[12:13], 0
  v_mov_b64 v[14:15], 0
  v_mov_b64 v[0:1], 0
  v_mov_b64 v[2:3], 0
  buffer_store_dwordx4 v[16:19], v208, s[8:11], s26 offen offset:2048 sc1
  v_mov_b64 v[24:25], 0
  v_mov_b64 v[26:27], 0
  v_mov_b64 v[4:5], 0
  v_mov_b64 v[6:7], 0
  buffer_store_dwordx4 v[20:23], v208, s[8:11], s26 offen offset:3072 sc1
  s_add_u32 s26, s26, 4096
  v_mov_b64 v[28:29], 0
  v_mov_b64 v[30:31], 0
  v_mov_b64 v[16:17], 0
  v_mov_b64 v[18:19], 0
  buffer_store_dwordx4 v[32:35], v208, s[8:11], s26 offen offset:0 sc1
  v_mov_b64 v[40:41], 0
  v_mov_b64 v[42:43], 0
  v_mov_b64 v[20:21], 0
  v_mov_b64 v[22:23], 0
  buffer_store_dwordx4 v[36:39], v208, s[8:11], s26 offen offset:1024 sc1
  v_mov_b64 v[44:45], 0
  v_mov_b64 v[46:47], 0
  v_mov_b64 v[32:33], 0
  v_mov_b64 v[34:35], 0
  buffer_store_dwordx4 v[48:51], v208, s[8:11], s26 offen offset:2048 sc1
  v_mov_b64 v[56:57], 0
  v_mov_b64 v[58:59], 0
  v_mov_b64 v[36:37], 0
  v_mov_b64 v[38:39], 0
  buffer_store_dwordx4 v[52:55], v208, s[8:11], s26 offen offset:3072 sc1
  s_add_u32 s26, s26, 4096
  v_mov_b64 v[60:61], 0
  v_mov_b64 v[62:63], 0
  v_mov_b64 v[48:49], 0
  v_mov_b64 v[50:51], 0
  buffer_store_dwordx4 v[64:67], v208, s[8:11], s26 offen offset:0 sc1
  v_mov_b64 v[72:73], 0
  v_mov_b64 v[74:75], 0
  v_mov_b64 v[52:53], 0
  v_mov_b64 v[54:55], 0
  buffer_store_dwordx4 v[68:71], v208, s[8:11], s26 offen offset:1024 sc1
  v_mov_b64 v[76:77], 0
  v_mov_b64 v[78:79], 0
  v_mov_b64 v[64:65], 0
  v_mov_b64 v[66:67], 0
  buffer_store_dwordx4 v[80:83], v208, s[8:11], s26 offen offset:2048 sc1
  v_mov_b64 v[88:89], 0
  v_mov_b64 v[90:91], 0
  v_mov_b64 v[68:69], 0
  v_mov_b64 v[70:71], 0
  buffer_store_dwordx4 v[84:87], v208, s[8:11], s26 offen offset:3072 sc1
  s_add_u32 s26, s26, 4096
  v_mov_b64 v[92:93], 0
  v_mov_b64 v[94:95], 0
  v_mov_b64 v[80:81], 0
  v_mov_b64 v[82:83], 0
  buffer_store_dwordx4 v[96:99], v208, s[8:11], s26 offen offset:0 sc1
  v_mov_b64 v[104:105], 0
  v_mov_b64 v[106:107], 0
  v_mov_b64 v[84:85], 0
  v_mov_b64 v[86:87], 0
  buffer_store_dwordx4 v[100:103], v208, s[8:11], s26 offen offset:1024 sc1
  v_mov_b64 v[108:109], 0
  v_mov_b64 v[110:111], 0
  v_mov_b64 v[96:97], 0
  v_mov_b64 v[98:99], 0
  buffer_store_dwordx4 v[112:115], v208, s[8:11], s26 offen offset:2048 sc1
  v_mov_b64 v[120:121], 0
  v_mov_b64 v[122:123], 0
  v_mov_b64 v[100:101], 0
  v_mov_b64 v[102:103], 0
  buffer_store_dwordx4 v[116:119], v208, s[8:11], s26 offen offset:3072 sc1
  s_add_u32 s26, s26, 4096
  v_mov_b64 v[124:125], 0
  v_mov_b64 v[126:127], 0
  v_mov_b64 v[112:113], 0
  v_mov_b64 v[114:115], 0
  s_mov_b32 s24, s6
  s_mov_b32 s35, 0
  s_add_u32 s22, s6, 1
  s_lshl_b32 s22, s22, 2
  s_mov_b32 s30, 1
  s_mov_b32 s61, 1
  s_lshl_b32 s33, s24, 2
  s_add_u32 s33, s33, s4
  s_mov_b32 s23, s33
  s_mov_b32 s21, s20
  s_lshr_b32 s36, s22, 1
  s_mov_b32 s57, s36
  s_mov_b32 s60, 0x10000000
  v_mov_b64 v[192:193], 0
  v_mov_b64 v[194:195], 0
  v_mov_b64 v[196:197], 0
  v_mov_b64 v[198:199], 0
  v_mov_b32 v200, 0
  v_mov_b32 v204, 0
  v_mov_b32 v201, 0
  v_mov_b32 v205, 0
  v_add_u32 v207, 0x1c000, v208
  v_mov_b64 v[116:117], 0
  v_mov_b64 v[118:119], 0
  s_waitcnt vmcnt(17) lgkmcnt(0)
  s_barrier
  s_branch L_k2_pc
L_k2_fin:
  s_waitcnt vmcnt(0) lgkmcnt(0)
  s_barrier
  s_mul_i32 s51, s5, 229376
  s_mul_i32 s52, s5, 114688
  s_cmp_eq_u32 s7, 1
  s_cbranch_scc1 L_k2_merge
  v_rcp_f32 v216, v200
  v_rcp_f32 v217, v201
  s_nop 0
  v_mul_f32 v216, v216, v213
  v_mul_f32 v217, v217, v214
  v_pk_mul_f32 v[0:1], v[0:1], v[216:217] op_sel_hi:[1,0]
  v_pk_mul_f32 v[2:3], v[2:3], v[216:217] op_sel_hi:[1,0]
  v_pk_mul_f32 v[8:9], v[8:9], v[216:217] op_sel_hi:[1,0]
  v_pk_mul_f32 v[10:11], v[10:11], v[216:217] op_sel_hi:[1,0]
  v_cvt_pk_bf16_f32 v0, v0, v1
  v_cvt_pk_bf16_f32 v1, v2, v3
  v_cvt_pk_bf16_f32 v2, v8, v9
  v_cvt_pk_bf16_f32 v3, v10, v11
  s_lshl_b32 s34, s33, 4
  s_add_u32 s34, s34, s5
  v_pk_mul_f32 v[4:5], v[4:5], v[216:217] op_sel:[0,1] op_sel_hi:[1,1]
  v_pk_mul_f32 v[6:7], v[6:7], v[216:217] op_sel:[0,1] op_sel_hi:[1,1]
  v_pk_mul_f32 v[12:13], v[12:13], v[216:217] op_sel:[0,1] op_sel_hi:[1,1]
  v_pk_mul_f32 v[14:15], v[14:15], v[216:217] op_sel:[0,1] op_sel_hi:[1,1]
  v_cvt_pk_bf16_f32 v4, v4, v5
  v_cvt_pk_bf16_f32 v5, v6, v7
  v_cvt_pk_bf16_f32 v6, v12, v13
  v_cvt_pk_bf16_f32 v7, v14, v15
  s_lshl_b32 s34, s34, 13
  s_add_u32 s34, s34, 0x3000000
  buffer_load_dwordx4 a[160:163], v208, s[8:11], s34 offen offset:0
  v_pk_mul_f32 v[16:17], v[16:17], v[216:217] op_sel_hi:[1,0]
  v_pk_mul_f32 v[18:19], v[18:19], v[216:217] op_sel_hi:[1,0]
  v_pk_mul_f32 v[24:25], v[24:25], v[216:217] op_sel_hi:[1,0]
  v_pk_mul_f32 v[26:27], v[26:27], v[216:217] op_sel_hi:[1,0]
  v_cvt_pk_bf16_f32 v16, v16, v17
  v_cvt_pk_bf16_f32 v17, v18, v19
  v_cvt_pk_bf16_f32 v18, v24, v25
  v_cvt_pk_bf16_f32 v19, v26, v27
  buffer_load_dwordx4 a[164:167], v208, s[8:11], s34 offen offset:1024
  buffer_load_dwordx4 a[168:171], v208, s[8:11], s34 offen offset:2048
  buffer_load_dwordx4 a[172:175], v208, s[8:11], s34 offen offset:3072
  v_pk_mul_f32 v[20:21], v[20:21], v[216:217] op_sel:[0,1] op_sel_hi:[1,1]
  v_pk_mul_f32 v[22:23], v[22:23], v[216:217] op_sel:[0,1] op_sel_hi:[1,1]
  v_pk_mul_f32 v[28:29], v[28:29], v[216:217] op_sel:[0,1] op_sel_hi:[1,1]
  v_pk_mul_f32 v[30:31], v[30:31], v[216:217] op_sel:[0,1] op_sel_hi:[1,1]
  v_cvt_pk_bf16_f32 v20, v20, v21
  v_cvt_pk_bf16_f32 v21, v22, v23
  v_cvt_pk_bf16_f32 v22, v28, v29
  v_cvt_pk_bf16_f32 v23, v30, v31
  s_add_u32 s34, s34, 4096
  buffer_load_dwordx4 a[176:179], v208, s[8:11], s34 offen offset:0
  buffer_load_dwordx4 a[180:183], v208, s[8:11], s34 offen offset:1024
  v_pk_mul_f32 v[32:33], v[32:33], v[216:217] op_sel_hi:[1,0]
  v_pk_mul_f32 v[34:35], v[34:35], v[216:217] op_sel_hi:[1,0]
  v_pk_mul_f32 v[40:41], v[40:41], v[216:217] op_sel_hi:[1,0]
  v_pk_mul_f32 v[42:43], v[42:43], v[216:217] op_sel_hi:[1,0]
  v_cvt_pk_bf16_f32 v32, v32, v33
  v_cvt_pk_bf16_f32 v33, v34, v35
  v_cvt_pk_bf16_f32 v34, v40, v41
  v_cvt_pk_bf16_f32 v35, v42, v43
  buffer_load_dwordx4 a[184:187], v208, s[8:11], s34 offen offset:2048
  buffer_load_dwordx4 a[188:191], v208, s[8:11], s34 offen offset:3072
  s_add_u32 s26, s51, 0
  v_pk_mul_f32 v[36:37], v[36:37], v[216:217] op_sel:[0,1] op_sel_hi:[1,1]
  v_pk_mul_f32 v[38:39], v[38:39], v[216:217] op_sel:[0,1] op_sel_hi:[1,1]
  v_pk_mul_f32 v[44:45], v[44:45], v[216:217] op_sel:[0,1] op_sel_hi:[1,1]
  v_pk_mul_f32 v[46:47], v[46:47], v[216:217] op_sel:[0,1] op_sel_hi:[1,1]
  v_cvt_pk_bf16_f32 v36, v36, v37
  v_cvt_pk_bf16_f32 v37, v38, v39
  v_cvt_pk_bf16_f32 v38, v44, v45
  v_cvt_pk_bf16_f32 v39, v46, v47
  s_add_u32 m0, s50, 0
  s_add_u32 s27, s52, 0
  buffer_load_dwordx4 v239, s[12:15], s26 offen offset:0 lds
  v_pk_mul_f32 v[48:49], v[48:49], v[216:217] op_sel_hi:[1,0]
  v_pk_mul_f32 v[50:51], v[50:51], v[216:217] op_sel_hi:[1,0]
  v_pk_mul_f32 v[56:57], v[56:57], v[216:217] op_sel_hi:[1,0]
  v_pk_mul_f32 v[58:59], v[58:59], v[216:217] op_sel_hi:[1,0]
  v_cvt_pk_bf16_f32 v48, v48, v49
  v_cvt_pk_bf16_f32 v49, v50, v51
  v_cvt_pk_bf16_f32 v50, v56, v57
  v_cvt_pk_bf16_f32 v51, v58, v59
  buffer_load_dwordx4 v240, s[12:15], s26 offen offset:1024 lds
  buffer_load_dwordx4 v241, s[12:15], s26 offen offset:2048 lds
  buffer_load_dwordx4 v242, s[12:15], s26 offen offset:3072 lds
  v_pk_mul_f32 v[52:53], v[52:53], v[216:217] op_sel:[0,1] op_sel_hi:[1,1]
  v_pk_mul_f32 v[54:55], v[54:55], v[216:217] op_sel:[0,1] op_sel_hi:[1,1]
  v_pk_mul_f32 v[60:61], v[60:61], v[216:217] op_sel:[0,1] op_sel_hi:[1,1]
  v_pk_mul_f32 v[62:63], v[62:63], v[216:217] op_sel:[0,1] op_sel_hi:[1,1]
  v_cvt_pk_bf16_f32 v52, v52, v53
  v_cvt_pk_bf16_f32 v53, v54, v55
  v_cvt_pk_bf16_f32 v54, v60, v61
  s_add_u32 m0, s50, 4096
  v_cvt_pk_bf16_f32 v55, v62, v63
  buffer_load_dwordx4 v243, s[12:15], s26 offen offset:0 lds
  buffer_load_dwordx4 v244, s[12:15], s26 offen offset:1024 lds
  v_pk_mul_f32 v[64:65], v[64:65], v[216:217] op_sel_hi:[1,0]
  v_pk_mul_f32 v[66:67], v[66:67], v[216:217] op_sel_hi:[1,0]
  v_pk_mul_f32 v[72:73], v[72:73], v[216:217] op_sel_hi:[1,0]
  v_pk_mul_f32 v[74:75], v[74:75], v[216:217] op_sel_hi:[1,0]
  v_cvt_pk_bf16_f32 v64, v64, v65
  v_cvt_pk_bf16_f32 v65, v66, v67
  v_cvt_pk_bf16_f32 v66, v72, v73
  v_cvt_pk_bf16_f32 v67, v74, v75
  buffer_load_dwordx4 v245, s[12:15], s26 offen offset:2048 lds
  buffer_load_dwordx4 v246, s[12:15], s26 offen offset:3072 lds
  s_add_u32 m0, s25, 32768
  v_pk_mul_f32 v[68:69], v[68:69], v[216:217] op_sel:[0,1] op_sel_hi:[1,1]
  v_pk_mul_f32 v[70:71], v[70:71], v[216:217] op_sel:[0,1] op_sel_hi:[1,1]
  v_pk_mul_f32 v[76:77], v[76:77], v[216:217] op_sel:[0,1] op_sel_hi:[1,1]
  v_pk_mul_f32 v[78:79], v[78:79], v[216:217] op_sel:[0,1] op_sel_hi:[1,1]
  v_cvt_pk_bf16_f32 v68, v68, v69
  v_cvt_pk_bf16_f32 v69, v70, v71
  v_cvt_pk_bf16_f32 v70, v76, v77
  v_cvt_pk_bf16_f32 v71, v78, v79
  buffer_load_dwordx4 v247, s[16:19], s27 offen offset:0 lds
  buffer_load_dwordx4 v248, s[16:19], s27 offen offset:1024 lds
  buffer_load_dwordx4 v249, s[16:19], s27 offen offset:2048 lds
  v_pk_mul_f32 v[80:81], v[80:81], v[216:217] op_sel_hi:[1,0]
  v_pk_mul_f32 v[82:83], v[82:83], v[216:217] op_sel_hi:[1,0]
  v_pk_mul_f32 v[88:89], v[88:89], v[216:217] op_sel_hi:[1,0]
  v_pk_mul_f32 v[90:91], v[90:91], v[216:217] op_sel_hi:[1,0]
  v_cvt_pk_bf16_f32 v80, v80, v81
  v_cvt_pk_bf16_f32 v81, v82, v83
  v_cvt_pk_bf16_f32 v82, v88, v89
  v_cvt_pk_bf16_f32 v83, v90, v91
  buffer_load_dwordx4 v250, s[16:19], s27 offen offset:3072 lds
  s_add_u32 s26, s51, 128
  s_add_u32 s27, s52, 128
  v_pk_mul_f32 v[84:85], v[84:85], v[216:217] op_sel:[0,1] op_sel_hi:[1,1]
  v_pk_mul_f32 v[86:87], v[86:87], v[216:217] op_sel:[0,1] op_sel_hi:[1,1]
  v_pk_mul_f32 v[92:93], v[92:93], v[216:217] op_sel:[0,1] op_sel_hi:[1,1]
  v_pk_mul_f32 v[94:95], v[94:95], v[216:217] op_sel:[0,1] op_sel_hi:[1,1]
  v_cvt_pk_bf16_f32 v84, v84, v85
  v_cvt_pk_bf16_f32 v85, v86, v87
  v_cvt_pk_bf16_f32 v86, v92, v93
  s_add_u32 m0, s50, 49152
  v_cvt_pk_bf16_f32 v87, v94, v95
  buffer_load_dwordx4 v239, s[12:15], s26 offen offset:0 lds
  buffer_load_dwordx4 v240, s[12:15], s26 offen offset:1024 lds
  v_pk_mul_f32 v[96:97], v[96:97], v[216:217] op_sel_hi:[1,0]
  v_pk_mul_f32 v[98:99], v[98:99], v[216:217] op_sel_hi:[1,0]
  v_pk_mul_f32 v[104:105], v[104:105], v[216:217] op_sel_hi:[1,0]
  v_pk_mul_f32 v[106:107], v[106:107], v[216:217] op_sel_hi:[1,0]
  v_cvt_pk_bf16_f32 v96, v96, v97
  v_cvt_pk_bf16_f32 v97, v98, v99
  v_cvt_pk_bf16_f32 v98, v104, v105
  v_cvt_pk_bf16_f32 v99, v106, v107
  buffer_load_dwordx4 v241, s[12:15], s26 offen offset:2048 lds
  buffer_load_dwordx4 v242, s[12:15], s26 offen offset:3072 lds
  s_add_u32 m0, s50, 53248
  v_pk_mul_f32 v[100:101], v[100:101], v[216:217] op_sel:[0,1] op_sel_hi:[1,1]
  v_pk_mul_f32 v[102:103], v[102:103], v[216:217] op_sel:[0,1] op_sel_hi:[1,1]
  v_pk_mul_f32 v[108:109], v[108:109], v[216:217] op_sel:[0,1] op_sel_hi:[1,1]
  v_pk_mul_f32 v[110:111], v[110:111], v[216:217] op_sel:[0,1] op_sel_hi:[1,1]
  v_cvt_pk_bf16_f32 v100, v100, v101
  v_cvt_pk_bf16_f32 v101, v102, v103
  v_cvt_pk_bf16_f32 v102, v108, v109
  v_cvt_pk_bf16_f32 v103, v110, v111
  buffer_load_dwordx4 v243, s[12:15], s26 offen offset:0 lds
  buffer_load_dwordx4 v244, s[12:15], s26 offen offset:1024 lds
  buffer_load_dwordx4 v245, s[12:15], s26 offen offset:2048 lds
  v_pk_mul_f32 v[112:113], v[112:113], v[216:217] op_sel_hi:[1,0]
  v_pk_mul_f32 v[114:115], v[114:115], v[216:217] op_sel_hi:[1,0]
  v_pk_mul_f32 v[120:121], v[120:121], v[216:217] op_sel_hi:[1,0]
  v_pk_mul_f32 v[122:123], v[122:123], v[216:217] op_sel_hi:[1,0]
  v_cvt_pk_bf16_f32 v112, v112, v113
  v_cvt_pk_bf16_f32 v113, v114, v115
  v_cvt_pk_bf16_f32 v114, v120, v121
  v_cvt_pk_bf16_f32 v115, v122, v123
  buffer_load_dwordx4 v246, s[12:15], s26 offen offset:3072 lds
  s_add_u32 m0, s25, 81920
  s_nop 0
  buffer_load_dwordx4 v247, s[16:19], s27 offen offset:0 lds
  v_pk_mul_f32 v[116:117], v[116:117], v[216:217] op_sel:[0,1] op_sel_hi:[1,1]
  v_pk_mul_f32 v[118:119], v[118:119], v[216:217] op_sel:[0,1] op_sel_hi:[1,1]
  v_pk_mul_f32 v[124:125], v[124:125], v[216:217] op_sel:[0,1] op_sel_hi:[1,1]
  v_pk_mul_f32 v[126:127], v[126:127], v[216:217] op_sel:[0,1] op_sel_hi:[1,1]
  v_cvt_pk_bf16_f32 v116, v116, v117
  v_cvt_pk_bf16_f32 v117, v118, v119
  v_cvt_pk_bf16_f32 v118, v124, v125
  v_cvt_pk_bf16_f32 v119, v126, v127
  buffer_load_dwordx4 v248, s[16:19], s27 offen offset:1024 lds
  buffer_load_dwordx4 v249, s[16:19], s27 offen offset:2048 lds
  buffer_load_dwordx4 v250, s[16:19], s27 offen offset:3072 lds
  s_branch L_k2_proj
L_k2_merge:
  v_max_f32 v220, v204, v226
  v_sub_f32 v216, v204, v220
  v_sub_f32 v218, v226, v220
  v_max_f32 v221, v205, v227
  v_sub_f32 v217, v205, v221
  v_sub_f32 v219, v227, v221
  v_exp_f32 v216, v216
  v_exp_f32 v218, v218
  v_exp_f32 v217, v217
  v_exp_f32 v219, v219
  s_nop 0
  v_mul_f32 v218, v218, v228
  v_fma_f32 v222, v216, v200, v218
  v_mul_f32 v219, v219, v229
  v_fma_f32 v223, v217, v201, v219
  v_rcp_f32 v222, v222
  v_rcp_f32 v223, v223
  s_nop 0
  v_mul_f32 v222, v222, v213
  v_mul_f32 v216, v216, v222
  v_mul_f32 v218, v218, v222
  v_mul_f32 v223, v223, v214
  v_mul_f32 v217, v217, v223
  v_mul_f32 v219, v219, v223
  v_accvgpr_read_b32 v128, a192
  v_accvgpr_read_b32 v129, a193
  v_accvgpr_read_b32 v130, a194
  v_accvgpr_read_b32 v131, a195
  v_lshlrev_b32 v136, 16, v128
  v_and_b32 v137, 0xffff0000, v128
  v_lshlrev_b32 v138, 16, v129
  v_and_b32 v139, 0xffff0000, v129
  v_lshlrev_b32 v140, 16, v130
  v_and_b32 v141, 0xffff0000, v130
  v_lshlrev_b32 v142, 16, v131
  v_and_b32 v143, 0xffff0000, v131
  v_pk_mul_f32 v[0:1], v[0:1], v[216:217] op_sel_hi:[1,0]
  v_pk_mul_f32 v[2:3], v[2:3], v[216:217] op_sel_hi:[1,0]
  v_pk_mul_f32 v[8:9], v[8:9], v[216:217] op_sel_hi:[1,0]
  v_pk_mul_f32 v[10:11], v[10:11], v[216:217] op_sel_hi:[1,0]
  v_pk_fma_f32 v[0:1], v[136:137], v[218:219], v[0:1] op_sel_hi:[1,0,1]
  v_pk_fma_f32 v[2:3], v[138:139], v[218:219], v[2:3] op_sel_hi:[1,0,1]
  v_pk_fma_f32 v[8:9], v[140:141], v[218:219], v[8:9] op_sel_hi:[1,0,1]
  v_pk_fma_f32 v[10:11], v[142:143], v[218:219], v[10:11] op_sel_hi:[1,0,1]
  v_cvt_pk_bf16_f32 v0, v0, v1
  v_cvt_pk_bf16_f32 v1, v2, v3
  v_cvt_pk_bf16_f32 v2, v8, v9
  v_cvt_pk_bf16_f32 v3, v10, v11
  s_lshl_b32 s34, s33, 4
  s_add_u32 s34, s34, s5
  v_accvgpr_read_b32 v128, a196
  v_accvgpr_read_b32 v129, a197
  v_accvgpr_read_b32 v130, a198
  v_accvgpr_read_b32 v131, a199
  v_lshlrev_b32 v136, 16, v128
  v_and_b32 v137, 0xffff0000, v128
  v_lshlrev_b32 v138, 16, v129
  v_and_b32 v139, 0xffff0000, v129
  v_lshlrev_b32 v140, 16, v130
  v_and_b32 v141, 0xffff0000, v130
  v_lshlrev_b32 v142, 16, v131
  v_and_b32 v143, 0xffff0000, v131
  v_pk_mul_f32 v[4:5], v[4:5], v[216:217] op_sel:[0,1] op_sel_hi:[1,1]
  v_pk_mul_f32 v[6:7], v[6:7], v[216:217] op_sel:[0,1] op_sel_hi:[1,1]
  v_pk_mul_f32 v[12:13], v[12:13], v[216:217] op_sel:[0,1] op_sel_hi:[1,1]
  v_pk_mul_f32 v[14:15], v[14:15], v[216:217] op_sel:[0,1] op_sel_hi:[1,1]
  v_pk_fma_f32 v[4:5], v[136:137], v[218:219], v[4:5] op_sel:[0,1,0] op_sel_hi:[1,1,1]
  v_pk_fma_f32 v[6:7], v[138:139], v[218:219], v[6:7] op_sel:[0,1,0] op_sel_hi:[1,1,1]
  v_pk_fma_f32 v[12:13], v[140:141], v[218:219], v[12:13] op_sel:[0,1,0] op_sel_hi:[1,1,1]
  v_pk_fma_f32 v[14:15], v[142:143], v[218:219], v[14:15] op_sel:[0,1,0] op_sel_hi:[1,1,1]
  v_cvt_pk_bf16_f32 v4, v4, v5
  v_cvt_pk_bf16_f32 v5, v6, v7
  v_cvt_pk_bf16_f32 v6, v12, v13
  v_cvt_pk_bf16_f32 v7, v14, v15
  s_lshl_b32 s34, s34, 13
  s_add_u32 s34, s34, 0x3000000
  buffer_load_dwordx4 a[160:163], v208, s[8:11], s34 offen offset:0
  v_accvgpr_read_b32 v128, a200
  v_accvgpr_read_b32 v129, a201
  v_accvgpr_read_b32 v130, a202
  v_accvgpr_read_b32 v131, a203
  v_lshlrev_b32 v136, 16, v128
  v_and_b32 v137, 0xffff0000, v128
  v_lshlrev_b32 v138, 16, v129
  v_and_b32 v139, 0xffff0000, v129
  v_lshlrev_b32 v140, 16, v130
  v_and_b32 v141, 0xffff0000, v130
  v_lshlrev_b32 v142, 16, v131
  v_and_b32 v143, 0xffff0000, v131
  v_pk_mul_f32 v[16:17], v[16:17], v[216:217] op_sel_hi:[1,0]
  v_pk_mul_f32 v[18:19], v[18:19], v[216:217] op_sel_hi:[1,0]
  v_pk_mul_f32 v[24:25], v[24:25], v[216:217] op_sel_hi:[1,0]
  v_pk_mul_f32 v[26:27], v[26:27], v[216:217] op_sel_hi:[1,0]
  v_pk_fma_f32 v[16:17], v[136:137], v[218:219], v[16:17] op_sel_hi:[1,0,1]
  v_pk_fma_f32 v[18:19], v[138:139], v[218:219], v[18:19] op_sel_hi:[1,0,1]
  v_pk_fma_f32 v[24:25], v[140:141], v[218:219], v[24:25] op_sel_hi:[1,0,1]
  v_pk_fma_f32 v[26:27], v[142:143], v[218:219], v[26:27] op_sel_hi:[1,0,1]
  v_cvt_pk_bf16_f32 v16, v16, v17
  v_cvt_pk_bf16_f32 v17, v18, v19
  v_cvt_pk_bf16_f32 v18, v24, v25
  v_cvt_pk_bf16_f32 v19, v26, v27
  buffer_load_dwordx4 a[164:167], v208, s[8:11], s34 offen offset:1024
  buffer_load_dwordx4 a[168:171], v208, s[8:11], s34 offen offset:2048
  buffer_load_dwordx4 a[172:175], v208, s[8:11], s34 offen offset:3072
  v_accvgpr_read_b32 v128, a204
  v_accvgpr_read_b32 v129, a205
  v_accvgpr_read_b32 v130, a206
  v_accvgpr_read_b32 v131, a207
  v_lshlrev_b32 v136, 16, v128
  v_and_b32 v137, 0xffff0000, v128
  v_lshlrev_b32 v138, 16, v129
  v_and_b32 v139, 0xffff0000, v129
  v_lshlrev_b32 v140, 16, v130
  v_and_b32 v141, 0xffff0000, v130
  v_lshlrev_b32 v142, 16, v131
  v_and_b32 v143, 0xffff0000, v131
  v_pk_mul_f32 v[20:21], v[20:21], v[216:217] op_sel:[0,1] op_sel_hi:[1,1]
  v_pk_mul_f32 v[22:23], v[22:23], v[216:217] op_sel:[0,1] op_sel_hi:[1,1]
  v_pk_mul_f32 v[28:29], v[28:29], v[216:217] op_sel:[0,1] op_sel_hi:[1,1]
  v_pk_mul_f32 v[30:31], v[30:31], v[216:217] op_sel:[0,1] op_sel_hi:[1,1]
  v_pk_fma_f32 v[20:21], v[136:137], v[218:219], v[20:21] op_sel:[0,1,0] op_sel_hi:[1,1,1]
  v_pk_fma_f32 v[22:23], v[138:139], v[218:219], v[22:23] op_sel:[0,1,0] op_sel_hi:[1,1,1]
  v_pk_fma_f32 v[28:29], v[140:141], v[218:219], v[28:29] op_sel:[0,1,0] op_sel_hi:[1,1,1]
  v_pk_fma_f32 v[30:31], v[142:143], v[218:219], v[30:31] op_sel:[0,1,0] op_sel_hi:[1,1,1]
  v_cvt_pk_bf16_f32 v20, v20, v21
  v_cvt_pk_bf16_f32 v21, v22, v23
  v_cvt_pk_bf16_f32 v22, v28, v29
  v_cvt_pk_bf16_f32 v23, v30, v31
  s_add_u32 s34, s34, 4096
  buffer_load_dwordx4 a[176:179], v208, s[8:11], s34 offen offset:0
  buffer_load_dwordx4 a[180:183], v208, s[8:11], s34 offen offset:1024
  v_accvgpr_read_b32 v128, a208
  v_accvgpr_read_b32 v129, a209
  v_accvgpr_read_b32 v130, a210
  v_accvgpr_read_b32 v131, a211
  v_lshlrev_b32 v136, 16, v128
  v_and_b32 v137, 0xffff0000, v128
  v_lshlrev_b32 v138, 16, v129
  v_and_b32 v139, 0xffff0000, v129
  v_lshlrev_b32 v140, 16, v130
  v_and_b32 v141, 0xffff0000, v130
  v_lshlrev_b32 v142, 16, v131
  v_and_b32 v143, 0xffff0000, v131
  v_pk_mul_f32 v[32:33], v[32:33], v[216:217] op_sel_hi:[1,0]
  v_pk_mul_f32 v[34:35], v[34:35], v[216:217] op_sel_hi:[1,0]
  v_pk_mul_f32 v[40:41], v[40:41], v[216:217] op_sel_hi:[1,0]
  v_pk_mul_f32 v[42:43], v[42:43], v[216:217] op_sel_hi:[1,0]
  v_pk_fma_f32 v[32:33], v[136:137], v[218:219], v[32:33] op_sel_hi:[1,0,1]
  v_pk_fma_f32 v[34:35], v[138:139], v[218:219], v[34:35] op_sel_hi:[1,0,1]
  v_pk_fma_f32 v[40:41], v[140:141], v[218:219], v[40:41] op_sel_hi:[1,0,1]
  v_pk_fma_f32 v[42:43], v[142:143], v[218:219], v[42:43] op_sel_hi:[1,0,1]
  v_cvt_pk_bf16_f32 v32, v32, v33
  v_cvt_pk_bf16_f32 v33, v34, v35
  v_cvt_pk_bf16_f32 v34, v40, v41
  v_cvt_pk_bf16_f32 v35, v42, v43
  buffer_load_dwordx4 a[184:187], v208, s[8:11], s34 offen offset:2048
  buffer_load_dwordx4 a[188:191], v208, s[8:11], s34 offen offset:3072
  s_add_u32 s26, s51, 0
  v_accvgpr_read_b32 v128, a212
  v_accvgpr_read_b32 v129, a213
  v_accvgpr_read_b32 v130, a214
  v_accvgpr_read_b32 v131, a215
  v_lshlrev_b32 v136, 16, v128
  v_and_b32 v137, 0xffff0000, v128
  v_lshlrev_b32 v138, 16, v129
  v_and_b32 v139, 0xffff0000, v129
  v_lshlrev_b32 v140, 16, v130
  v_and_b32 v141, 0xffff0000, v130
  v_lshlrev_b32 v142, 16, v131
  v_and_b32 v143, 0xffff0000, v131
  v_pk_mul_f32 v[36:37], v[36:37], v[216:217] op_sel:[0,1] op_sel_hi:[1,1]
  v_pk_mul_f32 v[38:39], v[38:39], v[216:217] op_sel:[0,1] op_sel_hi:[1,1]
  v_pk_mul_f32 v[44:45], v[44:45], v[216:217] op_sel:[0,1] op_sel_hi:[1,1]
  v_pk_mul_f32 v[46:47], v[46:47], v[216:217] op_sel:[0,1] op_sel_hi:[1,1]
  v_pk_fma_f32 v[36:37], v[136:137], v[218:219], v[36:37] op_sel:[0,1,0] op_sel_hi:[1,1,1]
  v_pk_fma_f32 v[38:39], v[138:139], v[218:219], v[38:39] op_sel:[0,1,0] op_sel_hi:[1,1,1]
  v_pk_fma_f32 v[44:45], v[140:141], v[218:219], v[44:45] op_sel:[0,1,0] op_sel_hi:[1,1,1]
  v_pk_fma_f32 v[46:47], v[142:143], v[218:219], v[46:47] op_sel:[0,1,0] op_sel_hi:[1,1,1]
  v_cvt_pk_bf16_f32 v36, v36, v37
  v_cvt_pk_bf16_f32 v37, v38, v39
  v_cvt_pk_bf16_f32 v38, v44, v45
  v_cvt_pk_bf16_f32 v39, v46, v47
  s_add_u32 m0, s50, 0
  s_add_u32 s27, s52, 0
  buffer_load_dwordx4 v239, s[12:15], s26 offen offset:0 lds
  v_accvgpr_read_b32 v128, a216
  v_accvgpr_read_b32 v129, a217
  v_accvgpr_read_b32 v130, a218
  v_accvgpr_read_b32 v131, a219
  v_lshlrev_b32 v136, 16, v128
  v_and_b32 v137, 0xffff0000, v128
  v_lshlrev_b32 v138, 16, v129
  v_and_b32 v139, 0xffff0000, v129
  v_lshlrev_b32 v140, 16, v130
  v_and_b32 v141, 0xffff0000, v130
  v_lshlrev_b32 v142, 16, v131
  v_and_b32 v143, 0xffff0000, v131
  v_pk_mul_f32 v[48:49], v[48:49], v[216:217] op_sel_hi:[1,0]
  v_pk_mul_f32 v[50:51], v[50:51], v[216:217] op_sel_hi:[1,0]
  v_pk_mul_f32 v[56:57], v[56:57], v[216:217] op_sel_hi:[1,0]
  v_pk_mul_f32 v[58:59], v[58:59], v[216:217] op_sel_hi:[1,0]
  v_pk_fma_f32 v[48:49], v[136:137], v[218:219], v[48:49] op_sel_hi:[1,0,1]
  v_pk_fma_f32 v[50:51], v[138:139], v[218:219], v[50:51] op_sel_hi:[1,0,1]
  v_pk_fma_f32 v[56:57], v[140:141], v[218:219], v[56:57] op_sel_hi:[1,0,1]
  v_pk_fma_f32 v[58:59], v[142:143], v[218:219], v[58:59] op_sel_hi:[1,0,1]
  v_cvt_pk_bf16_f32 v48, v48, v49
  v_cvt_pk_bf16_f32 v49, v50, v51
  v_cvt_pk_bf16_f32 v50, v56, v57
  v_cvt_pk_bf16_f32 v51, v58, v59
  buffer_load_dwordx4 v240, s[12:15], s26 offen offset:1024 lds
  buffer_load_dwordx4 v241, s[12:15], s26 offen offset:2048 lds
  buffer_load_dwordx4 v242, s[12:15], s26 offen offset:3072 lds
  v_accvgpr_read_b32 v128, a220
  v_accvgpr_read_b32 v129, a221
  v_accvgpr_read_b32 v130, a222
  v_accvgpr_read_b32 v131, a223
  v_lshlrev_b32 v136, 16, v128
  v_and_b32 v137, 0xffff0000, v128
  v_lshlrev_b32 v138, 16, v129
  v_and_b32 v139, 0xffff0000, v129
  v_lshlrev_b32 v140, 16, v130
  v_and_b32 v141, 0xffff0000, v130
  v_lshlrev_b32 v142, 16, v131
  v_and_b32 v143, 0xffff0000, v131
  v_pk_mul_f32 v[52:53], v[52:53], v[216:217] op_sel:[0,1] op_sel_hi:[1,1]
  v_pk_mul_f32 v[54:55], v[54:55], v[216:217] op_sel:[0,1] op_sel_hi:[1,1]
  v_pk_mul_f32 v[60:61], v[60:61], v[216:217] op_sel:[0,1] op_sel_hi:[1,1]
  v_pk_mul_f32 v[62:63], v[62:63], v[216:217] op_sel:[0,1] op_sel_hi:[1,1]
  v_pk_fma_f32 v[52:53], v[136:137], v[218:219], v[52:53] op_sel:[0,1,0] op_sel_hi:[1,1,1]
  v_pk_fma_f32 v[54:55], v[138:139], v[218:219], v[54:55] op_sel:[0,1,0] op_sel_hi:[1,1,1]
  v_pk_fma_f32 v[60:61], v[140:141], v[218:219], v[60:61] op_sel:[0,1,0] op_sel_hi:[1,1,1]
  v_pk_fma_f32 v[62:63], v[142:143], v[218:219], v[62:63] op_sel:[0,1,0] op_sel_hi:[1,1,1]
  v_cvt_pk_bf16_f32 v52, v52, v53
  v_cvt_pk_bf16_f32 v53, v54, v55
  v_cvt_pk_bf16_f32 v54, v60, v61
  s_add_u32 m0, s50, 4096
  v_cvt_pk_bf16_f32 v55, v62, v63
  buffer_load_dwordx4 v243, s[12:15], s26 offen offset:0 lds
  buffer_load_dwordx4 v244, s[12:15], s26 offen offset:1024 lds
  v_accvgpr_read_b32 v128, a224
  v_accvgpr_read_b32 v129, a225
  v_accvgpr_read_b32 v130, a226
  v_accvgpr_read_b32 v131, a227
  v_lshlrev_b32 v136, 16, v128
  v_and_b32 v137, 0xffff0000, v128
  v_lshlrev_b32 v138, 16, v129
  v_and_b32 v139, 0xffff0000, v129
  v_lshlrev_b32 v140, 16, v130
  v_and_b32 v141, 0xffff0000, v130
  v_lshlrev_b32 v142, 16, v131
  v_and_b32 v143, 0xffff0000, v131
  v_pk_mul_f32 v[64:65], v[64:65], v[216:217] op_sel_hi:[1,0]
  v_pk_mul_f32 v[66:67], v[66:67], v[216:217] op_sel_hi:[1,0]
  v_pk_mul_f32 v[72:73], v[72:73], v[216:217] op_sel_hi:[1,0]
  v_pk_mul_f32 v[74:75], v[74:75], v[216:217] op_sel_hi:[1,0]
  v_pk_fma_f32 v[64:65], v[136:137], v[218:219], v[64:65] op_sel_hi:[1,0,1]
  v_pk_fma_f32 v[66:67], v[138:139], v[218:219], v[66:67] op_sel_hi:[1,0,1]
  v_pk_fma_f32 v[72:73], v[140:141], v[218:219], v[72:73] op_sel_hi:[1,0,1]
  v_pk_fma_f32 v[74:75], v[142:143], v[218:219], v[74:75] op_sel_hi:[1,0,1]
  v_cvt_pk_bf16_f32 v64, v64, v65
  v_cvt_pk_bf16_f32 v65, v66, v67
  v_cvt_pk_bf16_f32 v66, v72, v73
  v_cvt_pk_bf16_f32 v67, v74, v75
  buffer_load_dwordx4 v245, s[12:15], s26 offen offset:2048 lds
  buffer_load_dwordx4 v246, s[12:15], s26 offen offset:3072 lds
  s_add_u32 m0, s25, 32768
  v_accvgpr_read_b32 v128, a228
  v_accvgpr_read_b32 v129, a229
  v_accvgpr_read_b32 v130, a230
  v_accvgpr_read_b32 v131, a231
  v_lshlrev_b32 v136, 16, v128
  v_and_b32 v137, 0xffff0000, v128
  v_lshlrev_b32 v138, 16, v129
  v_and_b32 v139, 0xffff0000, v129
  v_lshlrev_b32 v140, 16, v130
  v_and_b32 v141, 0xffff0000, v130
  v_lshlrev_b32 v142, 16, v131
  v_and_b32 v143, 0xffff0000, v131
  v_pk_mul_f32 v[68:69], v[68:69], v[216:217] op_sel:[0,1] op_sel_hi:[1,1]
  v_pk_mul_f32 v[70:71], v[70:71], v[216:217] op_sel:[0,1] op_sel_hi:[1,1]
  v_pk_mul_f32 v[76:77], v[76:77], v[216:217] op_sel:[0,1] op_sel_hi:[1,1]
  v_pk_mul_f32 v[78:79], v[78:79], v[216:217] op_sel:[0,1] op_sel_hi:[1,1]
  v_pk_fma_f32 v[68:69], v[136:137], v[218:219], v[68:69] op_sel:[0,1,0] op_sel_hi:[1,1,1]
  v_pk_fma_f32 v[70:71], v[138:139], v[218:219], v[70:71] op_sel:[0,1,0] op_sel_hi:[1,1,1]
  v_pk_fma_f32 v[76:77], v[140:141], v[218:219], v[76:77] op_sel:[0,1,0] op_sel_hi:[1,1,1]
  v_pk_fma_f32 v[78:79], v[142:143], v[218:219], v[78:79] op_sel:[0,1,0] op_sel_hi:[1,1,1]
  v_cvt_pk_bf16_f32 v68, v68, v69
  v_cvt_pk_bf16_f32 v69, v70, v71
  v_cvt_pk_bf16_f32 v70, v76, v77
  v_cvt_pk_bf16_f32 v71, v78, v79
  buffer_load_dwordx4 v247, s[16:19], s27 offen offset:0 lds
  buffer_load_dwordx4 v248, s[16:19], s27 offen offset:1024 lds
  buffer_load_dwordx4 v249, s[16:19], s27 offen offset:2048 lds
  v_accvgpr_read_b32 v128, a232
  v_accvgpr_read_b32 v129, a233
  v_accvgpr_read_b32 v130, a234
  v_accvgpr_read_b32 v131, a235
  v_lshlrev_b32 v136, 16, v128
  v_and_b32 v137, 0xffff0000, v128
  v_lshlrev_b32 v138, 16, v129
  v_and_b32 v139, 0xffff0000, v129
  v_lshlrev_b32 v140, 16, v130
  v_and_b32 v141, 0xffff0000, v130
  v_lshlrev_b32 v142, 16, v131
  v_and_b32 v143, 0xffff0000, v131
  v_pk_mul_f32 v[80:81], v[80:81], v[216:217] op_sel_hi:[1,0]
  v_pk_mul_f32 v[82:83], v[82:83], v[216:217] op_sel_hi:[1,0]
  v_pk_mul_f32 v[88:89], v[88:89], v[216:217] op_sel_hi:[1,0]
  v_pk_mul_f32 v[90:91], v[90:91], v[216:217] op_sel_hi:[1,0]
  v_pk_fma_f32 v[80:81], v[136:137], v[218:219], v[80:81] op_sel_hi:[1,0,1]
  v_pk_fma_f32 v[82:83], v[138:139], v[218:219], v[82:83] op_sel_hi:[1,0,1]
  v_pk_fma_f32 v[88:89], v[140:141], v[218:219], v[88:89] op_sel_hi:[1,0,1]
  v_pk_fma_f32 v[90:91], v[142:143], v[218:219], v[90:91] op_sel_hi:[1,0,1]
  v_cvt_pk_bf16_f32 v80, v80, v81
  v_cvt_pk_bf16_f32 v81, v82, v83
  v_cvt_pk_bf16_f32 v82, v88, v89
  v_cvt_pk_bf16_f32 v83, v90, v91
  buffer_load_dwordx4 v250, s[16:19], s27 offen offset:3072 lds
  s_add_u32 s26, s51, 128
  s_add_u32 s27, s52, 128
  v_accvgpr_read_b32 v128, a236
  v_accvgpr_read_b32 v129, a237
  v_accvgpr_read_b32 v130, a238
  v_accvgpr_read_b32 v131, a239
  v_lshlrev_b32 v136, 16, v128
  v_and_b32 v137, 0xffff0000, v128
  v_lshlrev_b32 v138, 16, v129
  v_and_b32 v139, 0xffff0000, v129
  v_lshlrev_b32 v140, 16, v130
  v_and_b32 v141, 0xffff0000, v130
  v_lshlrev_b32 v142, 16, v131
  v_and_b32 v143, 0xffff0000, v131
  v_pk_mul_f32 v[84:85], v[84:85], v[216:217] op_sel:[0,1] op_sel_hi:[1,1]
  v_pk_mul_f32 v[86:87], v[86:87], v[216:217] op_sel:[0,1] op_sel_hi:[1,1]
  v_pk_mul_f32 v[92:93], v[92:93], v[216:217] op_sel:[0,1] op_sel_hi:[1,1]
  v_pk_mul_f32 v[94:95], v[94:95], v[216:217] op_sel:[0,1] op_sel_hi:[1,1]
  v_pk_fma_f32 v[84:85], v[136:137], v[218:219], v[84:85] op_sel:[0,1,0] op_sel_hi:[1,1,1]
  v_pk_fma_f32 v[86:87], v[138:139], v[218:219], v[86:87] op_sel:[0,1,0] op_sel_hi:[1,1,1]
  v_pk_fma_f32 v[92:93], v[140:141], v[218:219], v[92:93] op_sel:[0,1,0] op_sel_hi:[1,1,1]
  v_pk_fma_f32 v[94:95], v[142:143], v[218:219], v[94:95] op_sel:[0,1,0] op_sel_hi:[1,1,1]
  v_cvt_pk_bf16_f32 v84, v84, v85
  v_cvt_pk_bf16_f32 v85, v86, v87
  v_cvt_pk_bf16_f32 v86, v92, v93
  s_add_u32 m0, s50, 49152
  v_cvt_pk_bf16_f32 v87, v94, v95
  buffer_load_dwordx4 v239, s[12:15], s26 offen offset:0 lds
  buffer_load_dwordx4 v240, s[12:15], s26 offen offset:1024 lds
  v_accvgpr_read_b32 v128, a240
  v_accvgpr_read_b32 v129, a241
  v_accvgpr_read_b32 v130, a242
  v_accvgpr_read_b32 v131, a243
  v_lshlrev_b32 v136, 16, v128
  v_and_b32 v137, 0xffff0000, v128
  v_lshlrev_b32 v138, 16, v129
  v_and_b32 v139, 0xffff0000, v129
  v_lshlrev_b32 v140, 16, v130
  v_and_b32 v141, 0xffff0000, v130
  v_lshlrev_b32 v142, 16, v131
  v_and_b32 v143, 0xffff0000, v131
  v_pk_mul_f32 v[96:97], v[96:97], v[216:217] op_sel_hi:[1,0]
  v_pk_mul_f32 v[98:99], v[98:99], v[216:217] op_sel_hi:[1,0]
  v_pk_mul_f32 v[104:105], v[104:105], v[216:217] op_sel_hi:[1,0]
  v_pk_mul_f32 v[106:107], v[106:107], v[216:217] op_sel_hi:[1,0]
  v_pk_fma_f32 v[96:97], v[136:137], v[218:219], v[96:97] op_sel_hi:[1,0,1]
  v_pk_fma_f32 v[98:99], v[138:139], v[218:219], v[98:99] op_sel_hi:[1,0,1]
  v_pk_fma_f32 v[104:105], v[140:141], v[218:219], v[104:105] op_sel_hi:[1,0,1]
  v_pk_fma_f32 v[106:107], v[142:143], v[218:219], v[106:107] op_sel_hi:[1,0,1]
  v_cvt_pk_bf16_f32 v96, v96, v97
  v_cvt_pk_bf16_f32 v97, v98, v99
  v_cvt_pk_bf16_f32 v98, v104, v105
  v_cvt_pk_bf16_f32 v99, v106, v107
  buffer_load_dwordx4 v241, s[12:15], s26 offen offset:2048 lds
  buffer_load_dwordx4 v242, s[12:15], s26 offen offset:3072 lds
  s_add_u32 m0, s50, 53248
  v_accvgpr_read_b32 v128, a244
  v_accvgpr_read_b32 v129, a245
  v_accvgpr_read_b32 v130, a246
  v_accvgpr_read_b32 v131, a247
  v_lshlrev_b32 v136, 16, v128
  v_and_b32 v137, 0xffff0000, v128
  v_lshlrev_b32 v138, 16, v129
  v_and_b32 v139, 0xffff0000, v129
  v_lshlrev_b32 v140, 16, v130
  v_and_b32 v141, 0xffff0000, v130
  v_lshlrev_b32 v142, 16, v131
  v_and_b32 v143, 0xffff0000, v131
  v_pk_mul_f32 v[100:101], v[100:101], v[216:217] op_sel:[0,1] op_sel_hi:[1,1]
  v_pk_mul_f32 v[102:103], v[102:103], v[216:217] op_sel:[0,1] op_sel_hi:[1,1]
  v_pk_mul_f32 v[108:109], v[108:109], v[216:217] op_sel:[0,1] op_sel_hi:[1,1]
  v_pk_mul_f32 v[110:111], v[110:111], v[216:217] op_sel:[0,1] op_sel_hi:[1,1]
  v_pk_fma_f32 v[100:101], v[136:137], v[218:219], v[100:101] op_sel:[0,1,0] op_sel_hi:[1,1,1]
  v_pk_fma_f32 v[102:103], v[138:139], v[218:219], v[102:103] op_sel:[0,1,0] op_sel_hi:[1,1,1]
  v_pk_fma_f32 v[108:109], v[140:141], v[218:219], v[108:109] op_sel:[0,1,0] op_sel_hi:[1,1,1]
  v_pk_fma_f32 v[110:111], v[142:143], v[218:219], v[110:111] op_sel:[0,1,0] op_sel_hi:[1,1,1]
  v_cvt_pk_bf16_f32 v100, v100, v101
  v_cvt_pk_bf16_f32 v101, v102, v103
  v_cvt_pk_bf16_f32 v102, v108, v109
  v_cvt_pk_bf16_f32 v103, v110, v111
  buffer_load_dwordx4 v243, s[12:15], s26 offen offset:0 lds
  buffer_load_dwordx4 v244, s[12:15], s26 offen offset:1024 lds
  buffer_load_dwordx4 v245, s[12:15], s26 offen offset:2048 lds
  v_accvgpr_read_b32 v128, a248
  v_accvgpr_read_b32 v129, a249
  v_accvgpr_read_b32 v130, a250
  v_accvgpr_read_b32 v131, a251
  v_lshlrev_b32 v136, 16, v128
  v_and_b32 v137, 0xffff0000, v128
  v_lshlrev_b32 v138, 16, v129
  v_and_b32 v139, 0xffff0000, v129
  v_lshlrev_b32 v140, 16, v130
  v_and_b32 v141, 0xffff0000, v130
  v_lshlrev_b32 v142, 16, v131
  v_and_b32 v143, 0xffff0000, v131
  v_pk_mul_f32 v[112:113], v[112:113], v[216:217] op_sel_hi:[1,0]
  v_pk_mul_f32 v[114:115], v[114:115], v[216:217] op_sel_hi:[1,0]
  v_pk_mul_f32 v[120:121], v[120:121], v[216:217] op_sel_hi:[1,0]
  v_pk_mul_f32 v[122:123], v[122:123], v[216:217] op_sel_hi:[1,0]
  v_pk_fma_f32 v[112:113], v[136:137], v[218:219], v[112:113] op_sel_hi:[1,0,1]
  v_pk_fma_f32 v[114:115], v[138:139], v[218:219], v[114:115] op_sel_hi:[1,0,1]
  v_pk_fma_f32 v[120:121], v[140:141], v[218:219], v[120:121] op_sel_hi:[1,0,1]
  v_pk_fma_f32 v[122:123], v[142:143], v[218:219], v[122:123] op_sel_hi:[1,0,1]
  v_cvt_pk_bf16_f32 v112, v112, v113
  v_cvt_pk_bf16_f32 v113, v114, v115
  v_cvt_pk_bf16_f32 v114, v120, v121
  v_cvt_pk_bf16_f32 v115, v122, v123
  buffer_load_dwordx4 v246, s[12:15], s26 offen offset:3072 lds
  s_add_u32 m0, s25, 81920
  s_nop 0
  buffer_load_dwordx4 v247, s[16:19], s27 offen offset:0 lds
  v_accvgpr_read_b32 v128, a252
  v_accvgpr_read_b32 v129, a253
  v_accvgpr_read_b32 v130, a254
  v_accvgpr_read_b32 v131, a255
  v_lshlrev_b32 v136, 16, v128
  v_and_b32 v137, 0xffff0000, v128
  v_lshlrev_b32 v138, 16, v129
  v_and_b32 v139, 0xffff0000, v129
  v_lshlrev_b32 v140, 16, v130
  v_and_b32 v141, 0xffff0000, v130
  v_lshlrev_b32 v142, 16, v131
  v_and_b32 v143, 0xffff0000, v131
  v_pk_mul_f32 v[116:117], v[116:117], v[216:217] op_sel:[0,1] op_sel_hi:[1,1]
  v_pk_mul_f32 v[118:119], v[118:119], v[216:217] op_sel:[0,1] op_sel_hi:[1,1]
  v_pk_mul_f32 v[124:125], v[124:125], v[216:217] op_sel:[0,1] op_sel_hi:[1,1]
  v_pk_mul_f32 v[126:127], v[126:127], v[216:217] op_sel:[0,1] op_sel_hi:[1,1]
  v_pk_fma_f32 v[116:117], v[136:137], v[218:219], v[116:117] op_sel:[0,1,0] op_sel_hi:[1,1,1]
  v_pk_fma_f32 v[118:119], v[138:139], v[218:219], v[118:119] op_sel:[0,1,0] op_sel_hi:[1,1,1]
  v_pk_fma_f32 v[124:125], v[140:141], v[218:219], v[124:125] op_sel:[0,1,0] op_sel_hi:[1,1,1]
  v_pk_fma_f32 v[126:127], v[142:143], v[218:219], v[126:127] op_sel:[0,1,0] op_sel_hi:[1,1,1]
  v_cvt_pk_bf16_f32 v116, v116, v117
  v_cvt_pk_bf16_f32 v117, v118, v119
  v_cvt_pk_bf16_f32 v118, v124, v125
  v_cvt_pk_bf16_f32 v119, v126, v127
  buffer_load_dwordx4 v248, s[16:19], s27 offen offset:1024 lds
  buffer_load_dwordx4 v249, s[16:19], s27 offen offset:2048 lds
  buffer_load_dwordx4 v250, s[16:19], s27 offen offset:3072 lds
L_k2_proj:
  s_mul_i32 s53, s33, 458752
  s_lshl_b32 s26, s5, 10
  s_add_u32 s53, s53, s26
  s_add_u32 s53, s53, 0x3800000
  v_add_u32 v8, 98304, v231
  v_add_u32 v9, 98304, v232
  v_add_u32 v10, 98304, v233
  v_add_u32 v11, 98304, v234
  s_waitcnt vmcnt(12)
  s_barrier
  ds_read_b64_tr_b16 a[192:193], v231 offset:0
  ds_read_b64_tr_b16 a[194:195], v231 offset:2048
  ds_read_b64_tr_b16 a[196:197], v231 offset:4096
  ds_read_b64_tr_b16 a[198:199], v231 offset:6144
  ds_read_b64_tr_b16 a[200:201], v232 offset:0
  ds_read_b64_tr_b16 a[202:203], v232 offset:2048
  ds_read_b64_tr_b16 a[204:205], v232 offset:4096
  ds_read_b64_tr_b16 a[206:207], v232 offset:6144
  ds_read_b64_tr_b16 a[208:209], v233 offset:0
  ds_read_b64_tr_b16 a[210:211], v233 offset:2048
  ds_read_b64_tr_b16 a[212:213], v233 offset:4096
  ds_read_b64_tr_b16 a[214:215], v233 offset:6144
  s_waitcnt lgkmcnt(8)
  v_mfma_f32_16x16x32_bf16 v[128:131], a[192:195], v[0:3], 0
  s_add_u32 s26, s51, 256
  ds_read_b64_tr_b16 a[216:217], v234 offset:0
  v_mfma_f32_16x16x32_bf16 v[128:131], a[196:199], v[16:19], v[128:131]
  ds_read_b64_tr_b16 a[218:219], v234 offset:2048
  v_mfma_f32_16x16x32_bf16 v[132:135], a[192:195], v[4:7], 0
  ds_read_b64_tr_b16 a[220:221], v234 offset:4096
  v_mfma_f32_16x16x32_bf16 v[132:135], a[196:199], v[20:23], v[132:135]
  s_waitcnt lgkmcnt(7)
  ds_read_b64_tr_b16 a[222:223], v234 offset:6144
  v_mfma_f32_16x16x32_bf16 v[136:139], a[200:203], v[0:3], 0
  s_add_u32 s27, s52, 256
  ds_read_b64_tr_b16 a[192:193], v231 offset:8192
  v_mfma_f32_16x16x32_bf16 v[136:139], a[204:207], v[16:19], v[136:139]
  ds_read_b64_tr_b16 a[194:195], v231 offset:10240
  v_mfma_f32_16x16x32_bf16 v[140:143], a[200:203], v[4:7], 0
  s_add_u32 m0, s50, 98304
  ds_read_b64_tr_b16 a[196:197], v231 offset:12288
  v_mfma_f32_16x16x32_bf16 v[140:143], a[204:207], v[20:23], v[140:143]
  s_waitcnt lgkmcnt(3)
  ds_read_b64_tr_b16 a[198:199], v231 offset:14336
  v_mfma_f32_16x16x32_bf16 v[144:147], a[208:211], v[0:3], 0
  ds_read_b64_tr_b16 a[200:201], v232 offset:8192
  v_mfma_f32_16x16x32_bf16 v[144:147], a[212:215], v[16:19], v[144:147]
  ds_read_b64_tr_b16 a[202:203], v232 offset:10240
  v_mfma_f32_16x16x32_bf16 v[148:151], a[208:211], v[4:7], 0
  ds_read_b64_tr_b16 a[204:205], v232 offset:12288
  buffer_load_dwordx4 v239, s[12:15], s26 offen offset:0 lds
  v_mfma_f32_16x16x32_bf16 v[148:151], a[212:215], v[20:23], v[148:151]
  ds_read_b64_tr_b16 a[206:207], v232 offset:14336
  v_mfma_f32_16x16x32_bf16 v[152:155], a[216:219], v[0:3], 0
  ds_read_b64_tr_b16 a[208:209], v233 offset:8192
  v_mfma_f32_16x16x32_bf16 v[152:155], a[220:223], v[16:19], v[152:155]
  ds_read_b64_tr_b16 a[210:211], v233 offset:10240
  buffer_load_dwordx4 v240, s[12:15], s26 offen offset:1024 lds
  v_mfma_f32_16x16x32_bf16 v[156:159], a[216:219], v[4:7], 0
  ds_read_b64_tr_b16 a[212:213], v233 offset:12288
  v_mfma_f32_16x16x32_bf16 v[156:159], a[220:223], v[20:23], v[156:159]
  s_waitcnt lgkmcnt(3)
  ds_read_b64_tr_b16 a[214:215], v233 offset:14336
  v_mfma_f32_16x16x32_bf16 v[128:131], a[192:195], v[32:35], v[128:131]
  ds_read_b64_tr_b16 a[216:217], v234 offset:8192
  v_mfma_f32_16x16x32_bf16 v[128:131], a[196:199], v[48:51], v[128:131]
  ds_read_b64_tr_b16 a[218:219], v234 offset:10240
  buffer_load_dwordx4 v241, s[12:15], s26 offen offset:2048 lds
  v_mfma_f32_16x16x32_bf16 v[132:135], a[192:195], v[36:39], v[132:135]
  ds_read_b64_tr_b16 a[220:221], v234 offset:12288
  v_mfma_f32_16x16x32_bf16 v[132:135], a[196:199], v[52:55], v[132:135]
  ds_read_b64_tr_b16 a[222:223], v234 offset:14336
  v_mfma_f32_16x16x32_bf16 v[136:139], a[200:203], v[32:35], v[136:139]
  ds_read_b64_tr_b16 a[192:193], v231 offset:16384
  buffer_load_dwordx4 v242, s[12:15], s26 offen offset:3072 lds
  v_mfma_f32_16x16x32_bf16 v[136:139], a[204:207], v[48:51], v[136:139]
  ds_read_b64_tr_b16 a[194:195], v231 offset:18432
  v_mfma_f32_16x16x32_bf16 v[140:143], a[200:203], v[36:39], v[140:143]
  ds_read_b64_tr_b16 a[196:197], v231 offset:20480
  v_mfma_f32_16x16x32_bf16 v[140:143], a[204:207], v[52:55], v[140:143]
  s_waitcnt lgkmcnt(3)
  ds_read_b64_tr_b16 a[198:199], v231 offset:22528
  v_mfma_f32_16x16x32_bf16 v[144:147], a[208:211], v[32:35], v[144:147]
  s_add_u32 m0, s50, 102400
  ds_read_b64_tr_b16 a[200:201], v232 offset:16384
  v_mfma_f32_16x16x32_bf16 v[144:147], a[212:215], v[48:51], v[144:147]
  ds_read_b64_tr_b16 a[202:203], v232 offset:18432
  v_mfma_f32_16x16x32_bf16 v[148:151], a[208:211], v[36:39], v[148:151]
  ds_read_b64_tr_b16 a[204:205], v232 offset:20480
  v_mfma_f32_16x16x32_bf16 v[148:151], a[212:215], v[52:55], v[148:151]
  ds_read_b64_tr_b16 a[206:207], v232 offset:22528
  buffer_load_dwordx4 v243, s[12:15], s26 offen offset:0 lds
  v_mfma_f32_16x16x32_bf16 v[152:155], a[216:219], v[32:35], v[152:155]
  ds_read_b64_tr_b16 a[208:209], v233 offset:16384
  v_mfma_f32_16x16x32_bf16 v[152:155], a[220:223], v[48:51], v[152:155]
  ds_read_b64_tr_b16 a[210:211], v233 offset:18432
  v_mfma_f32_16x16x32_bf16 v[156:159], a[216:219], v[36:39], v[156:159]
  ds_read_b64_tr_b16 a[212:213], v233 offset:20480
  buffer_load_dwordx4 v244, s[12:15], s26 offen offset:1024 lds
  v_mfma_f32_16x16x32_bf16 v[156:159], a[220:223], v[52:55], v[156:159]
  s_waitcnt lgkmcnt(3)
  ds_read_b64_tr_b16 a[214:215], v233 offset:22528
  v_mfma_f32_16x16x32_bf16 v[128:131], a[192:195], v[64:67], v[128:131]
  ds_read_b64_tr_b16 a[216:217], v234 offset:16384
  v_mfma_f32_16x16x32_bf16 v[128:131], a[196:199], v[80:83], v[128:131]
  ds_read_b64_tr_b16 a[218:219], v234 offset:18432
  v_mfma_f32_16x16x32_bf16 v[132:135], a[192:195], v[68:71], v[132:135]
  ds_read_b64_tr_b16 a[220:221], v234 offset:20480
  buffer_load_dwordx4 v245, s[12:15], s26 offen offset:2048 lds
  v_mfma_f32_16x16x32_bf16 v[132:135], a[196:199], v[84:87], v[132:135]
  ds_read_b64_tr_b16 a[222:223], v234 offset:22528
  v_mfma_f32_16x16x32_bf16 v[136:139], a[200:203], v[64:67], v[136:139]
  ds_read_b64_tr_b16 a[192:193], v231 offset:24576
  v_mfma_f32_16x16x32_bf16 v[136:139], a[204:207], v[80:83], v[136:139]
  ds_read_b64_tr_b16 a[194:195], v231 offset:26624
  buffer_load_dwordx4 v246, s[12:15], s26 offen offset:3072 lds
  v_mfma_f32_16x16x32_bf16 v[140:143], a[200:203], v[68:71], v[140:143]
  ds_read_b64_tr_b16 a[196:197], v231 offset:28672
  v_mfma_f32_16x16x32_bf16 v[140:143], a[204:207], v[84:87], v[140:143]
  s_waitcnt lgkmcnt(3)
  ds_read_b64_tr_b16 a[198:199], v231 offset:30720
  v_mfma_f32_16x16x32_bf16 v[144:147], a[208:211], v[64:67], v[144:147]
  s_add_u32 m0, s25, 131072
  ds_read_b64_tr_b16 a[200:201], v232 offset:24576
  v_mfma_f32_16x16x32_bf16 v[144:147], a[212:215], v[80:83], v[144:147]
  ds_read_b64_tr_b16 a[202:203], v232 offset:26624
  v_mfma_f32_16x16x32_bf16 v[148:151], a[208:211], v[68:71], v[148:151]
  ds_read_b64_tr_b16 a[204:205], v232 offset:28672
  v_mfma_f32_16x16x32_bf16 v[148:151], a[212:215], v[84:87], v[148:151]
  ds_read_b64_tr_b16 a[206:207], v232 offset:30720
  v_mfma_f32_16x16x32_bf16 v[152:155], a[216:219], v[64:67], v[152:155]
  ds_read_b64_tr_b16 a[208:209], v233 offset:24576
  buffer_load_dwordx4 v247, s[16:19], s27 offen offset:0 lds
  v_mfma_f32_16x16x32_bf16 v[152:155], a[220:223], v[80:83], v[152:155]
  ds_read_b64_tr_b16 a[210:211], v233 offset:26624
  v_mfma_f32_16x16x32_bf16 v[156:159], a[216:219], v[68:71], v[156:159]
  ds_read_b64_tr_b16 a[212:213], v233 offset:28672
  v_mfma_f32_16x16x32_bf16 v[156:159], a[220:223], v[84:87], v[156:159]
  s_waitcnt lgkmcnt(3)
  ds_read_b64_tr_b16 a[214:215], v233 offset:30720
  buffer_load_dwordx4 v248, s[16:19], s27 offen offset:1024 lds
  v_mfma_f32_16x16x32_bf16 v[128:131], a[192:195], v[96:99], v[128:131]
  ds_read_b64_tr_b16 a[216:217], v234 offset:24576
  v_mfma_f32_16x16x32_bf16 v[128:131], a[196:199], v[112:115], v[128:131]
  ds_read_b64_tr_b16 a[218:219], v234 offset:26624
  v_mfma_f32_16x16x32_bf16 v[132:135], a[192:195], v[100:103], v[132:135]
  ds_read_b64_tr_b16 a[220:221], v234 offset:28672
  v_mfma_f32_16x16x32_bf16 v[132:135], a[196:199], v[116:119], v[132:135]
  ds_read_b64_tr_b16 a[222:223], v234 offset:30720
  buffer_load_dwordx4 v249, s[16:19], s27 offen offset:2048 lds
  v_mfma_f32_16x16x32_bf16 v[136:139], a[200:203], v[96:99], v[136:139]
  ds_read_b64_tr_b16 a[192:193], v231 offset:32768
  v_mfma_f32_16x16x32_bf16 v[136:139], a[204:207], v[112:115], v[136:139]
  ds_read_b64_tr_b16 a[194:195], v231 offset:34816
  v_mfma_f32_16x16x32_bf16 v[140:143], a[200:203], v[100:103], v[140:143]
  ds_read_b64_tr_b16 a[196:197], v231 offset:36864
  buffer_load_dwordx4 v250, s[16:19], s27 offen offset:3072 lds
  v_mfma_f32_16x16x32_bf16 v[140:143], a[204:207], v[116:119], v[140:143]
  s_waitcnt lgkmcnt(3)
  ds_read_b64_tr_b16 a[198:199], v231 offset:38912
  v_mfma_f32_16x16x32_bf16 v[144:147], a[208:211], v[96:99], v[144:147]
  ds_read_b64_tr_b16 a[200:201], v232 offset:32768
  v_mfma_f32_16x16x32_bf16 v[144:147], a[212:215], v[112:115], v[144:147]
  ds_read_b64_tr_b16 a[202:203], v232 offset:34816
  v_mfma_f32_16x16x32_bf16 v[148:151], a[208:211], v[100:103], v[148:151]
  ds_read_b64_tr_b16 a[204:205], v232 offset:36864
  v_mfma_f32_16x16x32_bf16 v[148:151], a[212:215], v[116:119], v[148:151]
  ds_read_b64_tr_b16 a[206:207], v232 offset:38912
  v_mfma_f32_16x16x32_bf16 v[152:155], a[216:219], v[96:99], v[152:155]
  ds_read_b64_tr_b16 a[208:209], v233 offset:32768
  v_mfma_f32_16x16x32_bf16 v[152:155], a[220:223], v[112:115], v[152:155]
  ds_read_b64_tr_b16 a[210:211], v233 offset:34816
  v_mfma_f32_16x16x32_bf16 v[156:159], a[216:219], v[100:103], v[156:159]
  ds_read_b64_tr_b16 a[212:213], v233 offset:36864
  v_mfma_f32_16x16x32_bf16 v[156:159], a[220:223], v[116:119], v[156:159]
  s_waitcnt lgkmcnt(3)
  ds_read_b64_tr_b16 a[214:215], v233 offset:38912
  v_mfma_f32_16x16x32_bf16 v[128:131], a[192:195], a[160:163], v[128:131]
  ds_read_b64_tr_b16 a[216:217], v234 offset:32768
  v_mfma_f32_16x16x32_bf16 v[128:131], a[196:199], a[168:171], v[128:131]
  ds_read_b64_tr_b16 a[218:219], v234 offset:34816
  v_mfma_f32_16x16x32_bf16 v[132:135], a[192:195], a[164:167], v[132:135]
  ds_read_b64_tr_b16 a[220:221], v234 offset:36864
  v_mfma_f32_16x16x32_bf16 v[132:135], a[196:199], a[172:175], v[132:135]
  ds_read_b64_tr_b16 a[222:223], v234 offset:38912
  v_mfma_f32_16x16x32_bf16 v[136:139], a[200:203], a[160:163], v[136:139]
  ds_read_b64_tr_b16 a[192:193], v231 offset:40960
  v_mfma_f32_16x16x32_bf16 v[136:139], a[204:207], a[168:171], v[136:139]
  ds_read_b64_tr_b16 a[194:195], v231 offset:43008
  v_mfma_f32_16x16x32_bf16 v[140:143], a[200:203], a[164:167], v[140:143]
  ds_read_b64_tr_b16 a[196:197], v231 offset:45056
  v_mfma_f32_16x16x32_bf16 v[140:143], a[204:207], a[172:175], v[140:143]
  s_waitcnt lgkmcnt(3)
  ds_read_b64_tr_b16 a[198:199], v231 offset:47104
  v_mfma_f32_16x16x32_bf16 v[144:147], a[208:211], a[160:163], v[144:147]
  ds_read_b64_tr_b16 a[200:201], v232 offset:40960
  v_mfma_f32_16x16x32_bf16 v[144:147], a[212:215], a[168:171], v[144:147]
  ds_read_b64_tr_b16 a[202:203], v232 offset:43008
  v_mfma_f32_16x16x32_bf16 v[148:151], a[208:211], a[164:167], v[148:151]
  ds_read_b64_tr_b16 a[204:205], v232 offset:45056
  v_mfma_f32_16x16x32_bf16 v[148:151], a[212:215], a[172:175], v[148:151]
  ds_read_b64_tr_b16 a[206:207], v232 offset:47104
  v_mfma_f32_16x16x32_bf16 v[152:155], a[216:219], a[160:163], v[152:155]
  ds_read_b64_tr_b16 a[208:209], v233 offset:40960
  v_mfma_f32_16x16x32_bf16 v[152:155], a[220:223], a[168:171], v[152:155]
  ds_read_b64_tr_b16 a[210:211], v233 offset:43008
  v_mfma_f32_16x16x32_bf16 v[156:159], a[216:219], a[164:167], v[156:159]
  ds_read_b64_tr_b16 a[212:213], v233 offset:45056
  v_mfma_f32_16x16x32_bf16 v[156:159], a[220:223], a[172:175], v[156:159]
  s_waitcnt lgkmcnt(3)
  ds_read_b64_tr_b16 a[214:215], v233 offset:47104
  v_mfma_f32_16x16x32_bf16 v[128:131], a[192:195], a[176:179], v[128:131]
  ds_read_b64_tr_b16 a[216:217], v234 offset:40960
  v_mfma_f32_16x16x32_bf16 v[160:163], a[196:199], a[184:187], v[128:131]
  ds_read_b64_tr_b16 a[218:219], v234 offset:43008
  v_mfma_f32_16x16x32_bf16 v[132:135], a[192:195], a[180:183], v[132:135]
  ds_read_b64_tr_b16 a[220:221], v234 offset:45056
  v_mfma_f32_16x16x32_bf16 v[164:167], a[196:199], a[188:191], v[132:135]
  ds_read_b64_tr_b16 a[222:223], v234 offset:47104
  v_mfma_f32_16x16x32_bf16 v[136:139], a[200:203], a[176:179], v[136:139]
  v_mfma_f32_16x16x32_bf16 v[168:171], a[204:207], a[184:187], v[136:139]
  v_mfma_f32_16x16x32_bf16 v[140:143], a[200:203], a[180:183], v[140:143]
  v_mfma_f32_16x16x32_bf16 v[172:175], a[204:207], a[188:191], v[140:143]
  s_waitcnt vmcnt(12) lgkmcnt(0)
  s_barrier
  v_mfma_f32_16x16x32_bf16 v[144:147], a[208:211], a[176:179], v[144:147]
  ds_read_b64_tr_b16 a[192:193], v235 offset:0
  ds_read_b64_tr_b16 a[194:195], v235 offset:2048
  v_mfma_f32_16x16x32_bf16 v[176:179], a[212:215], a[184:187], v[144:147]
  ds_read_b64_tr_b16 a[196:197], v235 offset:4096
  ds_read_b64_tr_b16 a[198:199], v235 offset:6144
  v_mfma_f32_16x16x32_bf16 v[148:151], a[208:211], a[180:183], v[148:151]
  ds_read_b64_tr_b16 a[200:201], v236 offset:0
  ds_read_b64_tr_b16 a[202:203], v236 offset:2048
  v_mfma_f32_16x16x32_bf16 v[180:183], a[212:215], a[188:191], v[148:151]
  ds_read_b64_tr_b16 a[204:205], v236 offset:4096
  ds_read_b64_tr_b16 a[206:207], v236 offset:6144
  ds_read_b64_tr_b16 a[208:209], v237 offset:0
  v_mfma_f32_16x16x32_bf16 v[152:155], a[216:219], a[176:179], v[152:155]
  ds_read_b64_tr_b16 a[210:211], v237 offset:2048
  v_mfma_f32_16x16x32_bf16 v[184:187], a[220:223], a[184:187], v[152:155]
  ds_read_b64_tr_b16 a[212:213], v237 offset:4096
  v_mfma_f32_16x16x32_bf16 v[156:159], a[216:219], a[180:183], v[156:159]
  ds_read_b64_tr_b16 a[214:215], v237 offset:6144
  v_mfma_f32_16x16x32_bf16 v[188:191], a[220:223], a[188:191], v[156:159]
  s_waitcnt lgkmcnt(8)
  v_mfma_f32_16x16x32_bf16 v[128:131], a[192:195], v[0:3], 0
  s_add_u32 s26, s51, 384
  ds_read_b64_tr_b16 a[216:217], v238 offset:0
  v_mfma_f32_16x16x32_bf16 v[128:131], a[196:199], v[16:19], v[128:131]
  s_add_u32 s39, s53, 0
  ds_read_b64_tr_b16 a[218:219], v238 offset:2048
  v_cvt_pk_bf16_f32 v160, v160, v161
  v_mfma_f32_16x16x32_bf16 v[132:135], a[192:195], v[4:7], 0
  ds_read_b64_tr_b16 a[220:221], v238 offset:4096
  v_cvt_pk_bf16_f32 v161, v162, v163
  v_mfma_f32_16x16x32_bf16 v[132:135], a[196:199], v[20:23], v[132:135]
  s_waitcnt lgkmcnt(7)
  ds_read_b64_tr_b16 a[222:223], v238 offset:6144
  v_cvt_pk_bf16_f32 v162, v168, v169
  v_mfma_f32_16x16x32_bf16 v[136:139], a[200:203], v[0:3], 0
  s_add_u32 s27, s52, 384
  ds_read_b64_tr_b16 a[192:193], v235 offset:8192
  v_cvt_pk_bf16_f32 v163, v170, v171
  v_mfma_f32_16x16x32_bf16 v[136:139], a[204:207], v[16:19], v[136:139]
  ds_read_b64_tr_b16 a[194:195], v235 offset:10240
  v_cvt_pk_bf16_f32 v164, v164, v165
  v_mfma_f32_16x16x32_bf16 v[140:143], a[200:203], v[4:7], 0
  s_add_u32 m0, s50, 0
  ds_read_b64_tr_b16 a[196:197], v235 offset:12288
  v_cvt_pk_bf16_f32 v165, v166, v167
  v_mfma_f32_16x16x32_bf16 v[140:143], a[204:207], v[20:23], v[140:143]
  s_waitcnt lgkmcnt(3)
  ds_read_b64_tr_b16 a[198:199], v235 offset:14336
  v_cvt_pk_bf16_f32 v166, v172, v173
  v_mfma_f32_16x16x32_bf16 v[144:147], a[208:211], v[0:3], 0
  ds_read_b64_tr_b16 a[200:201], v236 offset:8192
  v_cvt_pk_bf16_f32 v167, v174, v175
  v_mfma_f32_16x16x32_bf16 v[144:147], a[212:215], v[16:19], v[144:147]
  ds_read_b64_tr_b16 a[202:203], v236 offset:10240
  v_cvt_pk_bf16_f32 v176, v176, v177
  v_mfma_f32_16x16x32_bf16 v[148:151], a[208:211], v[4:7], 0
  ds_read_b64_tr_b16 a[204:205], v236 offset:12288
  buffer_load_dwordx4 v239, s[12:15], s26 offen offset:0 lds
  v_mfma_f32_16x16x32_bf16 v[148:151], a[212:215], v[20:23], v[148:151]
  ds_read_b64_tr_b16 a[206:207], v236 offset:14336
  v_cvt_pk_bf16_f32 v177, v178, v179
  v_mfma_f32_16x16x32_bf16 v[152:155], a[216:219], v[0:3], 0
  ds_read_b64_tr_b16 a[208:209], v237 offset:8192
  v_cvt_pk_bf16_f32 v178, v184, v185
  v_mfma_f32_16x16x32_bf16 v[152:155], a[220:223], v[16:19], v[152:155]
  ds_read_b64_tr_b16 a[210:211], v237 offset:10240
  buffer_load_dwordx4 v240, s[12:15], s26 offen offset:1024 lds
  v_mfma_f32_16x16x32_bf16 v[156:159], a[216:219], v[4:7], 0
  ds_read_b64_tr_b16 a[212:213], v237 offset:12288
  v_cvt_pk_bf16_f32 v179, v186, v187
  v_mfma_f32_16x16x32_bf16 v[156:159], a[220:223], v[20:23], v[156:159]
  s_waitcnt lgkmcnt(3)
  ds_read_b64_tr_b16 a[214:215], v237 offset:14336
  v_cvt_pk_bf16_f32 v180, v180, v181
  v_mfma_f32_16x16x32_bf16 v[128:131], a[192:195], v[32:35], v[128:131]
  ds_read_b64_tr_b16 a[216:217], v238 offset:8192
  v_cvt_pk_bf16_f32 v181, v182, v183
  v_mfma_f32_16x16x32_bf16 v[128:131], a[196:199], v[48:51], v[128:131]
  ds_read_b64_tr_b16 a[218:219], v238 offset:10240
  buffer_load_dwordx4 v241, s[12:15], s26 offen offset:2048 lds
  v_mfma_f32_16x16x32_bf16 v[132:135], a[192:195], v[36:39], v[132:135]
  ds_read_b64_tr_b16 a[220:221], v238 offset:12288
  v_cvt_pk_bf16_f32 v182, v188, v189
  v_mfma_f32_16x16x32_bf16 v[132:135], a[196:199], v[52:55], v[132:135]
  ds_read_b64_tr_b16 a[222:223], v238 offset:14336
  v_cvt_pk_bf16_f32 v183, v190, v191
  v_mfma_f32_16x16x32_bf16 v[136:139], a[200:203], v[32:35], v[136:139]
  ds_read_b64_tr_b16 a[192:193], v235 offset:16384
  buffer_load_dwordx4 v242, s[12:15], s26 offen offset:3072 lds
  v_mfma_f32_16x16x32_bf16 v[136:139], a[204:207], v[48:51], v[136:139]
  ds_read_b64_tr_b16 a[194:195], v235 offset:18432
  v_mfma_f32_16x16x32_bf16 v[140:143], a[200:203], v[36:39], v[140:143]
  ds_read_b64_tr_b16 a[196:197], v235 offset:20480
  v_mfma_f32_16x16x32_bf16 v[140:143], a[204:207], v[52:55], v[140:143]
  s_waitcnt lgkmcnt(3)
  ds_read_b64_tr_b16 a[198:199], v235 offset:22528
  v_mfma_f32_16x16x32_bf16 v[144:147], a[208:211], v[32:35], v[144:147]
  s_add_u32 m0, s50, 4096
  ds_read_b64_tr_b16 a[200:201], v236 offset:16384
  v_mfma_f32_16x16x32_bf16 v[144:147], a[212:215], v[48:51], v[144:147]
  ds_read_b64_tr_b16 a[202:203], v236 offset:18432
  v_mfma_f32_16x16x32_bf16 v[148:151], a[208:211], v[36:39], v[148:151]
  ds_read_b64_tr_b16 a[204:205], v236 offset:20480
  v_mfma_f32_16x16x32_bf16 v[148:151], a[212:215], v[52:55], v[148:151]
  ds_read_b64_tr_b16 a[206:207], v236 offset:22528
  buffer_load_dwordx4 v243, s[12:15], s26 offen offset:0 lds
  v_mfma_f32_16x16x32_bf16 v[152:155], a[216:219], v[32:35], v[152:155]
  ds_read_b64_tr_b16 a[208:209], v237 offset:16384
  v_mfma_f32_16x16x32_bf16 v[152:155], a[220:223], v[48:51], v[152:155]
  ds_read_b64_tr_b16 a[210:211], v237 offset:18432
  v_mfma_f32_16x16x32_bf16 v[156:159], a[216:219], v[36:39], v[156:159]
  ds_read_b64_tr_b16 a[212:213], v237 offset:20480
  buffer_load_dwordx4 v244, s[12:15], s26 offen offset:1024 lds
  v_mfma_f32_16x16x32_bf16 v[156:159], a[220:223], v[52:55], v[156:159]
  s_waitcnt lgkmcnt(3)
  ds_read_b64_tr_b16 a[214:215], v237 offset:22528
  v_mfma_f32_16x16x32_bf16 v[128:131], a[192:195], v[64:67], v[128:131]
  ds_read_b64_tr_b16 a[216:217], v238 offset:16384
  v_mfma_f32_16x16x32_bf16 v[128:131], a[196:199], v[80:83], v[128:131]
  ds_read_b64_tr_b16 a[218:219], v238 offset:18432
  v_mfma_f32_16x16x32_bf16 v[132:135], a[192:195], v[68:71], v[132:135]
  ds_read_b64_tr_b16 a[220:221], v238 offset:20480
  buffer_load_dwordx4 v245, s[12:15], s26 offen offset:2048 lds
  v_mfma_f32_16x16x32_bf16 v[132:135], a[196:199], v[84:87], v[132:135]
  ds_read_b64_tr_b16 a[222:223], v238 offset:22528
  v_mfma_f32_16x16x32_bf16 v[136:139], a[200:203], v[64:67], v[136:139]
  ds_read_b64_tr_b16 a[192:193], v235 offset:24576
  v_mfma_f32_16x16x32_bf16 v[136:139], a[204:207], v[80:83], v[136:139]
  ds_read_b64_tr_b16 a[194:195], v235 offset:26624
  buffer_load_dwordx4 v246, s[12:15], s26 offen offset:3072 lds
  v_mfma_f32_16x16x32_bf16 v[140:143], a[200:203], v[68:71], v[140:143]
  ds_read_b64_tr_b16 a[196:197], v235 offset:28672
  v_mfma_f32_16x16x32_bf16 v[140:143], a[204:207], v[84:87], v[140:143]
  s_waitcnt lgkmcnt(3)
  ds_read_b64_tr_b16 a[198:199], v235 offset:30720
  v_mfma_f32_16x16x32_bf16 v[144:147], a[208:211], v[64:67], v[144:147]
  s_add_u32 m0, s25, 32768
  ds_read_b64_tr_b16 a[200:201], v236 offset:24576
  v_mfma_f32_16x16x32_bf16 v[144:147], a[212:215], v[80:83], v[144:147]
  ds_read_b64_tr_b16 a[202:203], v236 offset:26624
  v_mfma_f32_16x16x32_bf16 v[148:151], a[208:211], v[68:71], v[148:151]
  ds_read_b64_tr_b16 a[204:205], v236 offset:28672
  v_mfma_f32_16x16x32_bf16 v[148:151], a[212:215], v[84:87], v[148:151]
  ds_read_b64_tr_b16 a[206:207], v236 offset:30720
  v_mfma_f32_16x16x32_bf16 v[152:155], a[216:219], v[64:67], v[152:155]
  ds_read_b64_tr_b16 a[208:209], v237 offset:24576
  buffer_load_dwordx4 v247, s[16:19], s27 offen offset:0 lds
  v_mfma_f32_16x16x32_bf16 v[152:155], a[220:223], v[80:83], v[152:155]
  ds_read_b64_tr_b16 a[210:211], v237 offset:26624
  v_mfma_f32_16x16x32_bf16 v[156:159], a[216:219], v[68:71], v[156:159]
  ds_read_b64_tr_b16 a[212:213], v237 offset:28672
  v_mfma_f32_16x16x32_bf16 v[156:159], a[220:223], v[84:87], v[156:159]
  s_waitcnt lgkmcnt(3)
  ds_read_b64_tr_b16 a[214:215], v237 offset:30720
  buffer_load_dwordx4 v248, s[16:19], s27 offen offset:1024 lds
  v_mfma_f32_16x16x32_bf16 v[128:131], a[192:195], v[96:99], v[128:131]
  ds_read_b64_tr_b16 a[216:217], v238 offset:24576
  v_mfma_f32_16x16x32_bf16 v[128:131], a[196:199], v[112:115], v[128:131]
  ds_read_b64_tr_b16 a[218:219], v238 offset:26624
  v_mfma_f32_16x16x32_bf16 v[132:135], a[192:195], v[100:103], v[132:135]
  ds_read_b64_tr_b16 a[220:221], v238 offset:28672
  v_mfma_f32_16x16x32_bf16 v[132:135], a[196:199], v[116:119], v[132:135]
  ds_read_b64_tr_b16 a[222:223], v238 offset:30720
  buffer_load_dwordx4 v249, s[16:19], s27 offen offset:2048 lds
  v_mfma_f32_16x16x32_bf16 v[136:139], a[200:203], v[96:99], v[136:139]
  ds_read_b64_tr_b16 a[192:193], v235 offset:32768
  v_mfma_f32_16x16x32_bf16 v[136:139], a[204:207], v[112:115], v[136:139]
  ds_read_b64_tr_b16 a[194:195], v235 offset:34816
  v_mfma_f32_16x16x32_bf16 v[140:143], a[200:203], v[100:103], v[140:143]
  ds_read_b64_tr_b16 a[196:197], v235 offset:36864
  buffer_load_dwordx4 v250, s[16:19], s27 offen offset:3072 lds
  v_mfma_f32_16x16x32_bf16 v[140:143], a[204:207], v[116:119], v[140:143]
  s_waitcnt lgkmcnt(3)
  ds_read_b64_tr_b16 a[198:199], v235 offset:38912
  v_mfma_f32_16x16x32_bf16 v[144:147], a[208:211], v[96:99], v[144:147]
  ds_read_b64_tr_b16 a[200:201], v236 offset:32768
  v_mfma_f32_16x16x32_bf16 v[144:147], a[212:215], v[112:115], v[144:147]
  ds_read_b64_tr_b16 a[202:203], v236 offset:34816
  v_mfma_f32_16x16x32_bf16 v[148:151], a[208:211], v[100:103], v[148:151]
  ds_read_b64_tr_b16 a[204:205], v236 offset:36864
  v_mfma_f32_16x16x32_bf16 v[148:151], a[212:215], v[116:119], v[148:151]
  ds_read_b64_tr_b16 a[206:207], v236 offset:38912
  v_mfma_f32_16x16x32_bf16 v[152:155], a[216:219], v[96:99], v[152:155]
  ds_read_b64_tr_b16 a[208:209], v237 offset:32768
  buffer_store_dwordx4 v[160:163], v251, s[8:11], s39 offen sc1
  v_mfma_f32_16x16x32_bf16 v[152:155], a[220:223], v[112:115], v[152:155]
  ds_read_b64_tr_b16 a[210:211], v237 offset:34816
  v_mfma_f32_16x16x32_bf16 v[156:159], a[216:219], v[100:103], v[156:159]
  ds_read_b64_tr_b16 a[212:213], v237 offset:36864
  v_mfma_f32_16x16x32_bf16 v[156:159], a[220:223], v[116:119], v[156:159]
  s_waitcnt lgkmcnt(3)
  ds_read_b64_tr_b16 a[214:215], v237 offset:38912
  v_mfma_f32_16x16x32_bf16 v[128:131], a[192:195], a[160:163], v[128:131]
  ds_read_b64_tr_b16 a[216:217], v238 offset:32768
  buffer_store_dwordx4 v[164:167], v252, s[8:11], s39 offen sc1
  v_mfma_f32_16x16x32_bf16 v[128:131], a[196:199], a[168:171], v[128:131]
  ds_read_b64_tr_b16 a[218:219], v238 offset:34816
  v_mfma_f32_16x16x32_bf16 v[132:135], a[192:195], a[164:167], v[132:135]
  ds_read_b64_tr_b16 a[220:221], v238 offset:36864
  v_mfma_f32_16x16x32_bf16 v[132:135], a[196:199], a[172:175], v[132:135]
  ds_read_b64_tr_b16 a[222:223], v238 offset:38912
  v_mfma_f32_16x16x32_bf16 v[136:139], a[200:203], a[160:163], v[136:139]
  ds_read_b64_tr_b16 a[192:193], v235 offset:40960
  buffer_store_dwordx4 v[176:179], v253, s[8:11], s39 offen sc1
  v_mfma_f32_16x16x32_bf16 v[136:139], a[204:207], a[168:171], v[136:139]
  ds_read_b64_tr_b16 a[194:195], v235 offset:43008
  v_mfma_f32_16x16x32_bf16 v[140:143], a[200:203], a[164:167], v[140:143]
  ds_read_b64_tr_b16 a[196:197], v235 offset:45056
  v_mfma_f32_16x16x32_bf16 v[140:143], a[204:207], a[172:175], v[140:143]
  s_waitcnt lgkmcnt(3)
  ds_read_b64_tr_b16 a[198:199], v235 offset:47104
  v_mfma_f32_16x16x32_bf16 v[144:147], a[208:211], a[160:163], v[144:147]
  ds_read_b64_tr_b16 a[200:201], v236 offset:40960
  buffer_store_dwordx4 v[180:183], v254, s[8:11], s39 offen sc1
  v_mfma_f32_16x16x32_bf16 v[144:147], a[212:215], a[168:171], v[144:147]
  ds_read_b64_tr_b16 a[202:203], v236 offset:43008
  v_mfma_f32_16x16x32_bf16 v[148:151], a[208:211], a[164:167], v[148:151]
  ds_read_b64_tr_b16 a[204:205], v236 offset:45056
  v_mfma_f32_16x16x32_bf16 v[148:151], a[212:215], a[172:175], v[148:151]
  ds_read_b64_tr_b16 a[206:207], v236 offset:47104
  v_mfma_f32_16x16x32_bf16 v[152:155], a[216:219], a[160:163], v[152:155]
  ds_read_b64_tr_b16 a[208:209], v237 offset:40960
  v_mfma_f32_16x16x32_bf16 v[152:155], a[220:223], a[168:171], v[152:155]
  ds_read_b64_tr_b16 a[210:211], v237 offset:43008
  v_mfma_f32_16x16x32_bf16 v[156:159], a[216:219], a[164:167], v[156:159]
  ds_read_b64_tr_b16 a[212:213], v237 offset:45056
  v_mfma_f32_16x16x32_bf16 v[156:159], a[220:223], a[172:175], v[156:159]
  s_waitcnt lgkmcnt(3)
  ds_read_b64_tr_b16 a[214:215], v237 offset:47104
  v_mfma_f32_16x16x32_bf16 v[128:131], a[192:195], a[176:179], v[128:131]
  ds_read_b64_tr_b16 a[216:217], v238 offset:40960
  v_mfma_f32_16x16x32_bf16 v[160:163], a[196:199], a[184:187], v[128:131]
  ds_read_b64_tr_b16 a[218:219], v238 offset:43008
  v_mfma_f32_16x16x32_bf16 v[132:135], a[192:195], a[180:183], v[132:135]
  ds_read_b64_tr_b16 a[220:221], v238 offset:45056
  v_mfma_f32_16x16x32_bf16 v[164:167], a[196:199], a[188:191], v[132:135]
  ds_read_b64_tr_b16 a[222:223], v238 offset:47104
  v_mfma_f32_16x16x32_bf16 v[136:139], a[200:203], a[176:179], v[136:139]
  v_mfma_f32_16x16x32_bf16 v[168:171], a[204:207], a[184:187], v[136:139]
  v_mfma_f32_16x16x32_bf16 v[140:143], a[200:203], a[180:183], v[140:143]
  v_mfma_f32_16x16x32_bf16 v[172:175], a[204:207], a[188:191], v[140:143]
  s_waitcnt vmcnt(16) lgkmcnt(0)
  s_barrier
  v_mfma_f32_16x16x32_bf16 v[144:147], a[208:211], a[176:179], v[144:147]
  ds_read_b64_tr_b16 a[192:193], v8 offset:0
  ds_read_b64_tr_b16 a[194:195], v8 offset:2048
  v_mfma_f32_16x16x32_bf16 v[176:179], a[212:215], a[184:187], v[144:147]
  ds_read_b64_tr_b16 a[196:197], v8 offset:4096
  ds_read_b64_tr_b16 a[198:199], v8 offset:6144
  v_mfma_f32_16x16x32_bf16 v[148:151], a[208:211], a[180:183], v[148:151]
  ds_read_b64_tr_b16 a[200:201], v9 offset:0
  ds_read_b64_tr_b16 a[202:203], v9 offset:2048
  v_mfma_f32_16x16x32_bf16 v[180:183], a[212:215], a[188:191], v[148:151]
  ds_read_b64_tr_b16 a[204:205], v9 offset:4096
  ds_read_b64_tr_b16 a[206:207], v9 offset:6144
  ds_read_b64_tr_b16 a[208:209], v10 offset:0
  v_mfma_f32_16x16x32_bf16 v[152:155], a[216:219], a[176:179], v[152:155]
  ds_read_b64_tr_b16 a[210:211], v10 offset:2048
  v_mfma_f32_16x16x32_bf16 v[184:187], a[220:223], a[184:187], v[152:155]
  ds_read_b64_tr_b16 a[212:213], v10 offset:4096
  v_mfma_f32_16x16x32_bf16 v[156:159], a[216:219], a[180:183], v[156:159]
  ds_read_b64_tr_b16 a[214:215], v10 offset:6144
  v_mfma_f32_16x16x32_bf16 v[188:191], a[220:223], a[188:191], v[156:159]
  s_waitcnt lgkmcnt(8)
  v_mfma_f32_16x16x32_bf16 v[128:131], a[192:195], v[0:3], 0
  s_add_u32 s26, s51, 512
  ds_read_b64_tr_b16 a[216:217], v11 offset:0
  v_mfma_f32_16x16x32_bf16 v[128:131], a[196:199], v[16:19], v[128:131]
  s_add_u32 s39, s53, 65536
  ds_read_b64_tr_b16 a[218:219], v11 offset:2048
  v_cvt_pk_bf16_f32 v160, v160, v161
  v_mfma_f32_16x16x32_bf16 v[132:135], a[192:195], v[4:7], 0
  ds_read_b64_tr_b16 a[220:221], v11 offset:4096
  v_cvt_pk_bf16_f32 v161, v162, v163
  v_mfma_f32_16x16x32_bf16 v[132:135], a[196:199], v[20:23], v[132:135]
  s_waitcnt lgkmcnt(7)
  ds_read_b64_tr_b16 a[222:223], v11 offset:6144
  v_cvt_pk_bf16_f32 v162, v168, v169
  v_mfma_f32_16x16x32_bf16 v[136:139], a[200:203], v[0:3], 0
  s_add_u32 s27, s52, 512
  ds_read_b64_tr_b16 a[192:193], v8 offset:8192
  v_cvt_pk_bf16_f32 v163, v170, v171
  v_mfma_f32_16x16x32_bf16 v[136:139], a[204:207], v[16:19], v[136:139]
  ds_read_b64_tr_b16 a[194:195], v8 offset:10240
  v_cvt_pk_bf16_f32 v164, v164, v165
  v_mfma_f32_16x16x32_bf16 v[140:143], a[200:203], v[4:7], 0
  s_add_u32 m0, s50, 49152
  ds_read_b64_tr_b16 a[196:197], v8 offset:12288
  v_cvt_pk_bf16_f32 v165, v166, v167
  v_mfma_f32_16x16x32_bf16 v[140:143], a[204:207], v[20:23], v[140:143]
  s_waitcnt lgkmcnt(3)
  ds_read_b64_tr_b16 a[198:199], v8 offset:14336
  v_cvt_pk_bf16_f32 v166, v172, v173
  v_mfma_f32_16x16x32_bf16 v[144:147], a[208:211], v[0:3], 0
  ds_read_b64_tr_b16 a[200:201], v9 offset:8192
  v_cvt_pk_bf16_f32 v167, v174, v175
  v_mfma_f32_16x16x32_bf16 v[144:147], a[212:215], v[16:19], v[144:147]
  ds_read_b64_tr_b16 a[202:203], v9 offset:10240
  v_cvt_pk_bf16_f32 v176, v176, v177
  v_mfma_f32_16x16x32_bf16 v[148:151], a[208:211], v[4:7], 0
  ds_read_b64_tr_b16 a[204:205], v9 offset:12288
  buffer_load_dwordx4 v239, s[12:15], s26 offen offset:0 lds
  v_mfma_f32_16x16x32_bf16 v[148:151], a[212:215], v[20:23], v[148:151]
  ds_read_b64_tr_b16 a[206:207], v9 offset:14336
  v_cvt_pk_bf16_f32 v177, v178, v179
  v_mfma_f32_16x16x32_bf16 v[152:155], a[216:219], v[0:3], 0
  ds_read_b64_tr_b16 a[208:209], v10 offset:8192
  v_cvt_pk_bf16_f32 v178, v184, v185
  v_mfma_f32_16x16x32_bf16 v[152:155], a[220:223], v[16:19], v[152:155]
  ds_read_b64_tr_b16 a[210:211], v10 offset:10240
  buffer_load_dwordx4 v240, s[12:15], s26 offen offset:1024 lds
  v_mfma_f32_16x16x32_bf16 v[156:159], a[216:219], v[4:7], 0
  ds_read_b64_tr_b16 a[212:213], v10 offset:12288
  v_cvt_pk_bf16_f32 v179, v186, v187
  v_mfma_f32_16x16x32_bf16 v[156:159], a[220:223], v[20:23], v[156:159]
  s_waitcnt lgkmcnt(3)
  ds_read_b64_tr_b16 a[214:215], v10 offset:14336
  v_cvt_pk_bf16_f32 v180, v180, v181
  v_mfma_f32_16x16x32_bf16 v[128:131], a[192:195], v[32:35], v[128:131]
  ds_read_b64_tr_b16 a[216:217], v11 offset:8192
  v_cvt_pk_bf16_f32 v181, v182, v183
  v_mfma_f32_16x16x32_bf16 v[128:131], a[196:199], v[48:51], v[128:131]
  ds_read_b64_tr_b16 a[218:219], v11 offset:10240
  buffer_load_dwordx4 v241, s[12:15], s26 offen offset:2048 lds
  v_mfma_f32_16x16x32_bf16 v[132:135], a[192:195], v[36:39], v[132:135]
  ds_read_b64_tr_b16 a[220:221], v11 offset:12288
  v_cvt_pk_bf16_f32 v182, v188, v189
  v_mfma_f32_16x16x32_bf16 v[132:135], a[196:199], v[52:55], v[132:135]
  ds_read_b64_tr_b16 a[222:223], v11 offset:14336
  v_cvt_pk_bf16_f32 v183, v190, v191
  v_mfma_f32_16x16x32_bf16 v[136:139], a[200:203], v[32:35], v[136:139]
  ds_read_b64_tr_b16 a[192:193], v8 offset:16384
  buffer_load_dwordx4 v242, s[12:15], s26 offen offset:3072 lds
  v_mfma_f32_16x16x32_bf16 v[136:139], a[204:207], v[48:51], v[136:139]
  ds_read_b64_tr_b16 a[194:195], v8 offset:18432
  v_mfma_f32_16x16x32_bf16 v[140:143], a[200:203], v[36:39], v[140:143]
  ds_read_b64_tr_b16 a[196:197], v8 offset:20480
  v_mfma_f32_16x16x32_bf16 v[140:143], a[204:207], v[52:55], v[140:143]
  s_waitcnt lgkmcnt(3)
  ds_read_b64_tr_b16 a[198:199], v8 offset:22528
  v_mfma_f32_16x16x32_bf16 v[144:147], a[208:211], v[32:35], v[144:147]
  s_add_u32 m0, s50, 53248
  ds_read_b64_tr_b16 a[200:201], v9 offset:16384
  v_mfma_f32_16x16x32_bf16 v[144:147], a[212:215], v[48:51], v[144:147]
  ds_read_b64_tr_b16 a[202:203], v9 offset:18432
  v_mfma_f32_16x16x32_bf16 v[148:151], a[208:211], v[36:39], v[148:151]
  ds_read_b64_tr_b16 a[204:205], v9 offset:20480
  v_mfma_f32_16x16x32_bf16 v[148:151], a[212:215], v[52:55], v[148:151]
  ds_read_b64_tr_b16 a[206:207], v9 offset:22528
  buffer_load_dwordx4 v243, s[12:15], s26 offen offset:0 lds
  v_mfma_f32_16x16x32_bf16 v[152:155], a[216:219], v[32:35], v[152:155]
  ds_read_b64_tr_b16 a[208:209], v10 offset:16384
  v_mfma_f32_16x16x32_bf16 v[152:155], a[220:223], v[48:51], v[152:155]
  ds_read_b64_tr_b16 a[210:211], v10 offset:18432
  v_mfma_f32_16x16x32_bf16 v[156:159], a[216:219], v[36:39], v[156:159]
  ds_read_b64_tr_b16 a[212:213], v10 offset:20480
  buffer_load_dwordx4 v244, s[12:15], s26 offen offset:1024 lds
  v_mfma_f32_16x16x32_bf16 v[156:159], a[220:223], v[52:55], v[156:159]
  s_waitcnt lgkmcnt(3)
  ds_read_b64_tr_b16 a[214:215], v10 offset:22528
  v_mfma_f32_16x16x32_bf16 v[128:131], a[192:195], v[64:67], v[128:131]
  ds_read_b64_tr_b16 a[216:217], v11 offset:16384
  v_mfma_f32_16x16x32_bf16 v[128:131], a[196:199], v[80:83], v[128:131]
  ds_read_b64_tr_b16 a[218:219], v11 offset:18432
  v_mfma_f32_16x16x32_bf16 v[132:135], a[192:195], v[68:71], v[132:135]
  ds_read_b64_tr_b16 a[220:221], v11 offset:20480
  buffer_load_dwordx4 v245, s[12:15], s26 offen offset:2048 lds
  v_mfma_f32_16x16x32_bf16 v[132:135], a[196:199], v[84:87], v[132:135]
  ds_read_b64_tr_b16 a[222:223], v11 offset:22528
  v_mfma_f32_16x16x32_bf16 v[136:139], a[200:203], v[64:67], v[136:139]
  ds_read_b64_tr_b16 a[192:193], v8 offset:24576
  v_mfma_f32_16x16x32_bf16 v[136:139], a[204:207], v[80:83], v[136:139]
  ds_read_b64_tr_b16 a[194:195], v8 offset:26624
  buffer_load_dwordx4 v246, s[12:15], s26 offen offset:3072 lds
  v_mfma_f32_16x16x32_bf16 v[140:143], a[200:203], v[68:71], v[140:143]
  ds_read_b64_tr_b16 a[196:197], v8 offset:28672
  v_mfma_f32_16x16x32_bf16 v[140:143], a[204:207], v[84:87], v[140:143]
  s_waitcnt lgkmcnt(3)
  ds_read_b64_tr_b16 a[198:199], v8 offset:30720
  v_mfma_f32_16x16x32_bf16 v[144:147], a[208:211], v[64:67], v[144:147]
  s_add_u32 m0, s25, 81920
  ds_read_b64_tr_b16 a[200:201], v9 offset:24576
  v_mfma_f32_16x16x32_bf16 v[144:147], a[212:215], v[80:83], v[144:147]
  ds_read_b64_tr_b16 a[202:203], v9 offset:26624
  v_mfma_f32_16x16x32_bf16 v[148:151], a[208:211], v[68:71], v[148:151]
  ds_read_b64_tr_b16 a[204:205], v9 offset:28672
  v_mfma_f32_16x16x32_bf16 v[148:151], a[212:215], v[84:87], v[148:151]
  ds_read_b64_tr_b16 a[206:207], v9 offset:30720
  v_mfma_f32_16x16x32_bf16 v[152:155], a[216:219], v[64:67], v[152:155]
  ds_read_b64_tr_b16 a[208:209], v10 offset:24576
  buffer_load_dwordx4 v247, s[16:19], s27 offen offset:0 lds
  v_mfma_f32_16x16x32_bf16 v[152:155], a[220:223], v[80:83], v[152:155]
  ds_read_b64_tr_b16 a[210:211], v10 offset:26624
  v_mfma_f32_16x16x32_bf16 v[156:159], a[216:219], v[68:71], v[156:159]
  ds_read_b64_tr_b16 a[212:213], v10 offset:28672
  v_mfma_f32_16x16x32_bf16 v[156:159], a[220:223], v[84:87], v[156:159]
  s_waitcnt lgkmcnt(3)
  ds_read_b64_tr_b16 a[214:215], v10 offset:30720
  buffer_load_dwordx4 v248, s[16:19], s27 offen offset:1024 lds
  v_mfma_f32_16x16x32_bf16 v[128:131], a[192:195], v[96:99], v[128:131]
  ds_read_b64_tr_b16 a[216:217], v11 offset:24576
  v_mfma_f32_16x16x32_bf16 v[128:131], a[196:199], v[112:115], v[128:131]
  ds_read_b64_tr_b16 a[218:219], v11 offset:26624
  v_mfma_f32_16x16x32_bf16 v[132:135], a[192:195], v[100:103], v[132:135]
  ds_read_b64_tr_b16 a[220:221], v11 offset:28672
  v_mfma_f32_16x16x32_bf16 v[132:135], a[196:199], v[116:119], v[132:135]
  ds_read_b64_tr_b16 a[222:223], v11 offset:30720
  buffer_load_dwordx4 v249, s[16:19], s27 offen offset:2048 lds
  v_mfma_f32_16x16x32_bf16 v[136:139], a[200:203], v[96:99], v[136:139]
  ds_read_b64_tr_b16 a[192:193], v8 offset:32768
  v_mfma_f32_16x16x32_bf16 v[136:139], a[204:207], v[112:115], v[136:139]
  ds_read_b64_tr_b16 a[194:195], v8 offset:34816
  v_mfma_f32_16x16x32_bf16 v[140:143], a[200:203], v[100:103], v[140:143]
  ds_read_b64_tr_b16 a[196:197], v8 offset:36864
  buffer_load_dwordx4 v250, s[16:19], s27 offen offset:3072 lds
  v_mfma_f32_16x16x32_bf16 v[140:143], a[204:207], v[116:119], v[140:143]
  s_waitcnt lgkmcnt(3)
  ds_read_b64_tr_b16 a[198:199], v8 offset:38912
  v_mfma_f32_16x16x32_bf16 v[144:147], a[208:211], v[96:99], v[144:147]
  ds_read_b64_tr_b16 a[200:201], v9 offset:32768
  v_mfma_f32_16x16x32_bf16 v[144:147], a[212:215], v[112:115], v[144:147]
  ds_read_b64_tr_b16 a[202:203], v9 offset:34816
  v_mfma_f32_16x16x32_bf16 v[148:151], a[208:211], v[100:103], v[148:151]
  ds_read_b64_tr_b16 a[204:205], v9 offset:36864
  v_mfma_f32_16x16x32_bf16 v[148:151], a[212:215], v[116:119], v[148:151]
  ds_read_b64_tr_b16 a[206:207], v9 offset:38912
  v_mfma_f32_16x16x32_bf16 v[152:155], a[216:219], v[96:99], v[152:155]
  ds_read_b64_tr_b16 a[208:209], v10 offset:32768
  buffer_store_dwordx4 v[160:163], v251, s[8:11], s39 offen sc1
  v_mfma_f32_16x16x32_bf16 v[152:155], a[220:223], v[112:115], v[152:155]
  ds_read_b64_tr_b16 a[210:211], v10 offset:34816
  v_mfma_f32_16x16x32_bf16 v[156:159], a[216:219], v[100:103], v[156:159]
  ds_read_b64_tr_b16 a[212:213], v10 offset:36864
  v_mfma_f32_16x16x32_bf16 v[156:159], a[220:223], v[116:119], v[156:159]
  s_waitcnt lgkmcnt(3)
  ds_read_b64_tr_b16 a[214:215], v10 offset:38912
  v_mfma_f32_16x16x32_bf16 v[128:131], a[192:195], a[160:163], v[128:131]
  ds_read_b64_tr_b16 a[216:217], v11 offset:32768
  buffer_store_dwordx4 v[164:167], v252, s[8:11], s39 offen sc1
  v_mfma_f32_16x16x32_bf16 v[128:131], a[196:199], a[168:171], v[128:131]
  ds_read_b64_tr_b16 a[218:219], v11 offset:34816
  v_mfma_f32_16x16x32_bf16 v[132:135], a[192:195], a[164:167], v[132:135]
  ds_read_b64_tr_b16 a[220:221], v11 offset:36864
  v_mfma_f32_16x16x32_bf16 v[132:135], a[196:199], a[172:175], v[132:135]
  ds_read_b64_tr_b16 a[222:223], v11 offset:38912
  v_mfma_f32_16x16x32_bf16 v[136:139], a[200:203], a[160:163], v[136:139]
  ds_read_b64_tr_b16 a[192:193], v8 offset:40960
  buffer_store_dwordx4 v[176:179], v253, s[8:11], s39 offen sc1
  v_mfma_f32_16x16x32_bf16 v[136:139], a[204:207], a[168:171], v[136:139]
  ds_read_b64_tr_b16 a[194:195], v8 offset:43008
  v_mfma_f32_16x16x32_bf16 v[140:143], a[200:203], a[164:167], v[140:143]
  ds_read_b64_tr_b16 a[196:197], v8 offset:45056
  v_mfma_f32_16x16x32_bf16 v[140:143], a[204:207], a[172:175], v[140:143]
  s_waitcnt lgkmcnt(3)
  ds_read_b64_tr_b16 a[198:199], v8 offset:47104
  v_mfma_f32_16x16x32_bf16 v[144:147], a[208:211], a[160:163], v[144:147]
  ds_read_b64_tr_b16 a[200:201], v9 offset:40960
  buffer_store_dwordx4 v[180:183], v254, s[8:11], s39 offen sc1
  v_mfma_f32_16x16x32_bf16 v[144:147], a[212:215], a[168:171], v[144:147]
  ds_read_b64_tr_b16 a[202:203], v9 offset:43008
  v_mfma_f32_16x16x32_bf16 v[148:151], a[208:211], a[164:167], v[148:151]
  ds_read_b64_tr_b16 a[204:205], v9 offset:45056
  v_mfma_f32_16x16x32_bf16 v[148:151], a[212:215], a[172:175], v[148:151]
  ds_read_b64_tr_b16 a[206:207], v9 offset:47104
  v_mfma_f32_16x16x32_bf16 v[152:155], a[216:219], a[160:163], v[152:155]
  ds_read_b64_tr_b16 a[208:209], v10 offset:40960
  v_mfma_f32_16x16x32_bf16 v[152:155], a[220:223], a[168:171], v[152:155]
  ds_read_b64_tr_b16 a[210:211], v10 offset:43008
  v_mfma_f32_16x16x32_bf16 v[156:159], a[216:219], a[164:167], v[156:159]
  ds_read_b64_tr_b16 a[212:213], v10 offset:45056
  v_mfma_f32_16x16x32_bf16 v[156:159], a[220:223], a[172:175], v[156:159]
  s_waitcnt lgkmcnt(3)
  ds_read_b64_tr_b16 a[214:215], v10 offset:47104
  v_mfma_f32_16x16x32_bf16 v[128:131], a[192:195], a[176:179], v[128:131]
  ds_read_b64_tr_b16 a[216:217], v11 offset:40960
  v_mfma_f32_16x16x32_bf16 v[160:163], a[196:199], a[184:187], v[128:131]
  ds_read_b64_tr_b16 a[218:219], v11 offset:43008
  v_mfma_f32_16x16x32_bf16 v[132:135], a[192:195], a[180:183], v[132:135]
  ds_read_b64_tr_b16 a[220:221], v11 offset:45056
  v_mfma_f32_16x16x32_bf16 v[164:167], a[196:199], a[188:191], v[132:135]
  ds_read_b64_tr_b16 a[222:223], v11 offset:47104
  v_mfma_f32_16x16x32_bf16 v[136:139], a[200:203], a[176:179], v[136:139]
  v_mfma_f32_16x16x32_bf16 v[168:171], a[204:207], a[184:187], v[136:139]
  v_mfma_f32_16x16x32_bf16 v[140:143], a[200:203], a[180:183], v[140:143]
  v_mfma_f32_16x16x32_bf16 v[172:175], a[204:207], a[188:191], v[140:143]
  s_waitcnt vmcnt(20) lgkmcnt(0)
  s_barrier
  v_mfma_f32_16x16x32_bf16 v[144:147], a[208:211], a[176:179], v[144:147]
  ds_read_b64_tr_b16 a[192:193], v231 offset:0
  ds_read_b64_tr_b16 a[194:195], v231 offset:2048
  v_mfma_f32_16x16x32_bf16 v[176:179], a[212:215], a[184:187], v[144:147]
  ds_read_b64_tr_b16 a[196:197], v231 offset:4096
  ds_read_b64_tr_b16 a[198:199], v231 offset:6144
  v_mfma_f32_16x16x32_bf16 v[148:151], a[208:211], a[180:183], v[148:151]
  ds_read_b64_tr_b16 a[200:201], v232 offset:0
  ds_read_b64_tr_b16 a[202:203], v232 offset:2048
  v_mfma_f32_16x16x32_bf16 v[180:183], a[212:215], a[188:191], v[148:151]
  ds_read_b64_tr_b16 a[204:205], v232 offset:4096
  ds_read_b64_tr_b16 a[206:207], v232 offset:6144
  ds_read_b64_tr_b16 a[208:209], v233 offset:0
  v_mfma_f32_16x16x32_bf16 v[152:155], a[216:219], a[176:179], v[152:155]
  ds_read_b64_tr_b16 a[210:211], v233 offset:2048
  v_mfma_f32_16x16x32_bf16 v[184:187], a[220:223], a[184:187], v[152:155]
  ds_read_b64_tr_b16 a[212:213], v233 offset:4096
  v_mfma_f32_16x16x32_bf16 v[156:159], a[216:219], a[180:183], v[156:159]
  ds_read_b64_tr_b16 a[214:215], v233 offset:6144
  v_mfma_f32_16x16x32_bf16 v[188:191], a[220:223], a[188:191], v[156:159]
  s_waitcnt lgkmcnt(8)
  v_mfma_f32_16x16x32_bf16 v[128:131], a[192:195], v[0:3], 0
  s_add_u32 s26, s51, 640
  ds_read_b64_tr_b16 a[216:217], v234 offset:0
  v_mfma_f32_16x16x32_bf16 v[128:131], a[196:199], v[16:19], v[128:131]
  s_add_u32 s39, s53, 131072
  ds_read_b64_tr_b16 a[218:219], v234 offset:2048
  v_cvt_pk_bf16_f32 v160, v160, v161
  v_mfma_f32_16x16x32_bf16 v[132:135], a[192:195], v[4:7], 0
  ds_read_b64_tr_b16 a[220:221], v234 offset:4096
  v_cvt_pk_bf16_f32 v161, v162, v163
  v_mfma_f32_16x16x32_bf16 v[132:135], a[196:199], v[20:23], v[132:135]
  s_waitcnt lgkmcnt(7)
  ds_read_b64_tr_b16 a[222:223], v234 offset:6144
  v_cvt_pk_bf16_f32 v162, v168, v169
  v_mfma_f32_16x16x32_bf16 v[136:139], a[200:203], v[0:3], 0
  s_add_u32 s27, s52, 640
  ds_read_b64_tr_b16 a[192:193], v231 offset:8192
  v_cvt_pk_bf16_f32 v163, v170, v171
  v_mfma_f32_16x16x32_bf16 v[136:139], a[204:207], v[16:19], v[136:139]
  ds_read_b64_tr_b16 a[194:195], v231 offset:10240
  v_cvt_pk_bf16_f32 v164, v164, v165
  v_mfma_f32_16x16x32_bf16 v[140:143], a[200:203], v[4:7], 0
  s_add_u32 m0, s50, 98304
  ds_read_b64_tr_b16 a[196:197], v231 offset:12288
  v_cvt_pk_bf16_f32 v165, v166, v167
  v_mfma_f32_16x16x32_bf16 v[140:143], a[204:207], v[20:23], v[140:143]
  s_waitcnt lgkmcnt(3)
  ds_read_b64_tr_b16 a[198:199], v231 offset:14336
  v_cvt_pk_bf16_f32 v166, v172, v173
  v_mfma_f32_16x16x32_bf16 v[144:147], a[208:211], v[0:3], 0
  ds_read_b64_tr_b16 a[200:201], v232 offset:8192
  v_cvt_pk_bf16_f32 v167, v174, v175
  v_mfma_f32_16x16x32_bf16 v[144:147], a[212:215], v[16:19], v[144:147]
  ds_read_b64_tr_b16 a[202:203], v232 offset:10240
  v_cvt_pk_bf16_f32 v176, v176, v177
  v_mfma_f32_16x16x32_bf16 v[148:151], a[208:211], v[4:7], 0
  ds_read_b64_tr_b16 a[204:205], v232 offset:12288
  buffer_load_dwordx4 v239, s[12:15], s26 offen offset:0 lds
  v_mfma_f32_16x16x32_bf16 v[148:151], a[212:215], v[20:23], v[148:151]
  ds_read_b64_tr_b16 a[206:207], v232 offset:14336
  v_cvt_pk_bf16_f32 v177, v178, v179
  v_mfma_f32_16x16x32_bf16 v[152:155], a[216:219], v[0:3], 0
  ds_read_b64_tr_b16 a[208:209], v233 offset:8192
  v_cvt_pk_bf16_f32 v178, v184, v185
  v_mfma_f32_16x16x32_bf16 v[152:155], a[220:223], v[16:19], v[152:155]
  ds_read_b64_tr_b16 a[210:211], v233 offset:10240
  buffer_load_dwordx4 v240, s[12:15], s26 offen offset:1024 lds
  v_mfma_f32_16x16x32_bf16 v[156:159], a[216:219], v[4:7], 0
  ds_read_b64_tr_b16 a[212:213], v233 offset:12288
  v_cvt_pk_bf16_f32 v179, v186, v187
  v_mfma_f32_16x16x32_bf16 v[156:159], a[220:223], v[20:23], v[156:159]
  s_waitcnt lgkmcnt(3)
  ds_read_b64_tr_b16 a[214:215], v233 offset:14336
  v_cvt_pk_bf16_f32 v180, v180, v181
  v_mfma_f32_16x16x32_bf16 v[128:131], a[192:195], v[32:35], v[128:131]
  ds_read_b64_tr_b16 a[216:217], v234 offset:8192
  v_cvt_pk_bf16_f32 v181, v182, v183
  v_mfma_f32_16x16x32_bf16 v[128:131], a[196:199], v[48:51], v[128:131]
  ds_read_b64_tr_b16 a[218:219], v234 offset:10240
  buffer_load_dwordx4 v241, s[12:15], s26 offen offset:2048 lds
  v_mfma_f32_16x16x32_bf16 v[132:135], a[192:195], v[36:39], v[132:135]
  ds_read_b64_tr_b16 a[220:221], v234 offset:12288
  v_cvt_pk_bf16_f32 v182, v188, v189
  v_mfma_f32_16x16x32_bf16 v[132:135], a[196:199], v[52:55], v[132:135]
  ds_read_b64_tr_b16 a[222:223], v234 offset:14336
  v_cvt_pk_bf16_f32 v183, v190, v191
  v_mfma_f32_16x16x32_bf16 v[136:139], a[200:203], v[32:35], v[136:139]
  ds_read_b64_tr_b16 a[192:193], v231 offset:16384
  buffer_load_dwordx4 v242, s[12:15], s26 offen offset:3072 lds
  v_mfma_f32_16x16x32_bf16 v[136:139], a[204:207], v[48:51], v[136:139]
  ds_read_b64_tr_b16 a[194:195], v231 offset:18432
  v_mfma_f32_16x16x32_bf16 v[140:143], a[200:203], v[36:39], v[140:143]
  ds_read_b64_tr_b16 a[196:197], v231 offset:20480
  v_mfma_f32_16x16x32_bf16 v[140:143], a[204:207], v[52:55], v[140:143]
  s_waitcnt lgkmcnt(3)
  ds_read_b64_tr_b16 a[198:199], v231 offset:22528
  v_mfma_f32_16x16x32_bf16 v[144:147], a[208:211], v[32:35], v[144:147]
  s_add_u32 m0, s50, 102400
  ds_read_b64_tr_b16 a[200:201], v232 offset:16384
  v_mfma_f32_16x16x32_bf16 v[144:147], a[212:215], v[48:51], v[144:147]
  ds_read_b64_tr_b16 a[202:203], v232 offset:18432
  v_mfma_f32_16x16x32_bf16 v[148:151], a[208:211], v[36:39], v[148:151]
  ds_read_b64_tr_b16 a[204:205], v232 offset:20480
  v_mfma_f32_16x16x32_bf16 v[148:151], a[212:215], v[52:55], v[148:151]
  ds_read_b64_tr_b16 a[206:207], v232 offset:22528
  buffer_load_dwordx4 v243, s[12:15], s26 offen offset:0 lds
  v_mfma_f32_16x16x32_bf16 v[152:155], a[216:219], v[32:35], v[152:155]
  ds_read_b64_tr_b16 a[208:209], v233 offset:16384
  v_mfma_f32_16x16x32_bf16 v[152:155], a[220:223], v[48:51], v[152:155]
  ds_read_b64_tr_b16 a[210:211], v233 offset:18432
  v_mfma_f32_16x16x32_bf16 v[156:159], a[216:219], v[36:39], v[156:159]
  ds_read_b64_tr_b16 a[212:213], v233 offset:20480
  buffer_load_dwordx4 v244, s[12:15], s26 offen offset:1024 lds
  v_mfma_f32_16x16x32_bf16 v[156:159], a[220:223], v[52:55], v[156:159]
  s_waitcnt lgkmcnt(3)
  ds_read_b64_tr_b16 a[214:215], v233 offset:22528
  v_mfma_f32_16x16x32_bf16 v[128:131], a[192:195], v[64:67], v[128:131]
  ds_read_b64_tr_b16 a[216:217], v234 offset:16384
  v_mfma_f32_16x16x32_bf16 v[128:131], a[196:199], v[80:83], v[128:131]
  ds_read_b64_tr_b16 a[218:219], v234 offset:18432
  v_mfma_f32_16x16x32_bf16 v[132:135], a[192:195], v[68:71], v[132:135]
  ds_read_b64_tr_b16 a[220:221], v234 offset:20480
  buffer_load_dwordx4 v245, s[12:15], s26 offen offset:2048 lds
  v_mfma_f32_16x16x32_bf16 v[132:135], a[196:199], v[84:87], v[132:135]
  ds_read_b64_tr_b16 a[222:223], v234 offset:22528
  v_mfma_f32_16x16x32_bf16 v[136:139], a[200:203], v[64:67], v[136:139]
  ds_read_b64_tr_b16 a[192:193], v231 offset:24576
  v_mfma_f32_16x16x32_bf16 v[136:139], a[204:207], v[80:83], v[136:139]
  ds_read_b64_tr_b16 a[194:195], v231 offset:26624
  buffer_load_dwordx4 v246, s[12:15], s26 offen offset:3072 lds
  v_mfma_f32_16x16x32_bf16 v[140:143], a[200:203], v[68:71], v[140:143]
  ds_read_b64_tr_b16 a[196:197], v231 offset:28672
  v_mfma_f32_16x16x32_bf16 v[140:143], a[204:207], v[84:87], v[140:143]
  s_waitcnt lgkmcnt(3)
  ds_read_b64_tr_b16 a[198:199], v231 offset:30720
  v_mfma_f32_16x16x32_bf16 v[144:147], a[208:211], v[64:67], v[144:147]
  s_add_u32 m0, s25, 131072
  ds_read_b64_tr_b16 a[200:201], v232 offset:24576
  v_mfma_f32_16x16x32_bf16 v[144:147], a[212:215], v[80:83], v[144:147]
  ds_read_b64_tr_b16 a[202:203], v232 offset:26624
  v_mfma_f32_16x16x32_bf16 v[148:151], a[208:211], v[68:71], v[148:151]
  ds_read_b64_tr_b16 a[204:205], v232 offset:28672
  v_mfma_f32_16x16x32_bf16 v[148:151], a[212:215], v[84:87], v[148:151]
  ds_read_b64_tr_b16 a[206:207], v232 offset:30720
  v_mfma_f32_16x16x32_bf16 v[152:155], a[216:219], v[64:67], v[152:155]
  ds_read_b64_tr_b16 a[208:209], v233 offset:24576
  buffer_load_dwordx4 v247, s[16:19], s27 offen offset:0 lds
  v_mfma_f32_16x16x32_bf16 v[152:155], a[220:223], v[80:83], v[152:155]
  ds_read_b64_tr_b16 a[210:211], v233 offset:26624
  v_mfma_f32_16x16x32_bf16 v[156:159], a[216:219], v[68:71], v[156:159]
  ds_read_b64_tr_b16 a[212:213], v233 offset:28672
  v_mfma_f32_16x16x32_bf16 v[156:159], a[220:223], v[84:87], v[156:159]
  s_waitcnt lgkmcnt(3)
  ds_read_b64_tr_b16 a[214:215], v233 offset:30720
  buffer_load_dwordx4 v248, s[16:19], s27 offen offset:1024 lds
  v_mfma_f32_16x16x32_bf16 v[128:131], a[192:195], v[96:99], v[128:131]
  ds_read_b64_tr_b16 a[216:217], v234 offset:24576
  v_mfma_f32_16x16x32_bf16 v[128:131], a[196:199], v[112:115], v[128:131]
  ds_read_b64_tr_b16 a[218:219], v234 offset:26624
  v_mfma_f32_16x16x32_bf16 v[132:135], a[192:195], v[100:103], v[132:135]
  ds_read_b64_tr_b16 a[220:221], v234 offset:28672
  v_mfma_f32_16x16x32_bf16 v[132:135], a[196:199], v[116:119], v[132:135]
  ds_read_b64_tr_b16 a[222:223], v234 offset:30720
  buffer_load_dwordx4 v249, s[16:19], s27 offen offset:2048 lds
  v_mfma_f32_16x16x32_bf16 v[136:139], a[200:203], v[96:99], v[136:139]
  ds_read_b64_tr_b16 a[192:193], v231 offset:32768
  v_mfma_f32_16x16x32_bf16 v[136:139], a[204:207], v[112:115], v[136:139]
  ds_read_b64_tr_b16 a[194:195], v231 offset:34816
  v_mfma_f32_16x16x32_bf16 v[140:143], a[200:203], v[100:103], v[140:143]
  ds_read_b64_tr_b16 a[196:197], v231 offset:36864
  buffer_load_dwordx4 v250, s[16:19], s27 offen offset:3072 lds
  v_mfma_f32_16x16x32_bf16 v[140:143], a[204:207], v[116:119], v[140:143]
  s_waitcnt lgkmcnt(3)
  ds_read_b64_tr_b16 a[198:199], v231 offset:38912
  v_mfma_f32_16x16x32_bf16 v[144:147], a[208:211], v[96:99], v[144:147]
  ds_read_b64_tr_b16 a[200:201], v232 offset:32768
  v_mfma_f32_16x16x32_bf16 v[144:147], a[212:215], v[112:115], v[144:147]
  ds_read_b64_tr_b16 a[202:203], v232 offset:34816
  v_mfma_f32_16x16x32_bf16 v[148:151], a[208:211], v[100:103], v[148:151]
  ds_read_b64_tr_b16 a[204:205], v232 offset:36864
  v_mfma_f32_16x16x32_bf16 v[148:151], a[212:215], v[116:119], v[148:151]
  ds_read_b64_tr_b16 a[206:207], v232 offset:38912
  v_mfma_f32_16x16x32_bf16 v[152:155], a[216:219], v[96:99], v[152:155]
  ds_read_b64_tr_b16 a[208:209], v233 offset:32768
  buffer_store_dwordx4 v[160:163], v251, s[8:11], s39 offen sc1
  v_mfma_f32_16x16x32_bf16 v[152:155], a[220:223], v[112:115], v[152:155]
  ds_read_b64_tr_b16 a[210:211], v233 offset:34816
  v_mfma_f32_16x16x32_bf16 v[156:159], a[216:219], v[100:103], v[156:159]
  ds_read_b64_tr_b16 a[212:213], v233 offset:36864
  v_mfma_f32_16x16x32_bf16 v[156:159], a[220:223], v[116:119], v[156:159]
  s_waitcnt lgkmcnt(3)
  ds_read_b64_tr_b16 a[214:215], v233 offset:38912
  v_mfma_f32_16x16x32_bf16 v[128:131], a[192:195], a[160:163], v[128:131]
  ds_read_b64_tr_b16 a[216:217], v234 offset:32768
  buffer_store_dwordx4 v[164:167], v252, s[8:11], s39 offen sc1
  v_mfma_f32_16x16x32_bf16 v[128:131], a[196:199], a[168:171], v[128:131]
  ds_read_b64_tr_b16 a[218:219], v234 offset:34816
  v_mfma_f32_16x16x32_bf16 v[132:135], a[192:195], a[164:167], v[132:135]
  ds_read_b64_tr_b16 a[220:221], v234 offset:36864
  v_mfma_f32_16x16x32_bf16 v[132:135], a[196:199], a[172:175], v[132:135]
  ds_read_b64_tr_b16 a[222:223], v234 offset:38912
  v_mfma_f32_16x16x32_bf16 v[136:139], a[200:203], a[160:163], v[136:139]
  ds_read_b64_tr_b16 a[192:193], v231 offset:40960
  buffer_store_dwordx4 v[176:179], v253, s[8:11], s39 offen sc1
  v_mfma_f32_16x16x32_bf16 v[136:139], a[204:207], a[168:171], v[136:139]
  ds_read_b64_tr_b16 a[194:195], v231 offset:43008
  v_mfma_f32_16x16x32_bf16 v[140:143], a[200:203], a[164:167], v[140:143]
  ds_read_b64_tr_b16 a[196:197], v231 offset:45056
  v_mfma_f32_16x16x32_bf16 v[140:143], a[204:207], a[172:175], v[140:143]
  s_waitcnt lgkmcnt(3)
  ds_read_b64_tr_b16 a[198:199], v231 offset:47104
  v_mfma_f32_16x16x32_bf16 v[144:147], a[208:211], a[160:163], v[144:147]
  ds_read_b64_tr_b16 a[200:201], v232 offset:40960
  buffer_store_dwordx4 v[180:183], v254, s[8:11], s39 offen sc1
  v_mfma_f32_16x16x32_bf16 v[144:147], a[212:215], a[168:171], v[144:147]
  ds_read_b64_tr_b16 a[202:203], v232 offset:43008
  v_mfma_f32_16x16x32_bf16 v[148:151], a[208:211], a[164:167], v[148:151]
  ds_read_b64_tr_b16 a[204:205], v232 offset:45056
  v_mfma_f32_16x16x32_bf16 v[148:151], a[212:215], a[172:175], v[148:151]
  ds_read_b64_tr_b16 a[206:207], v232 offset:47104
  v_mfma_f32_16x16x32_bf16 v[152:155], a[216:219], a[160:163], v[152:155]
  ds_read_b64_tr_b16 a[208:209], v233 offset:40960
  v_mfma_f32_16x16x32_bf16 v[152:155], a[220:223], a[168:171], v[152:155]
  ds_read_b64_tr_b16 a[210:211], v233 offset:43008
  v_mfma_f32_16x16x32_bf16 v[156:159], a[216:219], a[164:167], v[156:159]
  ds_read_b64_tr_b16 a[212:213], v233 offset:45056
  v_mfma_f32_16x16x32_bf16 v[156:159], a[220:223], a[172:175], v[156:159]
  s_waitcnt lgkmcnt(3)
  ds_read_b64_tr_b16 a[214:215], v233 offset:47104
  v_mfma_f32_16x16x32_bf16 v[128:131], a[192:195], a[176:179], v[128:131]
  ds_read_b64_tr_b16 a[216:217], v234 offset:40960
  v_mfma_f32_16x16x32_bf16 v[160:163], a[196:199], a[184:187], v[128:131]
  ds_read_b64_tr_b16 a[218:219], v234 offset:43008
  v_mfma_f32_16x16x32_bf16 v[132:135], a[192:195], a[180:183], v[132:135]
  ds_read_b64_tr_b16 a[220:221], v234 offset:45056
  v_mfma_f32_16x16x32_bf16 v[164:167], a[196:199], a[188:191], v[132:135]
  ds_read_b64_tr_b16 a[222:223], v234 offset:47104
  v_mfma_f32_16x16x32_bf16 v[136:139], a[200:203], a[176:179], v[136:139]
  v_mfma_f32_16x16x32_bf16 v[168:171], a[204:207], a[184:187], v[136:139]
  v_mfma_f32_16x16x32_bf16 v[140:143], a[200:203], a[180:183], v[140:143]
  v_mfma_f32_16x16x32_bf16 v[172:175], a[204:207], a[188:191], v[140:143]
  s_waitcnt vmcnt(20) lgkmcnt(0)
  s_barrier
  v_mfma_f32_16x16x32_bf16 v[144:147], a[208:211], a[176:179], v[144:147]
  ds_read_b64_tr_b16 a[192:193], v235 offset:0
  ds_read_b64_tr_b16 a[194:195], v235 offset:2048
  v_mfma_f32_16x16x32_bf16 v[176:179], a[212:215], a[184:187], v[144:147]
  ds_read_b64_tr_b16 a[196:197], v235 offset:4096
  ds_read_b64_tr_b16 a[198:199], v235 offset:6144
  v_mfma_f32_16x16x32_bf16 v[148:151], a[208:211], a[180:183], v[148:151]
  ds_read_b64_tr_b16 a[200:201], v236 offset:0
  ds_read_b64_tr_b16 a[202:203], v236 offset:2048
  v_mfma_f32_16x16x32_bf16 v[180:183], a[212:215], a[188:191], v[148:151]
  ds_read_b64_tr_b16 a[204:205], v236 offset:4096
  ds_read_b64_tr_b16 a[206:207], v236 offset:6144
  ds_read_b64_tr_b16 a[208:209], v237 offset:0
  v_mfma_f32_16x16x32_bf16 v[152:155], a[216:219], a[176:179], v[152:155]
  ds_read_b64_tr_b16 a[210:211], v237 offset:2048
  v_mfma_f32_16x16x32_bf16 v[184:187], a[220:223], a[184:187], v[152:155]
  ds_read_b64_tr_b16 a[212:213], v237 offset:4096
  v_mfma_f32_16x16x32_bf16 v[156:159], a[216:219], a[180:183], v[156:159]
  ds_read_b64_tr_b16 a[214:215], v237 offset:6144
  v_mfma_f32_16x16x32_bf16 v[188:191], a[220:223], a[188:191], v[156:159]
  s_waitcnt lgkmcnt(8)
  v_mfma_f32_16x16x32_bf16 v[128:131], a[192:195], v[0:3], 0
  s_add_u32 s26, s51, 768
  ds_read_b64_tr_b16 a[216:217], v238 offset:0
  v_mfma_f32_16x16x32_bf16 v[128:131], a[196:199], v[16:19], v[128:131]
  s_add_u32 s39, s53, 196608
  ds_read_b64_tr_b16 a[218:219], v238 offset:2048
  v_cvt_pk_bf16_f32 v160, v160, v161
  v_mfma_f32_16x16x32_bf16 v[132:135], a[192:195], v[4:7], 0
  ds_read_b64_tr_b16 a[220:221], v238 offset:4096
  v_cvt_pk_bf16_f32 v161, v162, v163
  v_mfma_f32_16x16x32_bf16 v[132:135], a[196:199], v[20:23], v[132:135]
  s_waitcnt lgkmcnt(7)
  ds_read_b64_tr_b16 a[222:223], v238 offset:6144
  v_cvt_pk_bf16_f32 v162, v168, v169
  v_mfma_f32_16x16x32_bf16 v[136:139], a[200:203], v[0:3], 0
  s_add_u32 s27, s52, 768
  ds_read_b64_tr_b16 a[192:193], v235 offset:8192
  v_cvt_pk_bf16_f32 v163, v170, v171
  v_mfma_f32_16x16x32_bf16 v[136:139], a[204:207], v[16:19], v[136:139]
  ds_read_b64_tr_b16 a[194:195], v235 offset:10240
  v_cvt_pk_bf16_f32 v164, v164, v165
  v_mfma_f32_16x16x32_bf16 v[140:143], a[200:203], v[4:7], 0
  s_add_u32 m0, s50, 0
  ds_read_b64_tr_b16 a[196:197], v235 offset:12288
  v_cvt_pk_bf16_f32 v165, v166, v167
  v_mfma_f32_16x16x32_bf16 v[140:143], a[204:207], v[20:23], v[140:143]
  s_waitcnt lgkmcnt(3)
  ds_read_b64_tr_b16 a[198:199], v235 offset:14336
  v_cvt_pk_bf16_f32 v166, v172, v173
  v_mfma_f32_16x16x32_bf16 v[144:147], a[208:211], v[0:3], 0
  ds_read_b64_tr_b16 a[200:201], v236 offset:8192
  v_cvt_pk_bf16_f32 v167, v174, v175
  v_mfma_f32_16x16x32_bf16 v[144:147], a[212:215], v[16:19], v[144:147]
  ds_read_b64_tr_b16 a[202:203], v236 offset:10240
  v_cvt_pk_bf16_f32 v176, v176, v177
  v_mfma_f32_16x16x32_bf16 v[148:151], a[208:211], v[4:7], 0
  ds_read_b64_tr_b16 a[204:205], v236 offset:12288
  buffer_load_dwordx4 v239, s[12:15], s26 offen offset:0 lds
  v_mfma_f32_16x16x32_bf16 v[148:151], a[212:215], v[20:23], v[148:151]
  ds_read_b64_tr_b16 a[206:207], v236 offset:14336
  v_cvt_pk_bf16_f32 v177, v178, v179
  v_mfma_f32_16x16x32_bf16 v[152:155], a[216:219], v[0:3], 0
  ds_read_b64_tr_b16 a[208:209], v237 offset:8192
  v_cvt_pk_bf16_f32 v178, v184, v185
  v_mfma_f32_16x16x32_bf16 v[152:155], a[220:223], v[16:19], v[152:155]
  ds_read_b64_tr_b16 a[210:211], v237 offset:10240
  buffer_load_dwordx4 v240, s[12:15], s26 offen offset:1024 lds
  v_mfma_f32_16x16x32_bf16 v[156:159], a[216:219], v[4:7], 0
  ds_read_b64_tr_b16 a[212:213], v237 offset:12288
  v_cvt_pk_bf16_f32 v179, v186, v187
  v_mfma_f32_16x16x32_bf16 v[156:159], a[220:223], v[20:23], v[156:159]
  s_waitcnt lgkmcnt(3)
  ds_read_b64_tr_b16 a[214:215], v237 offset:14336
  v_cvt_pk_bf16_f32 v180, v180, v181
  v_mfma_f32_16x16x32_bf16 v[128:131], a[192:195], v[32:35], v[128:131]
  ds_read_b64_tr_b16 a[216:217], v238 offset:8192
  v_cvt_pk_bf16_f32 v181, v182, v183
  v_mfma_f32_16x16x32_bf16 v[128:131], a[196:199], v[48:51], v[128:131]
  ds_read_b64_tr_b16 a[218:219], v238 offset:10240
  buffer_load_dwordx4 v241, s[12:15], s26 offen offset:2048 lds
  v_mfma_f32_16x16x32_bf16 v[132:135], a[192:195], v[36:39], v[132:135]
  ds_read_b64_tr_b16 a[220:221], v238 offset:12288
  v_cvt_pk_bf16_f32 v182, v188, v189
  v_mfma_f32_16x16x32_bf16 v[132:135], a[196:199], v[52:55], v[132:135]
  ds_read_b64_tr_b16 a[222:223], v238 offset:14336
  v_cvt_pk_bf16_f32 v183, v190, v191
  v_mfma_f32_16x16x32_bf16 v[136:139], a[200:203], v[32:35], v[136:139]
  ds_read_b64_tr_b16 a[192:193], v235 offset:16384
  buffer_load_dwordx4 v242, s[12:15], s26 offen offset:3072 lds
  v_mfma_f32_16x16x32_bf16 v[136:139], a[204:207], v[48:51], v[136:139]
  ds_read_b64_tr_b16 a[194:195], v235 offset:18432
  v_mfma_f32_16x16x32_bf16 v[140:143], a[200:203], v[36:39], v[140:143]
  ds_read_b64_tr_b16 a[196:197], v235 offset:20480
  v_mfma_f32_16x16x32_bf16 v[140:143], a[204:207], v[52:55], v[140:143]
  s_waitcnt lgkmcnt(3)
  ds_read_b64_tr_b16 a[198:199], v235 offset:22528
  v_mfma_f32_16x16x32_bf16 v[144:147], a[208:211], v[32:35], v[144:147]
  s_add_u32 m0, s50, 4096
  ds_read_b64_tr_b16 a[200:201], v236 offset:16384
  v_mfma_f32_16x16x32_bf16 v[144:147], a[212:215], v[48:51], v[144:147]
  ds_read_b64_tr_b16 a[202:203], v236 offset:18432
  v_mfma_f32_16x16x32_bf16 v[148:151], a[208:211], v[36:39], v[148:151]
  ds_read_b64_tr_b16 a[204:205], v236 offset:20480
  v_mfma_f32_16x16x32_bf16 v[148:151], a[212:215], v[52:55], v[148:151]
  ds_read_b64_tr_b16 a[206:207], v236 offset:22528
  buffer_load_dwordx4 v243, s[12:15], s26 offen offset:0 lds
  v_mfma_f32_16x16x32_bf16 v[152:155], a[216:219], v[32:35], v[152:155]
  ds_read_b64_tr_b16 a[208:209], v237 offset:16384
  v_mfma_f32_16x16x32_bf16 v[152:155], a[220:223], v[48:51], v[152:155]
  ds_read_b64_tr_b16 a[210:211], v237 offset:18432
  v_mfma_f32_16x16x32_bf16 v[156:159], a[216:219], v[36:39], v[156:159]
  ds_read_b64_tr_b16 a[212:213], v237 offset:20480
  buffer_load_dwordx4 v244, s[12:15], s26 offen offset:1024 lds
  v_mfma_f32_16x16x32_bf16 v[156:159], a[220:223], v[52:55], v[156:159]
  s_waitcnt lgkmcnt(3)
  ds_read_b64_tr_b16 a[214:215], v237 offset:22528
  v_mfma_f32_16x16x32_bf16 v[128:131], a[192:195], v[64:67], v[128:131]
  ds_read_b64_tr_b16 a[216:217], v238 offset:16384
  v_mfma_f32_16x16x32_bf16 v[128:131], a[196:199], v[80:83], v[128:131]
  ds_read_b64_tr_b16 a[218:219], v238 offset:18432
  v_mfma_f32_16x16x32_bf16 v[132:135], a[192:195], v[68:71], v[132:135]
  ds_read_b64_tr_b16 a[220:221], v238 offset:20480
  buffer_load_dwordx4 v245, s[12:15], s26 offen offset:2048 lds
  v_mfma_f32_16x16x32_bf16 v[132:135], a[196:199], v[84:87], v[132:135]
  ds_read_b64_tr_b16 a[222:223], v238 offset:22528
  v_mfma_f32_16x16x32_bf16 v[136:139], a[200:203], v[64:67], v[136:139]
  ds_read_b64_tr_b16 a[192:193], v235 offset:24576
  v_mfma_f32_16x16x32_bf16 v[136:139], a[204:207], v[80:83], v[136:139]
  ds_read_b64_tr_b16 a[194:195], v235 offset:26624
  buffer_load_dwordx4 v246, s[12:15], s26 offen offset:3072 lds
  v_mfma_f32_16x16x32_bf16 v[140:143], a[200:203], v[68:71], v[140:143]
  ds_read_b64_tr_b16 a[196:197], v235 offset:28672
  v_mfma_f32_16x16x32_bf16 v[140:143], a[204:207], v[84:87], v[140:143]
  s_waitcnt lgkmcnt(3)
  ds_read_b64_tr_b16 a[198:199], v235 offset:30720
  v_mfma_f32_16x16x32_bf16 v[144:147], a[208:211], v[64:67], v[144:147]
  s_add_u32 m0, s25, 32768
  ds_read_b64_tr_b16 a[200:201], v236 offset:24576
  v_mfma_f32_16x16x32_bf16 v[144:147], a[212:215], v[80:83], v[144:147]
  ds_read_b64_tr_b16 a[202:203], v236 offset:26624
  v_mfma_f32_16x16x32_bf16 v[148:151], a[208:211], v[68:71], v[148:151]
  ds_read_b64_tr_b16 a[204:205], v236 offset:28672
  v_mfma_f32_16x16x32_bf16 v[148:151], a[212:215], v[84:87], v[148:151]
  ds_read_b64_tr_b16 a[206:207], v236 offset:30720
  v_mfma_f32_16x16x32_bf16 v[152:155], a[216:219], v[64:67], v[152:155]
  ds_read_b64_tr_b16 a[208:209], v237 offset:24576
  buffer_load_dwordx4 v247, s[16:19], s27 offen offset:0 lds
  v_mfma_f32_16x16x32_bf16 v[152:155], a[220:223], v[80:83], v[152:155]
  ds_read_b64_tr_b16 a[210:211], v237 offset:26624
  v_mfma_f32_16x16x32_bf16 v[156:159], a[216:219], v[68:71], v[156:159]
  ds_read_b64_tr_b16 a[212:213], v237 offset:28672
  v_mfma_f32_16x16x32_bf16 v[156:159], a[220:223], v[84:87], v[156:159]
  s_waitcnt lgkmcnt(3)
  ds_read_b64_tr_b16 a[214:215], v237 offset:30720
  buffer_load_dwordx4 v248, s[16:19], s27 offen offset:1024 lds
  v_mfma_f32_16x16x32_bf16 v[128:131], a[192:195], v[96:99], v[128:131]
  ds_read_b64_tr_b16 a[216:217], v238 offset:24576
  v_mfma_f32_16x16x32_bf16 v[128:131], a[196:199], v[112:115], v[128:131]
  ds_read_b64_tr_b16 a[218:219], v238 offset:26624
  v_mfma_f32_16x16x32_bf16 v[132:135], a[192:195], v[100:103], v[132:135]
  ds_read_b64_tr_b16 a[220:221], v238 offset:28672
  v_mfma_f32_16x16x32_bf16 v[132:135], a[196:199], v[116:119], v[132:135]
  ds_read_b64_tr_b16 a[222:223], v238 offset:30720
  buffer_load_dwordx4 v249, s[16:19], s27 offen offset:2048 lds
  v_mfma_f32_16x16x32_bf16 v[136:139], a[200:203], v[96:99], v[136:139]
  ds_read_b64_tr_b16 a[192:193], v235 offset:32768
  v_mfma_f32_16x16x32_bf16 v[136:139], a[204:207], v[112:115], v[136:139]
  ds_read_b64_tr_b16 a[194:195], v235 offset:34816
  v_mfma_f32_16x16x32_bf16 v[140:143], a[200:203], v[100:103], v[140:143]
  ds_read_b64_tr_b16 a[196:197], v235 offset:36864
  buffer_load_dwordx4 v250, s[16:19], s27 offen offset:3072 lds
  v_mfma_f32_16x16x32_bf16 v[140:143], a[204:207], v[116:119], v[140:143]
  s_waitcnt lgkmcnt(3)
  ds_read_b64_tr_b16 a[198:199], v235 offset:38912
  v_mfma_f32_16x16x32_bf16 v[144:147], a[208:211], v[96:99], v[144:147]
  ds_read_b64_tr_b16 a[200:201], v236 offset:32768
  v_mfma_f32_16x16x32_bf16 v[144:147], a[212:215], v[112:115], v[144:147]
  ds_read_b64_tr_b16 a[202:203], v236 offset:34816
  v_mfma_f32_16x16x32_bf16 v[148:151], a[208:211], v[100:103], v[148:151]
  ds_read_b64_tr_b16 a[204:205], v236 offset:36864
  v_mfma_f32_16x16x32_bf16 v[148:151], a[212:215], v[116:119], v[148:151]
  ds_read_b64_tr_b16 a[206:207], v236 offset:38912
  v_mfma_f32_16x16x32_bf16 v[152:155], a[216:219], v[96:99], v[152:155]
  ds_read_b64_tr_b16 a[208:209], v237 offset:32768
  buffer_store_dwordx4 v[160:163], v251, s[8:11], s39 offen sc1
  v_mfma_f32_16x16x32_bf16 v[152:155], a[220:223], v[112:115], v[152:155]
  ds_read_b64_tr_b16 a[210:211], v237 offset:34816
  v_mfma_f32_16x16x32_bf16 v[156:159], a[216:219], v[100:103], v[156:159]
  ds_read_b64_tr_b16 a[212:213], v237 offset:36864
  v_mfma_f32_16x16x32_bf16 v[156:159], a[220:223], v[116:119], v[156:159]
  s_waitcnt lgkmcnt(3)
  ds_read_b64_tr_b16 a[214:215], v237 offset:38912
  v_mfma_f32_16x16x32_bf16 v[128:131], a[192:195], a[160:163], v[128:131]
  ds_read_b64_tr_b16 a[216:217], v238 offset:32768
  buffer_store_dwordx4 v[164:167], v252, s[8:11], s39 offen sc1
  v_mfma_f32_16x16x32_bf16 v[128:131], a[196:199], a[168:171], v[128:131]
  ds_read_b64_tr_b16 a[218:219], v238 offset:34816
  v_mfma_f32_16x16x32_bf16 v[132:135], a[192:195], a[164:167], v[132:135]
  ds_read_b64_tr_b16 a[220:221], v238 offset:36864
  v_mfma_f32_16x16x32_bf16 v[132:135], a[196:199], a[172:175], v[132:135]
  ds_read_b64_tr_b16 a[222:223], v238 offset:38912
  v_mfma_f32_16x16x32_bf16 v[136:139], a[200:203], a[160:163], v[136:139]
  ds_read_b64_tr_b16 a[192:193], v235 offset:40960
  buffer_store_dwordx4 v[176:179], v253, s[8:11], s39 offen sc1
  v_mfma_f32_16x16x32_bf16 v[136:139], a[204:207], a[168:171], v[136:139]
  ds_read_b64_tr_b16 a[194:195], v235 offset:43008
  v_mfma_f32_16x16x32_bf16 v[140:143], a[200:203], a[164:167], v[140:143]
  ds_read_b64_tr_b16 a[196:197], v235 offset:45056
  v_mfma_f32_16x16x32_bf16 v[140:143], a[204:207], a[172:175], v[140:143]
  s_waitcnt lgkmcnt(3)
  ds_read_b64_tr_b16 a[198:199], v235 offset:47104
  v_mfma_f32_16x16x32_bf16 v[144:147], a[208:211], a[160:163], v[144:147]
  ds_read_b64_tr_b16 a[200:201], v236 offset:40960
  buffer_store_dwordx4 v[180:183], v254, s[8:11], s39 offen sc1
  v_mfma_f32_16x16x32_bf16 v[144:147], a[212:215], a[168:171], v[144:147]
  ds_read_b64_tr_b16 a[202:203], v236 offset:43008
  v_mfma_f32_16x16x32_bf16 v[148:151], a[208:211], a[164:167], v[148:151]
  ds_read_b64_tr_b16 a[204:205], v236 offset:45056
  v_mfma_f32_16x16x32_bf16 v[148:151], a[212:215], a[172:175], v[148:151]
  ds_read_b64_tr_b16 a[206:207], v236 offset:47104
  v_mfma_f32_16x16x32_bf16 v[152:155], a[216:219], a[160:163], v[152:155]
  ds_read_b64_tr_b16 a[208:209], v237 offset:40960
  v_mfma_f32_16x16x32_bf16 v[152:155], a[220:223], a[168:171], v[152:155]
  ds_read_b64_tr_b16 a[210:211], v237 offset:43008
  v_mfma_f32_16x16x32_bf16 v[156:159], a[216:219], a[164:167], v[156:159]
  ds_read_b64_tr_b16 a[212:213], v237 offset:45056
  v_mfma_f32_16x16x32_bf16 v[156:159], a[220:223], a[172:175], v[156:159]
  s_waitcnt lgkmcnt(3)
  ds_read_b64_tr_b16 a[214:215], v237 offset:47104
  v_mfma_f32_16x16x32_bf16 v[128:131], a[192:195], a[176:179], v[128:131]
  ds_read_b64_tr_b16 a[216:217], v238 offset:40960
  v_mfma_f32_16x16x32_bf16 v[160:163], a[196:199], a[184:187], v[128:131]
  ds_read_b64_tr_b16 a[218:219], v238 offset:43008
  v_mfma_f32_16x16x32_bf16 v[132:135], a[192:195], a[180:183], v[132:135]
  ds_read_b64_tr_b16 a[220:221], v238 offset:45056
  v_mfma_f32_16x16x32_bf16 v[164:167], a[196:199], a[188:191], v[132:135]
  ds_read_b64_tr_b16 a[222:223], v238 offset:47104
  v_mfma_f32_16x16x32_bf16 v[136:139], a[200:203], a[176:179], v[136:139]
  v_mfma_f32_16x16x32_bf16 v[168:171], a[204:207], a[184:187], v[136:139]
  v_mfma_f32_16x16x32_bf16 v[140:143], a[200:203], a[180:183], v[140:143]
  v_mfma_f32_16x16x32_bf16 v[172:175], a[204:207], a[188:191], v[140:143]
  s_waitcnt vmcnt(20) lgkmcnt(0)
  s_barrier
  v_mfma_f32_16x16x32_bf16 v[144:147], a[208:211], a[176:179], v[144:147]
  ds_read_b64_tr_b16 a[192:193], v8 offset:0
  ds_read_b64_tr_b16 a[194:195], v8 offset:2048
  v_mfma_f32_16x16x32_bf16 v[176:179], a[212:215], a[184:187], v[144:147]
  ds_read_b64_tr_b16 a[196:197], v8 offset:4096
  ds_read_b64_tr_b16 a[198:199], v8 offset:6144
  v_mfma_f32_16x16x32_bf16 v[148:151], a[208:211], a[180:183], v[148:151]
  ds_read_b64_tr_b16 a[200:201], v9 offset:0
  ds_read_b64_tr_b16 a[202:203], v9 offset:2048
  v_mfma_f32_16x16x32_bf16 v[180:183], a[212:215], a[188:191], v[148:151]
  ds_read_b64_tr_b16 a[204:205], v9 offset:4096
  ds_read_b64_tr_b16 a[206:207], v9 offset:6144
  ds_read_b64_tr_b16 a[208:209], v10 offset:0
  v_mfma_f32_16x16x32_bf16 v[152:155], a[216:219], a[176:179], v[152:155]
  ds_read_b64_tr_b16 a[210:211], v10 offset:2048
  v_mfma_f32_16x16x32_bf16 v[184:187], a[220:223], a[184:187], v[152:155]
  ds_read_b64_tr_b16 a[212:213], v10 offset:4096
  v_mfma_f32_16x16x32_bf16 v[156:159], a[216:219], a[180:183], v[156:159]
  ds_read_b64_tr_b16 a[214:215], v10 offset:6144
  v_mfma_f32_16x16x32_bf16 v[188:191], a[220:223], a[188:191], v[156:159]
  s_waitcnt lgkmcnt(8)
  v_mfma_f32_16x16x32_bf16 v[128:131], a[192:195], v[0:3], 0
  s_add_u32 s39, s53, 262144
  ds_read_b64_tr_b16 a[216:217], v11 offset:0
  v_cvt_pk_bf16_f32 v160, v160, v161
  v_mfma_f32_16x16x32_bf16 v[128:131], a[196:199], v[16:19], v[128:131]
  ds_read_b64_tr_b16 a[218:219], v11 offset:2048
  v_cvt_pk_bf16_f32 v161, v162, v163
  v_mfma_f32_16x16x32_bf16 v[132:135], a[192:195], v[4:7], 0
  ds_read_b64_tr_b16 a[220:221], v11 offset:4096
  v_cvt_pk_bf16_f32 v162, v168, v169
  v_mfma_f32_16x16x32_bf16 v[132:135], a[196:199], v[20:23], v[132:135]
  s_waitcnt lgkmcnt(7)
  ds_read_b64_tr_b16 a[222:223], v11 offset:6144
  v_cvt_pk_bf16_f32 v163, v170, v171
  v_mfma_f32_16x16x32_bf16 v[136:139], a[200:203], v[0:3], 0
  ds_read_b64_tr_b16 a[192:193], v8 offset:8192
  v_cvt_pk_bf16_f32 v164, v164, v165
  v_mfma_f32_16x16x32_bf16 v[136:139], a[204:207], v[16:19], v[136:139]
  ds_read_b64_tr_b16 a[194:195], v8 offset:10240
  v_cvt_pk_bf16_f32 v165, v166, v167
  v_mfma_f32_16x16x32_bf16 v[140:143], a[200:203], v[4:7], 0
  ds_read_b64_tr_b16 a[196:197], v8 offset:12288
  v_cvt_pk_bf16_f32 v166, v172, v173
  v_mfma_f32_16x16x32_bf16 v[140:143], a[204:207], v[20:23], v[140:143]
  s_waitcnt lgkmcnt(3)
  ds_read_b64_tr_b16 a[198:199], v8 offset:14336
  v_cvt_pk_bf16_f32 v167, v174, v175
  v_mfma_f32_16x16x32_bf16 v[144:147], a[208:211], v[0:3], 0
  ds_read_b64_tr_b16 a[200:201], v9 offset:8192
  v_cvt_pk_bf16_f32 v176, v176, v177
  v_mfma_f32_16x16x32_bf16 v[144:147], a[212:215], v[16:19], v[144:147]
  ds_read_b64_tr_b16 a[202:203], v9 offset:10240
  v_cvt_pk_bf16_f32 v177, v178, v179
  v_mfma_f32_16x16x32_bf16 v[148:151], a[208:211], v[4:7], 0
  ds_read_b64_tr_b16 a[204:205], v9 offset:12288
  v_cvt_pk_bf16_f32 v178, v184, v185
  v_mfma_f32_16x16x32_bf16 v[148:151], a[212:215], v[20:23], v[148:151]
  ds_read_b64_tr_b16 a[206:207], v9 offset:14336
  v_cvt_pk_bf16_f32 v179, v186, v187
  v_mfma_f32_16x16x32_bf16 v[152:155], a[216:219], v[0:3], 0
  ds_read_b64_tr_b16 a[208:209], v10 offset:8192
  v_cvt_pk_bf16_f32 v180, v180, v181
  v_mfma_f32_16x16x32_bf16 v[152:155], a[220:223], v[16:19], v[152:155]
  ds_read_b64_tr_b16 a[210:211], v10 offset:10240
  v_cvt_pk_bf16_f32 v181, v182, v183
  v_mfma_f32_16x16x32_bf16 v[156:159], a[216:219], v[4:7], 0
  ds_read_b64_tr_b16 a[212:213], v10 offset:12288
  v_cvt_pk_bf16_f32 v182, v188, v189
  v_mfma_f32_16x16x32_bf16 v[156:159], a[220:223], v[20:23], v[156:159]
  s_waitcnt lgkmcnt(3)
  ds_read_b64_tr_b16 a[214:215], v10 offset:14336
  v_cvt_pk_bf16_f32 v183, v190, v191
  v_mfma_f32_16x16x32_bf16 v[128:131], a[192:195], v[32:35], v[128:131]
  ds_read_b64_tr_b16 a[216:217], v11 offset:8192
  v_mfma_f32_16x16x32_bf16 v[128:131], a[196:199], v[48:51], v[128:131]
  ds_read_b64_tr_b16 a[218:219], v11 offset:10240
  v_mfma_f32_16x16x32_bf16 v[132:135], a[192:195], v[36:39], v[132:135]
  ds_read_b64_tr_b16 a[220:221], v11 offset:12288
  v_mfma_f32_16x16x32_bf16 v[132:135], a[196:199], v[52:55], v[132:135]
  ds_read_b64_tr_b16 a[222:223], v11 offset:14336
  v_mfma_f32_16x16x32_bf16 v[136:139], a[200:203], v[32:35], v[136:139]
  ds_read_b64_tr_b16 a[192:193], v8 offset:16384
  v_mfma_f32_16x16x32_bf16 v[136:139], a[204:207], v[48:51], v[136:139]
  ds_read_b64_tr_b16 a[194:195], v8 offset:18432
  v_mfma_f32_16x16x32_bf16 v[140:143], a[200:203], v[36:39], v[140:143]
  ds_read_b64_tr_b16 a[196:197], v8 offset:20480
  v_mfma_f32_16x16x32_bf16 v[140:143], a[204:207], v[52:55], v[140:143]
  s_waitcnt lgkmcnt(3)
  ds_read_b64_tr_b16 a[198:199], v8 offset:22528
  v_mfma_f32_16x16x32_bf16 v[144:147], a[208:211], v[32:35], v[144:147]
  ds_read_b64_tr_b16 a[200:201], v9 offset:16384
  v_mfma_f32_16x16x32_bf16 v[144:147], a[212:215], v[48:51], v[144:147]
  ds_read_b64_tr_b16 a[202:203], v9 offset:18432
  v_mfma_f32_16x16x32_bf16 v[148:151], a[208:211], v[36:39], v[148:151]
  ds_read_b64_tr_b16 a[204:205], v9 offset:20480
  v_mfma_f32_16x16x32_bf16 v[148:151], a[212:215], v[52:55], v[148:151]
  ds_read_b64_tr_b16 a[206:207], v9 offset:22528
  v_mfma_f32_16x16x32_bf16 v[152:155], a[216:219], v[32:35], v[152:155]
  ds_read_b64_tr_b16 a[208:209], v10 offset:16384
  v_mfma_f32_16x16x32_bf16 v[152:155], a[220:223], v[48:51], v[152:155]
  ds_read_b64_tr_b16 a[210:211], v10 offset:18432
  v_mfma_f32_16x16x32_bf16 v[156:159], a[216:219], v[36:39], v[156:159]
  ds_read_b64_tr_b16 a[212:213], v10 offset:20480
  v_mfma_f32_16x16x32_bf16 v[156:159], a[220:223], v[52:55], v[156:159]
  s_waitcnt lgkmcnt(3)
  ds_read_b64_tr_b16 a[214:215], v10 offset:22528
  v_mfma_f32_16x16x32_bf16 v[128:131], a[192:195], v[64:67], v[128:131]
  ds_read_b64_tr_b16 a[216:217], v11 offset:16384
  v_mfma_f32_16x16x32_bf16 v[128:131], a[196:199], v[80:83], v[128:131]
  ds_read_b64_tr_b16 a[218:219], v11 offset:18432
  v_mfma_f32_16x16x32_bf16 v[132:135], a[192:195], v[68:71], v[132:135]
  ds_read_b64_tr_b16 a[220:221], v11 offset:20480
  v_mfma_f32_16x16x32_bf16 v[132:135], a[196:199], v[84:87], v[132:135]
  ds_read_b64_tr_b16 a[222:223], v11 offset:22528
  v_mfma_f32_16x16x32_bf16 v[136:139], a[200:203], v[64:67], v[136:139]
  ds_read_b64_tr_b16 a[192:193], v8 offset:24576
  v_mfma_f32_16x16x32_bf16 v[136:139], a[204:207], v[80:83], v[136:139]
  ds_read_b64_tr_b16 a[194:195], v8 offset:26624
  v_mfma_f32_16x16x32_bf16 v[140:143], a[200:203], v[68:71], v[140:143]
  ds_read_b64_tr_b16 a[196:197], v8 offset:28672
  v_mfma_f32_16x16x32_bf16 v[140:143], a[204:207], v[84:87], v[140:143]
  s_waitcnt lgkmcnt(3)
  ds_read_b64_tr_b16 a[198:199], v8 offset:30720
  v_mfma_f32_16x16x32_bf16 v[144:147], a[208:211], v[64:67], v[144:147]
  ds_read_b64_tr_b16 a[200:201], v9 offset:24576
  v_mfma_f32_16x16x32_bf16 v[144:147], a[212:215], v[80:83], v[144:147]
  ds_read_b64_tr_b16 a[202:203], v9 offset:26624
  v_mfma_f32_16x16x32_bf16 v[148:151], a[208:211], v[68:71], v[148:151]
  ds_read_b64_tr_b16 a[204:205], v9 offset:28672
  v_mfma_f32_16x16x32_bf16 v[148:151], a[212:215], v[84:87], v[148:151]
  ds_read_b64_tr_b16 a[206:207], v9 offset:30720
  v_mfma_f32_16x16x32_bf16 v[152:155], a[216:219], v[64:67], v[152:155]
  ds_read_b64_tr_b16 a[208:209], v10 offset:24576
  v_mfma_f32_16x16x32_bf16 v[152:155], a[220:223], v[80:83], v[152:155]
  ds_read_b64_tr_b16 a[210:211], v10 offset:26624
  v_mfma_f32_16x16x32_bf16 v[156:159], a[216:219], v[68:71], v[156:159]
  ds_read_b64_tr_b16 a[212:213], v10 offset:28672
  v_mfma_f32_16x16x32_bf16 v[156:159], a[220:223], v[84:87], v[156:159]
  s_waitcnt lgkmcnt(3)
  ds_read_b64_tr_b16 a[214:215], v10 offset:30720
  v_mfma_f32_16x16x32_bf16 v[128:131], a[192:195], v[96:99], v[128:131]
  ds_read_b64_tr_b16 a[216:217], v11 offset:24576
  v_mfma_f32_16x16x32_bf16 v[128:131], a[196:199], v[112:115], v[128:131]
  ds_read_b64_tr_b16 a[218:219], v11 offset:26624
  v_mfma_f32_16x16x32_bf16 v[132:135], a[192:195], v[100:103], v[132:135]
  ds_read_b64_tr_b16 a[220:221], v11 offset:28672
  v_mfma_f32_16x16x32_bf16 v[132:135], a[196:199], v[116:119], v[132:135]
  ds_read_b64_tr_b16 a[222:223], v11 offset:30720
  v_mfma_f32_16x16x32_bf16 v[136:139], a[200:203], v[96:99], v[136:139]
  ds_read_b64_tr_b16 a[192:193], v8 offset:32768
  v_mfma_f32_16x16x32_bf16 v[136:139], a[204:207], v[112:115], v[136:139]
  ds_read_b64_tr_b16 a[194:195], v8 offset:34816
  v_mfma_f32_16x16x32_bf16 v[140:143], a[200:203], v[100:103], v[140:143]
  ds_read_b64_tr_b16 a[196:197], v8 offset:36864
  v_mfma_f32_16x16x32_bf16 v[140:143], a[204:207], v[116:119], v[140:143]
  s_waitcnt lgkmcnt(3)
  ds_read_b64_tr_b16 a[198:199], v8 offset:38912
  v_mfma_f32_16x16x32_bf16 v[144:147], a[208:211], v[96:99], v[144:147]
  ds_read_b64_tr_b16 a[200:201], v9 offset:32768
  v_mfma_f32_16x16x32_bf16 v[144:147], a[212:215], v[112:115], v[144:147]
  ds_read_b64_tr_b16 a[202:203], v9 offset:34816
  v_mfma_f32_16x16x32_bf16 v[148:151], a[208:211], v[100:103], v[148:151]
  ds_read_b64_tr_b16 a[204:205], v9 offset:36864
  v_mfma_f32_16x16x32_bf16 v[148:151], a[212:215], v[116:119], v[148:151]
  ds_read_b64_tr_b16 a[206:207], v9 offset:38912
  v_mfma_f32_16x16x32_bf16 v[152:155], a[216:219], v[96:99], v[152:155]
  ds_read_b64_tr_b16 a[208:209], v10 offset:32768
  buffer_store_dwordx4 v[160:163], v251, s[8:11], s39 offen sc1
  v_mfma_f32_16x16x32_bf16 v[152:155], a[220:223], v[112:115], v[152:155]
  ds_read_b64_tr_b16 a[210:211], v10 offset:34816
  v_mfma_f32_16x16x32_bf16 v[156:159], a[216:219], v[100:103], v[156:159]
  ds_read_b64_tr_b16 a[212:213], v10 offset:36864
  v_mfma_f32_16x16x32_bf16 v[156:159], a[220:223], v[116:119], v[156:159]
  s_waitcnt lgkmcnt(3)
  ds_read_b64_tr_b16 a[214:215], v10 offset:38912
  v_mfma_f32_16x16x32_bf16 v[128:131], a[192:195], a[160:163], v[128:131]
  ds_read_b64_tr_b16 a[216:217], v11 offset:32768
  buffer_store_dwordx4 v[164:167], v252, s[8:11], s39 offen sc1
  v_mfma_f32_16x16x32_bf16 v[128:131], a[196:199], a[168:171], v[128:131]
  ds_read_b64_tr_b16 a[218:219], v11 offset:34816
  v_mfma_f32_16x16x32_bf16 v[132:135], a[192:195], a[164:167], v[132:135]
  ds_read_b64_tr_b16 a[220:221], v11 offset:36864
  v_mfma_f32_16x16x32_bf16 v[132:135], a[196:199], a[172:175], v[132:135]
  ds_read_b64_tr_b16 a[222:223], v11 offset:38912
  v_mfma_f32_16x16x32_bf16 v[136:139], a[200:203], a[160:163], v[136:139]
  ds_read_b64_tr_b16 a[192:193], v8 offset:40960
  buffer_store_dwordx4 v[176:179], v253, s[8:11], s39 offen sc1
  v_mfma_f32_16x16x32_bf16 v[136:139], a[204:207], a[168:171], v[136:139]
  ds_read_b64_tr_b16 a[194:195], v8 offset:43008
  v_mfma_f32_16x16x32_bf16 v[140:143], a[200:203], a[164:167], v[140:143]
  ds_read_b64_tr_b16 a[196:197], v8 offset:45056
  v_mfma_f32_16x16x32_bf16 v[140:143], a[204:207], a[172:175], v[140:143]
  s_waitcnt lgkmcnt(3)
  ds_read_b64_tr_b16 a[198:199], v8 offset:47104
  v_mfma_f32_16x16x32_bf16 v[144:147], a[208:211], a[160:163], v[144:147]
  ds_read_b64_tr_b16 a[200:201], v9 offset:40960
  buffer_store_dwordx4 v[180:183], v254, s[8:11], s39 offen sc1
  v_mfma_f32_16x16x32_bf16 v[144:147], a[212:215], a[168:171], v[144:147]
  ds_read_b64_tr_b16 a[202:203], v9 offset:43008
  v_mfma_f32_16x16x32_bf16 v[148:151], a[208:211], a[164:167], v[148:151]
  ds_read_b64_tr_b16 a[204:205], v9 offset:45056
  v_mfma_f32_16x16x32_bf16 v[148:151], a[212:215], a[172:175], v[148:151]
  ds_read_b64_tr_b16 a[206:207], v9 offset:47104
  v_mfma_f32_16x16x32_bf16 v[152:155], a[216:219], a[160:163], v[152:155]
  ds_read_b64_tr_b16 a[208:209], v10 offset:40960
  v_mfma_f32_16x16x32_bf16 v[152:155], a[220:223], a[168:171], v[152:155]
  ds_read_b64_tr_b16 a[210:211], v10 offset:43008
  v_mfma_f32_16x16x32_bf16 v[156:159], a[216:219], a[164:167], v[156:159]
  ds_read_b64_tr_b16 a[212:213], v10 offset:45056
  v_mfma_f32_16x16x32_bf16 v[156:159], a[220:223], a[172:175], v[156:159]
  s_waitcnt lgkmcnt(3)
  ds_read_b64_tr_b16 a[214:215], v10 offset:47104
  v_mfma_f32_16x16x32_bf16 v[128:131], a[192:195], a[176:179], v[128:131]
  ds_read_b64_tr_b16 a[216:217], v11 offset:40960
  v_mfma_f32_16x16x32_bf16 v[160:163], a[196:199], a[184:187], v[128:131]
  ds_read_b64_tr_b16 a[218:219], v11 offset:43008
  v_mfma_f32_16x16x32_bf16 v[132:135], a[192:195], a[180:183], v[132:135]
  ds_read_b64_tr_b16 a[220:221], v11 offset:45056
  v_mfma_f32_16x16x32_bf16 v[164:167], a[196:199], a[188:191], v[132:135]
  ds_read_b64_tr_b16 a[222:223], v11 offset:47104
  v_mfma_f32_16x16x32_bf16 v[136:139], a[200:203], a[176:179], v[136:139]
  v_mfma_f32_16x16x32_bf16 v[168:171], a[204:207], a[184:187], v[136:139]
  v_mfma_f32_16x16x32_bf16 v[140:143], a[200:203], a[180:183], v[140:143]
  v_mfma_f32_16x16x32_bf16 v[172:175], a[204:207], a[188:191], v[140:143]
  s_waitcnt vmcnt(8) lgkmcnt(0)
  s_barrier
  v_mfma_f32_16x16x32_bf16 v[144:147], a[208:211], a[176:179], v[144:147]
  ds_read_b64_tr_b16 a[192:193], v231 offset:0
  ds_read_b64_tr_b16 a[194:195], v231 offset:2048
  v_mfma_f32_16x16x32_bf16 v[176:179], a[212:215], a[184:187], v[144:147]
  ds_read_b64_tr_b16 a[196:197], v231 offset:4096
  ds_read_b64_tr_b16 a[198:199], v231 offset:6144
  v_mfma_f32_16x16x32_bf16 v[148:151], a[208:211], a[180:183], v[148:151]
  ds_read_b64_tr_b16 a[200:201], v232 offset:0
  ds_read_b64_tr_b16 a[202:203], v232 offset:2048
  v_mfma_f32_16x16x32_bf16 v[180:183], a[212:215], a[188:191], v[148:151]
  ds_read_b64_tr_b16 a[204:205], v232 offset:4096
  ds_read_b64_tr_b16 a[206:207], v232 offset:6144
  ds_read_b64_tr_b16 a[208:209], v233 offset:0
  v_mfma_f32_16x16x32_bf16 v[152:155], a[216:219], a[176:179], v[152:155]
  ds_read_b64_tr_b16 a[210:211], v233 offset:2048
  v_mfma_f32_16x16x32_bf16 v[184:187], a[220:223], a[184:187], v[152:155]
  ds_read_b64_tr_b16 a[212:213], v233 offset:4096
  v_mfma_f32_16x16x32_bf16 v[156:159], a[216:219], a[180:183], v[156:159]
  ds_read_b64_tr_b16 a[214:215], v233 offset:6144
  v_mfma_f32_16x16x32_bf16 v[188:191], a[220:223], a[188:191], v[156:159]
  s_waitcnt lgkmcnt(8)
  v_mfma_f32_16x16x32_bf16 v[128:131], a[192:195], v[0:3], 0
  s_add_u32 s39, s53, 327680
  ds_read_b64_tr_b16 a[216:217], v234 offset:0
  v_cvt_pk_bf16_f32 v160, v160, v161
  v_mfma_f32_16x16x32_bf16 v[128:131], a[196:199], v[16:19], v[128:131]
  ds_read_b64_tr_b16 a[218:219], v234 offset:2048
  v_cvt_pk_bf16_f32 v161, v162, v163
  v_mfma_f32_16x16x32_bf16 v[132:135], a[192:195], v[4:7], 0
  ds_read_b64_tr_b16 a[220:221], v234 offset:4096
  v_cvt_pk_bf16_f32 v162, v168, v169
  v_mfma_f32_16x16x32_bf16 v[132:135], a[196:199], v[20:23], v[132:135]
  s_waitcnt lgkmcnt(7)
  ds_read_b64_tr_b16 a[222:223], v234 offset:6144
  v_cvt_pk_bf16_f32 v163, v170, v171
  v_mfma_f32_16x16x32_bf16 v[136:139], a[200:203], v[0:3], 0
  ds_read_b64_tr_b16 a[192:193], v231 offset:8192
  v_cvt_pk_bf16_f32 v164, v164, v165
  v_mfma_f32_16x16x32_bf16 v[136:139], a[204:207], v[16:19], v[136:139]
  ds_read_b64_tr_b16 a[194:195], v231 offset:10240
  v_cvt_pk_bf16_f32 v165, v166, v167
  v_mfma_f32_16x16x32_bf16 v[140:143], a[200:203], v[4:7], 0
  ds_read_b64_tr_b16 a[196:197], v231 offset:12288
  v_cvt_pk_bf16_f32 v166, v172, v173
  v_mfma_f32_16x16x32_bf16 v[140:143], a[204:207], v[20:23], v[140:143]
  s_waitcnt lgkmcnt(3)
  ds_read_b64_tr_b16 a[198:199], v231 offset:14336
  v_cvt_pk_bf16_f32 v167, v174, v175
  v_mfma_f32_16x16x32_bf16 v[144:147], a[208:211], v[0:3], 0
  ds_read_b64_tr_b16 a[200:201], v232 offset:8192
  v_cvt_pk_bf16_f32 v176, v176, v177
  v_mfma_f32_16x16x32_bf16 v[144:147], a[212:215], v[16:19], v[144:147]
  ds_read_b64_tr_b16 a[202:203], v232 offset:10240
  v_cvt_pk_bf16_f32 v177, v178, v179
  v_mfma_f32_16x16x32_bf16 v[148:151], a[208:211], v[4:7], 0
  ds_read_b64_tr_b16 a[204:205], v232 offset:12288
  v_cvt_pk_bf16_f32 v178, v184, v185
  v_mfma_f32_16x16x32_bf16 v[148:151], a[212:215], v[20:23], v[148:151]
  ds_read_b64_tr_b16 a[206:207], v232 offset:14336
  v_cvt_pk_bf16_f32 v179, v186, v187
  v_mfma_f32_16x16x32_bf16 v[152:155], a[216:219], v[0:3], 0
  ds_read_b64_tr_b16 a[208:209], v233 offset:8192
  v_cvt_pk_bf16_f32 v180, v180, v181
  v_mfma_f32_16x16x32_bf16 v[152:155], a[220:223], v[16:19], v[152:155]
  ds_read_b64_tr_b16 a[210:211], v233 offset:10240
  v_cvt_pk_bf16_f32 v181, v182, v183
  v_mfma_f32_16x16x32_bf16 v[156:159], a[216:219], v[4:7], 0
  ds_read_b64_tr_b16 a[212:213], v233 offset:12288
  v_cvt_pk_bf16_f32 v182, v188, v189
  v_mfma_f32_16x16x32_bf16 v[156:159], a[220:223], v[20:23], v[156:159]
  s_waitcnt lgkmcnt(3)
  ds_read_b64_tr_b16 a[214:215], v233 offset:14336
  v_cvt_pk_bf16_f32 v183, v190, v191
  v_mfma_f32_16x16x32_bf16 v[128:131], a[192:195], v[32:35], v[128:131]
  ds_read_b64_tr_b16 a[216:217], v234 offset:8192
  v_mfma_f32_16x16x32_bf16 v[128:131], a[196:199], v[48:51], v[128:131]
  ds_read_b64_tr_b16 a[218:219], v234 offset:10240
  v_mfma_f32_16x16x32_bf16 v[132:135], a[192:195], v[36:39], v[132:135]
  ds_read_b64_tr_b16 a[220:221], v234 offset:12288
  v_mfma_f32_16x16x32_bf16 v[132:135], a[196:199], v[52:55], v[132:135]
  ds_read_b64_tr_b16 a[222:223], v234 offset:14336
  v_mfma_f32_16x16x32_bf16 v[136:139], a[200:203], v[32:35], v[136:139]
  ds_read_b64_tr_b16 a[192:193], v231 offset:16384
  v_mfma_f32_16x16x32_bf16 v[136:139], a[204:207], v[48:51], v[136:139]
  ds_read_b64_tr_b16 a[194:195], v231 offset:18432
  v_mfma_f32_16x16x32_bf16 v[140:143], a[200:203], v[36:39], v[140:143]
  ds_read_b64_tr_b16 a[196:197], v231 offset:20480
  v_mfma_f32_16x16x32_bf16 v[140:143], a[204:207], v[52:55], v[140:143]
  s_waitcnt lgkmcnt(3)
  ds_read_b64_tr_b16 a[198:199], v231 offset:22528
  v_mfma_f32_16x16x32_bf16 v[144:147], a[208:211], v[32:35], v[144:147]
  ds_read_b64_tr_b16 a[200:201], v232 offset:16384
  v_mfma_f32_16x16x32_bf16 v[144:147], a[212:215], v[48:51], v[144:147]
  ds_read_b64_tr_b16 a[202:203], v232 offset:18432
  v_mfma_f32_16x16x32_bf16 v[148:151], a[208:211], v[36:39], v[148:151]
  ds_read_b64_tr_b16 a[204:205], v232 offset:20480
  v_mfma_f32_16x16x32_bf16 v[148:151], a[212:215], v[52:55], v[148:151]
  ds_read_b64_tr_b16 a[206:207], v232 offset:22528
  v_mfma_f32_16x16x32_bf16 v[152:155], a[216:219], v[32:35], v[152:155]
  ds_read_b64_tr_b16 a[208:209], v233 offset:16384
  v_mfma_f32_16x16x32_bf16 v[152:155], a[220:223], v[48:51], v[152:155]
  ds_read_b64_tr_b16 a[210:211], v233 offset:18432
  v_mfma_f32_16x16x32_bf16 v[156:159], a[216:219], v[36:39], v[156:159]
  ds_read_b64_tr_b16 a[212:213], v233 offset:20480
  v_mfma_f32_16x16x32_bf16 v[156:159], a[220:223], v[52:55], v[156:159]
  s_waitcnt lgkmcnt(3)
  ds_read_b64_tr_b16 a[214:215], v233 offset:22528
  v_mfma_f32_16x16x32_bf16 v[128:131], a[192:195], v[64:67], v[128:131]
  ds_read_b64_tr_b16 a[216:217], v234 offset:16384
  v_mfma_f32_16x16x32_bf16 v[128:131], a[196:199], v[80:83], v[128:131]
  ds_read_b64_tr_b16 a[218:219], v234 offset:18432
  v_mfma_f32_16x16x32_bf16 v[132:135], a[192:195], v[68:71], v[132:135]
  ds_read_b64_tr_b16 a[220:221], v234 offset:20480
  v_mfma_f32_16x16x32_bf16 v[132:135], a[196:199], v[84:87], v[132:135]
  ds_read_b64_tr_b16 a[222:223], v234 offset:22528
  v_mfma_f32_16x16x32_bf16 v[136:139], a[200:203], v[64:67], v[136:139]
  ds_read_b64_tr_b16 a[192:193], v231 offset:24576
  v_mfma_f32_16x16x32_bf16 v[136:139], a[204:207], v[80:83], v[136:139]
  ds_read_b64_tr_b16 a[194:195], v231 offset:26624
  v_mfma_f32_16x16x32_bf16 v[140:143], a[200:203], v[68:71], v[140:143]
  ds_read_b64_tr_b16 a[196:197], v231 offset:28672
  v_mfma_f32_16x16x32_bf16 v[140:143], a[204:207], v[84:87], v[140:143]
  s_waitcnt lgkmcnt(3)
  ds_read_b64_tr_b16 a[198:199], v231 offset:30720
  v_mfma_f32_16x16x32_bf16 v[144:147], a[208:211], v[64:67], v[144:147]
  ds_read_b64_tr_b16 a[200:201], v232 offset:24576
  v_mfma_f32_16x16x32_bf16 v[144:147], a[212:215], v[80:83], v[144:147]
  ds_read_b64_tr_b16 a[202:203], v232 offset:26624
  v_mfma_f32_16x16x32_bf16 v[148:151], a[208:211], v[68:71], v[148:151]
  ds_read_b64_tr_b16 a[204:205], v232 offset:28672
  v_mfma_f32_16x16x32_bf16 v[148:151], a[212:215], v[84:87], v[148:151]
  ds_read_b64_tr_b16 a[206:207], v232 offset:30720
  v_mfma_f32_16x16x32_bf16 v[152:155], a[216:219], v[64:67], v[152:155]
  ds_read_b64_tr_b16 a[208:209], v233 offset:24576
  v_mfma_f32_16x16x32_bf16 v[152:155], a[220:223], v[80:83], v[152:155]
  ds_read_b64_tr_b16 a[210:211], v233 offset:26624
  v_mfma_f32_16x16x32_bf16 v[156:159], a[216:219], v[68:71], v[156:159]
  ds_read_b64_tr_b16 a[212:213], v233 offset:28672
  v_mfma_f32_16x16x32_bf16 v[156:159], a[220:223], v[84:87], v[156:159]
  s_waitcnt lgkmcnt(3)
  ds_read_b64_tr_b16 a[214:215], v233 offset:30720
  v_mfma_f32_16x16x32_bf16 v[128:131], a[192:195], v[96:99], v[128:131]
  ds_read_b64_tr_b16 a[216:217], v234 offset:24576
  v_mfma_f32_16x16x32_bf16 v[128:131], a[196:199], v[112:115], v[128:131]
  ds_read_b64_tr_b16 a[218:219], v234 offset:26624
  v_mfma_f32_16x16x32_bf16 v[132:135], a[192:195], v[100:103], v[132:135]
  ds_read_b64_tr_b16 a[220:221], v234 offset:28672
  v_mfma_f32_16x16x32_bf16 v[132:135], a[196:199], v[116:119], v[132:135]
  ds_read_b64_tr_b16 a[222:223], v234 offset:30720
  v_mfma_f32_16x16x32_bf16 v[136:139], a[200:203], v[96:99], v[136:139]
  ds_read_b64_tr_b16 a[192:193], v231 offset:32768
  v_mfma_f32_16x16x32_bf16 v[136:139], a[204:207], v[112:115], v[136:139]
  ds_read_b64_tr_b16 a[194:195], v231 offset:34816
  v_mfma_f32_16x16x32_bf16 v[140:143], a[200:203], v[100:103], v[140:143]
  ds_read_b64_tr_b16 a[196:197], v231 offset:36864
  v_mfma_f32_16x16x32_bf16 v[140:143], a[204:207], v[116:119], v[140:143]
  s_waitcnt lgkmcnt(3)
  ds_read_b64_tr_b16 a[198:199], v231 offset:38912
  v_mfma_f32_16x16x32_bf16 v[144:147], a[208:211], v[96:99], v[144:147]
  ds_read_b64_tr_b16 a[200:201], v232 offset:32768
  v_mfma_f32_16x16x32_bf16 v[144:147], a[212:215], v[112:115], v[144:147]
  ds_read_b64_tr_b16 a[202:203], v232 offset:34816
  v_mfma_f32_16x16x32_bf16 v[148:151], a[208:211], v[100:103], v[148:151]
  ds_read_b64_tr_b16 a[204:205], v232 offset:36864
  v_mfma_f32_16x16x32_bf16 v[148:151], a[212:215], v[116:119], v[148:151]
  ds_read_b64_tr_b16 a[206:207], v232 offset:38912
  v_mfma_f32_16x16x32_bf16 v[152:155], a[216:219], v[96:99], v[152:155]
  ds_read_b64_tr_b16 a[208:209], v233 offset:32768
  buffer_store_dwordx4 v[160:163], v251, s[8:11], s39 offen sc1
  v_mfma_f32_16x16x32_bf16 v[152:155], a[220:223], v[112:115], v[152:155]
  ds_read_b64_tr_b16 a[210:211], v233 offset:34816
  v_mfma_f32_16x16x32_bf16 v[156:159], a[216:219], v[100:103], v[156:159]
  ds_read_b64_tr_b16 a[212:213], v233 offset:36864
  v_mfma_f32_16x16x32_bf16 v[156:159], a[220:223], v[116:119], v[156:159]
  s_waitcnt lgkmcnt(3)
  ds_read_b64_tr_b16 a[214:215], v233 offset:38912
  v_mfma_f32_16x16x32_bf16 v[128:131], a[192:195], a[160:163], v[128:131]
  ds_read_b64_tr_b16 a[216:217], v234 offset:32768
  buffer_store_dwordx4 v[164:167], v252, s[8:11], s39 offen sc1
  v_mfma_f32_16x16x32_bf16 v[128:131], a[196:199], a[168:171], v[128:131]
  ds_read_b64_tr_b16 a[218:219], v234 offset:34816
  v_mfma_f32_16x16x32_bf16 v[132:135], a[192:195], a[164:167], v[132:135]
  ds_read_b64_tr_b16 a[220:221], v234 offset:36864
  v_mfma_f32_16x16x32_bf16 v[132:135], a[196:199], a[172:175], v[132:135]
  ds_read_b64_tr_b16 a[222:223], v234 offset:38912
  v_mfma_f32_16x16x32_bf16 v[136:139], a[200:203], a[160:163], v[136:139]
  ds_read_b64_tr_b16 a[192:193], v231 offset:40960
  buffer_store_dwordx4 v[176:179], v253, s[8:11], s39 offen sc1
  v_mfma_f32_16x16x32_bf16 v[136:139], a[204:207], a[168:171], v[136:139]
  ds_read_b64_tr_b16 a[194:195], v231 offset:43008
  v_mfma_f32_16x16x32_bf16 v[140:143], a[200:203], a[164:167], v[140:143]
  ds_read_b64_tr_b16 a[196:197], v231 offset:45056
  v_mfma_f32_16x16x32_bf16 v[140:143], a[204:207], a[172:175], v[140:143]
  s_waitcnt lgkmcnt(3)
  ds_read_b64_tr_b16 a[198:199], v231 offset:47104
  v_mfma_f32_16x16x32_bf16 v[144:147], a[208:211], a[160:163], v[144:147]
  ds_read_b64_tr_b16 a[200:201], v232 offset:40960
  buffer_store_dwordx4 v[180:183], v254, s[8:11], s39 offen sc1
  v_mfma_f32_16x16x32_bf16 v[144:147], a[212:215], a[168:171], v[144:147]
  ds_read_b64_tr_b16 a[202:203], v232 offset:43008
  v_mfma_f32_16x16x32_bf16 v[148:151], a[208:211], a[164:167], v[148:151]
  ds_read_b64_tr_b16 a[204:205], v232 offset:45056
  v_mfma_f32_16x16x32_bf16 v[148:151], a[212:215], a[172:175], v[148:151]
  ds_read_b64_tr_b16 a[206:207], v232 offset:47104
  v_mfma_f32_16x16x32_bf16 v[152:155], a[216:219], a[160:163], v[152:155]
  ds_read_b64_tr_b16 a[208:209], v233 offset:40960
  v_mfma_f32_16x16x32_bf16 v[152:155], a[220:223], a[168:171], v[152:155]
  ds_read_b64_tr_b16 a[210:211], v233 offset:43008
  v_mfma_f32_16x16x32_bf16 v[156:159], a[216:219], a[164:167], v[156:159]
  ds_read_b64_tr_b16 a[212:213], v233 offset:45056
  v_mfma_f32_16x16x32_bf16 v[156:159], a[220:223], a[172:175], v[156:159]
  s_waitcnt lgkmcnt(3)
  ds_read_b64_tr_b16 a[214:215], v233 offset:47104
  v_mfma_f32_16x16x32_bf16 v[128:131], a[192:195], a[176:179], v[128:131]
  ds_read_b64_tr_b16 a[216:217], v234 offset:40960
  v_mfma_f32_16x16x32_bf16 v[160:163], a[196:199], a[184:187], v[128:131]
  ds_read_b64_tr_b16 a[218:219], v234 offset:43008
  v_mfma_f32_16x16x32_bf16 v[132:135], a[192:195], a[180:183], v[132:135]
  ds_read_b64_tr_b16 a[220:221], v234 offset:45056
  v_mfma_f32_16x16x32_bf16 v[164:167], a[196:199], a[188:191], v[132:135]
  ds_read_b64_tr_b16 a[222:223], v234 offset:47104
  v_mfma_f32_16x16x32_bf16 v[136:139], a[200:203], a[176:179], v[136:139]
  v_mfma_f32_16x16x32_bf16 v[168:171], a[204:207], a[184:187], v[136:139]
  v_mfma_f32_16x16x32_bf16 v[140:143], a[200:203], a[180:183], v[140:143]
  v_mfma_f32_16x16x32_bf16 v[172:175], a[204:207], a[188:191], v[140:143]
  s_waitcnt lgkmcnt(0)
  v_mfma_f32_16x16x32_bf16 v[144:147], a[208:211], a[176:179], v[144:147]
  v_mfma_f32_16x16x32_bf16 v[176:179], a[212:215], a[184:187], v[144:147]
  v_mfma_f32_16x16x32_bf16 v[148:151], a[208:211], a[180:183], v[148:151]
  v_mfma_f32_16x16x32_bf16 v[180:183], a[212:215], a[188:191], v[148:151]
  v_mfma_f32_16x16x32_bf16 v[152:155], a[216:219], a[176:179], v[152:155]
  v_mfma_f32_16x16x32_bf16 v[184:187], a[220:223], a[184:187], v[152:155]
  v_mfma_f32_16x16x32_bf16 v[156:159], a[216:219], a[180:183], v[156:159]
  v_mfma_f32_16x16x32_bf16 v[188:191], a[220:223], a[188:191], v[156:159]
  s_add_u32 s39, s53, 393216
  s_nop 7
  v_cvt_pk_bf16_f32 v160, v160, v161
  v_cvt_pk_bf16_f32 v161, v162, v163
  v_cvt_pk_bf16_f32 v162, v168, v169
  v_cvt_pk_bf16_f32 v163, v170, v171
  buffer_store_dwordx4 v[160:163], v251, s[8:11], s39 offen sc1
  v_cvt_pk_bf16_f32 v164, v164, v165
  v_cvt_pk_bf16_f32 v165, v166, v167
  v_cvt_pk_bf16_f32 v166, v172, v173
  v_cvt_pk_bf16_f32 v167, v174, v175
  buffer_store_dwordx4 v[164:167], v252, s[8:11], s39 offen sc1
  v_cvt_pk_bf16_f32 v176, v176, v177
  v_cvt_pk_bf16_f32 v177, v178, v179
  v_cvt_pk_bf16_f32 v178, v184, v185
  v_cvt_pk_bf16_f32 v179, v186, v187
  buffer_store_dwordx4 v[176:179], v253, s[8:11], s39 offen sc1
  v_cvt_pk_bf16_f32 v180, v180, v181
  v_cvt_pk_bf16_f32 v181, v182, v183
  v_cvt_pk_bf16_f32 v182, v188, v189
  v_cvt_pk_bf16_f32 v183, v190, v191
  buffer_store_dwordx4 v[180:183], v254, s[8:11], s39 offen sc1
  s_endpgm
L_k2_evt:
  s_cmp_eq_u32 s7, 1
  s_cbranch_scc1 L_k2_evt_c
  s_cmp_eq_u32 s61, 1
  s_cbranch_scc0 L_k2_evt_pw
  s_mov_b32 s61, 0
  s_cmp_eq_u32 s4, 0
  s_cbranch_scc0 L_k2_evt_p1
  v_mov_b32 v216, 1
  buffer_store_dword v216, off, s[8:11], s38 sc1
L_k2_evt_p1:
  s_mov_b32 s57, 3
  s_cmp_le_u32 s36, 3
  s_cbranch_scc0 L_k2_evt_back
L_k2_evt_pw:
  s_mul_i32 s26, s5, 229376
  s_mul_i32 s27, s5, 114688
  buffer_load_dword v255, v225, s[12:15], s26 offen
  buffer_load_dword v255, v230, s[16:19], s27 offen
  s_mov_b32 s57, 0xffff
  s_branch L_k2_evt_back
L_k2_evt_c:
  s_cmp_eq_u32 s36, 3
  s_cbranch_scc0 L_k2_evt_c2
  s_mul_i32 s26, s5, 229376
  s_mul_i32 s27, s5, 114688
  buffer_load_dword v255, v225, s[12:15], s26 offen
  buffer_load_dword v255, v230, s[16:19], s27 offen
  s_mov_b32 s57, 2
  s_branch L_k2_evt_back
L_k2_evt_c2:
  s_cmp_eq_u32 s36, 2
  s_cbranch_scc0 L_k2_evt_c1
  buffer_load_dword v226, off, s[8:11], s38 sc1
  s_mov_b32 s57, 1
  s_branch L_k2_evt_back
L_k2_evt_c1:
  s_mov_b32 s27, 0x400000
L_k2_poll:
  v_readfirstlane_b32 s26, v226
  s_sub_u32 s27, s27, 1
  s_cmp_eq_u32 s27, 0
  s_cbranch_scc1 L_k2_polled
  s_cmp_eq_u32 s26, 1
  s_cbranch_scc1 L_k2_polled
  s_sleep 4
  buffer_load_dword v226, off, s[8:11], s38 sc1
  s_waitcnt vmcnt(0)
  s_branch L_k2_poll
L_k2_polled:
  s_mov_b32 s26, s37
  buffer_load_dwordx4 a[192:195], v208, s[8:11], s26 offen offset:0 sc1
  buffer_load_dwordx4 a[196:199], v208, s[8:11], s26 offen offset:1024 sc1
  buffer_load_dwordx4 a[200:203], v208, s[8:11], s26 offen offset:2048 sc1
  buffer_load_dwordx4 a[204:207], v208, s[8:11], s26 offen offset:3072 sc1
  s_add_u32 s26, s26, 4096
  buffer_load_dwordx4 a[208:211], v208, s[8:11], s26 offen offset:0 sc1
  buffer_load_dwordx4 a[212:215], v208, s[8:11], s26 offen offset:1024 sc1
  buffer_load_dwordx4 a[216:219], v208, s[8:11], s26 offen offset:2048 sc1
  buffer_load_dwordx4 a[220:223], v208, s[8:11], s26 offen offset:3072 sc1
  s_add_u32 s26, s26, 4096
  buffer_load_dwordx4 a[224:227], v208, s[8:11], s26 offen offset:0 sc1
  buffer_load_dwordx4 a[228:231], v208, s[8:11], s26 offen offset:1024 sc1
  buffer_load_dwordx4 a[232:235], v208, s[8:11], s26 offen offset:2048 sc1
  buffer_load_dwordx4 a[236:239], v208, s[8:11], s26 offen offset:3072 sc1
  s_add_u32 s26, s26, 4096
  buffer_load_dwordx4 a[240:243], v208, s[8:11], s26 offen offset:0 sc1
  buffer_load_dwordx4 a[244:247], v208, s[8:11], s26 offen offset:1024 sc1
  buffer_load_dwordx4 a[248:251], v208, s[8:11], s26 offen offset:2048 sc1
  buffer_load_dwordx4 a[252:255], v208, s[8:11], s26 offen offset:3072 sc1
  s_add_u32 s26, s26, 4096
  buffer_load_dwordx4 v[226:229], v208, s[8:11], s26 offen sc1
  s_mov_b32 s57, 0xffff
  s_branch L_k2_evt_back
L_k2_maskp:
  s_nop 7
  s_cmp_eq_u32 s23, 0
  s_cbranch_scc1 L_k2_maskp_d
  v_mov_b32 v128, v212
  v_mov_b32 v129, v212
  v_mov_b32 v130, v212
  v_mov_b32 v131, v212
  v_mov_b32 v132, v212
  v_mov_b32 v133, v212
  v_mov_b32 v134, v212
  v_mov_b32 v135, v212
  v_mov_b32 v136, v212
  v_mov_b32 v137, v212
  v_mov_b32 v138, v212
  v_mov_b32 v139, v212
  v_mov_b32 v140, v212
  v_mov_b32 v141, v212
  v_mov_b32 v142, v212
  v_mov_b32 v143, v212
  s_branch L_k2_maskp_back
L_k2_maskp_d:
  v_cndmask_b32 v128, v128, v212, s[64:65]
  v_cndmask_b32 v140, v140, v212, s[64:65]
  v_mov_b32 v136, v212
  v_cndmask_b32 v129, v129, v212, s[66:67]
  v_cndmask_b32 v141, v141, v212, s[66:67]
  v_mov_b32 v137, v212
  v_cndmask_b32 v130, v130, v212, s[68:69]
  v_cndmask_b32 v142, v142, v212, s[68:69]
  v_mov_b32 v138, v212
  v_cndmask_b32 v131, v131, v212, s[70:71]
  v_cndmask_b32 v143, v143, v212, s[70:71]
  v_mov_b32 v139, v212
  s_branch L_k2_maskp_back
L_k2_mask0:
  s_cmp_eq_u32 s23, 0
  s_cbranch_scc1 L_k2_mask0_d
  v_mov_b32 v128, v212
  v_mov_b32 v129, v212
  v_mov_b32 v130, v212
  v_mov_b32 v131, v212
  v_mov_b32 v132, v212
  v_mov_b32 v133, v212
  v_mov_b32 v134, v212
  v_mov_b32 v135, v212
  v_mov_b32 v136, v212
  v_mov_b32 v137, v212
  v_mov_b32 v138, v212
  v_mov_b32 v139, v212
  v_mov_b32 v140, v212
  v_mov_b32 v141, v212
  v_mov_b32 v142, v212
  v_mov_b32 v143, v212
  s_branch L_k2_mask0_back
L_k2_mask0_d:
  v_cndmask_b32 v128, v128, v212, s[64:65]
  v_cndmask_b32 v140, v140, v212, s[64:65]
  v_mov_b32 v136, v212
  v_cndmask_b32 v129, v129, v212, s[66:67]
  v_cndmask_b32 v141, v141, v212, s[66:67]
  v_mov_b32 v137, v212
  v_cndmask_b32 v130, v130, v212, s[68:69]
  v_cndmask_b32 v142, v142, v212, s[68:69]
  v_mov_b32 v138, v212
  v_cndmask_b32 v131, v131, v212, s[70:71]
  v_cndmask_b32 v143, v143, v212, s[70:71]
  v_mov_b32 v139, v212
  s_branch L_k2_mask0_back
L_k2_mask1:
  s_cmp_eq_u32 s23, 0
  s_cbranch_scc1 L_k2_mask1_d
  v_mov_b32 v144, v212
  v_mov_b32 v145, v212
  v_mov_b32 v146, v212
  v_mov_b32 v147, v212
  v_mov_b32 v148, v212
  v_mov_b32 v149, v212
  v_mov_b32 v150, v212
  v_mov_b32 v151, v212
  v_mov_b32 v152, v212
  v_mov_b32 v153, v212
  v_mov_b32 v154, v212
  v_mov_b32 v155, v212
  v_mov_b32 v156, v212
  v_mov_b32 v157, v212
  v_mov_b32 v158, v212
  v_mov_b32 v159, v212
  s_branch L_k2_mask1_back
L_k2_mask1_d:
  v_cndmask_b32 v144, v144, v212, s[64:65]
  v_cndmask_b32 v156, v156, v212, s[64:65]
  v_mov_b32 v152, v212
  v_cndmask_b32 v145, v145, v212, s[66:67]
  v_cndmask_b32 v157, v157, v212, s[66:67]
  v_mov_b32 v153, v212
  v_cndmask_b32 v146, v146, v212, s[68:69]
  v_cndmask_b32 v158, v158, v212, s[68:69]
  v_mov_b32 v154, v212
  v_cndmask_b32 v147, v147, v212, s[70:71]
  v_cndmask_b32 v159, v159, v212, s[70:71]
  v_mov_b32 v155, v212
  s_branch L_k2_mask1_back
L_k2_slow0:
  s_nop 7
  v_max3_f32 v217, v128, v129, v130
  v_max3_f32 v217, v217, v131, v136
  v_max3_f32 v217, v217, v137, v138
  v_max_f32 v217, v217, v139
  v_max3_f32 v218, v132, v133, v134
  v_max3_f32 v218, v218, v135, v140
  v_max3_f32 v218, v218, v141, v142
  v_max_f32 v218, v218, v143
  v_mov_b32 v219, v217
  v_mov_b32 v220, v218
  s_nop 1
  v_permlane32_swap_b32 v217, v219
  v_permlane32_swap_b32 v218, v220
  s_nop 1
  v_max_f32 v217, v217, v219
  v_max_f32 v218, v218, v220
  v_mov_b32 v219, v217
  v_mov_b32 v220, v218
  s_nop 1
  v_permlane16_swap_b32 v217, v219
  v_permlane16_swap_b32 v218, v220
  s_nop 1
  v_max_f32 v217, v217, v219
  v_max_f32 v218, v218, v220
  v_max_f32 v217, s31, v217
  v_max_f32 v218, s31, v218
  v_add_f32 v204, v204, v217
  v_sub_f32 v219, 0, v217
  v_min_f32 v219, 0, v219
  v_add_f32 v205, v205, v218
  v_sub_f32 v220, 0, v218
  v_min_f32 v220, 0, v220
  v_exp_f32 v219, v219
  v_exp_f32 v220, v220
  v_sub_f32 v192, 0, v204
  v_sub_f32 v193, 0, v204
  v_sub_f32 v194, 0, v204
  v_sub_f32 v195, 0, v204
  v_sub_f32 v196, 0, v205
  v_sub_f32 v197, 0, v205
  v_sub_f32 v198, 0, v205
  v_sub_f32 v199, 0, v205
  v_mul_f32 v200, v200, v219
  v_mul_f32 v201, v201, v220
  v_sub_f32 v128, v128, v217
  v_sub_f32 v129, v129, v217
  v_sub_f32 v130, v130, v217
  v_sub_f32 v131, v131, v217
  v_sub_f32 v132, v132, v218
  v_sub_f32 v133, v133, v218
  v_sub_f32 v134, v134, v218
  v_sub_f32 v135, v135, v218
  v_sub_f32 v136, v136, v217
  v_sub_f32 v137, v137, v217
  v_sub_f32 v138, v138, v217
  v_sub_f32 v139, v139, v217
  v_sub_f32 v140, v140, v218
  v_sub_f32 v141, v141, v218
  v_sub_f32 v142, v142, v218
  v_sub_f32 v143, v143, v218
  v_sub_f32 v144, v144, v217
  v_sub_f32 v145, v145, v217
  v_sub_f32 v146, v146, v217
  v_sub_f32 v147, v147, v217
  v_sub_f32 v148, v148, v218
  v_sub_f32 v149, v149, v218
  v_sub_f32 v150, v150, v218
  v_sub_f32 v151, v151, v218
  v_sub_f32 v152, v152, v217
  v_sub_f32 v153, v153, v217
  v_sub_f32 v154, v154, v217
  v_sub_f32 v155, v155, v217
  v_sub_f32 v156, v156, v218
  v_sub_f32 v157, v157, v218
  v_sub_f32 v158, v158, v218
  v_sub_f32 v159, v159, v218
  s_cmp_eq_u32 s29, 1
  s_cbranch_scc0 L_k2_slow0_full
  v_exp_f32 v160, v128
  v_exp_f32 v161, v129
  v_exp_f32 v162, v130
  v_exp_f32 v163, v131
  v_exp_f32 v164, v132
  v_exp_f32 v165, v133
  v_exp_f32 v166, v134
  v_exp_f32 v167, v135
  v_add_f32 v202, v160, v161
  v_add_f32 v203, v164, v165
  v_cvt_pk_bf16_f32 v176, v160, v161
  v_cvt_pk_bf16_f32 v177, v162, v163
  v_cvt_pk_bf16_f32 v180, v164, v165
  v_cvt_pk_bf16_f32 v181, v166, v167
  s_branch L_k2_pro_back
L_k2_slow0_full:
  v_mul_f32 v0, v0, v219
  v_mul_f32 v1, v1, v219
  v_mul_f32 v2, v2, v219
  v_mul_f32 v3, v3, v219
  v_mul_f32 v4, v4, v220
  v_mul_f32 v5, v5, v220
  v_mul_f32 v6, v6, v220
  v_mul_f32 v7, v7, v220
  v_mul_f32 v8, v8, v219
  v_mul_f32 v9, v9, v219
  v_mul_f32 v10, v10, v219
  v_mul_f32 v11, v11, v219
  v_mul_f32 v12, v12, v220
  v_mul_f32 v13, v13, v220
  v_mul_f32 v14, v14, v220
  v_mul_f32 v15, v15, v220
  v_mul_f32 v16, v16, v219
  v_mul_f32 v17, v17, v219
  v_mul_f32 v18, v18, v219
  v_mul_f32 v19, v19, v219
  v_mul_f32 v20, v20, v220
  v_mul_f32 v21, v21, v220
  v_mul_f32 v22, v22, v220
  v_mul_f32 v23, v23, v220
  v_mul_f32 v24, v24, v219
  v_mul_f32 v25, v25, v219
  v_mul_f32 v26, v26, v219
  v_mul_f32 v27, v27, v219
  v_mul_f32 v28, v28, v220
  v_mul_f32 v29, v29, v220
  v_mul_f32 v30, v30, v220
  v_mul_f32 v31, v31, v220
  v_mul_f32 v32, v32, v219
  v_mul_f32 v33, v33, v219
  v_mul_f32 v34, v34, v219
  v_mul_f32 v35, v35, v219
  v_mul_f32 v36, v36, v220
  v_mul_f32 v37, v37, v220
  v_mul_f32 v38, v38, v220
  v_mul_f32 v39, v39, v220
  v_mul_f32 v40, v40, v219
  v_mul_f32 v41, v41, v219
  v_mul_f32 v42, v42, v219
  v_mul_f32 v43, v43, v219
  v_mul_f32 v44, v44, v220
  v_mul_f32 v45, v45, v220
  v_mul_f32 v46, v46, v220
  v_mul_f32 v47, v47, v220
  v_mul_f32 v48, v48, v219
  v_mul_f32 v49, v49, v219
  v_mul_f32 v50, v50, v219
  v_mul_f32 v51, v51, v219
  v_mul_f32 v52, v52, v220
  v_mul_f32 v53, v53, v220
  v_mul_f32 v54, v54, v220
  v_mul_f32 v55, v55, v220
  v_mul_f32 v56, v56, v219
  v_mul_f32 v57, v57, v219
  v_mul_f32 v58, v58, v219
  v_mul_f32 v59, v59, v219
  v_mul_f32 v60, v60, v220
  v_mul_f32 v61, v61, v220
  v_mul_f32 v62, v62, v220
  v_mul_f32 v63, v63, v220
  v_mul_f32 v64, v64, v219
  v_mul_f32 v65, v65, v219
  v_mul_f32 v66, v66, v219
  v_mul_f32 v67, v67, v219
  v_mul_f32 v68, v68, v220
  v_mul_f32 v69, v69, v220
  v_mul_f32 v70, v70, v220
  v_mul_f32 v71, v71, v220
  v_mul_f32 v72, v72, v219
  v_mul_f32 v73, v73, v219
  v_mul_f32 v74, v74, v219
  v_mul_f32 v75, v75, v219
  v_mul_f32 v76, v76, v220
  v_mul_f32 v77, v77, v220
  v_mul_f32 v78, v78, v220
  v_mul_f32 v79, v79, v220
  v_mul_f32 v80, v80, v219
  v_mul_f32 v81, v81, v219
  v_mul_f32 v82, v82, v219
  v_mul_f32 v83, v83, v219
  v_mul_f32 v84, v84, v220
  v_mul_f32 v85, v85, v220
  v_mul_f32 v86, v86, v220
  v_mul_f32 v87, v87, v220
  v_mul_f32 v88, v88, v219
  v_mul_f32 v89, v89, v219
  v_mul_f32 v90, v90, v219
  v_mul_f32 v91, v91, v219
  v_mul_f32 v92, v92, v220
  v_mul_f32 v93, v93, v220
  v_mul_f32 v94, v94, v220
  v_mul_f32 v95, v95, v220
  v_mul_f32 v96, v96, v219
  v_mul_f32 v97, v97, v219
  v_mul_f32 v98, v98, v219
  v_mul_f32 v99, v99, v219
  v_mul_f32 v100, v100, v220
  v_mul_f32 v101, v101, v220
  v_mul_f32 v102, v102, v220
  v_mul_f32 v103, v103, v220
  v_mul_f32 v104, v104, v219
  v_mul_f32 v105, v105, v219
  v_mul_f32 v106, v106, v219
  v_mul_f32 v107, v107, v219
  v_mul_f32 v108, v108, v220
  v_mul_f32 v109, v109, v220
  v_mul_f32 v110, v110, v220
  v_mul_f32 v111, v111, v220
  v_mul_f32 v112, v112, v219
  v_mul_f32 v113, v113, v219
  v_mul_f32 v114, v114, v219
  v_mul_f32 v115, v115, v219
  v_mul_f32 v116, v116, v220
  v_mul_f32 v117, v117, v220
  v_mul_f32 v118, v118, v220
  v_mul_f32 v119, v119, v220
  v_mul_f32 v120, v120, v219
  v_mul_f32 v121, v121, v219
  v_mul_f32 v122, v122, v219
  v_mul_f32 v123, v123, v219
  v_mul_f32 v124, v124, v220
  v_mul_f32 v125, v125, v220
  v_mul_f32 v126, v126, v220
  v_mul_f32 v127, v127, v220
  v_exp_f32 v160, v128
  v_exp_f32 v161, v129
  v_exp_f32 v162, v130
  v_exp_f32 v163, v131
  v_exp_f32 v164, v132
  v_exp_f32 v165, v133
  v_exp_f32 v166, v134
  v_exp_f32 v167, v135
  v_add_f32 v202, v160, v161
  v_add_f32 v203, v164, v165
  v_cvt_pk_bf16_f32 v176, v160, v161
  v_cvt_pk_bf16_f32 v177, v162, v163
  v_cvt_pk_bf16_f32 v180, v164, v165
  v_cvt_pk_bf16_f32 v181, v166, v167
  s_nop 0
  v_exp_f32 v168, v136
  v_exp_f32 v169, v137
  v_add_f32 v202, v202, v162
  v_exp_f32 v170, v138
  v_exp_f32 v171, v139
  v_add_f32 v202, v202, v163
  v_exp_f32 v172, v140
  v_exp_f32 v173, v141
  v_add_f32 v203, v203, v166
  v_exp_f32 v174, v142
  v_exp_f32 v175, v143
  v_add_f32 v203, v203, v167
  v_add_f32 v202, v202, v168
  v_add_f32 v202, v202, v169
  v_add_f32 v202, v202, v170
  v_add_f32 v202, v202, v171
  v_cvt_pk_bf16_f32 v178, v168, v169
  v_cvt_pk_bf16_f32 v179, v170, v171
  v_add_f32 v203, v203, v172
  v_add_f32 v203, v203, v173
  v_add_f32 v203, v203, v174
  v_add_f32 v203, v203, v175
  v_cvt_pk_bf16_f32 v182, v172, v173
  v_cvt_pk_bf16_f32 v183, v174, v175
  s_cmp_eq_u32 s62, 1
  s_cbranch_scc1 L_k2m_slow0_back
  s_branch L_k2_slow0_back
L_k2_slow1:
  s_nop 7
  v_max3_f32 v217, v144, v145, v146
  v_max3_f32 v217, v217, v147, v152
  v_max3_f32 v217, v217, v153, v154
  v_max_f32 v217, v217, v155
  v_max3_f32 v218, v148, v149, v150
  v_max3_f32 v218, v218, v151, v156
  v_max3_f32 v218, v218, v157, v158
  v_max_f32 v218, v218, v159
  v_mov_b32 v219, v217
  v_mov_b32 v220, v218
  s_nop 1
  v_permlane32_swap_b32 v217, v219
  v_permlane32_swap_b32 v218, v220
  s_nop 1
  v_max_f32 v217, v217, v219
  v_max_f32 v218, v218, v220
  v_mov_b32 v219, v217
  v_mov_b32 v220, v218
  s_nop 1
  v_permlane16_swap_b32 v217, v219
  v_permlane16_swap_b32 v218, v220
  s_nop 1
  v_max_f32 v217, v217, v219
  v_max_f32 v218, v218, v220
  v_max_f32 v217, s31, v217
  v_max_f32 v218, s31, v218
  v_add_f32 v204, v204, v217
  v_sub_f32 v219, 0, v217
  v_min_f32 v219, 0, v219
  v_add_f32 v205, v205, v218
  v_sub_f32 v220, 0, v218
  v_min_f32 v220, 0, v220
  v_exp_f32 v219, v219
  v_exp_f32 v220, v220
  v_sub_f32 v192, 0, v204
  v_sub_f32 v193, 0, v204
  v_sub_f32 v194, 0, v204
  v_sub_f32 v195, 0, v204
  v_sub_f32 v196, 0, v205
  v_sub_f32 v197, 0, v205
  v_sub_f32 v198, 0, v205
  v_sub_f32 v199, 0, v205
  v_mul_f32 v200, v200, v219
  v_mul_f32 v201, v201, v220
  v_sub_f32 v144, v144, v217
  v_sub_f32 v145, v145, v217
  v_sub_f32 v146, v146, v217
  v_sub_f32 v147, v147, v217
  v_sub_f32 v148, v148, v218
  v_sub_f32 v149, v149, v218
  v_sub_f32 v150, v150, v218
  v_sub_f32 v151, v151, v218
  v_sub_f32 v152, v152, v217
  v_sub_f32 v153, v153, v217
  v_sub_f32 v154, v154, v217
  v_sub_f32 v155, v155, v217
  v_sub_f32 v156, v156, v218
  v_sub_f32 v157, v157, v218
  v_sub_f32 v158, v158, v218
  v_sub_f32 v159, v159, v218
  v_sub_f32 v128, v128, v217
  v_sub_f32 v129, v129, v217
  v_sub_f32 v130, v130, v217
  v_sub_f32 v131, v131, v217
  v_sub_f32 v132, v132, v218
  v_sub_f32 v133, v133, v218
  v_sub_f32 v134, v134, v218
  v_sub_f32 v135, v135, v218
  v_sub_f32 v136, v136, v217
  v_sub_f32 v137, v137, v217
  v_sub_f32 v138, v138, v217
  v_sub_f32 v139, v139, v217
  v_sub_f32 v140, v140, v218
  v_sub_f32 v141, v141, v218
  v_sub_f32 v142, v142, v218
  v_sub_f32 v143, v143, v218
  v_mul_f32 v0, v0, v219
  v_mul_f32 v1, v1, v219
  v_mul_f32 v2, v2, v219
  v_mul_f32 v3, v3, v219
  v_mul_f32 v4, v4, v220
  v_mul_f32 v5, v5, v220
  v_mul_f32 v6, v6, v220
  v_mul_f32 v7, v7, v220
  v_mul_f32 v8, v8, v219
  v_mul_f32 v9, v9, v219
  v_mul_f32 v10, v10, v219
  v_mul_f32 v11, v11, v219
  v_mul_f32 v12, v12, v220
  v_mul_f32 v13, v13, v220
  v_mul_f32 v14, v14, v220
  v_mul_f32 v15, v15, v220
  v_mul_f32 v16, v16, v219
  v_mul_f32 v17, v17, v219
  v_mul_f32 v18, v18, v219
  v_mul_f32 v19, v19, v219
  v_mul_f32 v20, v20, v220
  v_mul_f32 v21, v21, v220
  v_mul_f32 v22, v22, v220
  v_mul_f32 v23, v23, v220
  v_mul_f32 v24, v24, v219
  v_mul_f32 v25, v25, v219
  v_mul_f32 v26, v26, v219
  v_mul_f32 v27, v27, v219
  v_mul_f32 v28, v28, v220
  v_mul_f32 v29, v29, v220
  v_mul_f32 v30, v30, v220
  v_mul_f32 v31, v31, v220
  v_mul_f32 v32, v32, v219
  v_mul_f32 v33, v33, v219
  v_mul_f32 v34, v34, v219
  v_mul_f32 v35, v35, v219
  v_mul_f32 v36, v36, v220
  v_mul_f32 v37, v37, v220
  v_mul_f32 v38, v38, v220
  v_mul_f32 v39, v39, v220
  v_mul_f32 v40, v40, v219
  v_mul_f32 v41, v41, v219
  v_mul_f32 v42, v42, v219
  v_mul_f32 v43, v43, v219
  v_mul_f32 v44, v44, v220
  v_mul_f32 v45, v45, v220
  v_mul_f32 v46, v46, v220
  v_mul_f32 v47, v47, v220
  v_mul_f32 v48, v48, v219
  v_mul_f32 v49, v49, v219
  v_mul_f32 v50, v50, v219
  v_mul_f32 v51, v51, v219
  v_mul_f32 v52, v52, v220
  v_mul_f32 v53, v53, v220
  v_mul_f32 v54, v54, v220
  v_mul_f32 v55, v55, v220
  v_mul_f32 v56, v56, v219
  v_mul_f32 v57, v57, v219
  v_mul_f32 v58, v58, v219
  v_mul_f32 v59, v59, v219
  v_mul_f32 v60, v60, v220
  v_mul_f32 v61, v61, v220
  v_mul_f32 v62, v62, v220
  v_mul_f32 v63, v63, v220
  v_mul_f32 v64, v64, v219
  v_mul_f32 v65, v65, v219
  v_mul_f32 v66, v66, v219
  v_mul_f32 v67, v67, v219
  v_mul_f32 v68, v68, v220
  v_mul_f32 v69, v69, v220
  v_mul_f32 v70, v70, v220
  v_mul_f32 v71, v71, v220
  v_mul_f32 v72, v72, v219
  v_mul_f32 v73, v73, v219
  v_mul_f32 v74, v74, v219
  v_mul_f32 v75, v75, v219
  v_mul_f32 v76, v76, v220
  v_mul_f32 v77, v77, v220
  v_mul_f32 v78, v78, v220
  v_mul_f32 v79, v79, v220
  v_mul_f32 v80, v80, v219
  v_mul_f32 v81, v81, v219
  v_mul_f32 v82, v82, v219
  v_mul_f32 v83, v83, v219
  v_mul_f32 v84, v84, v220
  v_mul_f32 v85, v85, v220
  v_mul_f32 v86, v86, v220
  v_mul_f32 v87, v87, v220
  v_mul_f32 v88, v88, v219
  v_mul_f32 v89, v89, v219
  v_mul_f32 v90, v90, v219
  v_mul_f32 v91, v91, v219
  v_mul_f32 v92, v92, v220
  v_mul_f32 v93, v93, v220
  v_mul_f32 v94, v94, v220
  v_mul_f32 v95, v95, v220
  v_mul_f32 v96, v96, v219
  v_mul_f32 v97, v97, v219
  v_mul_f32 v98, v98, v219
  v_mul_f32 v99, v99, v219
  v_mul_f32 v100, v100, v220
  v_mul_f32 v101, v101, v220
  v_mul_f32 v102, v102, v220
  v_mul_f32 v103, v103, v220
  v_mul_f32 v104, v104, v219
  v_mul_f32 v105, v105, v219
  v_mul_f32 v106, v106, v219
  v_mul_f32 v107, v107, v219
  v_mul_f32 v108, v108, v220
  v_mul_f32 v109, v109, v220
  v_mul_f32 v110, v110, v220
  v_mul_f32 v111, v111, v220
  v_mul_f32 v112, v112, v219
  v_mul_f32 v113, v113, v219
  v_mul_f32 v114, v114, v219
  v_mul_f32 v115, v115, v219
  v_mul_f32 v116, v116, v220
  v_mul_f32 v117, v117, v220
  v_mul_f32 v118, v118, v220
  v_mul_f32 v119, v119, v220
  v_mul_f32 v120, v120, v219
  v_mul_f32 v121, v121, v219
  v_mul_f32 v122, v122, v219
  v_mul_f32 v123, v123, v219
  v_mul_f32 v124, v124, v220
  v_mul_f32 v125, v125, v220
  v_mul_f32 v126, v126, v220
  v_mul_f32 v127, v127, v220
  v_exp_f32 v160, v144
  v_exp_f32 v161, v145
  v_exp_f32 v162, v146
  v_exp_f32 v163, v147
  v_exp_f32 v164, v148
  v_exp_f32 v165, v149
  v_exp_f32 v166, v150
  v_exp_f32 v167, v151
  v_add_f32 v202, v160, v161
  v_add_f32 v203, v164, v165
  v_cvt_pk_bf16_f32 v184, v160, v161
  v_cvt_pk_bf16_f32 v185, v162, v163
  v_cvt_pk_bf16_f32 v188, v164, v165
  v_cvt_pk_bf16_f32 v189, v166, v167
  s_nop 0
  v_exp_f32 v168, v152
  v_exp_f32 v169, v153
  v_add_f32 v202, v202, v162
  v_exp_f32 v170, v154
  v_exp_f32 v171, v155
  v_add_f32 v202, v202, v163
  v_exp_f32 v172, v156
  v_exp_f32 v173, v157
  v_add_f32 v203, v203, v166
  v_exp_f32 v174, v158
  v_exp_f32 v175, v159
  v_add_f32 v203, v203, v167
  v_add_f32 v202, v202, v168
  v_add_f32 v202, v202, v169
  v_add_f32 v202, v202, v170
  v_add_f32 v202, v202, v171
  v_cvt_pk_bf16_f32 v186, v168, v169
  v_cvt_pk_bf16_f32 v187, v170, v171
  v_add_f32 v203, v203, v172
  v_add_f32 v203, v203, v173
  v_add_f32 v203, v203, v174
  v_add_f32 v203, v203, v175
  v_cvt_pk_bf16_f32 v190, v172, v173
  v_cvt_pk_bf16_f32 v191, v174, v175
  s_cmp_eq_u32 s62, 1
  s_cbranch_scc1 L_k2m_slow1_back
  s_branch L_k2_slow1_back
L_k2_end:
  s_endpgm
.globl k3_reduce_kernel
.p2align 8
.type k3_reduce_kernel,@function
k3_reduce_kernel:
  s_cmp_ge_u32 s2, 448
  s_cbranch_scc1 L_k3_end
  s_load_dwordx2 s[4:5], s[0:1], 104
  s_load_dwordx2 s[6:7], s[0:1], 88
  v_lshrrev_b32 v1, 6, v0
  v_and_b32 v2, 63, v0
  v_readfirstlane_b32 s3, v1
  s_lshl_b32 s16, s2, 2
  s_add_u32 s16, s16, s3
  v_lshlrev_b32 v3, 4, v2
  s_lshl_b32 s17, s16, 14
  s_add_u32 s17, s17, 0x3800000
  s_waitcnt lgkmcnt(0)
  s_mov_b32 s8, s4
  s_and_b32 s9, s5, 0xffff
  s_mov_b32 s10, 0x10000000
  s_mov_b32 s11, 0x20000
  s_mov_b32 s12, s6
  s_and_b32 s13, s7, 0xffff
  s_mov_b32 s14, 0x1c0000
  s_mov_b32 s15, 0x20000
  buffer_load_dwordx4 v[16:19], v3, s[8:11], s17 offen offset:0
  buffer_load_dwordx4 v[20:23], v3, s[8:11], s17 offen offset:1024
  buffer_load_dwordx4 v[24:27], v3, s[8:11], s17 offen offset:2048
  buffer_load_dwordx4 v[28:31], v3, s[8:11], s17 offen offset:3072
  s_add_u32 s17, s17, 4096
  buffer_load_dwordx4 v[32:35], v3, s[8:11], s17 offen offset:0
  buffer_load_dwordx4 v[36:39], v3, s[8:11], s17 offen offset:1024
  buffer_load_dwordx4 v[40:43], v3, s[8:11], s17 offen offset:2048
  buffer_load_dwordx4 v[44:47], v3, s[8:11], s17 offen offset:3072
  s_add_u32 s17, s17, 4096
  buffer_load_dwordx4 v[48:51], v3, s[8:11], s17 offen offset:0
  buffer_load_dwordx4 v[52:55], v3, s[8:11], s17 offen offset:1024
  buffer_load_dwordx4 v[56:59], v3, s[8:11], s17 offen offset:2048
  buffer_load_dwordx4 v[60:63], v3, s[8:11], s17 offen offset:3072
  s_add_u32 s17, s17, 4096
  buffer_load_dwordx4 v[64:67], v3, s[8:11], s17 offen offset:0
  buffer_load_dwordx4 v[68:71], v3, s[8:11], s17 offen offset:1024
  buffer_load_dwordx4 v[72:75], v3, s[8:11], s17 offen offset:2048
  buffer_load_dwordx4 v[76:79], v3, s[8:11], s17 offen offset:3072
  s_mul_i32 s18, s16, 2341
  s_lshr_b32 s18, s18, 16
  s_mul_i32 s19, s18, 28
  s_sub_u32 s19, s16, s19
  s_and_b32 s20, s19, 1
  s_lshr_b32 s21, s19, 1
  s_lshl_b32 s22, s18, 5
  s_lshl_b32 s20, s20, 4
  s_add_u32 s22, s22, s20
  s_mul_i32 s22, s22, 896
  s_lshl_b32 s21, s21, 6
  s_add_u32 s22, s22, s21
  v_and_b32 v4, 15, v2
  v_mul_u32_u24 v4, 896, v4
  v_lshrrev_b32 v5, 4, v2
  v_lshl_add_u32 v4, v5, 3, v4
  s_waitcnt vmcnt(15)
  v_lshlrev_b32 v8, 16, v16
  v_and_b32 v9, 0xffff0000, v16
  v_lshlrev_b32 v10, 16, v17
  v_and_b32 v11, 0xffff0000, v17
  v_lshlrev_b32 v12, 16, v18
  v_and_b32 v13, 0xffff0000, v18
  v_lshlrev_b32 v14, 16, v19
  v_and_b32 v15, 0xffff0000, v19
  s_waitcnt vmcnt(14)
  v_lshlrev_b32 v6, 16, v20
  v_and_b32 v7, 0xffff0000, v20
  v_add_f32 v8, v8, v6
  v_add_f32 v9, v9, v7
  v_lshlrev_b32 v6, 16, v21
  v_and_b32 v7, 0xffff0000, v21
  v_add_f32 v10, v10, v6
  v_add_f32 v11, v11, v7
  v_lshlrev_b32 v6, 16, v22
  v_and_b32 v7, 0xffff0000, v22
  v_add_f32 v12, v12, v6
  v_add_f32 v13, v13, v7
  v_lshlrev_b32 v6, 16, v23
  v_and_b32 v7, 0xffff0000, v23
  v_add_f32 v14, v14, v6
  v_add_f32 v15, v15, v7
  s_waitcnt vmcnt(13)
  v_lshlrev_b32 v6, 16, v24
  v_and_b32 v7, 0xffff0000, v24
  v_add_f32 v8, v8, v6
  v_add_f32 v9, v9, v7
  v_lshlrev_b32 v6, 16, v25
  v_and_b32 v7, 0xffff0000, v25
  v_add_f32 v10, v10, v6
  v_add_f32 v11, v11, v7
  v_lshlrev_b32 v6, 16, v26
  v_and_b32 v7, 0xffff0000, v26
  v_add_f32 v12, v12, v6
  v_add_f32 v13, v13, v7
  v_lshlrev_b32 v6, 16, v27
  v_and_b32 v7, 0xffff0000, v27
  v_add_f32 v14, v14, v6
  v_add_f32 v15, v15, v7
  s_waitcnt vmcnt(12)
  v_lshlrev_b32 v6, 16, v28
  v_and_b32 v7, 0xffff0000, v28
  v_add_f32 v8, v8, v6
  v_add_f32 v9, v9, v7
  v_lshlrev_b32 v6, 16, v29
  v_and_b32 v7, 0xffff0000, v29
  v_add_f32 v10, v10, v6
  v_add_f32 v11, v11, v7
  v_lshlrev_b32 v6, 16, v30
  v_and_b32 v7, 0xffff0000, v30
  v_add_f32 v12, v12, v6
  v_add_f32 v13, v13, v7
  v_lshlrev_b32 v6, 16, v31
  v_and_b32 v7, 0xffff0000, v31
  v_add_f32 v14, v14, v6
  v_add_f32 v15, v15, v7
  s_waitcnt vmcnt(11)
  v_lshlrev_b32 v6, 16, v32
  v_and_b32 v7, 0xffff0000, v32
  v_add_f32 v8, v8, v6
  v_add_f32 v9, v9, v7
  v_lshlrev_b32 v6, 16, v33
  v_and_b32 v7, 0xffff0000, v33
  v_add_f32 v10, v10, v6
  v_add_f32 v11, v11, v7
  v_lshlrev_b32 v6, 16, v34
  v_and_b32 v7, 0xffff0000, v34
  v_add_f32 v12, v12, v6
  v_add_f32 v13, v13, v7
  v_lshlrev_b32 v6, 16, v35
  v_and_b32 v7, 0xffff0000, v35
  v_add_f32 v14, v14, v6
  v_add_f32 v15, v15, v7
  s_waitcnt vmcnt(10)
  v_lshlrev_b32 v6, 16, v36
  v_and_b32 v7, 0xffff0000, v36
  v_add_f32 v8, v8, v6
  v_add_f32 v9, v9, v7
  v_lshlrev_b32 v6, 16, v37
  v_and_b32 v7, 0xffff0000, v37
  v_add_f32 v10, v10, v6
  v_add_f32 v11, v11, v7
  v_lshlrev_b32 v6, 16, v38
  v_and_b32 v7, 0xffff0000, v38
  v_add_f32 v12, v12, v6
  v_add_f32 v13, v13, v7
  v_lshlrev_b32 v6, 16, v39
  v_and_b32 v7, 0xffff0000, v39
  v_add_f32 v14, v14, v6
  v_add_f32 v15, v15, v7
  s_waitcnt vmcnt(9)
  v_lshlrev_b32 v6, 16, v40
  v_and_b32 v7, 0xffff0000, v40
  v_add_f32 v8, v8, v6
  v_add_f32 v9, v9, v7
  v_lshlrev_b32 v6, 16, v41
  v_and_b32 v7, 0xffff0000, v41
  v_add_f32 v10, v10, v6
  v_add_f32 v11, v11, v7
  v_lshlrev_b32 v6, 16, v42
  v_and_b32 v7, 0xffff0000, v42
  v_add_f32 v12, v12, v6
  v_add_f32 v13, v13, v7
  v_lshlrev_b32 v6, 16, v43
  v_and_b32 v7, 0xffff0000, v43
  v_add_f32 v14, v14, v6
  v_add_f32 v15, v15, v7
  s_waitcnt vmcnt(8)
  v_lshlrev_b32 v6, 16, v44
  v_and_b32 v7, 0xffff0000, v44
  v_add_f32 v8, v8, v6
  v_add_f32 v9, v9, v7
  v_lshlrev_b32 v6, 16, v45
  v_and_b32 v7, 0xffff0000, v45
  v_add_f32 v10, v10, v6
  v_add_f32 v11, v11, v7
  v_lshlrev_b32 v6, 16, v46
  v_and_b32 v7, 0xffff0000, v46
  v_add_f32 v12, v12, v6
  v_add_f32 v13, v13, v7
  v_lshlrev_b32 v6, 16, v47
  v_and_b32 v7, 0xffff0000, v47
  v_add_f32 v14, v14, v6
  v_add_f32 v15, v15, v7
  s_waitcnt vmcnt(7)
  v_lshlrev_b32 v6, 16, v48
  v_and_b32 v7, 0xffff0000, v48
  v_add_f32 v8, v8, v6
  v_add_f32 v9, v9, v7
  v_lshlrev_b32 v6, 16, v49
  v_and_b32 v7, 0xffff0000, v49
  v_add_f32 v10, v10, v6
  v_add_f32 v11, v11, v7
  v_lshlrev_b32 v6, 16, v50
  v_and_b32 v7, 0xffff0000, v50
  v_add_f32 v12, v12, v6
  v_add_f32 v13, v13, v7
  v_lshlrev_b32 v6, 16, v51
  v_and_b32 v7, 0xffff0000, v51
  v_add_f32 v14, v14, v6
  v_add_f32 v15, v15, v7
  s_waitcnt vmcnt(6)
  v_lshlrev_b32 v6, 16, v52
  v_and_b32 v7, 0xffff0000, v52
  v_add_f32 v8, v8, v6
  v_add_f32 v9, v9, v7
  v_lshlrev_b32 v6, 16, v53
  v_and_b32 v7, 0xffff0000, v53
  v_add_f32 v10, v10, v6
  v_add_f32 v11, v11, v7
  v_lshlrev_b32 v6, 16, v54
  v_and_b32 v7, 0xffff0000, v54
  v_add_f32 v12, v12, v6
  v_add_f32 v13, v13, v7
  v_lshlrev_b32 v6, 16, v55
  v_and_b32 v7, 0xffff0000, v55
  v_add_f32 v14, v14, v6
  v_add_f32 v15, v15, v7
  s_waitcnt vmcnt(5)
  v_lshlrev_b32 v6, 16, v56
  v_and_b32 v7, 0xffff0000, v56
  v_add_f32 v8, v8, v6
  v_add_f32 v9, v9, v7
  v_lshlrev_b32 v6, 16, v57
  v_and_b32 v7, 0xffff0000, v57
  v_add_f32 v10, v10, v6
  v_add_f32 v11, v11, v7
  v_lshlrev_b32 v6, 16, v58
  v_and_b32 v7, 0xffff0000, v58
  v_add_f32 v12, v12, v6
  v_add_f32 v13, v13, v7
  v_lshlrev_b32 v6, 16, v59
  v_and_b32 v7, 0xffff0000, v59
  v_add_f32 v14, v14, v6
  v_add_f32 v15, v15, v7
  s_waitcnt vmcnt(4)
  v_lshlrev_b32 v6, 16, v60
  v_and_b32 v7, 0xffff0000, v60
  v_add_f32 v8, v8, v6
  v_add_f32 v9, v9, v7
  v_lshlrev_b32 v6, 16, v61
  v_and_b32 v7, 0xffff0000, v61
  v_add_f32 v10, v10, v6
  v_add_f32 v11, v11, v7
  v_lshlrev_b32 v6, 16, v62
  v_and_b32 v7, 0xffff0000, v62
  v_add_f32 v12, v12, v6
  v_add_f32 v13, v13, v7
  v_lshlrev_b32 v6, 16, v63
  v_and_b32 v7, 0xffff0000, v63
  v_add_f32 v14, v14, v6
  v_add_f32 v15, v15, v7
  s_waitcnt vmcnt(3)
  v_lshlrev_b32 v6, 16, v64
  v_and_b32 v7, 0xffff0000, v64
  v_add_f32 v8, v8, v6
  v_add_f32 v9, v9, v7
  v_lshlrev_b32 v6, 16, v65
  v_and_b32 v7, 0xffff0000, v65
  v_add_f32 v10, v10, v6
  v_add_f32 v11, v11, v7
  v_lshlrev_b32 v6, 16, v66
  v_and_b32 v7, 0xffff0000, v66
  v_add_f32 v12, v12, v6
  v_add_f32 v13, v13, v7
  v_lshlrev_b32 v6, 16, v67
  v_and_b32 v7, 0xffff0000, v67
  v_add_f32 v14, v14, v6
  v_add_f32 v15, v15, v7
  s_waitcnt vmcnt(2)
  v_lshlrev_b32 v6, 16, v68
  v_and_b32 v7, 0xffff0000, v68
  v_add_f32 v8, v8, v6
  v_add_f32 v9, v9, v7
  v_lshlrev_b32 v6, 16, v69
  v_and_b32 v7, 0xffff0000, v69
  v_add_f32 v10, v10, v6
  v_add_f32 v11, v11, v7
  v_lshlrev_b32 v6, 16, v70
  v_and_b32 v7, 0xffff0000, v70
  v_add_f32 v12, v12, v6
  v_add_f32 v13, v13, v7
  v_lshlrev_b32 v6, 16, v71
  v_and_b32 v7, 0xffff0000, v71
  v_add_f32 v14, v14, v6
  v_add_f32 v15, v15, v7
  s_waitcnt vmcnt(1)
  v_lshlrev_b32 v6, 16, v72
  v_and_b32 v7, 0xffff0000, v72
  v_add_f32 v8, v8, v6
  v_add_f32 v9, v9, v7
  v_lshlrev_b32 v6, 16, v73
  v_and_b32 v7, 0xffff0000, v73
  v_add_f32 v10, v10, v6
  v_add_f32 v11, v11, v7
  v_lshlrev_b32 v6, 16, v74
  v_and_b32 v7, 0xffff0000, v74
  v_add_f32 v12, v12, v6
  v_add_f32 v13, v13, v7
  v_lshlrev_b32 v6, 16, v75
  v_and_b32 v7, 0xffff0000, v75
  v_add_f32 v14, v14, v6
  v_add_f32 v15, v15, v7
  s_waitcnt vmcnt(0)
  v_lshlrev_b32 v6, 16, v76
  v_and_b32 v7, 0xffff0000, v76
  v_add_f32 v8, v8, v6
  v_add_f32 v9, v9, v7
  v_lshlrev_b32 v6, 16, v77
  v_and_b32 v7, 0xffff0000, v77
  v_add_f32 v10, v10, v6
  v_add_f32 v11, v11, v7
  v_lshlrev_b32 v6, 16, v78
  v_and_b32 v7, 0xffff0000, v78
  v_add_f32 v12, v12, v6
  v_add_f32 v13, v13, v7
  v_lshlrev_b32 v6, 16, v79
  v_and_b32 v7, 0xffff0000, v79
  v_add_f32 v14, v14, v6
  v_add_f32 v15, v15, v7
  v_cvt_pk_bf16_f32 v16, v8, v9
  v_cvt_pk_bf16_f32 v17, v10, v11
  v_cvt_pk_bf16_f32 v18, v12, v13
  v_cvt_pk_bf16_f32 v19, v14, v15
  buffer_store_dwordx2 v[16:17], v4, s[12:15], s22 offen
  buffer_store_dwordx2 v[18:19], v4, s[12:15], s22 offen offset:32
L_k3_end:
  s_endpgm
.section .rodata,"a"
.p2align 6
.amdhsa_kernel k1_proj_kernel
  .amdhsa_next_free_vgpr 512
  .amdhsa_next_free_sgpr 102
  .amdhsa_accum_offset 256
  .amdhsa_group_segment_fixed_size 0
  .amdhsa_kernarg_size 112
  .amdhsa_user_sgpr_count 2
  .amdhsa_user_sgpr_kernarg_segment_ptr 1
  .amdhsa_system_sgpr_workgroup_id_x 1
.end_amdhsa_kernel
.p2align 6
.amdhsa_kernel k2_attn_kernel
  .amdhsa_next_free_vgpr 512
  .amdhsa_next_free_sgpr 102
  .amdhsa_accum_offset 256
  .amdhsa_group_segment_fixed_size 0
  .amdhsa_kernarg_size 112
  .amdhsa_user_sgpr_count 2
  .amdhsa_user_sgpr_kernarg_segment_ptr 1
  .amdhsa_system_sgpr_workgroup_id_x 1
.end_amdhsa_kernel
.p2align 6
.amdhsa_kernel k3_reduce_kernel
  .amdhsa_next_free_vgpr 80
  .amdhsa_next_free_sgpr 102
  .amdhsa_accum_offset 80
  .amdhsa_group_segment_fixed_size 0
  .amdhsa_kernarg_size 112
  .amdhsa_user_sgpr_count 2
  .amdhsa_user_sgpr_kernarg_segment_ptr 1
  .amdhsa_system_sgpr_workgroup_id_x 1
.end_amdhsa_kernel
```
